```python
import torch

def _softmax(x, axis=-1):
    return torch.softmax(x, dim=axis)
def _gelu(x):
    return torch.nn.functional.gelu(x, approximate="tanh")
def _silu(x):
    return torch.nn.functional.silu(x)
def _sigmoid(x):
    return torch.sigmoid(x)
def _layernorm(x, axis=-1, eps=1e-5):
    m = x.mean(dim=axis, keepdim=True)
    v = x.var(dim=axis, keepdim=True, unbiased=False)
    return (x - m) / torch.sqrt(v + eps)
def _scatter_add(tgt, idx, src, axis=0):
    return tgt.clone().index_add_(axis, idx, src)
def _segment_sum(src, seg, n):
    out = torch.zeros((n,) + src.shape[1:], dtype=src.dtype)
    return out.index_add_(0, seg, src)
def _pad(x, pw):
    flat = tuple(v for pair in reversed(pw) for v in pair)
    return torch.nn.functional.pad(x, flat)

kernel_name = 'parallel_sum__sliding_block__glu_gated_swiglu__prompt'

def setup_inputs():

    _w = (lambda a: (lambda t: t.to(torch.bfloat16) if t.is_floating_point() else t)(torch.as_tensor(a)))
    def _A_setup():
        B, S, D = 1, 2048, 1024
        return {
            "x": _w((lambda *s: torch.randn(*s, dtype=torch.bfloat16) * 0.05)(B, S, D)),
            "wqkv": _w((lambda *s: torch.randn(*s, dtype=torch.bfloat16) * 0.05)(D, 3 * D)),
            "wo": _w((lambda *s: torch.randn(*s, dtype=torch.bfloat16) * 0.05)(D, D)),
        }
    _A_in = _A_setup()

    def _B_setup():
        B, S, D, F = 1, 2048, 1024, 3584
        return {
            "x": _w((lambda *s: torch.randn(*s, dtype=torch.bfloat16) * 0.05)(B, S, D)),
            "w1": _w((lambda *s: torch.randn(*s, dtype=torch.bfloat16) * 0.8)(D, F) * (2.0 / D) ** 0.5),
            "w3": _w((lambda *s: torch.randn(*s, dtype=torch.bfloat16) * 0.8)(D, F) * (2.0 / D) ** 0.5),
            "w2": _w((lambda *s: torch.randn(*s, dtype=torch.bfloat16) * 0.8)(F, D) * (2.0 / F) ** 0.5),
        }
    _B_in = _B_setup()

    return {
        "A_x": _A_in["x"],
        "A_wqkv": _A_in["wqkv"],
        "A_wo": _A_in["wo"],
        "B_x": _B_in["x"],
        "B_w1": _B_in["w1"],
        "B_w3": _B_in["w3"],
        "B_w2": _B_in["w2"],
    }

def reference(A_x, A_wqkv, A_wo, B_x, B_w1, B_w3, B_w2):
    def _A_ref(x, wqkv, wo):
        B, S, D = x.shape
        H = 32; Dh = D // H; W = 256
        qkv = (lambda x, *d: x.permute(*d))((x @ wqkv).reshape(B, S, 3, H, Dh), 2, 0, 3, 1, 4)
        q, k, v = qkv[0], qkv[1], qkv[2]
        scores = torch.einsum("bhqd,bhkd->bhqk", q, k) * (Dh ** -0.5)
        idx = torch.arange(S)
        mask = (idx[:, None] - idx[None, :] >= 0) & (idx[:, None] - idx[None, :] < W)
        scores = torch.where(mask[None, None], scores, -1e9)
        p = _softmax(scores, axis=-1)
        o = torch.einsum("bhqk,bhkd->bhqd", p, v)
        return (lambda x, *d: x.permute(*d))(o, 0, 2, 1, 3).reshape(B, S, D) @ wo

    def _B_ref(x, w1, w3, w2):
        gate = torch.einsum("bsd,df->bsf", x, w1)
        up = torch.einsum("bsd,df->bsf", x, w3)
        h = _silu(gate) * up
        out = torch.einsum("bsf,fd->bsd", h, w2)
        return out

    x = A_x
    xn = _layernorm(x, axis=-1)
    return x + _A_ref(xn, A_wqkv, A_wo) + _B_ref(xn, B_w1, B_w3, B_w2)
```

```asm
; @launch grid=(256,1,1) block=(256,1,1) lds=163840
.amdgcn_target "amdgcn-amd-amdhsa--gfx950"
.text
.globl parallel_sum__sliding_block__glu_gated_swiglu__prompt_kernel
.p2align 8
.type parallel_sum__sliding_block__glu_gated_swiglu__prompt_kernel,@function
parallel_sum__sliding_block__glu_gated_swiglu__prompt_kernel:
    s_cmp_ge_u32 s2, 256
    s_cbranch_scc1 L_end_parallel_sum__sliding_block__glu_gated_swiglu__prompt_kernel
    s_load_dwordx2 s[16:17], s[0:1], 0
    s_load_dwordx2 s[4:5], s[0:1], 72
    s_load_dwordx2 s[8:9], s[0:1], 8
    s_load_dwordx4 s[60:63], s[0:1], 32
    s_load_dwordx4 s[24:27], s[0:1], 48
    s_load_dwordx2 s[28:29], s[0:1], 16
    s_getpc_b64 s[36:37]
L_pc0_parallel_sum__sliding_block__glu_gated_swiglu__prompt_kernel:
    s_mov_b32 s38, L_end_parallel_sum__sliding_block__glu_gated_swiglu__prompt_kernel-L_pc0_parallel_sum__sliding_block__glu_gated_swiglu__prompt_kernel
    s_mov_b32 s39, 0x20000
    s_lshr_b32 s43, s2, 3
    s_lshl_b32 s3, s43, 11
    v_lshrrev_b32 v2, 4, v0
    v_lshlrev_b32 v2, 7, v2
    buffer_load_dword v16, v2, s[36:39], s3 offen
    s_bfe_u32 s44, s2, 0x20001
    s_xor_b32 s59, s2, s44
    s_and_b32 s59, s59, 1
    s_lshl_b32 s59, s59, 2
    s_lshr_b32 s42, s2, 6
    s_add_u32 s42, s42, s59
    s_and_b32 s45, s43, 7
    s_lshl_b32 s41, s44, 3
    s_add_u32 s41, s41, s45
    v_lshrrev_b32 v1, 6, v0
    v_and_b32 v0, 63, v0
    v_lshlrev_b32 v12, 4, v0
    s_lshl_b32 s67, s42, 5
    s_add_u32 s67, s67, s41
    s_lshl_b32 s59, s67, 14
    v_lshl_add_u32 v20, v1, 12, v12
    v_readfirstlane_b32 s40, v1
    s_mov_b32 s18, 4194304
    s_mov_b32 s19, 0x20000
    s_waitcnt lgkmcnt(0)
    buffer_load_dwordx4 v[24:27], v20, s[16:19], s59 offen offset:0
    buffer_load_dwordx4 v[28:31], v20, s[16:19], s59 offen offset:1024
    buffer_load_dwordx4 v[32:35], v20, s[16:19], s59 offen offset:2048
    buffer_load_dwordx4 v[36:39], v20, s[16:19], s59 offen offset:3072
    s_add_u32 s0, s4, 33656832
    s_addc_u32 s1, s5, 0
    s_load_dwordx2 s[64:65], s[0:1], 0
    s_mov_b32 s6, 50331648
    s_mov_b32 s7, 0x20000
    s_mov_b32 s10, 6291456
    s_mov_b32 s11, 0x20000
    s_cmp_lt_u32 s40, 2
    s_cselect_b32 s12, s60, s62
    s_cselect_b32 s13, s61, s63
    s_mov_b32 s14, 7340032
    s_mov_b32 s15, 0x20000
    s_mov_b32 s32, s26
    s_mov_b32 s33, s27
    s_mov_b32 s34, 4194304
    s_mov_b32 s35, 0x20000
    s_mov_b32 s26, 7340032
    s_mov_b32 s27, 0x20000
    s_mov_b32 s30, 2097152
    s_mov_b32 s31, 0x20000
    s_mul_i32 s59, s44, 1792
    s_mul_i32 s60, s43, 14336
    s_add_u32 s57, s59, s60
    s_lshl_b32 s59, s44, 9
    s_mul_i32 s60, s43, 12288
    s_add_u32 s59, s59, s60
    s_mov_b32 s62, 7168
    s_cmp_eq_u32 s40, 1
    s_cselect_b32 s20, s8, s12
    s_cselect_b32 s21, s9, s13
    s_cselect_b32 s22, s10, s14
    s_cselect_b32 s57, s59, s57
    s_cselect_b32 s62, 6144, s62
    s_cselect_b32 s63, 12, 14
    s_cselect_b32 s61, 1536, 0
    s_lshl_b32 s58, s62, 6
    s_mul_i32 s59, s44, 1835008
    s_mul_i32 s60, s43, 57344
    s_add_u32 s59, s59, s60
    s_lshr_b32 s60, s42, 2
    s_mul_i32 s60, s60, 28672
    s_add_u32 s59, s59, s60
    s_cmp_eq_u32 s40, 3
    s_cselect_b32 s20, s24, s20
    s_cselect_b32 s21, s25, s21
    s_cselect_b32 s22, s26, s22
    s_mov_b32 s23, 0x20000
    s_cselect_b32 s62, 15728640, s62
    s_cselect_b32 s63, 16, s63
    s_cselect_b32 s58, 2048, s58
    s_cselect_b32 s46, 2147483632, s57
    s_cselect_b32 s47, 0, s58
    s_cselect_b32 s57, s59, s57
    s_cselect_b32 s60, 0, 3
    v_lshrrev_b32 v20, 5, v0
    v_mul_u32_u24 v20, s62, v20
    v_and_b32 v1, 31, v0
    v_lshl_add_u32 v20, v1, 7, v20
    v_lshrrev_b32 v21, 2, v1
    v_mul_u32_u24 v21, s61, v21
    v_add_u32 v20, v20, v21
    v_cmp_gt_u32 vcc, s63, v1
    v_mov_b32 v21, 2147483632
    s_mul_i32 s60, s60, s58
    s_add_u32 s57, s57, s60
    v_cndmask_b32 v17, v21, v20, vcc
    s_mov_b32 s74, s46
    s_mov_b32 s76, s47
    buffer_load_dword v16, v17, s[20:23], s74 offen
    s_add_u32 s74, s74, s76
    buffer_load_dword v16, v17, s[20:23], s74 offen
    s_add_u32 s74, s74, s76
    s_lshl_b32 s59, s2, 7
    s_lshl_b32 s60, s40, 15
    s_add_u32 s59, s59, s60
    s_add_u32 s59, s59, 33554432
    s_cmp_eq_u32 s40, 3
    s_cselect_b32 s59, 2147483632, s59
    v_lshlrev_b32 v20, 2, v1
    v_mov_b32 v21, 0
    buffer_store_dword v21, v20, s[4:7], s59 offen sc1
    s_lshl_b32 s59, s40, 1
    v_and_b32 v20, 7, v0
    v_xor_b32 v20, s59, v20
    v_lshlrev_b32 v20, 4, v20
    v_lshl_add_u32 v20, v0, 7, v20
    v_add_u32 v20, 122880, v20
    v_xor_b32 v21, 16, v20
    s_lshl_b32 s59, s40, 10
    s_add_u32 s59, s59, 122880
    v_add_u32 v22, s59, v12
    v_lshrrev_b32 v1, 3, v0
    v_xor_b32 v23, v0, v1
    v_and_b32 v23, 7, v23
    v_and_b32 v1, 3, v1
    v_lshl_add_u32 v23, v1, 4, v23
    v_lshlrev_b32 v23, 4, v23
    v_lshrrev_b32 v1, 5, v0
    v_lshl_add_u32 v23, v1, 17, v23
    s_lshl_b32 s85, s40, 18
    s_lshl_b32 s59, s42, 14
    s_add_u32 s85, s85, s59
    s_lshr_b32 s59, s41, 1
    s_lshl_b32 s59, s59, 10
    s_add_u32 s85, s85, s59
    s_and_b32 s59, s41, 1
    s_lshl_b32 s59, s59, 7
    s_add_u32 s85, s85, s59
    s_lshl_b32 s59, s41, 6
    s_mul_i32 s60, s40, 98304
    s_add_u32 s59, s59, s60
    v_add_u32 v40, 0, v0
    v_mul_u32_u24 v41, 5462, v40
    v_lshrrev_b32 v41, 16, v41
    v_mul_u32_u24 v42, 12, v41
    v_sub_u32 v40, v40, v42
    v_lshrrev_b32 v42, 1, v41
    v_and_b32 v42, 2, v42
    v_xor_b32 v40, v40, v42
    v_lshrrev_b32 v42, 2, v40
    v_lshlrev_b32 v42, 11, v42
    v_and_b32 v40, 3, v40
    v_lshl_add_u32 v40, v40, 4, v42
    v_lshrrev_b32 v42, 1, v41
    v_xor_b32 v42, v42, v41
    v_and_b32 v42, 4, v42
    v_mul_u32_u24 v42, 3, v42
    v_xor_b32 v42, v42, v41
    v_mul_u32_u24 v42, 6144, v42
    v_add3_u32 v40, v40, v42, s59
    v_subrev_u32 v2, 0, v40
    v_add_u32 v40, 64, v0
    v_mul_u32_u24 v41, 5462, v40
    v_lshrrev_b32 v41, 16, v41
    v_mul_u32_u24 v42, 12, v41
    v_sub_u32 v40, v40, v42
    v_lshrrev_b32 v42, 1, v41
    v_and_b32 v42, 2, v42
    v_xor_b32 v40, v40, v42
    v_lshrrev_b32 v42, 2, v40
    v_lshlrev_b32 v42, 11, v42
    v_and_b32 v40, 3, v40
    v_lshl_add_u32 v40, v40, 4, v42
    v_lshrrev_b32 v42, 1, v41
    v_xor_b32 v42, v42, v41
    v_and_b32 v42, 4, v42
    v_mul_u32_u24 v42, 3, v42
    v_xor_b32 v42, v42, v41
    v_mul_u32_u24 v42, 6144, v42
    v_add3_u32 v40, v40, v42, s59
    v_subrev_u32 v3, 1024, v40
    v_add_u32 v40, 128, v0
    v_mul_u32_u24 v41, 5462, v40
    v_lshrrev_b32 v41, 16, v41
    v_mul_u32_u24 v42, 12, v41
    v_sub_u32 v40, v40, v42
    v_lshrrev_b32 v42, 1, v41
    v_and_b32 v42, 2, v42
    v_xor_b32 v40, v40, v42
    v_lshrrev_b32 v42, 2, v40
    v_lshlrev_b32 v42, 11, v42
    v_and_b32_e64 v40, 3, v40
    v_lshl_add_u32 v40, v40, 4, v42
    v_lshrrev_b32 v42, 1, v41
    v_xor_b32 v42, v42, v41
    v_and_b32 v42, 4, v42
    v_mul_u32_u24 v42, 3, v42
    v_xor_b32_e64 v42, v42, v41
    v_mul_u32_u24 v42, 6144, v42
    v_add3_u32 v40, v40, v42, s59
    v_subrev_u32 v4, 2048, v40
    s_mul_i32 s59, s41, 224
    s_and_b32 s60, s40, 1
    s_mul_i32 s60, s60, 229376
    s_add_u32 s59, s59, s60
    s_and_b32 s60, s41, 1
    s_lshl_b32 s60, s60, 1
    v_add_u32_e64 v60, 0, v0
    v_mul_u32_u24 v61, 4682, v60
    v_lshrrev_b32 v61, 16, v61
    v_mul_u32_u24 v62, 14, v61
    v_sub_u32 v60, v60, v62
    v_add_u32 v60, s60, v60
    v_subrev_u32 v62, 14, v60
    v_min_u32 v60, v60, v62
    v_lshlrev_b32 v60, 4, v60
    v_lshrrev_b32 v62, 1, v61
    v_xor_b32 v62, v62, v61
    v_and_b32 v62, 4, v62
    v_mul_u32_u24 v62, 3, v62
    v_xor_b32 v62, v62, v61
    v_mul_u32_u24 v62, 7168, v62
    v_add3_u32 v60, v60, v62, s59
    v_subrev_u32 v5, 0, v60
    v_add_u32 v60, 64, v0
    v_mul_u32_u24 v61, 4682, v60
    v_lshrrev_b32 v61, 16, v61
    v_mul_u32_u24 v62, 14, v61
    v_sub_u32 v60, v60, v62
    v_add_u32 v60, s60, v60
    v_subrev_u32 v62, 14, v60
    v_min_u32 v60, v60, v62
    v_lshlrev_b32 v60, 4, v60
    v_lshrrev_b32 v62, 1, v61
    v_xor_b32 v62, v62, v61
    v_and_b32 v62, 4, v62
    v_mul_u32_u24 v62, 3, v62
    v_xor_b32 v62, v62, v61
    v_mul_u32_u24 v62, 7168, v62
    v_add3_u32 v60, v60, v62, s59
    v_subrev_u32 v6, 1024, v60
    v_add_u32 v60, 128, v0
    v_mul_u32_u24 v61, 4682, v60
    v_lshrrev_b32 v61, 16, v61
    v_mul_u32_u24 v62, 14, v61
    v_sub_u32 v60, v60, v62
    v_add_u32 v60, s60, v60
    v_subrev_u32 v62, 14, v60
    v_min_u32 v60, v60, v62
    v_lshlrev_b32 v60, 4, v60
    v_lshrrev_b32 v62, 1, v61
    v_xor_b32 v62, v62, v61
    v_and_b32 v62, 4, v62
    v_mul_u32_u24 v62, 3, v62
    v_xor_b32 v62, v62, v61
    v_mul_u32_u24 v62, 7168, v62
    v_add3_u32 v60, v60, v62, s59
    v_subrev_u32 v7, 2048, v60
    s_lshl_b32 s66, s40, 12
    s_lshl_b32 s46, s42, 14
    s_add_u32 s46, s46, s66
    s_mov_b32 s47, 0
    s_mov_b32 s48, 0
    s_mov_b32 s51, 0
    s_mov_b32 s54, 0
    s_mov_b32 s55, 4294885376
    s_mov_b32 s56, 40960
    s_mul_i32 s49, s40, 3072
    s_mul_i32 s50, s40, 7168
    s_add_u32 s50, s50, 12288
    v_lshrrev_b32 v40, 2, v0
    v_and_b32 v41, 7, v40
    v_and_b32 v40, 8, v40
    v_lshl_add_u32 v40, v40, 1, v41
    v_and_b32 v41, 3, v0
    v_lshlrev_b32 v41, 3, v41
    v_mul_u32_u24 v42, 224, v40
    v_add_u32 v15, v42, v41
    v_mul_u32_u24 v42, 192, v40
    v_add_u32 v42, v42, v41
    v_and_b32 v41, 16, v0
    v_lshlrev_b32 v41, 1, v41
    v_add_u32 v13, v42, v41
    v_xor_b32 v41, 32, v41
    v_add_u32 v14, v42, v41
    s_waitcnt vmcnt(3)
    v_lshlrev_b32 v40, 16, v24
    v_and_b32 v41, 0xffff0000, v24
    v_lshlrev_b32 v42, 16, v25
    v_and_b32 v43, 0xffff0000, v25
    v_lshlrev_b32 v44, 16, v26
    v_and_b32 v45, 0xffff0000, v26
    v_lshlrev_b32 v46, 16, v27
    v_and_b32 v47, 0xffff0000, v27
    v_lshlrev_b32_e64 v48, 16, v28
    v_and_b32 v49, 0xffff0000, v28
    v_lshlrev_b32 v50, 16, v29
    v_and_b32 v51, 0xffff0000, v29
    v_lshlrev_b32 v52, 16, v30
    v_and_b32 v53, 0xffff0000, v30
    v_lshlrev_b32 v54, 16, v31
    v_and_b32 v55, 0xffff0000, v31
    v_lshlrev_b32 v56, 16, v32
    v_and_b32 v57, 0xffff0000, v32
    v_lshlrev_b32_e64 v58, 16, v33
    v_and_b32 v59, 0xffff0000, v33
    v_lshlrev_b32 v60, 16, v34
    v_and_b32 v61, 0xffff0000, v34
    v_lshlrev_b32 v62, 16, v35
    v_and_b32 v63, 0xffff0000, v35
    v_lshlrev_b32 v64, 16, v36
    v_and_b32 v65, 0xffff0000, v36
    v_lshlrev_b32 v66, 16, v37
    v_and_b32 v67, 0xffff0000, v37
    v_lshlrev_b32_e64 v68, 16, v38
    v_and_b32 v69, 0xffff0000, v38
    v_lshlrev_b32_e64 v70, 16, v39
    v_and_b32 v71, 0xffff0000, v39
    v_pk_add_f32 v[72:73], v[40:41], v[42:43]
    v_pk_add_f32 v[74:75], v[44:45], v[46:47]
    v_pk_add_f32 v[76:77], v[48:49], v[50:51]
    v_pk_add_f32 v[78:79], v[52:53], v[54:55]
    v_pk_add_f32 v[72:73], v[72:73], v[74:75]
    v_pk_add_f32 v[76:77], v[76:77], v[78:79]
    v_pk_add_f32 v[72:73], v[72:73], v[76:77]
    v_add_f32_e64 v72, v72, v73
    v_pk_add_f32 v[80:81], v[56:57], v[58:59]
    v_pk_add_f32 v[82:83], v[60:61], v[62:63]
    v_pk_add_f32 v[84:85], v[64:65], v[66:67]
    v_pk_add_f32 v[86:87], v[68:69], v[70:71]
    v_pk_add_f32 v[80:81], v[80:81], v[82:83]
    v_pk_add_f32 v[84:85], v[84:85], v[86:87]
    v_pk_add_f32 v[80:81], v[80:81], v[84:85]
    v_add_f32 v80, v80, v81
    s_nop 1
    v_permlane32_swap_b32 v72, v80
    v_add_f32 v72, v72, v80
    s_nop 1
    v_add_f32_dpp v72, v72, v72 row_ror:8 row_mask:0xf bank_mask:0xf
    s_nop 1
    v_add_f32_dpp v72, v72, v72 row_ror:4 row_mask:0xf bank_mask:0xf
    s_nop 1
    v_add_f32_dpp v72, v72, v72 row_ror:2 row_mask:0xf bank_mask:0xf
    s_nop 1
    v_add_f32_dpp v72, v72, v72 row_ror:1 row_mask:0xf bank_mask:0xf
    v_mov_b32 v80, v72
    s_nop 1
    v_permlane16_swap_b32 v80, v72
    v_add_f32 v72, v72, v80
    v_mul_f32 v88, 0xba800000, v72
    v_mov_b32 v92, v88
    v_mov_b32 v90, v88
    s_nop 1
    v_permlane32_swap_b32 v88, v90
    v_pk_add_f32 v[96:97], v[40:41], v[88:89] op_sel_hi:[1,0]
    v_pk_add_f32 v[98:99], v[42:43], v[88:89] op_sel_hi:[1,0]
    v_pk_add_f32 v[100:101], v[44:45], v[88:89] op_sel_hi:[1,0]
    v_pk_add_f32 v[102:103], v[46:47], v[88:89] op_sel_hi:[1,0]
    v_pk_add_f32 v[104:105], v[48:49], v[88:89] op_sel_hi:[1,0]
    v_pk_add_f32 v[106:107], v[50:51], v[88:89] op_sel_hi:[1,0]
    v_pk_add_f32 v[108:109], v[52:53], v[88:89] op_sel_hi:[1,0]
    v_pk_add_f32 v[110:111], v[54:55], v[88:89] op_sel_hi:[1,0]
    v_pk_add_f32 v[112:113], v[56:57], v[90:91] op_sel_hi:[1,0]
    v_pk_add_f32 v[114:115], v[58:59], v[90:91] op_sel_hi:[1,0]
    v_pk_add_f32 v[116:117], v[60:61], v[90:91] op_sel_hi:[1,0]
    v_pk_add_f32 v[118:119], v[62:63], v[90:91] op_sel_hi:[1,0]
    v_pk_add_f32 v[120:121], v[64:65], v[90:91] op_sel_hi:[1,0]
    v_pk_add_f32 v[122:123], v[66:67], v[90:91] op_sel_hi:[1,0]
    v_pk_add_f32 v[124:125], v[68:69], v[90:91] op_sel_hi:[1,0]
    v_pk_add_f32 v[126:127], v[70:71], v[90:91] op_sel_hi:[1,0]
    v_pk_mul_f32 v[128:129], v[96:97], v[96:97]
    v_pk_mul_f32 v[132:133], v[100:101], v[100:101]
    v_pk_mul_f32 v[136:137], v[104:105], v[104:105]
    v_pk_mul_f32 v[140:141], v[108:109], v[108:109]
    v_pk_fma_f32 v[72:73], v[98:99], v[98:99], v[128:129]
    v_pk_fma_f32 v[74:75], v[102:103], v[102:103], v[132:133]
    v_pk_fma_f32 v[76:77], v[106:107], v[106:107], v[136:137]
    v_pk_fma_f32 v[78:79], v[110:111], v[110:111], v[140:141]
    v_pk_add_f32 v[72:73], v[72:73], v[74:75]
    v_pk_add_f32 v[76:77], v[76:77], v[78:79]
    v_pk_add_f32 v[72:73], v[72:73], v[76:77]
    v_add_f32_e64 v72, v72, v73
    v_pk_mul_f32 v[144:145], v[112:113], v[112:113]
    v_pk_mul_f32 v[148:149], v[116:117], v[116:117]
    v_pk_mul_f32 v[152:153], v[120:121], v[120:121]
    v_pk_mul_f32 v[156:157], v[124:125], v[124:125]
    v_pk_fma_f32 v[80:81], v[114:115], v[114:115], v[144:145]
    v_pk_fma_f32 v[82:83], v[118:119], v[118:119], v[148:149]
    v_pk_fma_f32 v[84:85], v[122:123], v[122:123], v[152:153]
    v_pk_fma_f32 v[86:87], v[126:127], v[126:127], v[156:157]
    v_pk_add_f32 v[80:81], v[80:81], v[82:83]
    v_pk_add_f32 v[84:85], v[84:85], v[86:87]
    v_pk_add_f32 v[80:81], v[80:81], v[84:85]
    v_add_f32 v80, v80, v81
    s_nop 1
    v_permlane32_swap_b32 v72, v80
    v_add_f32 v72, v72, v80
    s_nop 1
    v_add_f32_dpp v72, v72, v72 row_ror:8 row_mask:0xf bank_mask:0xf
    s_nop 1
    v_add_f32_dpp v72, v72, v72 row_ror:4 row_mask:0xf bank_mask:0xf
    s_nop 1
    v_add_f32_dpp v72, v72, v72 row_ror:2 row_mask:0xf bank_mask:0xf
    s_nop 1
    v_add_f32_dpp v72, v72, v72 row_ror:1 row_mask:0xf bank_mask:0xf
    v_mov_b32 v80, v72
    s_nop 1
    v_permlane16_swap_b32 v80, v72
    v_add_f32 v72, v72, v80
    v_mul_f32 v72, 0x3a800000, v72
    v_cvt_pk_bf16_f32 v72, v72, v72
    v_and_b32 v72, 0xffff0000, v72
    v_add_f32 v72, 0x3727c5ac, v72
    v_cvt_pk_bf16_f32 v72, v72, v72
    v_and_b32 v72, 0xffff0000, v72
    v_sqrt_f32_e64 v72, v72
    v_cvt_pk_bf16_f32 v92, v92, v92
    v_and_b32 v92, 0xffff0000, v92
    v_mov_b32 v88, v92
    v_mov_b32 v90, v88
    s_nop 1
    v_permlane32_swap_b32 v88, v90
    v_cvt_pk_bf16_f32 v72, v72, v72
    v_and_b32 v72, 0xffff0000, v72
    v_rcp_f32 v72, v72
    s_nop 0
    v_mul_f32 v72, 1040187392, v72
    v_mov_b32 v80, v72
    s_nop 1
    v_permlane32_swap_b32 v72, v80
    s_nop 0
    v_pk_add_f32 v[40:41], v[40:41], v[88:89] op_sel_hi:[1,0]
    v_pk_add_f32 v[42:43], v[42:43], v[88:89] op_sel_hi:[1,0]
    v_pk_add_f32 v[44:45], v[44:45], v[88:89] op_sel_hi:[1,0]
    v_pk_add_f32 v[46:47], v[46:47], v[88:89] op_sel_hi:[1,0]
    v_pk_add_f32 v[48:49], v[48:49], v[88:89] op_sel_hi:[1,0]
    v_pk_add_f32 v[50:51], v[50:51], v[88:89] op_sel_hi:[1,0]
    v_pk_add_f32 v[52:53], v[52:53], v[88:89] op_sel_hi:[1,0]
    v_pk_add_f32 v[54:55], v[54:55], v[88:89] op_sel_hi:[1,0]
    v_cvt_pk_bf16_f32 v24, v40, v41
    v_cvt_pk_bf16_f32 v25, v42, v43
    v_cvt_pk_bf16_f32 v26, v44, v45
    v_cvt_pk_bf16_f32 v27, v46, v47
    v_cvt_pk_bf16_f32 v28, v48, v49
    v_cvt_pk_bf16_f32 v29, v50, v51
    v_cvt_pk_bf16_f32 v30, v52, v53
    v_cvt_pk_bf16_f32 v31, v54, v55
    v_lshlrev_b32 v40, 16, v24
    v_and_b32 v41, 0xffff0000, v24
    v_lshlrev_b32 v42, 16, v25
    v_and_b32 v43, 0xffff0000, v25
    v_lshlrev_b32 v44, 16, v26
    v_and_b32 v45, 0xffff0000, v26
    v_lshlrev_b32 v46, 16, v27
    v_and_b32 v47, 0xffff0000, v27
    v_lshlrev_b32_e64 v48, 16, v28
    v_and_b32 v49, 0xffff0000, v28
    v_lshlrev_b32 v50, 16, v29
    v_and_b32 v51, 0xffff0000, v29
    v_lshlrev_b32 v52, 16, v30
    v_and_b32 v53, 0xffff0000, v30
    v_lshlrev_b32_e64 v54, 16, v31
    v_and_b32 v55, 0xffff0000, v31
    v_pk_mul_f32 v[40:41], v[40:41], v[72:73] op_sel_hi:[1,0]
    v_pk_mul_f32 v[42:43], v[42:43], v[72:73] op_sel_hi:[1,0]
    v_pk_mul_f32 v[44:45], v[44:45], v[72:73] op_sel_hi:[1,0]
    v_pk_mul_f32 v[46:47], v[46:47], v[72:73] op_sel_hi:[1,0]
    v_pk_mul_f32 v[48:49], v[48:49], v[72:73] op_sel_hi:[1,0]
    v_pk_mul_f32 v[50:51], v[50:51], v[72:73] op_sel_hi:[1,0]
    v_pk_mul_f32 v[52:53], v[52:53], v[72:73] op_sel_hi:[1,0]
    v_pk_mul_f32 v[54:55], v[54:55], v[72:73] op_sel_hi:[1,0]
    v_cvt_pk_bf16_f32 v24, v40, v41
    v_cvt_pk_bf16_f32 v25, v42, v43
    v_cvt_pk_bf16_f32 v26, v44, v45
    v_cvt_pk_bf16_f32 v27, v46, v47
    v_cvt_pk_bf16_f32 v28, v48, v49
    v_cvt_pk_bf16_f32 v29, v50, v51
    v_cvt_pk_bf16_f32 v30, v52, v53
    v_cvt_pk_bf16_f32 v31, v54, v55
    ds_write_b128 v20, v[24:27]
    ds_write_b128 v20, v[28:31] offset:8192
    v_pk_add_f32 v[56:57], v[56:57], v[90:91] op_sel_hi:[1,0]
    v_pk_add_f32 v[58:59], v[58:59], v[90:91] op_sel_hi:[1,0]
    v_pk_add_f32 v[60:61], v[60:61], v[90:91] op_sel_hi:[1,0]
    v_pk_add_f32 v[62:63], v[62:63], v[90:91] op_sel_hi:[1,0]
    v_pk_add_f32 v[64:65], v[64:65], v[90:91] op_sel_hi:[1,0]
    v_pk_add_f32 v[66:67], v[66:67], v[90:91] op_sel_hi:[1,0]
    v_pk_add_f32 v[68:69], v[68:69], v[90:91] op_sel_hi:[1,0]
    v_pk_add_f32 v[70:71], v[70:71], v[90:91] op_sel_hi:[1,0]
    v_cvt_pk_bf16_f32 v32, v56, v57
    v_cvt_pk_bf16_f32 v33, v58, v59
    v_cvt_pk_bf16_f32 v34, v60, v61
    v_cvt_pk_bf16_f32 v35, v62, v63
    v_cvt_pk_bf16_f32 v36, v64, v65
    v_cvt_pk_bf16_f32 v37, v66, v67
    v_cvt_pk_bf16_f32 v38, v68, v69
    v_cvt_pk_bf16_f32 v39, v70, v71
    v_lshlrev_b32 v56, 16, v32
    v_and_b32 v57, 0xffff0000, v32
    v_lshlrev_b32 v58, 16, v33
    v_and_b32 v59, 0xffff0000, v33
    v_lshlrev_b32_e64 v60, 16, v34
    v_and_b32 v61, 0xffff0000, v34
    v_lshlrev_b32 v62, 16, v35
    v_and_b32 v63, 0xffff0000, v35
    v_lshlrev_b32 v64, 16, v36
    v_and_b32 v65, 0xffff0000, v36
    v_lshlrev_b32 v66, 16, v37
    v_and_b32 v67, 0xffff0000, v37
    v_lshlrev_b32 v68, 16, v38
    v_and_b32 v69, 0xffff0000, v38
    v_lshlrev_b32_e64 v70, 16, v39
    v_and_b32 v71, 0xffff0000, v39
    v_pk_mul_f32 v[56:57], v[56:57], v[80:81] op_sel_hi:[1,0]
    v_pk_mul_f32 v[58:59], v[58:59], v[80:81] op_sel_hi:[1,0]
    v_pk_mul_f32 v[60:61], v[60:61], v[80:81] op_sel_hi:[1,0]
    v_pk_mul_f32 v[62:63], v[62:63], v[80:81] op_sel_hi:[1,0]
    v_pk_mul_f32 v[64:65], v[64:65], v[80:81] op_sel_hi:[1,0]
    v_pk_mul_f32 v[66:67], v[66:67], v[80:81] op_sel_hi:[1,0]
    v_pk_mul_f32 v[68:69], v[68:69], v[80:81] op_sel_hi:[1,0]
    v_pk_mul_f32 v[70:71], v[70:71], v[80:81] op_sel_hi:[1,0]
    v_cvt_pk_bf16_f32 v32, v56, v57
    v_cvt_pk_bf16_f32 v33, v58, v59
    v_cvt_pk_bf16_f32 v34, v60, v61
    v_cvt_pk_bf16_f32 v35, v62, v63
    v_cvt_pk_bf16_f32 v36, v64, v65
    v_cvt_pk_bf16_f32 v37, v66, v67
    v_cvt_pk_bf16_f32 v38, v68, v69
    v_cvt_pk_bf16_f32 v39, v70, v71
    ds_write_b128 v21, v[32:35]
    ds_write_b128 v21, v[36:39] offset:8192
    s_waitcnt lgkmcnt(0)
    s_barrier
    ds_read_b128 v[40:43], v22 offset:0
    ds_read_b128 v[44:47], v22 offset:4096
    ds_read_b128 v[48:51], v22 offset:8192
    ds_read_b128 v[52:55], v22 offset:12288
    s_mov_b32 s1, 0
    s_mul_i32 s64, s64, 0x9e3779b1
    s_add_u32 s64, s64, 0x7f4a7c15
    s_mul_i32 s65, s65, 0x85ebca6b
    s_add_u32 s65, s65, 0xc2b2ae35
    s_waitcnt lgkmcnt(3)
    buffer_store_dwordx4 v[40:43], v23, s[4:7], s85 offen sc1
    s_add_u32 s85, s85, 1048576
    s_waitcnt lgkmcnt(2)
    buffer_store_dwordx4 v[44:47], v23, s[4:7], s85 offen sc1
    s_add_u32 s85, s85, 1048576
    s_waitcnt lgkmcnt(1)
    buffer_store_dwordx4 v[48:51], v23, s[4:7], s85 offen sc1
    s_add_u32 s85, s85, 1048576
    s_waitcnt lgkmcnt(0)
    buffer_store_dwordx4 v[52:55], v23, s[4:7], s85 offen sc1
    s_add_u32 s85, s85, 1048576
    s_mul_i32 s59, s41, 224
    s_and_b32 s60, s40, 1
    s_mul_i32 s60, s60, 229376
    s_add_u32 s59, s59, s60
    s_and_b32 s60, s41, 1
    s_lshl_b32 s60, s60, 1
    v_add_u32 v60, 192, v0
    v_mul_u32_u24 v61, 4682, v60
    v_lshrrev_b32 v61, 16, v61
    v_mul_u32_u24 v62, 14, v61
    v_sub_u32 v60, v60, v62
    v_add_u32 v60, s60, v60
    v_subrev_u32 v62, 14, v60
    v_min_u32 v60, v60, v62
    v_lshlrev_b32 v60, 4, v60
    v_lshrrev_b32 v62, 1, v61
    v_xor_b32 v62, v62, v61
    v_and_b32 v62, 4, v62
    v_mul_u32_u24 v62, 3, v62
    v_xor_b32_e64 v62, v62, v61
    v_mul_u32_u24 v62, 7168, v62
    v_add3_u32 v60, v60, v62, s59
    v_subrev_u32 v8, 3072, v60
    v_add_u32 v60, 256, v0
    v_mul_u32_u24 v61, 4682, v60
    v_lshrrev_b32 v61, 16, v61
    v_mul_u32_u24 v62, 14, v61
    v_sub_u32 v60, v60, v62
    v_add_u32 v60, s60, v60
    v_subrev_u32 v62, 14, v60
    v_min_u32 v60, v60, v62
    v_lshlrev_b32 v60, 4, v60
    v_lshrrev_b32 v62, 1, v61
    v_xor_b32 v62, v62, v61
    v_and_b32 v62, 4, v62
    v_mul_u32_u24 v62, 3, v62
    v_xor_b32 v62, v62, v61
    v_mul_u32_u24 v62, 7168, v62
    v_add3_u32 v60, v60, v62, s59
    v_subrev_u32 v9, 0, v60
    v_add_u32 v60, 320, v0
    v_mul_u32_u24 v61, 4682, v60
    v_lshrrev_b32 v61, 16, v61
    v_mul_u32_u24 v62, 14, v61
    v_sub_u32 v60, v60, v62
    v_add_u32 v60, s60, v60
    v_subrev_u32 v62, 14, v60
    v_min_u32 v60, v60, v62
    v_lshlrev_b32 v60, 4, v60
    v_lshrrev_b32 v62, 1, v61
    v_xor_b32 v62, v62, v61
    v_and_b32 v62, 4, v62
    v_mul_u32_u24 v62, 3, v62
    v_xor_b32_e64 v62, v62, v61
    v_mul_u32_u24 v62, 7168, v62
    v_add3_u32 v60, v60, v62, s59
    v_subrev_u32 v10, 1024, v60
    v_add_u32 v60, 384, v0
    v_mul_u32_u24 v61, 4682, v60
    v_lshrrev_b32 v61, 16, v61
    v_mul_u32_u24 v62, 14, v61
    v_sub_u32 v60, v60, v62
    v_add_u32 v60, s60, v60
    v_subrev_u32 v62, 14, v60
    v_min_u32 v60, v60, v62
    v_lshlrev_b32 v60, 4, v60
    v_lshrrev_b32 v62, 1, v61
    v_xor_b32 v62, v62, v61
    v_and_b32 v62, 4, v62
    v_mul_u32_u24 v62, 3, v62
    v_xor_b32 v62, v62, v61
    v_mul_u32_u24 v62, 7168, v62
    v_add3_u32 v60, v60, v62, s59
    v_subrev_u32 v11, 2048, v60
    s_lshl_b32 s59, s42, 2
    s_add_u32 s78, s59, s44
    s_lshl_b32 s60, s78, 7
    s_lshl_b32 s61, s45, 3
    s_add_u32 s60, s60, s61
    s_add_u32 s60, s60, 33652736
    s_cmp_eq_u32 s40, 0
    s_cselect_b32 s52, s60, 2147483632
    s_add_u32 s59, s59, s40
    s_lshl_b32 s59, s59, 7
    s_add_u32 s53, s59, 33652736
    v_mov_b32 v24, s64
    v_mov_b32 v25, s65
    v_mov_b32 v22, 0
    v_and_b32 v23, 7, v0
    v_lshlrev_b32 v23, 3, v23
    s_lshl_b32 s69, s67, 7
    s_lshl_b32 s59, s40, 2
    s_add_u32 s69, s69, s59
    s_add_u32 s69, s69, 33554432
    s_lshl_b32 s67, s67, 15
    s_lshl_b32 s59, s40, 13
    s_add_u32 s67, s67, s59
    s_add_u32 s67, s67, 25165824
    s_add_u32 s68, s67, 4096
    s_add_u32 s63, s46, 4194304
    s_lshr_b32 s70, s41, 1
    s_mul_i32 s70, s70, 7
    s_add_u32 s70, s70, 32
    s_and_b32 s59, s41, 1
    s_add_u32 s71, s70, 3
    s_lshl_b32 s71, s71, 17
    s_add_u32 s71, s71, s63
    s_lshl_b32 s60, s59, 9
    s_add_u32 s71, s71, s60
    s_lshl_b32 s60, s59, 2
    s_add_u32 s70, s70, s60
    s_lshl_b32 s70, s70, 17
    s_add_u32 s70, s70, s63
    s_lshl_b32 s72, s41, 17
    s_add_u32 s72, s72, s63
    s_mul_i32 s73, s44, 3670016
    s_add_u32 s73, s73, 4194304
    s_add_u32 s73, s73, s63
    s_mul_i32 s75, s44, 1835008
    s_lshl_b32 s78, s78, 2
    s_add_u32 s78, s78, s40
    s_lshl_b32 s78, s78, 7
    s_add_u32 s78, s78, 33619968
    s_lshl_b32 s59, s45, 2
    s_add_u32 s77, s78, s59
    s_lshl_b32 s79, s40, 10
    s_add_u32 s79, s79, 33652736
    s_or_b32 s59, s2, s40
    s_mov_b32 s80, 2147483632
    s_cmp_eq_u32 s59, 0
    s_cselect_b32 s80, 33656832, s80
    s_and_b32 s59, s40, 1
    s_mul_i32 s59, s59, 4294942720
    s_cmp_lt_u32 s40, 2
    s_cselect_b32 s81, s59, 0
    s_cselect_b32 s82, 8192, 0
    s_cselect_b32 s83, 0, s59
    s_cselect_b32 s84, 0, 8192
    s_lshl_b32 s61, s40, 4
    s_add_u32 s61, s61, 33587200
    s_add_u32 s62, s66, 37748736
    s_add_u32 s59, s44, 1
    s_and_b32 s59, s59, 3
    s_lshr_b32 s60, s42, 2
    s_xor_b32 s60, s60, s59
    s_and_b32 s60, s60, 1
    s_lshl_b32 s59, s59, 1
    s_or_b32 s59, s59, s60
    s_and_b32 s60, s2, 0xfffffff8
    s_or_b32 s59, s59, s60
    s_mul_i32 s86, s59, 49152
    s_add_u32 s86, s86, 0
    s_add_u32 s86, s86, s62
    s_lshl_b32 s89, s59, 7
    s_add_u32 s89, s89, 0
    s_add_u32 s89, s89, s61
    s_add_u32 s59, s44, 2
    s_and_b32 s59, s59, 3
    s_lshr_b32 s60, s42, 2
    s_xor_b32 s60, s60, s59
    s_and_b32 s60, s60, 1
    s_lshl_b32 s59, s59, 1
    s_or_b32 s59, s59, s60
    s_and_b32 s60, s2, 0xfffffff8
    s_or_b32 s59, s59, s60
    s_mul_i32 s87, s59, 49152
    s_add_u32 s87, s87, 16384
    s_add_u32 s87, s87, s62
    s_lshl_b32 s90, s59, 7
    s_add_u32 s90, s90, 4
    s_add_u32 s90, s90, s61
    s_add_u32 s59, s44, 3
    s_and_b32 s59, s59, 3
    s_lshr_b32 s60, s42, 2
    s_xor_b32 s60, s60, s59
    s_and_b32 s60, s60, 1
    s_lshl_b32 s59, s59, 1
    s_or_b32 s59, s59, s60
    s_and_b32 s60, s2, 0xfffffff8
    s_or_b32 s59, s59, s60
    s_mul_i32 s88, s59, 49152
    s_add_u32 s88, s88, 32768
    s_add_u32 s88, s88, s62
    s_lshl_b32 s91, s59, 7
    s_add_u32 s91, s91, 8
    s_add_u32 s91, s91, s61
    s_lshl_b32 s97, s2, 7
    s_add_u32 s97, s97, s61
    s_mul_i32 s98, s2, 49152
    s_add_u32 s98, s98, s62
    s_add_u32 s99, s98, 16384
    s_add_u32 s100, s98, 32768
    s_lshl_b32 s101, s44, 19
    s_lshl_b32 s59, s43, 14
    s_add_u32 s101, s101, s59
    s_add_u32 s101, s101, s66
    s_lshl_b32 s3, s43, 2
    s_add_u32 s3, s3, s40
    s_mul_i32 s3, s3, 512
    s_add_u32 s3, s3, L_tail_parallel_sum__sliding_block__glu_gated_swiglu__prompt_kernel-L_pc0_parallel_sum__sliding_block__glu_gated_swiglu__prompt_kernel
    s_waitcnt vmcnt(0)
    s_barrier
    s_mov_b64 exec, 1
    buffer_store_dwordx2 v[24:25], v22, s[4:7], s52 offen sc1
    s_mov_b64 exec, -1
    s_add_u32 m0, s49, s51
    s_nop 0
    buffer_load_dwordx4 v2, s[8:11], s47 offen offset:0 lds
    buffer_load_dwordx4 v3, s[8:11], s47 offen offset:1024 lds
    buffer_load_dwordx4 v4, s[8:11], s47 offen offset:2048 lds
    s_add_u32 s47, s47, 393216
    s_add_u32 m0, s50, s51
    s_nop 0
    buffer_load_dwordx4 v5, s[12:15], s48 offen offset:0 lds
    buffer_load_dwordx4 v6, s[12:15], s48 offen offset:1024 lds
    buffer_load_dwordx4 v7, s[12:15], s48 offen offset:2048 lds
    buffer_load_dwordx4 v8, s[12:15], s48 offen offset:3072 lds
    s_add_u32 m0, m0, 4096
    s_nop 0
    buffer_load_dwordx4 v9, s[12:15], s48 offen offset:0 lds
    buffer_load_dwordx4 v10, s[12:15], s48 offen offset:1024 lds
    buffer_load_dwordx4 v11, s[12:15], s48 offen offset:2048 lds
    s_add_u32 s48, s48, 458752
    s_add_u32 s51, s51, 40960
    s_cmp_eq_u32 s51, 122880
    s_cselect_b32 s51, 0, s51
    buffer_load_dwordx2 v[26:27], v23, s[4:7], s53 offen sc1
    s_lshl_b32 s59, s45, 8
    s_lshl_b32 s60, s40, 15
    s_add_u32 s59, s59, s60
    v_lshrrev_b32 v240, 4, v0
    v_and_b32 v241, 15, v0
    v_add_u32 v242, 0, v240
    v_lshlrev_b32 v242, 1, v242
    v_xor_b32 v242, v242, v241
    v_lshlrev_b32 v242, 4, v242
    v_lshl_add_u32 v242, v240, 11, v242
    v_add_u32 v242, s59, v242
    v_add_u32 v243, 0, v242
    v_add_u32 v242, 14336, v242
    v_accvgpr_write_b32 a180, v243
    v_accvgpr_write_b32 a181, v242
    v_add_u32 v242, 4, v240
    v_lshlrev_b32 v242, 1, v242
    v_xor_b32 v242, v242, v241
    v_lshlrev_b32 v242, 4, v242
    v_lshl_add_u32 v242, v240, 11, v242
    v_add_u32_e64 v242, s59, v242
    v_add_u32 v243, 7168, v242
    v_add_u32 v242, 21504, v242
    v_accvgpr_write_b32 a182, v243
    v_accvgpr_write_b32 a183, v242
    s_add_u32 s59, s44, 0
    s_and_b32 s59, s59, 3
    s_lshl_b32 s59, s59, 10
    v_add_u32 v242, s59, v12
    v_accvgpr_write_b32 a184, v242
    s_add_u32 s59, s44, 1
    s_and_b32 s59, s59, 3
    s_lshl_b32 s59, s59, 10
    v_add_u32 v242, s59, v12
    v_accvgpr_write_b32 a185, v242
    s_add_u32 s59, s44, 2
    s_and_b32 s59, s59, 3
    s_lshl_b32 s59, s59, 10
    v_add_u32 v242, s59, v12
    v_accvgpr_write_b32 a186, v242
    s_add_u32 s59, s44, 3
    s_and_b32 s59, s59, 3
    s_lshl_b32 s59, s59, 10
    v_add_u32 v242, s59, v12
    v_accvgpr_write_b32 a187, v242
    v_add_u32_e64 v242, s66, v12
    v_add_u32 v243, 98304, v242
    v_add_u32 v242, 131072, v242
    v_accvgpr_write_b32 a188, v243
    v_accvgpr_write_b32 a189, v242
    s_lshl_b32 s59, s40, 5
    s_add_u32 s59, s59, 40960
    v_mov_b32 v242, s59
    v_accvgpr_write_b32 a190, v242
    s_cmp_eq_u32 s42, 0
    s_cselect_b32 s59, 32, 0
    v_mov_b32 v242, 1040203264
    v_cmp_le_u32 vcc, s59, v0
    v_lshlrev_b32 v243, 2, v0
    v_add_u32 v243, 40960, v243
    v_cndmask_b32 v242, 0, v242, vcc
    v_accvgpr_write_b32 a191, v242
    v_accvgpr_write_b32 a192, v243
    v_lshlrev_b32 v242, 2, v240
    v_mov_b32 v244, 4048155338
    v_add_u32 v243, 0, v242
    v_cmp_gt_u32 vcc, v243, v241
    s_nop 1
    v_cndmask_b32 v245, v244, 0, vcc
    v_cndmask_b32 v246, 0, v244, vcc
    v_accvgpr_write_b32 a193, v245
    v_accvgpr_write_b32 a194, v246
    v_add_u32 v243, 1, v242
    v_cmp_gt_u32 vcc, v243, v241
    s_nop 1
    v_cndmask_b32 v245, v244, 0, vcc
    v_cndmask_b32 v246, 0, v244, vcc
    v_accvgpr_write_b32 a195, v245
    v_accvgpr_write_b32 a196, v246
    v_add_u32 v243, 2, v242
    v_cmp_gt_u32 vcc, v243, v241
    s_nop 1
    v_cndmask_b32 v245, v244, 0, vcc
    v_cndmask_b32 v246, 0, v244, vcc
    v_accvgpr_write_b32 a197, v245
    v_accvgpr_write_b32 a198, v246
    v_add_u32 v243, 3, v242
    v_cmp_gt_u32 vcc, v243, v241
    s_nop 1
    v_cndmask_b32 v245, v244, 0, vcc
    v_cndmask_b32 v246, 0, v244, vcc
    v_accvgpr_write_b32 a199, v245
    v_accvgpr_write_b32 a200, v246
    v_lshrrev_b32 v242, 2, v0
    v_and_b32 v243, 7, v242
    v_lshlrev_b32 v243, 5, v243
    v_lshl_add_u32 v243, v242, 8, v243
    v_and_b32 v242, 3, v0
    v_lshl_add_u32 v243, v242, 3, v243
    v_accvgpr_write_b32 a201, v243
    v_and_b32 v242, 1, v240
    v_lshlrev_b32 v243, 5, v242
    v_lshrrev_b32_e64 v244, 1, v240
    v_lshl_add_u32 v243, v244, 4, v243
    v_lshl_add_u32 v243, v241, 11, v243
    s_lshl_b32 s59, s42, 19
    s_lshl_b32 s60, s40, 17
    s_add_u32 s59, s59, s60
    s_lshl_b32 s60, s44, 15
    s_add_u32 s59, s59, s60
    s_lshl_b32 s60, s45, 8
    s_add_u32 s59, s59, s60
    v_add_u32 v243, s59, v243
    v_accvgpr_write_b32 a202, v243
    s_waitcnt vmcnt(0)
    v_cmp_ne_u64 vcc, v[26:27], v[24:25]
    s_cmp_eq_u64 vcc, 0
    s_cbranch_scc1 L_lnok_parallel_sum__sliding_block__glu_gated_swiglu__prompt_kernel
L_lnp_parallel_sum__sliding_block__glu_gated_swiglu__prompt_kernel:
    s_add_u32 s1, s1, 1
    s_cmp_gt_u32 s1, 0x400000
    s_cbranch_scc1 L_end_parallel_sum__sliding_block__glu_gated_swiglu__prompt_kernel
    buffer_load_dwordx2 v[26:27], v23, s[4:7], s53 offen sc1
    s_waitcnt vmcnt(0)
    v_cmp_ne_u64 vcc, v[26:27], v[24:25]
    s_cmp_eq_u64 vcc, 0
    s_cbranch_scc0 L_lnp_parallel_sum__sliding_block__glu_gated_swiglu__prompt_kernel
L_lnok_parallel_sum__sliding_block__glu_gated_swiglu__prompt_kernel:
    s_add_u32 s59, s46, 131072
    buffer_load_dwordx4 a[0:3], v12, s[4:7], s46 offen offset:0 sc1
    buffer_load_dwordx4 a[16:19], v12, s[4:7], s59 offen offset:0 sc1
    buffer_load_dwordx4 a[4:7], v12, s[4:7], s46 offen offset:1024 sc1
    buffer_load_dwordx4 a[20:23], v12, s[4:7], s59 offen offset:1024 sc1
    buffer_load_dwordx4 a[8:11], v12, s[4:7], s46 offen offset:2048 sc1
    buffer_load_dwordx4 a[24:27], v12, s[4:7], s59 offen offset:2048 sc1
    buffer_load_dwordx4 a[12:15], v12, s[4:7], s46 offen offset:3072 sc1
    buffer_load_dwordx4 a[28:31], v12, s[4:7], s59 offen offset:3072 sc1
    s_add_u32 s46, s46, 262144
    buffer_load_dword v16, v17, s[20:23], s74 offen
    s_add_u32 s74, s74, s76
    s_barrier
    ds_read_b64_tr_b16 a[64:65], v13 offset:0
    ds_read_b64_tr_b16 a[66:67], v13 offset:1536
    ds_read_b64_tr_b16 a[68:69], v13 offset:6144
    ds_read_b64_tr_b16 a[70:71], v13 offset:7680
    ds_read_b64_tr_b16 a[72:73], v14 offset:0
    ds_read_b64_tr_b16 a[74:75], v14 offset:1536
    ds_read_b64_tr_b16 a[76:77], v14 offset:6144
    ds_read_b64_tr_b16 a[78:79], v14 offset:7680
    ds_read_b64_tr_b16 a[80:81], v13 offset:64
    ds_read_b64_tr_b16 a[82:83], v13 offset:1600
    ds_read_b64_tr_b16 a[84:85], v13 offset:6208
    ds_read_b64_tr_b16 a[86:87], v13 offset:7744
    s_lshl_b32 s74, s44, 20
    s_add_u32 s74, s74, s63
    s_lshl_b32 s76, s44, 19
    s_and_b32 s59, s44, 1
    s_sub_u32 s60, 0, s59
    s_bitcmp1_b32 s2, 0
    s_cselect_b32 s59, s59, s60
    s_mul_i32 s60, s59, 262144
    s_add_u32 s74, s74, s60
    s_mul_i32 s60, s59, 131072
    s_add_u32 s76, s76, s60
    s_waitcnt vmcnt(7) lgkmcnt(8)
    v_mfma_f32_16x16x32_bf16 v[20:23], a[64:67], a[0:3], 0
    ds_read_b64_tr_b16 a[88:89], v14 offset:64
    s_add_u32 m0, s49, s51
    v_mfma_f32_16x16x32_bf16 v[20:23], a[68:71], a[16:19], v[20:23]
    buffer_load_dwordx4 v2, s[8:11], s47 offen offset:0 lds
    s_waitcnt vmcnt(6)
    v_mfma_f32_16x16x32_bf16 v[24:27], a[68:71], a[20:23], 0
    ds_read_b64_tr_b16 a[90:91], v14 offset:1600
    v_lshlrev_b32_e64 v243, 4, v241
    v_mfma_f32_16x16x32_bf16 v[24:27], a[64:67], a[4:7], v[24:27]
    buffer_load_dwordx4 v3, s[8:11], s47 offen offset:1024 lds
    s_waitcnt vmcnt(5)
    v_mfma_f32_16x16x32_bf16 v[28:31], a[64:67], a[8:11], 0
    ds_read_b64_tr_b16 a[92:93], v14 offset:6208
    v_lshl_add_u32 v243, v242, 10, v243
    v_mfma_f32_16x16x32_bf16 v[28:31], a[68:71], a[24:27], v[28:31]
    v_lshl_add_u32 v243, v244, 8, v243
    v_accvgpr_write_b32 a203, v243
    s_waitcnt vmcnt(3)
    v_mfma_f32_16x16x32_bf16 v[32:35], a[68:71], a[28:31], 0
    ds_read_b64_tr_b16 a[94:95], v14 offset:7744
    v_and_b32_e64 v242, 7, v0
    v_mfma_f32_16x16x32_bf16 v[32:35], a[64:67], a[12:15], v[32:35]
    v_lshlrev_b32 v243, 2, v242
    v_accvgpr_write_b32 a204, v243
    s_waitcnt lgkmcnt(8)
    v_mfma_f32_16x16x32_bf16 v[48:51], a[72:75], a[12:15], 0
    ds_read_b64_tr_b16 a[64:65], v13 offset:128
    v_lshrrev_b32_e64 v243, 3, v0
    v_mfma_f32_16x16x32_bf16 v[48:51], a[76:79], a[28:31], v[48:51]
    buffer_load_dwordx4 v4, s[8:11], s47 offen offset:2048 lds
    v_mfma_f32_16x16x32_bf16 v[44:47], a[76:79], a[24:27], 0
    ds_read_b64_tr_b16 a[66:67], v13 offset:1664
    s_add_u32 s47, s47, 393216
    s_add_u32 m0, s50, s51
    v_mfma_f32_16x16x32_bf16 v[44:47], a[72:75], a[8:11], v[44:47]
    v_lshlrev_b32 v243, 7, v243
    v_lshl_add_u32 v243, v242, 3, v243
    v_mfma_f32_16x16x32_bf16 v[40:43], a[72:75], a[4:7], 0
    ds_read_b64_tr_b16 a[68:69], v13 offset:6272
    v_accvgpr_write_b32 a205, v243
    v_mfma_f32_16x16x32_bf16 v[40:43], a[76:79], a[20:23], v[40:43]
    buffer_load_dwordx4 v5, s[12:15], s48 offen offset:0 lds
    v_mfma_f32_16x16x32_bf16 v[36:39], a[76:79], a[16:19], 0
    ds_read_b64_tr_b16 a[70:71], v13 offset:7808
    v_and_b32 v243, 31, v0
    v_mfma_f32_16x16x32_bf16 v[36:39], a[72:75], a[0:3], v[36:39]
    v_lshlrev_b32 v243, 7, v243
    v_accvgpr_write_b32 a206, v243
    s_waitcnt lgkmcnt(8)
    v_mfma_f32_16x16x32_bf16 v[52:55], a[80:83], a[0:3], 0
    ds_read_b64_tr_b16 a[72:73], v14 offset:128
    v_min_u32 v243, 3, v0
    v_mfma_f32_16x16x32_bf16 v[52:55], a[84:87], a[16:19], v[52:55]
    v_lshlrev_b32_e64 v243, 7, v243
    v_accvgpr_write_b32 a207, v243
    v_mfma_f32_16x16x32_bf16 v[56:59], a[84:87], a[20:23], 0
    ds_read_b64_tr_b16 a[74:75], v14 offset:1664
    v_mfma_f32_16x16x32_bf16 v[56:59], a[80:83], a[4:7], v[56:59]
    buffer_load_dwordx4 v6, s[12:15], s48 offen offset:1024 lds
    v_mfma_f32_16x16x32_bf16 v[60:63], a[80:83], a[8:11], 0
    ds_read_b64_tr_b16 a[76:77], v14 offset:6272
    v_mfma_f32_16x16x32_bf16 v[60:63], a[84:87], a[24:27], v[60:63]
    v_mfma_f32_16x16x32_bf16 v[64:67], a[84:87], a[28:31], 0
    ds_read_b64_tr_b16 a[78:79], v14 offset:7808
    v_mfma_f32_16x16x32_bf16 v[64:67], a[80:83], a[12:15], v[64:67]
    s_waitcnt lgkmcnt(8)
    v_mfma_f32_16x16x32_bf16 v[80:83], a[88:91], a[12:15], 0
    ds_read_b64_tr_b16 a[80:81], v15 offset:12288
    v_mfma_f32_16x16x32_bf16 v[80:83], a[92:95], a[28:31], v[80:83]
    buffer_load_dwordx4 v7, s[12:15], s48 offen offset:2048 lds
    v_mfma_f32_16x16x32_bf16 v[76:79], a[92:95], a[24:27], 0
    ds_read_b64_tr_b16 a[82:83], v15 offset:14080
    v_mfma_f32_16x16x32_bf16 v[76:79], a[88:91], a[8:11], v[76:79]
    v_mfma_f32_16x16x32_bf16 v[72:75], a[88:91], a[4:7], 0
    ds_read_b64_tr_b16 a[84:85], v15 offset:19456
    v_mfma_f32_16x16x32_bf16 v[72:75], a[92:95], a[20:23], v[72:75]
    buffer_load_dwordx4 v8, s[12:15], s48 offen offset:3072 lds
    v_mfma_f32_16x16x32_bf16 v[68:71], a[92:95], a[16:19], 0
    ds_read_b64_tr_b16 a[86:87], v15 offset:21248
    s_add_u32 m0, m0, 4096
    v_mfma_f32_16x16x32_bf16 v[68:71], a[88:91], a[0:3], v[68:71]
    s_waitcnt lgkmcnt(8)
    v_mfma_f32_16x16x32_bf16 v[84:87], a[0:3], a[64:67], 0
    ds_read_b64_tr_b16 a[88:89], v15 offset:12320
    v_mfma_f32_16x16x32_bf16 v[84:87], a[16:19], a[68:71], v[84:87]
    v_mfma_f32_16x16x32_bf16 v[88:91], a[20:23], a[68:71], 0
    ds_read_b64_tr_b16 a[90:91], v15 offset:14112
    v_mfma_f32_16x16x32_bf16 v[88:91], a[4:7], a[64:67], v[88:91]
    buffer_load_dwordx4 v9, s[12:15], s48 offen offset:0 lds
    v_mfma_f32_16x16x32_bf16 v[92:95], a[8:11], a[64:67], 0
    ds_read_b64_tr_b16 a[92:93], v15 offset:19488
    v_mfma_f32_16x16x32_bf16 v[92:95], a[24:27], a[68:71], v[92:95]
    v_mfma_f32_16x16x32_bf16 v[96:99], a[28:31], a[68:71], 0
    ds_read_b64_tr_b16 a[94:95], v15 offset:21280
    v_mfma_f32_16x16x32_bf16 v[96:99], a[12:15], a[64:67], v[96:99]
    s_add_u32 s54, s54, 1
    s_waitcnt lgkmcnt(8)
    v_mfma_f32_16x16x32_bf16 v[112:115], a[12:15], a[72:75], 0
    ds_read_b64_tr_b16 a[64:65], v15 offset:12352
    v_mfma_f32_16x16x32_bf16 v[112:115], a[28:31], a[76:79], v[112:115]
    buffer_load_dwordx4 v10, s[12:15], s48 offen offset:1024 lds
    v_mfma_f32_16x16x32_bf16 v[108:111], a[24:27], a[76:79], 0
    ds_read_b64_tr_b16 a[66:67], v15 offset:14144
    v_mfma_f32_16x16x32_bf16 v[108:111], a[8:11], a[72:75], v[108:111]
    v_mfma_f32_16x16x32_bf16 v[104:107], a[4:7], a[72:75], 0
    ds_read_b64_tr_b16 a[68:69], v15 offset:19520
    v_mfma_f32_16x16x32_bf16 v[104:107], a[20:23], a[76:79], v[104:107]
    buffer_load_dwordx4 v11, s[12:15], s48 offen offset:2048 lds
    v_mfma_f32_16x16x32_bf16 v[100:103], a[16:19], a[76:79], 0
    ds_read_b64_tr_b16 a[70:71], v15 offset:21312
    s_add_u32 s48, s48, 458752
    s_add_u32 s51, s51, 40960
    v_mfma_f32_16x16x32_bf16 v[100:103], a[0:3], a[72:75], v[100:103]
    s_cmp_eq_u32 s51, 122880
    s_cselect_b32 s51, 0, s51
    s_waitcnt lgkmcnt(8)
    v_mfma_f32_16x16x32_bf16 v[116:119], a[80:83], a[0:3], 0
    ds_read_b64_tr_b16 a[72:73], v15 offset:12384
    s_cmp_eq_u32 s54, 3
    s_cselect_b32 s52, s55, s56
    s_cselect_b32 s54, 0, s54
    v_mfma_f32_16x16x32_bf16 v[116:119], a[84:87], a[16:19], v[116:119]
    buffer_load_dwordx4 a[32:35], v12, s[4:7], s46 offen offset:0 sc1
    v_mfma_f32_16x16x32_bf16 v[120:123], a[84:87], a[20:23], 0
    ds_read_b64_tr_b16 a[74:75], v15 offset:14176
    v_mfma_f32_16x16x32_bf16 v[120:123], a[80:83], a[4:7], v[120:123]
    v_mfma_f32_16x16x32_bf16 v[124:127], a[80:83], a[8:11], 0
    ds_read_b64_tr_b16 a[76:77], v15 offset:19552
    v_mfma_f32_16x16x32_bf16 v[124:127], a[84:87], a[24:27], v[124:127]
    buffer_load_dwordx4 a[36:39], v12, s[4:7], s46 offen offset:1024 sc1
    v_mfma_f32_16x16x32_bf16 v[128:131], a[84:87], a[28:31], 0
    ds_read_b64_tr_b16 a[78:79], v15 offset:21344
    v_mfma_f32_16x16x32_bf16 v[128:131], a[80:83], a[12:15], v[128:131]
    s_waitcnt lgkmcnt(8)
    v_mfma_f32_16x16x32_bf16 v[144:147], a[88:91], a[12:15], 0
    ds_read_b64_tr_b16 a[80:81], v15 offset:12416
    v_mfma_f32_16x16x32_bf16 v[144:147], a[92:95], a[28:31], v[144:147]
    v_mfma_f32_16x16x32_bf16 v[140:143], a[92:95], a[24:27], 0
    ds_read_b64_tr_b16 a[82:83], v15 offset:14208
    v_mfma_f32_16x16x32_bf16 v[140:143], a[88:91], a[8:11], v[140:143]
    buffer_load_dwordx4 a[40:43], v12, s[4:7], s46 offen offset:2048 sc1
    v_mfma_f32_16x16x32_bf16 v[136:139], a[88:91], a[4:7], 0
    ds_read_b64_tr_b16 a[84:85], v15 offset:19584
    v_mfma_f32_16x16x32_bf16 v[136:139], a[92:95], a[20:23], v[136:139]
    v_mfma_f32_16x16x32_bf16 v[132:135], a[92:95], a[16:19], 0
    ds_read_b64_tr_b16 a[86:87], v15 offset:21376
    v_mfma_f32_16x16x32_bf16 v[132:135], a[88:91], a[0:3], v[132:135]
    v_add_u32 v13, s52, v13
    s_waitcnt lgkmcnt(8)
    v_mfma_f32_16x16x32_bf16 v[148:151], a[64:67], a[0:3], 0
    ds_read_b64_tr_b16 a[88:89], v15 offset:12448
    v_mfma_f32_16x16x32_bf16 v[148:151], a[68:71], a[16:19], v[148:151]
    buffer_load_dwordx4 a[44:47], v12, s[4:7], s46 offen offset:3072 sc1
    v_mfma_f32_16x16x32_bf16 v[152:155], a[68:71], a[20:23], 0
    ds_read_b64_tr_b16 a[90:91], v15 offset:14240
    s_add_u32 s46, s46, 131072
    v_mfma_f32_16x16x32_bf16 v[152:155], a[64:67], a[4:7], v[152:155]
    v_mfma_f32_16x16x32_bf16 v[156:159], a[64:67], a[8:11], 0
    ds_read_b64_tr_b16 a[92:93], v15 offset:19616
    v_mfma_f32_16x16x32_bf16 v[156:159], a[68:71], a[24:27], v[156:159]
    buffer_load_dwordx4 a[48:51], v12, s[4:7], s46 offen offset:0 sc1
    v_mfma_f32_16x16x32_bf16 v[160:163], a[68:71], a[28:31], 0
    ds_read_b64_tr_b16 a[94:95], v15 offset:21408
    v_mfma_f32_16x16x32_bf16 v[160:163], a[64:67], a[12:15], v[160:163]
    v_add_u32 v14, s52, v14
    s_waitcnt lgkmcnt(8)
    v_mfma_f32_16x16x32_bf16 v[176:179], a[72:75], a[12:15], 0
    ds_read_b64_tr_b16 a[64:65], v15 offset:12480
    v_mfma_f32_16x16x32_bf16 v[176:179], a[76:79], a[28:31], v[176:179]
    v_mfma_f32_16x16x32_bf16 v[172:175], a[76:79], a[24:27], 0
    ds_read_b64_tr_b16 a[66:67], v15 offset:14272
    v_mfma_f32_16x16x32_bf16 v[172:175], a[72:75], a[8:11], v[172:175]
    buffer_load_dwordx4 a[52:55], v12, s[4:7], s46 offen offset:1024 sc1
    v_mfma_f32_16x16x32_bf16 v[168:171], a[72:75], a[4:7], 0
    ds_read_b64_tr_b16 a[68:69], v15 offset:19648
    v_mfma_f32_16x16x32_bf16 v[168:171], a[76:79], a[20:23], v[168:171]
    v_mfma_f32_16x16x32_bf16 v[164:167], a[76:79], a[16:19], 0
    ds_read_b64_tr_b16 a[70:71], v15 offset:21440
    v_mfma_f32_16x16x32_bf16 v[164:167], a[72:75], a[0:3], v[164:167]
    s_mov_b32 s53, 6
    s_waitcnt lgkmcnt(8)
    v_mfma_f32_16x16x32_bf16 v[180:183], a[80:83], a[0:3], 0
    ds_read_b64_tr_b16 a[72:73], v15 offset:26624
    v_mfma_f32_16x16x32_bf16 v[180:183], a[84:87], a[16:19], v[180:183]
    buffer_load_dwordx4 a[56:59], v12, s[4:7], s46 offen offset:2048 sc1
    v_mfma_f32_16x16x32_bf16 v[184:187], a[84:87], a[20:23], 0
    ds_read_b64_tr_b16 a[74:75], v15 offset:28416
    v_mfma_f32_16x16x32_bf16 v[184:187], a[80:83], a[4:7], v[184:187]
    v_mfma_f32_16x16x32_bf16 v[188:191], a[80:83], a[8:11], 0
    ds_read_b64_tr_b16 a[76:77], v15 offset:33792
    v_mfma_f32_16x16x32_bf16 v[188:191], a[84:87], a[24:27], v[188:191]
    buffer_load_dwordx4 a[60:63], v12, s[4:7], s46 offen offset:3072 sc1
    v_mfma_f32_16x16x32_bf16 v[192:195], a[84:87], a[28:31], 0
    ds_read_b64_tr_b16 a[78:79], v15 offset:35584
    s_add_u32 s46, s46, 131072
    v_mfma_f32_16x16x32_bf16 v[192:195], a[80:83], a[12:15], v[192:195]
    s_waitcnt lgkmcnt(8)
    v_mfma_f32_16x16x32_bf16 v[208:211], a[88:91], a[12:15], 0
    ds_read_b64_tr_b16 a[80:81], v15 offset:26656
    v_mfma_f32_16x16x32_bf16 v[208:211], a[92:95], a[28:31], v[208:211]
    v_mfma_f32_16x16x32_bf16 v[204:207], a[92:95], a[24:27], 0
    ds_read_b64_tr_b16 a[82:83], v15 offset:28448
    s_add_u32 m0, s49, s51
    v_mfma_f32_16x16x32_bf16 v[204:207], a[88:91], a[8:11], v[204:207]
    buffer_load_dwordx4 v2, s[8:11], s47 offen offset:0 lds
    v_mfma_f32_16x16x32_bf16 v[200:203], a[88:91], a[4:7], 0
    ds_read_b64_tr_b16 a[84:85], v15 offset:33824
    v_mfma_f32_16x16x32_bf16 v[200:203], a[92:95], a[20:23], v[200:203]
    buffer_load_dwordx4 v3, s[8:11], s47 offen offset:1024 lds
    v_mfma_f32_16x16x32_bf16 v[196:199], a[92:95], a[16:19], 0
    ds_read_b64_tr_b16 a[86:87], v15 offset:35616
    v_mfma_f32_16x16x32_bf16 v[196:199], a[88:91], a[0:3], v[196:199]
    s_waitcnt lgkmcnt(8)
    v_mfma_f32_16x16x32_bf16 v[212:215], a[64:67], a[0:3], 0
    ds_read_b64_tr_b16 a[88:89], v15 offset:26688
    v_mfma_f32_16x16x32_bf16 v[212:215], a[68:71], a[16:19], v[212:215]
    v_mfma_f32_16x16x32_bf16 v[216:219], a[68:71], a[20:23], 0
    ds_read_b64_tr_b16 a[90:91], v15 offset:28480
    v_mfma_f32_16x16x32_bf16 v[216:219], a[64:67], a[4:7], v[216:219]
    buffer_load_dwordx4 v4, s[8:11], s47 offen offset:2048 lds
    v_mfma_f32_16x16x32_bf16 v[220:223], a[64:67], a[8:11], 0
    ds_read_b64_tr_b16 a[92:93], v15 offset:33856
    s_add_u32 s47, s47, 393216
    s_add_u32 m0, s50, s51
    v_mfma_f32_16x16x32_bf16 v[220:223], a[68:71], a[24:27], v[220:223]
    v_mfma_f32_16x16x32_bf16 v[224:227], a[68:71], a[28:31], 0
    ds_read_b64_tr_b16 a[94:95], v15 offset:35648
    v_mfma_f32_16x16x32_bf16 v[224:227], a[64:67], a[12:15], v[224:227]
    s_waitcnt lgkmcnt(8)
    v_mfma_f32_16x16x32_bf16 v[240:243], a[72:75], a[12:15], 0
    ds_read_b64_tr_b16 a[64:65], v15 offset:26720
    v_mfma_f32_16x16x32_bf16 v[240:243], a[76:79], a[28:31], v[240:243]
    buffer_load_dwordx4 v5, s[12:15], s48 offen offset:0 lds
    v_mfma_f32_16x16x32_bf16 v[236:239], a[76:79], a[24:27], 0
    ds_read_b64_tr_b16 a[66:67], v15 offset:28512
    v_mfma_f32_16x16x32_bf16 v[236:239], a[72:75], a[8:11], v[236:239]
    v_mfma_f32_16x16x32_bf16 v[232:235], a[72:75], a[4:7], 0
    ds_read_b64_tr_b16 a[68:69], v15 offset:33888
    v_mfma_f32_16x16x32_bf16 v[232:235], a[76:79], a[20:23], v[232:235]
    buffer_load_dwordx4 v6, s[12:15], s48 offen offset:1024 lds
    v_mfma_f32_16x16x32_bf16 v[228:231], a[76:79], a[16:19], 0
    ds_read_b64_tr_b16 a[70:71], v15 offset:35680
    v_mfma_f32_16x16x32_bf16 v[228:231], a[72:75], a[0:3], v[228:231]
    s_waitcnt lgkmcnt(8)
    v_mfma_f32_16x16x32_bf16 v[244:247], a[80:83], a[0:3], 0
    ds_read_b64_tr_b16 a[72:73], v15 offset:26752
    v_mfma_f32_16x16x32_bf16 v[244:247], a[84:87], a[16:19], v[244:247]
    v_mfma_f32_16x16x32_bf16 v[248:251], a[84:87], a[20:23], 0
    ds_read_b64_tr_b16 a[74:75], v15 offset:28544
    v_mfma_f32_16x16x32_bf16 v[248:251], a[80:83], a[4:7], v[248:251]
    buffer_load_dwordx4 v7, s[12:15], s48 offen offset:2048 lds
    v_mfma_f32_16x16x32_bf16 v[252:255], a[80:83], a[8:11], 0
    ds_read_b64_tr_b16 a[76:77], v15 offset:33920
    v_mfma_f32_16x16x32_bf16 v[252:255], a[84:87], a[24:27], v[252:255]
    v_mfma_f32_16x16x32_bf16 a[96:99], a[84:87], a[28:31], 0
    ds_read_b64_tr_b16 a[78:79], v15 offset:35712
    v_mfma_f32_16x16x32_bf16 a[96:99], a[80:83], a[12:15], a[96:99]
    s_waitcnt lgkmcnt(8)
    v_mfma_f32_16x16x32_bf16 a[112:115], a[88:91], a[12:15], 0
    ds_read_b64_tr_b16 a[80:81], v15 offset:26784
    v_mfma_f32_16x16x32_bf16 a[112:115], a[92:95], a[28:31], a[112:115]
    buffer_load_dwordx4 v8, s[12:15], s48 offen offset:3072 lds
    v_mfma_f32_16x16x32_bf16 a[108:111], a[92:95], a[24:27], 0
    ds_read_b64_tr_b16 a[82:83], v15 offset:28576
    s_add_u32 m0, m0, 4096
    v_mfma_f32_16x16x32_bf16 a[108:111], a[88:91], a[8:11], a[108:111]
    v_mfma_f32_16x16x32_bf16 a[104:107], a[88:91], a[4:7], 0
    ds_read_b64_tr_b16 a[84:85], v15 offset:33952
    v_mfma_f32_16x16x32_bf16 a[104:107], a[92:95], a[20:23], a[104:107]
    buffer_load_dwordx4 v9, s[12:15], s48 offen offset:0 lds
    v_mfma_f32_16x16x32_bf16 a[100:103], a[92:95], a[16:19], 0
    ds_read_b64_tr_b16 a[86:87], v15 offset:35744
    v_mfma_f32_16x16x32_bf16 a[100:103], a[88:91], a[0:3], a[100:103]
    s_waitcnt lgkmcnt(8)
    v_mfma_f32_16x16x32_bf16 a[116:119], a[64:67], a[0:3], 0
    ds_read_b64_tr_b16 a[88:89], v15 offset:26816
    v_mfma_f32_16x16x32_bf16 a[116:119], a[68:71], a[16:19], a[116:119]
    ds_read_b64_tr_b16 a[90:91], v15 offset:28608
    v_mfma_f32_16x16x32_bf16 a[120:123], a[68:71], a[20:23], 0
    ds_read_b64_tr_b16 a[92:93], v15 offset:33984
    v_mfma_f32_16x16x32_bf16 a[120:123], a[64:67], a[4:7], a[120:123]
    ds_read_b64_tr_b16 a[94:95], v15 offset:35776
    v_mfma_f32_16x16x32_bf16 a[124:127], a[64:67], a[8:11], 0
    v_mfma_f32_16x16x32_bf16 a[124:127], a[68:71], a[24:27], a[124:127]
    buffer_load_dwordx4 v10, s[12:15], s48 offen offset:1024 lds
    v_mfma_f32_16x16x32_bf16 a[128:131], a[68:71], a[28:31], 0
    v_mfma_f32_16x16x32_bf16 a[128:131], a[64:67], a[12:15], a[128:131]
    s_waitcnt lgkmcnt(8)
    v_mfma_f32_16x16x32_bf16 a[144:147], a[72:75], a[12:15], 0
    buffer_load_dwordx4 v11, s[12:15], s48 offen offset:2048 lds
    v_mfma_f32_16x16x32_bf16 a[144:147], a[76:79], a[28:31], a[144:147]
    s_add_u32 s48, s48, 458752
    s_add_u32 s51, s51, 40960
    v_mfma_f32_16x16x32_bf16 a[140:143], a[76:79], a[24:27], 0
    s_cmp_eq_u32 s51, 122880
    s_cselect_b32 s51, 0, s51
    s_waitcnt vmcnt(18) lgkmcnt(0)
    s_barrier
    v_mfma_f32_16x16x32_bf16 a[140:143], a[72:75], a[8:11], a[140:143]
    ds_read_b64_tr_b16 a[64:65], v13 offset:0
    v_mfma_f32_16x16x32_bf16 a[136:139], a[72:75], a[4:7], 0
    ds_read_b64_tr_b16 a[66:67], v13 offset:1536
    v_mfma_f32_16x16x32_bf16 a[136:139], a[76:79], a[20:23], a[136:139]
    ds_read_b64_tr_b16 a[68:69], v13 offset:6144
    v_mfma_f32_16x16x32_bf16 a[132:135], a[76:79], a[16:19], 0
    ds_read_b64_tr_b16 a[70:71], v13 offset:7680
    v_mfma_f32_16x16x32_bf16 a[132:135], a[72:75], a[0:3], a[132:135]
    v_mfma_f32_16x16x32_bf16 a[148:151], a[80:83], a[0:3], 0
    ds_read_b64_tr_b16 a[72:73], v14 offset:0
    v_mfma_f32_16x16x32_bf16 a[148:151], a[84:87], a[16:19], a[148:151]
    buffer_load_dword v16, v17, s[20:23], s57 offen
    s_add_u32 s57, s57, s58
    v_mfma_f32_16x16x32_bf16 a[152:155], a[84:87], a[20:23], 0
    ds_read_b64_tr_b16 a[74:75], v14 offset:1536
    v_mfma_f32_16x16x32_bf16 a[152:155], a[80:83], a[4:7], a[152:155]
    v_mfma_f32_16x16x32_bf16 a[156:159], a[80:83], a[8:11], 0
    ds_read_b64_tr_b16 a[76:77], v14 offset:6144
    v_mfma_f32_16x16x32_bf16 a[156:159], a[84:87], a[24:27], a[156:159]
    v_mfma_f32_16x16x32_bf16 a[160:163], a[84:87], a[28:31], 0
    ds_read_b64_tr_b16 a[78:79], v14 offset:7680
    v_mfma_f32_16x16x32_bf16 a[160:163], a[80:83], a[12:15], a[160:163]
    v_add_u32 v15, s52, v15
    v_mfma_f32_16x16x32_bf16 a[176:179], a[88:91], a[12:15], 0
    ds_read_b64_tr_b16 a[80:81], v13 offset:64
    v_mfma_f32_16x16x32_bf16 a[176:179], a[92:95], a[28:31], a[176:179]
    v_mfma_f32_16x16x32_bf16 a[172:175], a[92:95], a[24:27], 0
    ds_read_b64_tr_b16 a[82:83], v13 offset:1600
    v_mfma_f32_16x16x32_bf16 a[172:175], a[88:91], a[8:11], a[172:175]
    v_mfma_f32_16x16x32_bf16 a[168:171], a[88:91], a[4:7], 0
    ds_read_b64_tr_b16 a[84:85], v13 offset:6208
    v_mfma_f32_16x16x32_bf16 a[168:171], a[92:95], a[20:23], a[168:171]
    v_mfma_f32_16x16x32_bf16 a[164:167], a[92:95], a[16:19], 0
    ds_read_b64_tr_b16 a[86:87], v13 offset:7744
    v_mfma_f32_16x16x32_bf16 a[164:167], a[88:91], a[0:3], a[164:167]
L_loop_parallel_sum__sliding_block__glu_gated_swiglu__prompt_kernel:
    s_waitcnt vmcnt(11) lgkmcnt(8)
    v_mfma_f32_16x16x32_bf16 v[20:23], a[64:67], a[32:35], v[20:23]
    ds_read_b64_tr_b16 a[88:89], v14 offset:64
    v_mfma_f32_16x16x32_bf16 v[20:23], a[68:71], a[48:51], v[20:23]
    buffer_load_dwordx4 a[0:3], v12, s[4:7], s46 offen offset:0 sc1
    v_mfma_f32_16x16x32_bf16 v[24:27], a[68:71], a[52:55], v[24:27]
    ds_read_b64_tr_b16 a[90:91], v14 offset:1600
    v_mfma_f32_16x16x32_bf16 v[24:27], a[64:67], a[36:39], v[24:27]
    v_mfma_f32_16x16x32_bf16 v[28:31], a[64:67], a[40:43], v[28:31]
    ds_read_b64_tr_b16 a[92:93], v14 offset:6208
    v_mfma_f32_16x16x32_bf16 v[28:31], a[68:71], a[56:59], v[28:31]
    buffer_load_dwordx4 a[4:7], v12, s[4:7], s46 offen offset:1024 sc1
    v_mfma_f32_16x16x32_bf16 v[32:35], a[68:71], a[60:63], v[32:35]
    ds_read_b64_tr_b16 a[94:95], v14 offset:7744
    v_mfma_f32_16x16x32_bf16 v[32:35], a[64:67], a[44:47], v[32:35]
    s_waitcnt lgkmcnt(8)
    v_mfma_f32_16x16x32_bf16 v[48:51], a[72:75], a[44:47], v[48:51]
    ds_read_b64_tr_b16 a[64:65], v13 offset:128
    v_mfma_f32_16x16x32_bf16 v[48:51], a[76:79], a[60:63], v[48:51]
    v_mfma_f32_16x16x32_bf16 v[44:47], a[76:79], a[56:59], v[44:47]
    ds_read_b64_tr_b16 a[66:67], v13 offset:1664
    v_mfma_f32_16x16x32_bf16 v[44:47], a[72:75], a[40:43], v[44:47]
    v_mfma_f32_16x16x32_bf16 v[40:43], a[72:75], a[36:39], v[40:43]
    ds_read_b64_tr_b16 a[68:69], v13 offset:6272
    v_mfma_f32_16x16x32_bf16 v[40:43], a[76:79], a[52:55], v[40:43]
    buffer_load_dwordx4 a[8:11], v12, s[4:7], s46 offen offset:2048 sc1
    v_mfma_f32_16x16x32_bf16 v[36:39], a[76:79], a[48:51], v[36:39]
    ds_read_b64_tr_b16 a[70:71], v13 offset:7808
    v_mfma_f32_16x16x32_bf16 v[36:39], a[72:75], a[32:35], v[36:39]
    s_waitcnt lgkmcnt(8)
    v_mfma_f32_16x16x32_bf16 v[52:55], a[80:83], a[32:35], v[52:55]
    ds_read_b64_tr_b16 a[72:73], v14 offset:128
    v_mfma_f32_16x16x32_bf16 v[52:55], a[84:87], a[48:51], v[52:55]
    v_mfma_f32_16x16x32_bf16 v[56:59], a[84:87], a[52:55], v[56:59]
    ds_read_b64_tr_b16 a[74:75], v14 offset:1664
    v_mfma_f32_16x16x32_bf16 v[56:59], a[80:83], a[36:39], v[56:59]
    v_mfma_f32_16x16x32_bf16 v[60:63], a[80:83], a[40:43], v[60:63]
    ds_read_b64_tr_b16 a[76:77], v14 offset:6272
    v_mfma_f32_16x16x32_bf16 v[60:63], a[84:87], a[56:59], v[60:63]
    buffer_load_dwordx4 a[12:15], v12, s[4:7], s46 offen offset:3072 sc1
    v_mfma_f32_16x16x32_bf16 v[64:67], a[84:87], a[60:63], v[64:67]
    ds_read_b64_tr_b16 a[78:79], v14 offset:7808
    s_add_u32 s46, s46, 131072
    v_mfma_f32_16x16x32_bf16 v[64:67], a[80:83], a[44:47], v[64:67]
    s_waitcnt lgkmcnt(8)
    v_mfma_f32_16x16x32_bf16 v[80:83], a[88:91], a[44:47], v[80:83]
    ds_read_b64_tr_b16 a[80:81], v15 offset:12288
    v_mfma_f32_16x16x32_bf16 v[80:83], a[92:95], a[60:63], v[80:83]
    v_mfma_f32_16x16x32_bf16 v[76:79], a[92:95], a[56:59], v[76:79]
    ds_read_b64_tr_b16 a[82:83], v15 offset:14080
    v_mfma_f32_16x16x32_bf16 v[76:79], a[88:91], a[40:43], v[76:79]
    v_mfma_f32_16x16x32_bf16 v[72:75], a[88:91], a[36:39], v[72:75]
    ds_read_b64_tr_b16 a[84:85], v15 offset:19456
    v_mfma_f32_16x16x32_bf16 v[72:75], a[92:95], a[52:55], v[72:75]
    buffer_load_dwordx4 a[16:19], v12, s[4:7], s46 offen offset:0 sc1
    v_mfma_f32_16x16x32_bf16 v[68:71], a[92:95], a[48:51], v[68:71]
    ds_read_b64_tr_b16 a[86:87], v15 offset:21248
    v_mfma_f32_16x16x32_bf16 v[68:71], a[88:91], a[32:35], v[68:71]
    s_waitcnt lgkmcnt(8)
    v_mfma_f32_16x16x32_bf16 v[84:87], a[32:35], a[64:67], v[84:87]
    ds_read_b64_tr_b16 a[88:89], v15 offset:12320
    v_mfma_f32_16x16x32_bf16 v[84:87], a[48:51], a[68:71], v[84:87]
    v_mfma_f32_16x16x32_bf16 v[88:91], a[52:55], a[68:71], v[88:91]
    ds_read_b64_tr_b16 a[90:91], v15 offset:14112
    v_mfma_f32_16x16x32_bf16 v[88:91], a[36:39], a[64:67], v[88:91]
    v_mfma_f32_16x16x32_bf16 v[92:95], a[40:43], a[64:67], v[92:95]
    ds_read_b64_tr_b16 a[92:93], v15 offset:19488
    v_mfma_f32_16x16x32_bf16 v[92:95], a[56:59], a[68:71], v[92:95]
    buffer_load_dwordx4 a[20:23], v12, s[4:7], s46 offen offset:1024 sc1
    v_mfma_f32_16x16x32_bf16 v[96:99], a[60:63], a[68:71], v[96:99]
    ds_read_b64_tr_b16 a[94:95], v15 offset:21280
    v_mfma_f32_16x16x32_bf16 v[96:99], a[44:47], a[64:67], v[96:99]
    s_add_u32 s54, s54, 1
    s_waitcnt lgkmcnt(8)
    v_mfma_f32_16x16x32_bf16 v[112:115], a[44:47], a[72:75], v[112:115]
    ds_read_b64_tr_b16 a[64:65], v15 offset:12352
    v_mfma_f32_16x16x32_bf16 v[112:115], a[60:63], a[76:79], v[112:115]
    v_mfma_f32_16x16x32_bf16 v[108:111], a[56:59], a[76:79], v[108:111]
    ds_read_b64_tr_b16 a[66:67], v15 offset:14144
    v_mfma_f32_16x16x32_bf16 v[108:111], a[40:43], a[72:75], v[108:111]
    v_mfma_f32_16x16x32_bf16 v[104:107], a[36:39], a[72:75], v[104:107]
    ds_read_b64_tr_b16 a[68:69], v15 offset:19520
    v_mfma_f32_16x16x32_bf16 v[104:107], a[52:55], a[76:79], v[104:107]
    buffer_load_dwordx4 a[24:27], v12, s[4:7], s46 offen offset:2048 sc1
    v_mfma_f32_16x16x32_bf16 v[100:103], a[48:51], a[76:79], v[100:103]
    ds_read_b64_tr_b16 a[70:71], v15 offset:21312
    v_mfma_f32_16x16x32_bf16 v[100:103], a[32:35], a[72:75], v[100:103]
    s_cmp_eq_u32 s54, 3
    s_cselect_b32 s52, s55, s56
    s_cselect_b32 s54, 0, s54
    s_waitcnt lgkmcnt(8)
    v_mfma_f32_16x16x32_bf16 v[116:119], a[80:83], a[32:35], v[116:119]
    ds_read_b64_tr_b16 a[72:73], v15 offset:12384
    v_mfma_f32_16x16x32_bf16 v[116:119], a[84:87], a[48:51], v[116:119]
    v_mfma_f32_16x16x32_bf16 v[120:123], a[84:87], a[52:55], v[120:123]
    ds_read_b64_tr_b16 a[74:75], v15 offset:14176
    v_mfma_f32_16x16x32_bf16 v[120:123], a[80:83], a[36:39], v[120:123]
    v_mfma_f32_16x16x32_bf16 v[124:127], a[80:83], a[40:43], v[124:127]
    ds_read_b64_tr_b16 a[76:77], v15 offset:19552
    v_mfma_f32_16x16x32_bf16 v[124:127], a[84:87], a[56:59], v[124:127]
    buffer_load_dwordx4 a[28:31], v12, s[4:7], s46 offen offset:3072 sc1
    v_mfma_f32_16x16x32_bf16 v[128:131], a[84:87], a[60:63], v[128:131]
    ds_read_b64_tr_b16 a[78:79], v15 offset:21344
    s_add_u32 s46, s46, 131072
    v_mfma_f32_16x16x32_bf16 v[128:131], a[80:83], a[44:47], v[128:131]
    s_waitcnt lgkmcnt(8)
    v_mfma_f32_16x16x32_bf16 v[144:147], a[88:91], a[44:47], v[144:147]
    ds_read_b64_tr_b16 a[80:81], v15 offset:12416
    v_mfma_f32_16x16x32_bf16 v[144:147], a[92:95], a[60:63], v[144:147]
    v_mfma_f32_16x16x32_bf16 v[140:143], a[92:95], a[56:59], v[140:143]
    ds_read_b64_tr_b16 a[82:83], v15 offset:14208
    v_mfma_f32_16x16x32_bf16 v[140:143], a[88:91], a[40:43], v[140:143]
    v_mfma_f32_16x16x32_bf16 v[136:139], a[88:91], a[36:39], v[136:139]
    ds_read_b64_tr_b16 a[84:85], v15 offset:19584
    s_add_u32 m0, s49, s51
    v_mfma_f32_16x16x32_bf16 v[136:139], a[92:95], a[52:55], v[136:139]
    buffer_load_dwordx4 v2, s[8:11], s47 offen offset:0 lds
    v_mfma_f32_16x16x32_bf16 v[132:135], a[92:95], a[48:51], v[132:135]
    ds_read_b64_tr_b16 a[86:87], v15 offset:21376
    v_mfma_f32_16x16x32_bf16 v[132:135], a[88:91], a[32:35], v[132:135]
    v_add_u32 v13, s52, v13
    s_waitcnt lgkmcnt(8)
    v_mfma_f32_16x16x32_bf16 v[148:151], a[64:67], a[32:35], v[148:151]
    ds_read_b64_tr_b16 a[88:89], v15 offset:12448
    v_mfma_f32_16x16x32_bf16 v[148:151], a[68:71], a[48:51], v[148:151]
    v_mfma_f32_16x16x32_bf16 v[152:155], a[68:71], a[52:55], v[152:155]
    ds_read_b64_tr_b16 a[90:91], v15 offset:14240
    v_mfma_f32_16x16x32_bf16 v[152:155], a[64:67], a[36:39], v[152:155]
    v_mfma_f32_16x16x32_bf16 v[156:159], a[64:67], a[40:43], v[156:159]
    ds_read_b64_tr_b16 a[92:93], v15 offset:19616
    v_mfma_f32_16x16x32_bf16 v[156:159], a[68:71], a[56:59], v[156:159]
    buffer_load_dwordx4 v3, s[8:11], s47 offen offset:1024 lds
    v_mfma_f32_16x16x32_bf16 v[160:163], a[68:71], a[60:63], v[160:163]
    ds_read_b64_tr_b16 a[94:95], v15 offset:21408
    v_mfma_f32_16x16x32_bf16 v[160:163], a[64:67], a[44:47], v[160:163]
    v_add_u32 v14, s52, v14
    s_waitcnt lgkmcnt(8)
    v_mfma_f32_16x16x32_bf16 v[176:179], a[72:75], a[44:47], v[176:179]
    ds_read_b64_tr_b16 a[64:65], v15 offset:12480
    v_mfma_f32_16x16x32_bf16 v[176:179], a[76:79], a[60:63], v[176:179]
    v_mfma_f32_16x16x32_bf16 v[172:175], a[76:79], a[56:59], v[172:175]
    ds_read_b64_tr_b16 a[66:67], v15 offset:14272
    v_mfma_f32_16x16x32_bf16 v[172:175], a[72:75], a[40:43], v[172:175]
    v_mfma_f32_16x16x32_bf16 v[168:171], a[72:75], a[36:39], v[168:171]
    ds_read_b64_tr_b16 a[68:69], v15 offset:19648
    v_mfma_f32_16x16x32_bf16 v[168:171], a[76:79], a[52:55], v[168:171]
    buffer_load_dwordx4 v4, s[8:11], s47 offen offset:2048 lds
    v_mfma_f32_16x16x32_bf16 v[164:167], a[76:79], a[48:51], v[164:167]
    ds_read_b64_tr_b16 a[70:71], v15 offset:21440
    s_add_u32 s47, s47, 393216
    s_add_u32 m0, s50, s51
    v_mfma_f32_16x16x32_bf16 v[164:167], a[72:75], a[32:35], v[164:167]
    s_waitcnt lgkmcnt(8)
    v_mfma_f32_16x16x32_bf16 v[180:183], a[80:83], a[32:35], v[180:183]
    ds_read_b64_tr_b16 a[72:73], v15 offset:26624
    v_mfma_f32_16x16x32_bf16 v[180:183], a[84:87], a[48:51], v[180:183]
    v_mfma_f32_16x16x32_bf16 v[184:187], a[84:87], a[52:55], v[184:187]
    ds_read_b64_tr_b16 a[74:75], v15 offset:28416
    v_mfma_f32_16x16x32_bf16 v[184:187], a[80:83], a[36:39], v[184:187]
    v_mfma_f32_16x16x32_bf16 v[188:191], a[80:83], a[40:43], v[188:191]
    ds_read_b64_tr_b16 a[76:77], v15 offset:33792
    v_mfma_f32_16x16x32_bf16 v[188:191], a[84:87], a[56:59], v[188:191]
    buffer_load_dwordx4 v5, s[12:15], s48 offen offset:0 lds
    v_mfma_f32_16x16x32_bf16 v[192:195], a[84:87], a[60:63], v[192:195]
    ds_read_b64_tr_b16 a[78:79], v15 offset:35584
    v_mfma_f32_16x16x32_bf16 v[192:195], a[80:83], a[44:47], v[192:195]
    s_waitcnt lgkmcnt(8)
    v_mfma_f32_16x16x32_bf16 v[208:211], a[88:91], a[44:47], v[208:211]
    ds_read_b64_tr_b16 a[80:81], v15 offset:26656
    v_mfma_f32_16x16x32_bf16 v[208:211], a[92:95], a[60:63], v[208:211]
    v_mfma_f32_16x16x32_bf16 v[204:207], a[92:95], a[56:59], v[204:207]
    ds_read_b64_tr_b16 a[82:83], v15 offset:28448
    v_mfma_f32_16x16x32_bf16 v[204:207], a[88:91], a[40:43], v[204:207]
    v_mfma_f32_16x16x32_bf16 v[200:203], a[88:91], a[36:39], v[200:203]
    ds_read_b64_tr_b16 a[84:85], v15 offset:33824
    v_mfma_f32_16x16x32_bf16 v[200:203], a[92:95], a[52:55], v[200:203]
    buffer_load_dwordx4 v6, s[12:15], s48 offen offset:1024 lds
    v_mfma_f32_16x16x32_bf16 v[196:199], a[92:95], a[48:51], v[196:199]
    ds_read_b64_tr_b16 a[86:87], v15 offset:35616
    v_mfma_f32_16x16x32_bf16 v[196:199], a[88:91], a[32:35], v[196:199]
    s_waitcnt lgkmcnt(8)
    v_mfma_f32_16x16x32_bf16 v[212:215], a[64:67], a[32:35], v[212:215]
    ds_read_b64_tr_b16 a[88:89], v15 offset:26688
    v_mfma_f32_16x16x32_bf16 v[212:215], a[68:71], a[48:51], v[212:215]
    v_mfma_f32_16x16x32_bf16 v[216:219], a[68:71], a[52:55], v[216:219]
    ds_read_b64_tr_b16 a[90:91], v15 offset:28480
    v_mfma_f32_16x16x32_bf16 v[216:219], a[64:67], a[36:39], v[216:219]
    v_mfma_f32_16x16x32_bf16 v[220:223], a[64:67], a[40:43], v[220:223]
    ds_read_b64_tr_b16 a[92:93], v15 offset:33856
    v_mfma_f32_16x16x32_bf16 v[220:223], a[68:71], a[56:59], v[220:223]
    buffer_load_dwordx4 v7, s[12:15], s48 offen offset:2048 lds
    v_mfma_f32_16x16x32_bf16 v[224:227], a[68:71], a[60:63], v[224:227]
    ds_read_b64_tr_b16 a[94:95], v15 offset:35648
    v_mfma_f32_16x16x32_bf16 v[224:227], a[64:67], a[44:47], v[224:227]
    s_waitcnt lgkmcnt(8)
    v_mfma_f32_16x16x32_bf16 v[240:243], a[72:75], a[44:47], v[240:243]
    ds_read_b64_tr_b16 a[64:65], v15 offset:26720
    v_mfma_f32_16x16x32_bf16 v[240:243], a[76:79], a[60:63], v[240:243]
    v_mfma_f32_16x16x32_bf16 v[236:239], a[76:79], a[56:59], v[236:239]
    ds_read_b64_tr_b16 a[66:67], v15 offset:28512
    v_mfma_f32_16x16x32_bf16 v[236:239], a[72:75], a[40:43], v[236:239]
    v_mfma_f32_16x16x32_bf16 v[232:235], a[72:75], a[36:39], v[232:235]
    ds_read_b64_tr_b16 a[68:69], v15 offset:33888
    v_mfma_f32_16x16x32_bf16 v[232:235], a[76:79], a[52:55], v[232:235]
    buffer_load_dwordx4 v8, s[12:15], s48 offen offset:3072 lds
    v_mfma_f32_16x16x32_bf16 v[228:231], a[76:79], a[48:51], v[228:231]
    ds_read_b64_tr_b16 a[70:71], v15 offset:35680
    s_add_u32 m0, m0, 4096
    v_mfma_f32_16x16x32_bf16 v[228:231], a[72:75], a[32:35], v[228:231]
    s_waitcnt lgkmcnt(8)
    v_mfma_f32_16x16x32_bf16 v[244:247], a[80:83], a[32:35], v[244:247]
    ds_read_b64_tr_b16 a[72:73], v15 offset:26752
    v_mfma_f32_16x16x32_bf16 v[244:247], a[84:87], a[48:51], v[244:247]
    v_mfma_f32_16x16x32_bf16 v[248:251], a[84:87], a[52:55], v[248:251]
    ds_read_b64_tr_b16 a[74:75], v15 offset:28544
    v_mfma_f32_16x16x32_bf16 v[248:251], a[80:83], a[36:39], v[248:251]
    v_mfma_f32_16x16x32_bf16 v[252:255], a[80:83], a[40:43], v[252:255]
    ds_read_b64_tr_b16 a[76:77], v15 offset:33920
    v_mfma_f32_16x16x32_bf16 v[252:255], a[84:87], a[56:59], v[252:255]
    buffer_load_dwordx4 v9, s[12:15], s48 offen offset:0 lds
    v_mfma_f32_16x16x32_bf16 a[96:99], a[84:87], a[60:63], a[96:99]
    ds_read_b64_tr_b16 a[78:79], v15 offset:35712
    v_mfma_f32_16x16x32_bf16 a[96:99], a[80:83], a[44:47], a[96:99]
    s_waitcnt lgkmcnt(8)
    v_mfma_f32_16x16x32_bf16 a[112:115], a[88:91], a[44:47], a[112:115]
    ds_read_b64_tr_b16 a[80:81], v15 offset:26784
    v_mfma_f32_16x16x32_bf16 a[112:115], a[92:95], a[60:63], a[112:115]
    v_mfma_f32_16x16x32_bf16 a[108:111], a[92:95], a[56:59], a[108:111]
    ds_read_b64_tr_b16 a[82:83], v15 offset:28576
    v_mfma_f32_16x16x32_bf16 a[108:111], a[88:91], a[40:43], a[108:111]
    v_mfma_f32_16x16x32_bf16 a[104:107], a[88:91], a[36:39], a[104:107]
    ds_read_b64_tr_b16 a[84:85], v15 offset:33952
    v_mfma_f32_16x16x32_bf16 a[104:107], a[92:95], a[52:55], a[104:107]
    buffer_load_dwordx4 v10, s[12:15], s48 offen offset:1024 lds
    v_mfma_f32_16x16x32_bf16 a[100:103], a[92:95], a[48:51], a[100:103]
    ds_read_b64_tr_b16 a[86:87], v15 offset:35744
    v_mfma_f32_16x16x32_bf16 a[100:103], a[88:91], a[32:35], a[100:103]
    s_waitcnt lgkmcnt(8)
    v_mfma_f32_16x16x32_bf16 a[116:119], a[64:67], a[32:35], a[116:119]
    ds_read_b64_tr_b16 a[88:89], v15 offset:26816
    v_mfma_f32_16x16x32_bf16 a[116:119], a[68:71], a[48:51], a[116:119]
    ds_read_b64_tr_b16 a[90:91], v15 offset:28608
    v_mfma_f32_16x16x32_bf16 a[120:123], a[68:71], a[52:55], a[120:123]
    ds_read_b64_tr_b16 a[92:93], v15 offset:33984
    v_mfma_f32_16x16x32_bf16 a[120:123], a[64:67], a[36:39], a[120:123]
    ds_read_b64_tr_b16 a[94:95], v15 offset:35776
    v_mfma_f32_16x16x32_bf16 a[124:127], a[64:67], a[40:43], a[124:127]
    v_mfma_f32_16x16x32_bf16 a[124:127], a[68:71], a[56:59], a[124:127]
    v_mfma_f32_16x16x32_bf16 a[128:131], a[68:71], a[60:63], a[128:131]
    buffer_load_dwordx4 v11, s[12:15], s48 offen offset:2048 lds
    v_mfma_f32_16x16x32_bf16 a[128:131], a[64:67], a[44:47], a[128:131]
    s_add_u32 s48, s48, 458752
    s_add_u32 s51, s51, 40960
    s_waitcnt lgkmcnt(8)
    v_mfma_f32_16x16x32_bf16 a[144:147], a[72:75], a[44:47], a[144:147]
    s_cmp_eq_u32 s51, 122880
    s_cselect_b32 s51, 0, s51
    v_mfma_f32_16x16x32_bf16 a[144:147], a[76:79], a[60:63], a[144:147]
    v_mfma_f32_16x16x32_bf16 a[140:143], a[76:79], a[56:59], a[140:143]
    s_waitcnt vmcnt(19) lgkmcnt(0)
    s_barrier
    v_mfma_f32_16x16x32_bf16 a[140:143], a[72:75], a[40:43], a[140:143]
    ds_read_b64_tr_b16 a[64:65], v13 offset:0
    v_mfma_f32_16x16x32_bf16 a[136:139], a[72:75], a[36:39], a[136:139]
    ds_read_b64_tr_b16 a[66:67], v13 offset:1536
    v_mfma_f32_16x16x32_bf16 a[136:139], a[76:79], a[52:55], a[136:139]
    ds_read_b64_tr_b16 a[68:69], v13 offset:6144
    v_mfma_f32_16x16x32_bf16 a[132:135], a[76:79], a[48:51], a[132:135]
    ds_read_b64_tr_b16 a[70:71], v13 offset:7680
    v_mfma_f32_16x16x32_bf16 a[132:135], a[72:75], a[32:35], a[132:135]
    v_mfma_f32_16x16x32_bf16 a[148:151], a[80:83], a[32:35], a[148:151]
    ds_read_b64_tr_b16 a[72:73], v14 offset:0
    v_mfma_f32_16x16x32_bf16 a[148:151], a[84:87], a[48:51], a[148:151]
    buffer_load_dword v16, v17, s[20:23], s57 offen
    s_add_u32 s57, s57, s58
    v_mfma_f32_16x16x32_bf16 a[152:155], a[84:87], a[52:55], a[152:155]
    ds_read_b64_tr_b16 a[74:75], v14 offset:1536
    v_mfma_f32_16x16x32_bf16 a[152:155], a[80:83], a[36:39], a[152:155]
    v_mfma_f32_16x16x32_bf16 a[156:159], a[80:83], a[40:43], a[156:159]
    ds_read_b64_tr_b16 a[76:77], v14 offset:6144
    v_mfma_f32_16x16x32_bf16 a[156:159], a[84:87], a[56:59], a[156:159]
    v_mfma_f32_16x16x32_bf16 a[160:163], a[84:87], a[60:63], a[160:163]
    ds_read_b64_tr_b16 a[78:79], v14 offset:7680
    v_mfma_f32_16x16x32_bf16 a[160:163], a[80:83], a[44:47], a[160:163]
    v_add_u32_e64 v15, s52, v15
    v_mfma_f32_16x16x32_bf16 a[176:179], a[88:91], a[44:47], a[176:179]
    ds_read_b64_tr_b16 a[80:81], v13 offset:64
    v_mfma_f32_16x16x32_bf16 a[176:179], a[92:95], a[60:63], a[176:179]
    v_mfma_f32_16x16x32_bf16 a[172:175], a[92:95], a[56:59], a[172:175]
    ds_read_b64_tr_b16 a[82:83], v13 offset:1600
    v_mfma_f32_16x16x32_bf16 a[172:175], a[88:91], a[40:43], a[172:175]
    v_mfma_f32_16x16x32_bf16 a[168:171], a[88:91], a[36:39], a[168:171]
    ds_read_b64_tr_b16 a[84:85], v13 offset:6208
    v_mfma_f32_16x16x32_bf16 a[168:171], a[92:95], a[52:55], a[168:171]
    v_mfma_f32_16x16x32_bf16 a[164:167], a[92:95], a[48:51], a[164:167]
    ds_read_b64_tr_b16 a[86:87], v13 offset:7744
    v_mfma_f32_16x16x32_bf16 a[164:167], a[88:91], a[32:35], a[164:167]
    s_waitcnt vmcnt(11) lgkmcnt(8)
    v_mfma_f32_16x16x32_bf16 v[20:23], a[64:67], a[0:3], v[20:23]
    ds_read_b64_tr_b16 a[88:89], v14 offset:64
    v_mfma_f32_16x16x32_bf16 v[20:23], a[68:71], a[16:19], v[20:23]
    buffer_load_dwordx4 a[32:35], v12, s[4:7], s46 offen offset:0 sc1
    v_mfma_f32_16x16x32_bf16 v[24:27], a[68:71], a[20:23], v[24:27]
    ds_read_b64_tr_b16 a[90:91], v14 offset:1600
    v_mfma_f32_16x16x32_bf16 v[24:27], a[64:67], a[4:7], v[24:27]
    v_mfma_f32_16x16x32_bf16 v[28:31], a[64:67], a[8:11], v[28:31]
    ds_read_b64_tr_b16 a[92:93], v14 offset:6208
    v_mfma_f32_16x16x32_bf16 v[28:31], a[68:71], a[24:27], v[28:31]
    buffer_load_dwordx4 a[36:39], v12, s[4:7], s46 offen offset:1024 sc1
    v_mfma_f32_16x16x32_bf16 v[32:35], a[68:71], a[28:31], v[32:35]
    ds_read_b64_tr_b16 a[94:95], v14 offset:7744
    v_mfma_f32_16x16x32_bf16 v[32:35], a[64:67], a[12:15], v[32:35]
    s_waitcnt lgkmcnt(8)
    v_mfma_f32_16x16x32_bf16 v[48:51], a[72:75], a[12:15], v[48:51]
    ds_read_b64_tr_b16 a[64:65], v13 offset:128
    v_mfma_f32_16x16x32_bf16 v[48:51], a[76:79], a[28:31], v[48:51]
    v_mfma_f32_16x16x32_bf16 v[44:47], a[76:79], a[24:27], v[44:47]
    ds_read_b64_tr_b16 a[66:67], v13 offset:1664
    v_mfma_f32_16x16x32_bf16 v[44:47], a[72:75], a[8:11], v[44:47]
    v_mfma_f32_16x16x32_bf16 v[40:43], a[72:75], a[4:7], v[40:43]
    ds_read_b64_tr_b16 a[68:69], v13 offset:6272
    v_mfma_f32_16x16x32_bf16 v[40:43], a[76:79], a[20:23], v[40:43]
    buffer_load_dwordx4 a[40:43], v12, s[4:7], s46 offen offset:2048 sc1
    v_mfma_f32_16x16x32_bf16 v[36:39], a[76:79], a[16:19], v[36:39]
    ds_read_b64_tr_b16 a[70:71], v13 offset:7808
    v_mfma_f32_16x16x32_bf16 v[36:39], a[72:75], a[0:3], v[36:39]
    s_waitcnt lgkmcnt(8)
    v_mfma_f32_16x16x32_bf16 v[52:55], a[80:83], a[0:3], v[52:55]
    ds_read_b64_tr_b16 a[72:73], v14 offset:128
    v_mfma_f32_16x16x32_bf16 v[52:55], a[84:87], a[16:19], v[52:55]
    v_mfma_f32_16x16x32_bf16 v[56:59], a[84:87], a[20:23], v[56:59]
    ds_read_b64_tr_b16 a[74:75], v14 offset:1664
    v_mfma_f32_16x16x32_bf16 v[56:59], a[80:83], a[4:7], v[56:59]
    v_mfma_f32_16x16x32_bf16 v[60:63], a[80:83], a[8:11], v[60:63]
    ds_read_b64_tr_b16 a[76:77], v14 offset:6272
    v_mfma_f32_16x16x32_bf16 v[60:63], a[84:87], a[24:27], v[60:63]
    buffer_load_dwordx4 a[44:47], v12, s[4:7], s46 offen offset:3072 sc1
    v_mfma_f32_16x16x32_bf16 v[64:67], a[84:87], a[28:31], v[64:67]
    ds_read_b64_tr_b16 a[78:79], v14 offset:7808
    s_add_u32 s46, s46, 131072
    v_mfma_f32_16x16x32_bf16 v[64:67], a[80:83], a[12:15], v[64:67]
    s_waitcnt lgkmcnt(8)
    v_mfma_f32_16x16x32_bf16 v[80:83], a[88:91], a[12:15], v[80:83]
    ds_read_b64_tr_b16 a[80:81], v15 offset:12288
    v_mfma_f32_16x16x32_bf16 v[80:83], a[92:95], a[28:31], v[80:83]
    v_mfma_f32_16x16x32_bf16 v[76:79], a[92:95], a[24:27], v[76:79]
    ds_read_b64_tr_b16 a[82:83], v15 offset:14080
    v_mfma_f32_16x16x32_bf16 v[76:79], a[88:91], a[8:11], v[76:79]
    v_mfma_f32_16x16x32_bf16 v[72:75], a[88:91], a[4:7], v[72:75]
    ds_read_b64_tr_b16 a[84:85], v15 offset:19456
    v_mfma_f32_16x16x32_bf16 v[72:75], a[92:95], a[20:23], v[72:75]
    buffer_load_dwordx4 a[48:51], v12, s[4:7], s46 offen offset:0 sc1
    v_mfma_f32_16x16x32_bf16 v[68:71], a[92:95], a[16:19], v[68:71]
    ds_read_b64_tr_b16 a[86:87], v15 offset:21248
    v_mfma_f32_16x16x32_bf16 v[68:71], a[88:91], a[0:3], v[68:71]
    s_waitcnt lgkmcnt(8)
    v_mfma_f32_16x16x32_bf16 v[84:87], a[0:3], a[64:67], v[84:87]
    ds_read_b64_tr_b16 a[88:89], v15 offset:12320
    v_mfma_f32_16x16x32_bf16 v[84:87], a[16:19], a[68:71], v[84:87]
    v_mfma_f32_16x16x32_bf16 v[88:91], a[20:23], a[68:71], v[88:91]
    ds_read_b64_tr_b16 a[90:91], v15 offset:14112
    v_mfma_f32_16x16x32_bf16 v[88:91], a[4:7], a[64:67], v[88:91]
    v_mfma_f32_16x16x32_bf16 v[92:95], a[8:11], a[64:67], v[92:95]
    ds_read_b64_tr_b16 a[92:93], v15 offset:19488
    v_mfma_f32_16x16x32_bf16 v[92:95], a[24:27], a[68:71], v[92:95]
    buffer_load_dwordx4 a[52:55], v12, s[4:7], s46 offen offset:1024 sc1
    v_mfma_f32_16x16x32_bf16 v[96:99], a[28:31], a[68:71], v[96:99]
    ds_read_b64_tr_b16 a[94:95], v15 offset:21280
    v_mfma_f32_16x16x32_bf16 v[96:99], a[12:15], a[64:67], v[96:99]
    s_add_u32 s54, s54, 1
    s_waitcnt lgkmcnt(8)
    v_mfma_f32_16x16x32_bf16 v[112:115], a[12:15], a[72:75], v[112:115]
    ds_read_b64_tr_b16 a[64:65], v15 offset:12352
    v_mfma_f32_16x16x32_bf16 v[112:115], a[28:31], a[76:79], v[112:115]
    v_mfma_f32_16x16x32_bf16 v[108:111], a[24:27], a[76:79], v[108:111]
    ds_read_b64_tr_b16 a[66:67], v15 offset:14144
    v_mfma_f32_16x16x32_bf16 v[108:111], a[8:11], a[72:75], v[108:111]
    v_mfma_f32_16x16x32_bf16 v[104:107], a[4:7], a[72:75], v[104:107]
    ds_read_b64_tr_b16 a[68:69], v15 offset:19520
    v_mfma_f32_16x16x32_bf16 v[104:107], a[20:23], a[76:79], v[104:107]
    buffer_load_dwordx4 a[56:59], v12, s[4:7], s46 offen offset:2048 sc1
    v_mfma_f32_16x16x32_bf16 v[100:103], a[16:19], a[76:79], v[100:103]
    ds_read_b64_tr_b16 a[70:71], v15 offset:21312
    v_mfma_f32_16x16x32_bf16 v[100:103], a[0:3], a[72:75], v[100:103]
    s_cmp_eq_u32 s54, 3
    s_cselect_b32 s52, s55, s56
    s_cselect_b32 s54, 0, s54
    s_waitcnt lgkmcnt(8)
    v_mfma_f32_16x16x32_bf16 v[116:119], a[80:83], a[0:3], v[116:119]
    ds_read_b64_tr_b16 a[72:73], v15 offset:12384
    v_mfma_f32_16x16x32_bf16 v[116:119], a[84:87], a[16:19], v[116:119]
    v_mfma_f32_16x16x32_bf16 v[120:123], a[84:87], a[20:23], v[120:123]
    ds_read_b64_tr_b16 a[74:75], v15 offset:14176
    v_mfma_f32_16x16x32_bf16 v[120:123], a[80:83], a[4:7], v[120:123]
    v_mfma_f32_16x16x32_bf16 v[124:127], a[80:83], a[8:11], v[124:127]
    ds_read_b64_tr_b16 a[76:77], v15 offset:19552
    v_mfma_f32_16x16x32_bf16 v[124:127], a[84:87], a[24:27], v[124:127]
    buffer_load_dwordx4 a[60:63], v12, s[4:7], s46 offen offset:3072 sc1
    v_mfma_f32_16x16x32_bf16 v[128:131], a[84:87], a[28:31], v[128:131]
    ds_read_b64_tr_b16 a[78:79], v15 offset:21344
    s_add_u32 s46, s46, 131072
    v_mfma_f32_16x16x32_bf16 v[128:131], a[80:83], a[12:15], v[128:131]
    s_waitcnt lgkmcnt(8)
    v_mfma_f32_16x16x32_bf16 v[144:147], a[88:91], a[12:15], v[144:147]
    ds_read_b64_tr_b16 a[80:81], v15 offset:12416
    v_mfma_f32_16x16x32_bf16 v[144:147], a[92:95], a[28:31], v[144:147]
    v_mfma_f32_16x16x32_bf16 v[140:143], a[92:95], a[24:27], v[140:143]
    ds_read_b64_tr_b16 a[82:83], v15 offset:14208
    v_mfma_f32_16x16x32_bf16 v[140:143], a[88:91], a[8:11], v[140:143]
    v_mfma_f32_16x16x32_bf16 v[136:139], a[88:91], a[4:7], v[136:139]
    ds_read_b64_tr_b16 a[84:85], v15 offset:19584
    s_add_u32 m0, s49, s51
    v_mfma_f32_16x16x32_bf16 v[136:139], a[92:95], a[20:23], v[136:139]
    buffer_load_dwordx4 v2, s[8:11], s47 offen offset:0 lds
    v_mfma_f32_16x16x32_bf16 v[132:135], a[92:95], a[16:19], v[132:135]
    ds_read_b64_tr_b16 a[86:87], v15 offset:21376
    v_mfma_f32_16x16x32_bf16 v[132:135], a[88:91], a[0:3], v[132:135]
    v_add_u32 v13, s52, v13
    s_waitcnt lgkmcnt(8)
    v_mfma_f32_16x16x32_bf16 v[148:151], a[64:67], a[0:3], v[148:151]
    ds_read_b64_tr_b16 a[88:89], v15 offset:12448
    v_mfma_f32_16x16x32_bf16 v[148:151], a[68:71], a[16:19], v[148:151]
    v_mfma_f32_16x16x32_bf16 v[152:155], a[68:71], a[20:23], v[152:155]
    ds_read_b64_tr_b16 a[90:91], v15 offset:14240
    v_mfma_f32_16x16x32_bf16 v[152:155], a[64:67], a[4:7], v[152:155]
    v_mfma_f32_16x16x32_bf16 v[156:159], a[64:67], a[8:11], v[156:159]
    ds_read_b64_tr_b16 a[92:93], v15 offset:19616
    v_mfma_f32_16x16x32_bf16 v[156:159], a[68:71], a[24:27], v[156:159]
    buffer_load_dwordx4 v3, s[8:11], s47 offen offset:1024 lds
    v_mfma_f32_16x16x32_bf16 v[160:163], a[68:71], a[28:31], v[160:163]
    ds_read_b64_tr_b16 a[94:95], v15 offset:21408
    v_mfma_f32_16x16x32_bf16 v[160:163], a[64:67], a[12:15], v[160:163]
    v_add_u32 v14, s52, v14
    s_waitcnt lgkmcnt(8)
    v_mfma_f32_16x16x32_bf16 v[176:179], a[72:75], a[12:15], v[176:179]
    ds_read_b64_tr_b16 a[64:65], v15 offset:12480
    v_mfma_f32_16x16x32_bf16 v[176:179], a[76:79], a[28:31], v[176:179]
    v_mfma_f32_16x16x32_bf16 v[172:175], a[76:79], a[24:27], v[172:175]
    ds_read_b64_tr_b16 a[66:67], v15 offset:14272
    v_mfma_f32_16x16x32_bf16 v[172:175], a[72:75], a[8:11], v[172:175]
    v_mfma_f32_16x16x32_bf16 v[168:171], a[72:75], a[4:7], v[168:171]
    ds_read_b64_tr_b16 a[68:69], v15 offset:19648
    v_mfma_f32_16x16x32_bf16 v[168:171], a[76:79], a[20:23], v[168:171]
    buffer_load_dwordx4 v4, s[8:11], s47 offen offset:2048 lds
    v_mfma_f32_16x16x32_bf16 v[164:167], a[76:79], a[16:19], v[164:167]
    ds_read_b64_tr_b16 a[70:71], v15 offset:21440
    s_add_u32 s47, s47, 393216
    s_add_u32 m0, s50, s51
    v_mfma_f32_16x16x32_bf16 v[164:167], a[72:75], a[0:3], v[164:167]
    s_waitcnt lgkmcnt(8)
    v_mfma_f32_16x16x32_bf16 v[180:183], a[80:83], a[0:3], v[180:183]
    ds_read_b64_tr_b16 a[72:73], v15 offset:26624
    v_mfma_f32_16x16x32_bf16 v[180:183], a[84:87], a[16:19], v[180:183]
    v_mfma_f32_16x16x32_bf16 v[184:187], a[84:87], a[20:23], v[184:187]
    ds_read_b64_tr_b16 a[74:75], v15 offset:28416
    v_mfma_f32_16x16x32_bf16 v[184:187], a[80:83], a[4:7], v[184:187]
    v_mfma_f32_16x16x32_bf16 v[188:191], a[80:83], a[8:11], v[188:191]
    ds_read_b64_tr_b16 a[76:77], v15 offset:33792
    v_mfma_f32_16x16x32_bf16 v[188:191], a[84:87], a[24:27], v[188:191]
    buffer_load_dwordx4 v5, s[12:15], s48 offen offset:0 lds
    v_mfma_f32_16x16x32_bf16 v[192:195], a[84:87], a[28:31], v[192:195]
    ds_read_b64_tr_b16 a[78:79], v15 offset:35584
    v_mfma_f32_16x16x32_bf16 v[192:195], a[80:83], a[12:15], v[192:195]
    s_waitcnt lgkmcnt(8)
    v_mfma_f32_16x16x32_bf16 v[208:211], a[88:91], a[12:15], v[208:211]
    ds_read_b64_tr_b16 a[80:81], v15 offset:26656
    v_mfma_f32_16x16x32_bf16 v[208:211], a[92:95], a[28:31], v[208:211]
    v_mfma_f32_16x16x32_bf16 v[204:207], a[92:95], a[24:27], v[204:207]
    ds_read_b64_tr_b16 a[82:83], v15 offset:28448
    v_mfma_f32_16x16x32_bf16 v[204:207], a[88:91], a[8:11], v[204:207]
    v_mfma_f32_16x16x32_bf16 v[200:203], a[88:91], a[4:7], v[200:203]
    ds_read_b64_tr_b16 a[84:85], v15 offset:33824
    v_mfma_f32_16x16x32_bf16 v[200:203], a[92:95], a[20:23], v[200:203]
    buffer_load_dwordx4 v6, s[12:15], s48 offen offset:1024 lds
    v_mfma_f32_16x16x32_bf16 v[196:199], a[92:95], a[16:19], v[196:199]
    ds_read_b64_tr_b16 a[86:87], v15 offset:35616
    v_mfma_f32_16x16x32_bf16 v[196:199], a[88:91], a[0:3], v[196:199]
    s_waitcnt lgkmcnt(8)
    v_mfma_f32_16x16x32_bf16 v[212:215], a[64:67], a[0:3], v[212:215]
    ds_read_b64_tr_b16 a[88:89], v15 offset:26688
    v_mfma_f32_16x16x32_bf16 v[212:215], a[68:71], a[16:19], v[212:215]
    v_mfma_f32_16x16x32_bf16 v[216:219], a[68:71], a[20:23], v[216:219]
    ds_read_b64_tr_b16 a[90:91], v15 offset:28480
    v_mfma_f32_16x16x32_bf16 v[216:219], a[64:67], a[4:7], v[216:219]
    v_mfma_f32_16x16x32_bf16 v[220:223], a[64:67], a[8:11], v[220:223]
    ds_read_b64_tr_b16 a[92:93], v15 offset:33856
    v_mfma_f32_16x16x32_bf16 v[220:223], a[68:71], a[24:27], v[220:223]
    buffer_load_dwordx4 v7, s[12:15], s48 offen offset:2048 lds
    v_mfma_f32_16x16x32_bf16 v[224:227], a[68:71], a[28:31], v[224:227]
    ds_read_b64_tr_b16 a[94:95], v15 offset:35648
    v_mfma_f32_16x16x32_bf16 v[224:227], a[64:67], a[12:15], v[224:227]
    s_waitcnt lgkmcnt(8)
    v_mfma_f32_16x16x32_bf16 v[240:243], a[72:75], a[12:15], v[240:243]
    ds_read_b64_tr_b16 a[64:65], v15 offset:26720
    v_mfma_f32_16x16x32_bf16 v[240:243], a[76:79], a[28:31], v[240:243]
    v_mfma_f32_16x16x32_bf16 v[236:239], a[76:79], a[24:27], v[236:239]
    ds_read_b64_tr_b16 a[66:67], v15 offset:28512
    v_mfma_f32_16x16x32_bf16 v[236:239], a[72:75], a[8:11], v[236:239]
    v_mfma_f32_16x16x32_bf16 v[232:235], a[72:75], a[4:7], v[232:235]
    ds_read_b64_tr_b16 a[68:69], v15 offset:33888
    v_mfma_f32_16x16x32_bf16 v[232:235], a[76:79], a[20:23], v[232:235]
    buffer_load_dwordx4 v8, s[12:15], s48 offen offset:3072 lds
    v_mfma_f32_16x16x32_bf16 v[228:231], a[76:79], a[16:19], v[228:231]
    ds_read_b64_tr_b16 a[70:71], v15 offset:35680
    s_add_u32 m0, m0, 4096
    v_mfma_f32_16x16x32_bf16 v[228:231], a[72:75], a[0:3], v[228:231]
    s_waitcnt lgkmcnt(8)
    v_mfma_f32_16x16x32_bf16 v[244:247], a[80:83], a[0:3], v[244:247]
    ds_read_b64_tr_b16 a[72:73], v15 offset:26752
    v_mfma_f32_16x16x32_bf16 v[244:247], a[84:87], a[16:19], v[244:247]
    v_mfma_f32_16x16x32_bf16 v[248:251], a[84:87], a[20:23], v[248:251]
    ds_read_b64_tr_b16 a[74:75], v15 offset:28544
    v_mfma_f32_16x16x32_bf16 v[248:251], a[80:83], a[4:7], v[248:251]
    v_mfma_f32_16x16x32_bf16 v[252:255], a[80:83], a[8:11], v[252:255]
    ds_read_b64_tr_b16 a[76:77], v15 offset:33920
    v_mfma_f32_16x16x32_bf16 v[252:255], a[84:87], a[24:27], v[252:255]
    buffer_load_dwordx4 v9, s[12:15], s48 offen offset:0 lds
    v_mfma_f32_16x16x32_bf16 a[96:99], a[84:87], a[28:31], a[96:99]
    ds_read_b64_tr_b16 a[78:79], v15 offset:35712
    v_mfma_f32_16x16x32_bf16 a[96:99], a[80:83], a[12:15], a[96:99]
    s_waitcnt lgkmcnt(8)
    v_mfma_f32_16x16x32_bf16 a[112:115], a[88:91], a[12:15], a[112:115]
    ds_read_b64_tr_b16 a[80:81], v15 offset:26784
    v_mfma_f32_16x16x32_bf16 a[112:115], a[92:95], a[28:31], a[112:115]
    v_mfma_f32_16x16x32_bf16 a[108:111], a[92:95], a[24:27], a[108:111]
    ds_read_b64_tr_b16 a[82:83], v15 offset:28576
    v_mfma_f32_16x16x32_bf16 a[108:111], a[88:91], a[8:11], a[108:111]
    v_mfma_f32_16x16x32_bf16 a[104:107], a[88:91], a[4:7], a[104:107]
    ds_read_b64_tr_b16 a[84:85], v15 offset:33952
    v_mfma_f32_16x16x32_bf16 a[104:107], a[92:95], a[20:23], a[104:107]
    buffer_load_dwordx4 v10, s[12:15], s48 offen offset:1024 lds
    v_mfma_f32_16x16x32_bf16 a[100:103], a[92:95], a[16:19], a[100:103]
    ds_read_b64_tr_b16 a[86:87], v15 offset:35744
    v_mfma_f32_16x16x32_bf16 a[100:103], a[88:91], a[0:3], a[100:103]
    s_waitcnt lgkmcnt(8)
    v_mfma_f32_16x16x32_bf16 a[116:119], a[64:67], a[0:3], a[116:119]
    ds_read_b64_tr_b16 a[88:89], v15 offset:26816
    v_mfma_f32_16x16x32_bf16 a[116:119], a[68:71], a[16:19], a[116:119]
    ds_read_b64_tr_b16 a[90:91], v15 offset:28608
    v_mfma_f32_16x16x32_bf16 a[120:123], a[68:71], a[20:23], a[120:123]
    ds_read_b64_tr_b16 a[92:93], v15 offset:33984
    v_mfma_f32_16x16x32_bf16 a[120:123], a[64:67], a[4:7], a[120:123]
    ds_read_b64_tr_b16 a[94:95], v15 offset:35776
    v_mfma_f32_16x16x32_bf16 a[124:127], a[64:67], a[8:11], a[124:127]
    v_mfma_f32_16x16x32_bf16 a[124:127], a[68:71], a[24:27], a[124:127]
    v_mfma_f32_16x16x32_bf16 a[128:131], a[68:71], a[28:31], a[128:131]
    buffer_load_dwordx4 v11, s[12:15], s48 offen offset:2048 lds
    v_mfma_f32_16x16x32_bf16 a[128:131], a[64:67], a[12:15], a[128:131]
    s_add_u32 s48, s48, 458752
    s_add_u32 s51, s51, 40960
    s_waitcnt lgkmcnt(8)
    v_mfma_f32_16x16x32_bf16 a[144:147], a[72:75], a[12:15], a[144:147]
    s_cmp_eq_u32 s51, 122880
    s_cselect_b32 s51, 0, s51
    v_mfma_f32_16x16x32_bf16 a[144:147], a[76:79], a[28:31], a[144:147]
    v_mfma_f32_16x16x32_bf16 a[140:143], a[76:79], a[24:27], a[140:143]
    s_waitcnt vmcnt(19) lgkmcnt(0)
    s_barrier
    v_mfma_f32_16x16x32_bf16 a[140:143], a[72:75], a[8:11], a[140:143]
    ds_read_b64_tr_b16 a[64:65], v13 offset:0
    v_mfma_f32_16x16x32_bf16 a[136:139], a[72:75], a[4:7], a[136:139]
    ds_read_b64_tr_b16 a[66:67], v13 offset:1536
    v_mfma_f32_16x16x32_bf16 a[136:139], a[76:79], a[20:23], a[136:139]
    ds_read_b64_tr_b16 a[68:69], v13 offset:6144
    v_mfma_f32_16x16x32_bf16 a[132:135], a[76:79], a[16:19], a[132:135]
    ds_read_b64_tr_b16 a[70:71], v13 offset:7680
    v_mfma_f32_16x16x32_bf16 a[132:135], a[72:75], a[0:3], a[132:135]
    v_mfma_f32_16x16x32_bf16 a[148:151], a[80:83], a[0:3], a[148:151]
    ds_read_b64_tr_b16 a[72:73], v14 offset:0
    v_mfma_f32_16x16x32_bf16 a[148:151], a[84:87], a[16:19], a[148:151]
    buffer_load_dword v16, v17, s[20:23], s57 offen
    s_add_u32 s57, s57, s58
    v_mfma_f32_16x16x32_bf16 a[152:155], a[84:87], a[20:23], a[152:155]
    ds_read_b64_tr_b16 a[74:75], v14 offset:1536
    v_mfma_f32_16x16x32_bf16 a[152:155], a[80:83], a[4:7], a[152:155]
    v_mfma_f32_16x16x32_bf16 a[156:159], a[80:83], a[8:11], a[156:159]
    ds_read_b64_tr_b16 a[76:77], v14 offset:6144
    v_mfma_f32_16x16x32_bf16 a[156:159], a[84:87], a[24:27], a[156:159]
    v_mfma_f32_16x16x32_bf16 a[160:163], a[84:87], a[28:31], a[160:163]
    ds_read_b64_tr_b16 a[78:79], v14 offset:7680
    v_mfma_f32_16x16x32_bf16 a[160:163], a[80:83], a[12:15], a[160:163]
    v_add_u32_e64 v15, s52, v15
    v_mfma_f32_16x16x32_bf16 a[176:179], a[88:91], a[12:15], a[176:179]
    ds_read_b64_tr_b16 a[80:81], v13 offset:64
    v_mfma_f32_16x16x32_bf16 a[176:179], a[92:95], a[28:31], a[176:179]
    v_mfma_f32_16x16x32_bf16 a[172:175], a[92:95], a[24:27], a[172:175]
    ds_read_b64_tr_b16 a[82:83], v13 offset:1600
    v_mfma_f32_16x16x32_bf16 a[172:175], a[88:91], a[8:11], a[172:175]
    v_mfma_f32_16x16x32_bf16 a[168:171], a[88:91], a[4:7], a[168:171]
    ds_read_b64_tr_b16 a[84:85], v13 offset:6208
    v_mfma_f32_16x16x32_bf16 a[168:171], a[92:95], a[20:23], a[168:171]
    v_mfma_f32_16x16x32_bf16 a[164:167], a[92:95], a[16:19], a[164:167]
    ds_read_b64_tr_b16 a[86:87], v13 offset:7744
    v_mfma_f32_16x16x32_bf16 a[164:167], a[88:91], a[0:3], a[164:167]
    s_sub_u32 s53, s53, 1
    s_cmp_lg_u32 s53, 0
    s_cbranch_scc1 L_loop_parallel_sum__sliding_block__glu_gated_swiglu__prompt_kernel
    s_waitcnt vmcnt(11) lgkmcnt(8)
    v_mfma_f32_16x16x32_bf16 v[20:23], a[64:67], a[32:35], v[20:23]
    ds_read_b64_tr_b16 a[88:89], v14 offset:64
    v_mfma_f32_16x16x32_bf16 v[20:23], a[68:71], a[48:51], v[20:23]
    buffer_load_dwordx4 a[0:3], v12, s[4:7], s46 offen offset:0 sc1
    v_mfma_f32_16x16x32_bf16 v[24:27], a[68:71], a[52:55], v[24:27]
    ds_read_b64_tr_b16 a[90:91], v14 offset:1600
    v_mfma_f32_16x16x32_bf16 v[24:27], a[64:67], a[36:39], v[24:27]
    v_mfma_f32_16x16x32_bf16 v[28:31], a[64:67], a[40:43], v[28:31]
    ds_read_b64_tr_b16 a[92:93], v14 offset:6208
    v_mfma_f32_16x16x32_bf16 v[28:31], a[68:71], a[56:59], v[28:31]
    buffer_load_dwordx4 a[4:7], v12, s[4:7], s46 offen offset:1024 sc1
    v_mfma_f32_16x16x32_bf16 v[32:35], a[68:71], a[60:63], v[32:35]
    ds_read_b64_tr_b16 a[94:95], v14 offset:7744
    v_mfma_f32_16x16x32_bf16 v[32:35], a[64:67], a[44:47], v[32:35]
    s_waitcnt lgkmcnt(8)
    v_mfma_f32_16x16x32_bf16 v[48:51], a[72:75], a[44:47], v[48:51]
    ds_read_b64_tr_b16 a[64:65], v13 offset:128
    v_mfma_f32_16x16x32_bf16 v[48:51], a[76:79], a[60:63], v[48:51]
    v_mfma_f32_16x16x32_bf16 v[44:47], a[76:79], a[56:59], v[44:47]
    ds_read_b64_tr_b16 a[66:67], v13 offset:1664
    v_mfma_f32_16x16x32_bf16 v[44:47], a[72:75], a[40:43], v[44:47]
    v_mfma_f32_16x16x32_bf16 v[40:43], a[72:75], a[36:39], v[40:43]
    ds_read_b64_tr_b16 a[68:69], v13 offset:6272
    v_mfma_f32_16x16x32_bf16 v[40:43], a[76:79], a[52:55], v[40:43]
    buffer_load_dwordx4 a[8:11], v12, s[4:7], s46 offen offset:2048 sc1
    v_mfma_f32_16x16x32_bf16 v[36:39], a[76:79], a[48:51], v[36:39]
    ds_read_b64_tr_b16 a[70:71], v13 offset:7808
    v_mfma_f32_16x16x32_bf16 v[36:39], a[72:75], a[32:35], v[36:39]
    s_waitcnt lgkmcnt(8)
    v_mfma_f32_16x16x32_bf16 v[52:55], a[80:83], a[32:35], v[52:55]
    ds_read_b64_tr_b16 a[72:73], v14 offset:128
    v_mfma_f32_16x16x32_bf16 v[52:55], a[84:87], a[48:51], v[52:55]
    v_mfma_f32_16x16x32_bf16 v[56:59], a[84:87], a[52:55], v[56:59]
    ds_read_b64_tr_b16 a[74:75], v14 offset:1664
    v_mfma_f32_16x16x32_bf16 v[56:59], a[80:83], a[36:39], v[56:59]
    v_mfma_f32_16x16x32_bf16 v[60:63], a[80:83], a[40:43], v[60:63]
    ds_read_b64_tr_b16 a[76:77], v14 offset:6272
    v_mfma_f32_16x16x32_bf16 v[60:63], a[84:87], a[56:59], v[60:63]
    buffer_load_dwordx4 a[12:15], v12, s[4:7], s46 offen offset:3072 sc1
    v_mfma_f32_16x16x32_bf16 v[64:67], a[84:87], a[60:63], v[64:67]
    ds_read_b64_tr_b16 a[78:79], v14 offset:7808
    s_add_u32 s46, s46, 131072
    v_mfma_f32_16x16x32_bf16 v[64:67], a[80:83], a[44:47], v[64:67]
    s_waitcnt lgkmcnt(8)
    v_mfma_f32_16x16x32_bf16 v[80:83], a[88:91], a[44:47], v[80:83]
    ds_read_b64_tr_b16 a[80:81], v15 offset:12288
    v_mfma_f32_16x16x32_bf16 v[80:83], a[92:95], a[60:63], v[80:83]
    v_mfma_f32_16x16x32_bf16 v[76:79], a[92:95], a[56:59], v[76:79]
    ds_read_b64_tr_b16 a[82:83], v15 offset:14080
    v_mfma_f32_16x16x32_bf16 v[76:79], a[88:91], a[40:43], v[76:79]
    v_mfma_f32_16x16x32_bf16 v[72:75], a[88:91], a[36:39], v[72:75]
    ds_read_b64_tr_b16 a[84:85], v15 offset:19456
    v_mfma_f32_16x16x32_bf16 v[72:75], a[92:95], a[52:55], v[72:75]
    buffer_load_dwordx4 a[16:19], v12, s[4:7], s46 offen offset:0 sc1
    v_mfma_f32_16x16x32_bf16 v[68:71], a[92:95], a[48:51], v[68:71]
    ds_read_b64_tr_b16 a[86:87], v15 offset:21248
    v_mfma_f32_16x16x32_bf16 v[68:71], a[88:91], a[32:35], v[68:71]
    s_waitcnt lgkmcnt(8)
    v_mfma_f32_16x16x32_bf16 v[84:87], a[32:35], a[64:67], v[84:87]
    ds_read_b64_tr_b16 a[88:89], v15 offset:12320
    v_mfma_f32_16x16x32_bf16 v[84:87], a[48:51], a[68:71], v[84:87]
    v_mfma_f32_16x16x32_bf16 v[88:91], a[52:55], a[68:71], v[88:91]
    ds_read_b64_tr_b16 a[90:91], v15 offset:14112
    v_mfma_f32_16x16x32_bf16 v[88:91], a[36:39], a[64:67], v[88:91]
    v_mfma_f32_16x16x32_bf16 v[92:95], a[40:43], a[64:67], v[92:95]
    ds_read_b64_tr_b16 a[92:93], v15 offset:19488
    v_mfma_f32_16x16x32_bf16 v[92:95], a[56:59], a[68:71], v[92:95]
    buffer_load_dwordx4 a[20:23], v12, s[4:7], s46 offen offset:1024 sc1
    v_mfma_f32_16x16x32_bf16 v[96:99], a[60:63], a[68:71], v[96:99]
    ds_read_b64_tr_b16 a[94:95], v15 offset:21280
    v_mfma_f32_16x16x32_bf16 v[96:99], a[44:47], a[64:67], v[96:99]
    s_add_u32 s54, s54, 1
    s_waitcnt lgkmcnt(8)
    v_mfma_f32_16x16x32_bf16 v[112:115], a[44:47], a[72:75], v[112:115]
    ds_read_b64_tr_b16 a[64:65], v15 offset:12352
    v_mfma_f32_16x16x32_bf16 v[112:115], a[60:63], a[76:79], v[112:115]
    v_mfma_f32_16x16x32_bf16 v[108:111], a[56:59], a[76:79], v[108:111]
    ds_read_b64_tr_b16 a[66:67], v15 offset:14144
    v_mfma_f32_16x16x32_bf16 v[108:111], a[40:43], a[72:75], v[108:111]
    v_mfma_f32_16x16x32_bf16 v[104:107], a[36:39], a[72:75], v[104:107]
    ds_read_b64_tr_b16 a[68:69], v15 offset:19520
    v_mfma_f32_16x16x32_bf16 v[104:107], a[52:55], a[76:79], v[104:107]
    buffer_load_dwordx4 a[24:27], v12, s[4:7], s46 offen offset:2048 sc1
    v_mfma_f32_16x16x32_bf16 v[100:103], a[48:51], a[76:79], v[100:103]
    ds_read_b64_tr_b16 a[70:71], v15 offset:21312
    v_mfma_f32_16x16x32_bf16 v[100:103], a[32:35], a[72:75], v[100:103]
    s_cmp_eq_u32 s54, 3
    s_cselect_b32 s52, s55, s56
    s_cselect_b32 s54, 0, s54
    s_waitcnt lgkmcnt(8)
    v_mfma_f32_16x16x32_bf16 v[116:119], a[80:83], a[32:35], v[116:119]
    ds_read_b64_tr_b16 a[72:73], v15 offset:12384
    v_mfma_f32_16x16x32_bf16 v[116:119], a[84:87], a[48:51], v[116:119]
    v_mfma_f32_16x16x32_bf16 v[120:123], a[84:87], a[52:55], v[120:123]
    ds_read_b64_tr_b16 a[74:75], v15 offset:14176
    v_mfma_f32_16x16x32_bf16 v[120:123], a[80:83], a[36:39], v[120:123]
    v_mfma_f32_16x16x32_bf16 v[124:127], a[80:83], a[40:43], v[124:127]
    ds_read_b64_tr_b16 a[76:77], v15 offset:19552
    v_mfma_f32_16x16x32_bf16 v[124:127], a[84:87], a[56:59], v[124:127]
    buffer_load_dwordx4 a[28:31], v12, s[4:7], s46 offen offset:3072 sc1
    v_mfma_f32_16x16x32_bf16 v[128:131], a[84:87], a[60:63], v[128:131]
    ds_read_b64_tr_b16 a[78:79], v15 offset:21344
    s_add_u32 s46, s46, 131072
    v_mfma_f32_16x16x32_bf16 v[128:131], a[80:83], a[44:47], v[128:131]
    s_waitcnt lgkmcnt(8)
    v_mfma_f32_16x16x32_bf16 v[144:147], a[88:91], a[44:47], v[144:147]
    ds_read_b64_tr_b16 a[80:81], v15 offset:12416
    v_mfma_f32_16x16x32_bf16 v[144:147], a[92:95], a[60:63], v[144:147]
    v_mfma_f32_16x16x32_bf16 v[140:143], a[92:95], a[56:59], v[140:143]
    ds_read_b64_tr_b16 a[82:83], v15 offset:14208
    v_mfma_f32_16x16x32_bf16 v[140:143], a[88:91], a[40:43], v[140:143]
    v_mfma_f32_16x16x32_bf16 v[136:139], a[88:91], a[36:39], v[136:139]
    ds_read_b64_tr_b16 a[84:85], v15 offset:19584
    s_add_u32 m0, s49, s51
    v_mfma_f32_16x16x32_bf16 v[136:139], a[92:95], a[52:55], v[136:139]
    buffer_load_dwordx4 v2, s[8:11], s47 offen offset:0 lds
    v_mfma_f32_16x16x32_bf16 v[132:135], a[92:95], a[48:51], v[132:135]
    ds_read_b64_tr_b16 a[86:87], v15 offset:21376
    v_mfma_f32_16x16x32_bf16 v[132:135], a[88:91], a[32:35], v[132:135]
    v_add_u32 v13, s52, v13
    s_waitcnt lgkmcnt(8)
    v_mfma_f32_16x16x32_bf16 v[148:151], a[64:67], a[32:35], v[148:151]
    ds_read_b64_tr_b16 a[88:89], v15 offset:12448
    v_mfma_f32_16x16x32_bf16 v[148:151], a[68:71], a[48:51], v[148:151]
    v_mfma_f32_16x16x32_bf16 v[152:155], a[68:71], a[52:55], v[152:155]
    ds_read_b64_tr_b16 a[90:91], v15 offset:14240
    v_mfma_f32_16x16x32_bf16 v[152:155], a[64:67], a[36:39], v[152:155]
    v_mfma_f32_16x16x32_bf16 v[156:159], a[64:67], a[40:43], v[156:159]
    ds_read_b64_tr_b16 a[92:93], v15 offset:19616
    v_mfma_f32_16x16x32_bf16 v[156:159], a[68:71], a[56:59], v[156:159]
    buffer_load_dwordx4 v3, s[8:11], s47 offen offset:1024 lds
    v_mfma_f32_16x16x32_bf16 v[160:163], a[68:71], a[60:63], v[160:163]
    ds_read_b64_tr_b16 a[94:95], v15 offset:21408
    v_mfma_f32_16x16x32_bf16 v[160:163], a[64:67], a[44:47], v[160:163]
    v_add_u32 v14, s52, v14
    s_waitcnt lgkmcnt(8)
    v_mfma_f32_16x16x32_bf16 v[176:179], a[72:75], a[44:47], v[176:179]
    ds_read_b64_tr_b16 a[64:65], v15 offset:12480
    v_mfma_f32_16x16x32_bf16 v[176:179], a[76:79], a[60:63], v[176:179]
    v_mfma_f32_16x16x32_bf16 v[172:175], a[76:79], a[56:59], v[172:175]
    ds_read_b64_tr_b16 a[66:67], v15 offset:14272
    v_mfma_f32_16x16x32_bf16 v[172:175], a[72:75], a[40:43], v[172:175]
    v_mfma_f32_16x16x32_bf16 v[168:171], a[72:75], a[36:39], v[168:171]
    ds_read_b64_tr_b16 a[68:69], v15 offset:19648
    v_mfma_f32_16x16x32_bf16 v[168:171], a[76:79], a[52:55], v[168:171]
    buffer_load_dwordx4 v4, s[8:11], s47 offen offset:2048 lds
    v_mfma_f32_16x16x32_bf16 v[164:167], a[76:79], a[48:51], v[164:167]
    ds_read_b64_tr_b16 a[70:71], v15 offset:21440
    s_add_u32 s47, s47, 393216
    s_add_u32 m0, s50, s51
    v_mfma_f32_16x16x32_bf16 v[164:167], a[72:75], a[32:35], v[164:167]
    s_waitcnt lgkmcnt(8)
    v_mfma_f32_16x16x32_bf16 v[180:183], a[80:83], a[32:35], v[180:183]
    ds_read_b64_tr_b16 a[72:73], v15 offset:26624
    v_mfma_f32_16x16x32_bf16 v[180:183], a[84:87], a[48:51], v[180:183]
    v_mfma_f32_16x16x32_bf16 v[184:187], a[84:87], a[52:55], v[184:187]
    ds_read_b64_tr_b16 a[74:75], v15 offset:28416
    v_mfma_f32_16x16x32_bf16 v[184:187], a[80:83], a[36:39], v[184:187]
    v_mfma_f32_16x16x32_bf16 v[188:191], a[80:83], a[40:43], v[188:191]
    ds_read_b64_tr_b16 a[76:77], v15 offset:33792
    v_mfma_f32_16x16x32_bf16 v[188:191], a[84:87], a[56:59], v[188:191]
    buffer_load_dwordx4 v5, s[12:15], s48 offen offset:0 lds
    v_mfma_f32_16x16x32_bf16 v[192:195], a[84:87], a[60:63], v[192:195]
    ds_read_b64_tr_b16 a[78:79], v15 offset:35584
    v_mfma_f32_16x16x32_bf16 v[192:195], a[80:83], a[44:47], v[192:195]
    s_waitcnt lgkmcnt(8)
    v_mfma_f32_16x16x32_bf16 v[208:211], a[88:91], a[44:47], v[208:211]
    ds_read_b64_tr_b16 a[80:81], v15 offset:26656
    v_mfma_f32_16x16x32_bf16 v[208:211], a[92:95], a[60:63], v[208:211]
    v_mfma_f32_16x16x32_bf16 v[204:207], a[92:95], a[56:59], v[204:207]
    ds_read_b64_tr_b16 a[82:83], v15 offset:28448
    v_mfma_f32_16x16x32_bf16 v[204:207], a[88:91], a[40:43], v[204:207]
    v_mfma_f32_16x16x32_bf16 v[200:203], a[88:91], a[36:39], v[200:203]
    ds_read_b64_tr_b16 a[84:85], v15 offset:33824
    v_mfma_f32_16x16x32_bf16 v[200:203], a[92:95], a[52:55], v[200:203]
    buffer_load_dwordx4 v6, s[12:15], s48 offen offset:1024 lds
    v_mfma_f32_16x16x32_bf16 v[196:199], a[92:95], a[48:51], v[196:199]
    ds_read_b64_tr_b16 a[86:87], v15 offset:35616
    v_mfma_f32_16x16x32_bf16 v[196:199], a[88:91], a[32:35], v[196:199]
    s_waitcnt lgkmcnt(8)
    v_mfma_f32_16x16x32_bf16 v[212:215], a[64:67], a[32:35], v[212:215]
    ds_read_b64_tr_b16 a[88:89], v15 offset:26688
    v_mfma_f32_16x16x32_bf16 v[212:215], a[68:71], a[48:51], v[212:215]
    v_mfma_f32_16x16x32_bf16 v[216:219], a[68:71], a[52:55], v[216:219]
    ds_read_b64_tr_b16 a[90:91], v15 offset:28480
    v_mfma_f32_16x16x32_bf16 v[216:219], a[64:67], a[36:39], v[216:219]
    v_mfma_f32_16x16x32_bf16 v[220:223], a[64:67], a[40:43], v[220:223]
    ds_read_b64_tr_b16 a[92:93], v15 offset:33856
    v_mfma_f32_16x16x32_bf16 v[220:223], a[68:71], a[56:59], v[220:223]
    buffer_load_dwordx4 v7, s[12:15], s48 offen offset:2048 lds
    v_mfma_f32_16x16x32_bf16 v[224:227], a[68:71], a[60:63], v[224:227]
    ds_read_b64_tr_b16 a[94:95], v15 offset:35648
    v_mfma_f32_16x16x32_bf16 v[224:227], a[64:67], a[44:47], v[224:227]
    s_waitcnt lgkmcnt(8)
    v_mfma_f32_16x16x32_bf16 v[240:243], a[72:75], a[44:47], v[240:243]
    ds_read_b64_tr_b16 a[64:65], v15 offset:26720
    v_mfma_f32_16x16x32_bf16 v[240:243], a[76:79], a[60:63], v[240:243]
    v_mfma_f32_16x16x32_bf16 v[236:239], a[76:79], a[56:59], v[236:239]
    ds_read_b64_tr_b16 a[66:67], v15 offset:28512
    v_mfma_f32_16x16x32_bf16 v[236:239], a[72:75], a[40:43], v[236:239]
    v_mfma_f32_16x16x32_bf16 v[232:235], a[72:75], a[36:39], v[232:235]
    ds_read_b64_tr_b16 a[68:69], v15 offset:33888
    v_mfma_f32_16x16x32_bf16 v[232:235], a[76:79], a[52:55], v[232:235]
    buffer_load_dwordx4 v8, s[12:15], s48 offen offset:3072 lds
    v_mfma_f32_16x16x32_bf16 v[228:231], a[76:79], a[48:51], v[228:231]
    ds_read_b64_tr_b16 a[70:71], v15 offset:35680
    s_add_u32 m0, m0, 4096
    v_mfma_f32_16x16x32_bf16 v[228:231], a[72:75], a[32:35], v[228:231]
    v_accvgpr_read_b32 v3, a206
    s_waitcnt lgkmcnt(8)
    v_mfma_f32_16x16x32_bf16 v[244:247], a[80:83], a[32:35], v[244:247]
    ds_read_b64_tr_b16 a[72:73], v15 offset:26752
    v_mfma_f32_16x16x32_bf16 v[244:247], a[84:87], a[48:51], v[244:247]
    v_mfma_f32_16x16x32_bf16 v[248:251], a[84:87], a[52:55], v[248:251]
    ds_read_b64_tr_b16 a[74:75], v15 offset:28544
    v_mfma_f32_16x16x32_bf16 v[248:251], a[80:83], a[36:39], v[248:251]
    v_mfma_f32_16x16x32_bf16 v[252:255], a[80:83], a[40:43], v[252:255]
    ds_read_b64_tr_b16 a[76:77], v15 offset:33920
    v_mfma_f32_16x16x32_bf16 v[252:255], a[84:87], a[56:59], v[252:255]
    buffer_load_dwordx4 v9, s[12:15], s48 offen offset:0 lds
    v_mfma_f32_16x16x32_bf16 a[96:99], a[84:87], a[60:63], a[96:99]
    ds_read_b64_tr_b16 a[78:79], v15 offset:35712
    v_mfma_f32_16x16x32_bf16 a[96:99], a[80:83], a[44:47], a[96:99]
    v_accvgpr_read_b32 v1, a207
    s_waitcnt lgkmcnt(8)
    v_mfma_f32_16x16x32_bf16 a[112:115], a[88:91], a[44:47], a[112:115]
    ds_read_b64_tr_b16 a[80:81], v15 offset:26784
    v_mfma_f32_16x16x32_bf16 a[112:115], a[92:95], a[60:63], a[112:115]
    v_mfma_f32_16x16x32_bf16 a[108:111], a[92:95], a[56:59], a[108:111]
    ds_read_b64_tr_b16 a[82:83], v15 offset:28576
    v_mfma_f32_16x16x32_bf16 a[108:111], a[88:91], a[40:43], a[108:111]
    v_mfma_f32_16x16x32_bf16 a[104:107], a[88:91], a[36:39], a[104:107]
    ds_read_b64_tr_b16 a[84:85], v15 offset:33952
    v_mfma_f32_16x16x32_bf16 a[104:107], a[92:95], a[52:55], a[104:107]
    buffer_load_dwordx4 v10, s[12:15], s48 offen offset:1024 lds
    v_mfma_f32_16x16x32_bf16 a[100:103], a[92:95], a[48:51], a[100:103]
    ds_read_b64_tr_b16 a[86:87], v15 offset:35744
    v_mfma_f32_16x16x32_bf16 a[100:103], a[88:91], a[32:35], a[100:103]
    v_accvgpr_read_b32 v2, a205
    s_waitcnt lgkmcnt(8)
    v_mfma_f32_16x16x32_bf16 a[116:119], a[64:67], a[32:35], a[116:119]
    ds_read_b64_tr_b16 a[88:89], v15 offset:26816
    v_mfma_f32_16x16x32_bf16 a[116:119], a[68:71], a[48:51], a[116:119]
    ds_read_b64_tr_b16 a[90:91], v15 offset:28608
    v_mfma_f32_16x16x32_bf16 a[120:123], a[68:71], a[52:55], a[120:123]
    ds_read_b64_tr_b16 a[92:93], v15 offset:33984
    v_mfma_f32_16x16x32_bf16 a[120:123], a[64:67], a[36:39], a[120:123]
    ds_read_b64_tr_b16 a[94:95], v15 offset:35776
    v_mfma_f32_16x16x32_bf16 a[124:127], a[64:67], a[40:43], a[124:127]
    v_mfma_f32_16x16x32_bf16 a[124:127], a[68:71], a[56:59], a[124:127]
    v_mfma_f32_16x16x32_bf16 a[128:131], a[68:71], a[60:63], a[128:131]
    buffer_load_dwordx4 v11, s[12:15], s48 offen offset:2048 lds
    v_mfma_f32_16x16x32_bf16 a[128:131], a[64:67], a[44:47], a[128:131]
    s_add_u32 s48, s48, 458752
    s_add_u32 s51, s51, 40960
    s_waitcnt lgkmcnt(8)
    v_mfma_f32_16x16x32_bf16 a[144:147], a[72:75], a[44:47], a[144:147]
    s_cmp_eq_u32 s51, 122880
    s_cselect_b32 s51, 0, s51
    v_mfma_f32_16x16x32_bf16 a[144:147], a[76:79], a[60:63], a[144:147]
    v_mfma_f32_16x16x32_bf16 a[140:143], a[76:79], a[56:59], a[140:143]
    s_waitcnt vmcnt(19) lgkmcnt(0)
    s_barrier
    v_mfma_f32_16x16x32_bf16 a[140:143], a[72:75], a[40:43], a[140:143]
    ds_read_b64_tr_b16 a[64:65], v13 offset:0
    v_mfma_f32_16x16x32_bf16 a[136:139], a[72:75], a[36:39], a[136:139]
    ds_read_b64_tr_b16 a[66:67], v13 offset:1536
    v_mfma_f32_16x16x32_bf16 a[136:139], a[76:79], a[52:55], a[136:139]
    ds_read_b64_tr_b16 a[68:69], v13 offset:6144
    v_mfma_f32_16x16x32_bf16 a[132:135], a[76:79], a[48:51], a[132:135]
    ds_read_b64_tr_b16 a[70:71], v13 offset:7680
    v_mfma_f32_16x16x32_bf16 a[132:135], a[72:75], a[32:35], a[132:135]
    v_mfma_f32_16x16x32_bf16 a[148:151], a[80:83], a[32:35], a[148:151]
    ds_read_b64_tr_b16 a[72:73], v14 offset:0
    v_mfma_f32_16x16x32_bf16 a[148:151], a[84:87], a[48:51], a[148:151]
    buffer_load_dword v1, v1, s[36:39], s3 offen
    v_mfma_f32_16x16x32_bf16 a[152:155], a[84:87], a[52:55], a[152:155]
    ds_read_b64_tr_b16 a[74:75], v14 offset:1536
    v_mfma_f32_16x16x32_bf16 a[152:155], a[80:83], a[36:39], a[152:155]
    buffer_load_dwordx2 v[4:5], v2, s[4:7], s79 offen sc1
    v_mfma_f32_16x16x32_bf16 a[156:159], a[80:83], a[40:43], a[156:159]
    ds_read_b64_tr_b16 a[76:77], v14 offset:6144
    v_mfma_f32_16x16x32_bf16 a[156:159], a[84:87], a[56:59], a[156:159]
    v_mfma_f32_16x16x32_bf16 a[160:163], a[84:87], a[60:63], a[160:163]
    ds_read_b64_tr_b16 a[78:79], v14 offset:7680
    v_mfma_f32_16x16x32_bf16 a[160:163], a[80:83], a[44:47], a[160:163]
    v_add_u32_e64 v15, s52, v15
    v_mfma_f32_16x16x32_bf16 a[176:179], a[88:91], a[44:47], a[176:179]
    ds_read_b64_tr_b16 a[80:81], v13 offset:64
    v_mfma_f32_16x16x32_bf16 a[176:179], a[92:95], a[60:63], a[176:179]
    v_mfma_f32_16x16x32_bf16 a[172:175], a[92:95], a[56:59], a[172:175]
    ds_read_b64_tr_b16 a[82:83], v13 offset:1600
    v_mfma_f32_16x16x32_bf16 a[172:175], a[88:91], a[40:43], a[172:175]
    v_mfma_f32_16x16x32_bf16 a[168:171], a[88:91], a[36:39], a[168:171]
    ds_read_b64_tr_b16 a[84:85], v13 offset:6208
    v_mfma_f32_16x16x32_bf16 a[168:171], a[92:95], a[52:55], a[168:171]
    v_mfma_f32_16x16x32_bf16 a[164:167], a[92:95], a[48:51], a[164:167]
    ds_read_b64_tr_b16 a[86:87], v13 offset:7744
    v_mfma_f32_16x16x32_bf16 a[164:167], a[88:91], a[32:35], a[164:167]
L_tail_parallel_sum__sliding_block__glu_gated_swiglu__prompt_kernel:
    s_waitcnt vmcnt(12) lgkmcnt(8)
    v_mfma_f32_16x16x32_bf16 v[20:23], a[64:67], a[0:3], v[20:23]
    ds_read_b64_tr_b16 a[88:89], v14 offset:64
    v_mfma_f32_16x16x32_bf16 v[20:23], a[68:71], a[16:19], v[20:23]
    buffer_load_dwordx4 a[32:35], v12, s[4:7], s46 offen offset:0 sc1
    v_mfma_f32_16x16x32_bf16 v[24:27], a[68:71], a[20:23], v[24:27]
    ds_read_b64_tr_b16 a[90:91], v14 offset:1600
    v_mfma_f32_16x16x32_bf16 v[24:27], a[64:67], a[4:7], v[24:27]
    v_mfma_f32_16x16x32_bf16 v[28:31], a[64:67], a[8:11], v[28:31]
    ds_read_b64_tr_b16 a[92:93], v14 offset:6208
    v_mfma_f32_16x16x32_bf16 v[28:31], a[68:71], a[24:27], v[28:31]
    buffer_load_dwordx4 a[36:39], v12, s[4:7], s46 offen offset:1024 sc1
    v_mfma_f32_16x16x32_bf16 v[32:35], a[68:71], a[28:31], v[32:35]
    ds_read_b64_tr_b16 a[94:95], v14 offset:7744
    v_mfma_f32_16x16x32_bf16 v[32:35], a[64:67], a[12:15], v[32:35]
    s_waitcnt lgkmcnt(8)
    v_mfma_f32_16x16x32_bf16 v[48:51], a[72:75], a[12:15], v[48:51]
    ds_read_b64_tr_b16 a[64:65], v13 offset:128
    v_mfma_f32_16x16x32_bf16 v[48:51], a[76:79], a[28:31], v[48:51]
    buffer_load_dwordx4 a[40:43], v12, s[4:7], s46 offen offset:2048 sc1
    v_mfma_f32_16x16x32_bf16 v[44:47], a[76:79], a[24:27], v[44:47]
    ds_read_b64_tr_b16 a[66:67], v13 offset:1664
    v_mfma_f32_16x16x32_bf16 v[44:47], a[72:75], a[8:11], v[44:47]
    v_mfma_f32_16x16x32_bf16 v[40:43], a[72:75], a[4:7], v[40:43]
    ds_read_b64_tr_b16 a[68:69], v13 offset:6272
    v_mfma_f32_16x16x32_bf16 v[40:43], a[76:79], a[20:23], v[40:43]
    buffer_load_dwordx4 a[44:47], v12, s[4:7], s46 offen offset:3072 sc1
    s_add_u32 s46, s46, 131072
    v_mfma_f32_16x16x32_bf16 v[36:39], a[76:79], a[16:19], v[36:39]
    ds_read_b64_tr_b16 a[70:71], v13 offset:7808
    v_mfma_f32_16x16x32_bf16 v[36:39], a[72:75], a[0:3], v[36:39]
    s_waitcnt lgkmcnt(8)
    v_mfma_f32_16x16x32_bf16 v[52:55], a[80:83], a[0:3], v[52:55]
    ds_read_b64_tr_b16 a[72:73], v14 offset:128
    v_mfma_f32_16x16x32_bf16 v[52:55], a[84:87], a[16:19], v[52:55]
    buffer_load_dwordx4 a[48:51], v12, s[4:7], s46 offen offset:0 sc1
    v_mfma_f32_16x16x32_bf16 v[56:59], a[84:87], a[20:23], v[56:59]
    ds_read_b64_tr_b16 a[74:75], v14 offset:1664
    v_mfma_f32_16x16x32_bf16 v[56:59], a[80:83], a[4:7], v[56:59]
    v_mfma_f32_16x16x32_bf16 v[60:63], a[80:83], a[8:11], v[60:63]
    ds_read_b64_tr_b16 a[76:77], v14 offset:6272
    v_mfma_f32_16x16x32_bf16 v[60:63], a[84:87], a[24:27], v[60:63]
    buffer_load_dwordx4 a[52:55], v12, s[4:7], s46 offen offset:1024 sc1
    v_mfma_f32_16x16x32_bf16 v[64:67], a[84:87], a[28:31], v[64:67]
    ds_read_b64_tr_b16 a[78:79], v14 offset:7808
    v_mfma_f32_16x16x32_bf16 v[64:67], a[80:83], a[12:15], v[64:67]
    s_waitcnt lgkmcnt(8)
    v_mfma_f32_16x16x32_bf16 v[80:83], a[88:91], a[12:15], v[80:83]
    ds_read_b64_tr_b16 a[80:81], v15 offset:12288
    v_mfma_f32_16x16x32_bf16 v[80:83], a[92:95], a[28:31], v[80:83]
    buffer_load_dwordx4 a[56:59], v12, s[4:7], s46 offen offset:2048 sc1
    v_mfma_f32_16x16x32_bf16 v[76:79], a[92:95], a[24:27], v[76:79]
    ds_read_b64_tr_b16 a[82:83], v15 offset:14080
    v_mfma_f32_16x16x32_bf16 v[76:79], a[88:91], a[8:11], v[76:79]
    v_mfma_f32_16x16x32_bf16 v[72:75], a[88:91], a[4:7], v[72:75]
    ds_read_b64_tr_b16 a[84:85], v15 offset:19456
    v_mfma_f32_16x16x32_bf16 v[72:75], a[92:95], a[20:23], v[72:75]
    buffer_load_dwordx4 a[60:63], v12, s[4:7], s46 offen offset:3072 sc1
    s_add_u32 s46, s46, 131072
    v_mfma_f32_16x16x32_bf16 v[68:71], a[92:95], a[16:19], v[68:71]
    ds_read_b64_tr_b16 a[86:87], v15 offset:21248
    v_mfma_f32_16x16x32_bf16 v[68:71], a[88:91], a[0:3], v[68:71]
    s_waitcnt lgkmcnt(8)
    v_mfma_f32_16x16x32_bf16 v[84:87], a[0:3], a[64:67], v[84:87]
    ds_read_b64_tr_b16 a[88:89], v15 offset:12320
    v_add_u32 v13, s55, v13
    v_mfma_f32_16x16x32_bf16 v[84:87], a[16:19], a[68:71], v[84:87]
    buffer_load_dword v16, v17, s[20:23], s57 offen
    s_add_u32 s57, s57, s58
    v_mfma_f32_16x16x32_bf16 v[88:91], a[20:23], a[68:71], v[88:91]
    ds_read_b64_tr_b16 a[90:91], v15 offset:14112
    v_add_u32 v14, s55, v14
    v_mfma_f32_16x16x32_bf16 v[88:91], a[4:7], a[64:67], v[88:91]
    v_mfma_f32_16x16x32_bf16 v[92:95], a[8:11], a[64:67], v[92:95]
    ds_read_b64_tr_b16 a[92:93], v15 offset:19488
    v_mfma_f32_16x16x32_bf16 v[92:95], a[24:27], a[68:71], v[92:95]
    buffer_load_dword v3, v3, s[28:31], s101 offen
    v_mfma_f32_16x16x32_bf16 v[96:99], a[28:31], a[68:71], v[96:99]
    ds_read_b64_tr_b16 a[94:95], v15 offset:21280
    v_mfma_f32_16x16x32_bf16 v[96:99], a[12:15], a[64:67], v[96:99]
    s_waitcnt lgkmcnt(8)
    v_mfma_f32_16x16x32_bf16 v[112:115], a[12:15], a[72:75], v[112:115]
    ds_read_b64_tr_b16 a[64:65], v15 offset:12352
    v_accvgpr_read_b32 v10, a188
    v_mfma_f32_16x16x32_bf16 v[112:115], a[28:31], a[76:79], v[112:115]
    v_accvgpr_read_b32 v11, a189
    v_accvgpr_read_b32 v6, a180
    v_mfma_f32_16x16x32_bf16 v[108:111], a[24:27], a[76:79], v[108:111]
    ds_read_b64_tr_b16 a[66:67], v15 offset:14144
    v_accvgpr_read_b32 v7, a182
    v_mfma_f32_16x16x32_bf16 v[108:111], a[8:11], a[72:75], v[108:111]
    v_accvgpr_read_b32 v8, a181
    v_accvgpr_read_b32 v9, a183
    v_mfma_f32_16x16x32_bf16 v[104:107], a[4:7], a[72:75], v[104:107]
    ds_read_b64_tr_b16 a[68:69], v15 offset:19520
    s_mov_b32 s46, 3241716283
    v_mfma_f32_16x16x32_bf16 v[104:107], a[20:23], a[76:79], v[104:107]
    s_mov_b32 s47, s46
    s_mov_b32 s48, 1015021568
    v_mfma_f32_16x16x32_bf16 v[100:103], a[16:19], a[76:79], v[100:103]
    ds_read_b64_tr_b16 a[70:71], v15 offset:21312
    s_mov_b32 s49, s48
    v_mfma_f32_16x16x32_bf16 v[100:103], a[0:3], a[72:75], v[100:103]
    s_mov_b32 s50, 1099076590
    s_mov_b32 s51, s50
    s_waitcnt lgkmcnt(8)
    v_mfma_f32_16x16x32_bf16 v[116:119], a[80:83], a[0:3], v[116:119]
    ds_read_b64_tr_b16 a[72:73], v15 offset:12384
    v_mfma_f32_16x16x32_bf16 v[116:119], a[84:87], a[16:19], v[116:119]
    v_mfma_f32_16x16x32_bf16 v[120:123], a[84:87], a[20:23], v[120:123]
    ds_read_b64_tr_b16 a[74:75], v15 offset:14176
    v_mfma_f32_16x16x32_bf16 v[120:123], a[80:83], a[4:7], v[120:123]
    v_mfma_f32_16x16x32_bf16 v[124:127], a[80:83], a[8:11], v[124:127]
    ds_read_b64_tr_b16 a[76:77], v15 offset:19552
    v_mfma_f32_16x16x32_bf16 v[124:127], a[84:87], a[24:27], v[124:127]
    v_mfma_f32_16x16x32_bf16 v[128:131], a[84:87], a[28:31], v[128:131]
    ds_read_b64_tr_b16 a[78:79], v15 offset:21344
    v_mfma_f32_16x16x32_bf16 v[128:131], a[80:83], a[12:15], v[128:131]
    s_waitcnt vmcnt(12)
    s_barrier
    s_waitcnt lgkmcnt(8)
    v_mfma_f32_16x16x32_bf16 v[144:147], a[88:91], a[12:15], v[144:147]
    ds_read_b64_tr_b16 a[80:81], v13 offset:64
    v_mfma_f32_16x16x32_bf16 v[144:147], a[92:95], a[28:31], v[144:147]
    v_mfma_f32_16x16x32_bf16 v[140:143], a[92:95], a[24:27], v[140:143]
    ds_read_b64_tr_b16 a[82:83], v13 offset:1600
    v_mfma_f32_16x16x32_bf16 v[140:143], a[88:91], a[8:11], v[140:143]
    v_mfma_f32_16x16x32_bf16 v[136:139], a[88:91], a[4:7], v[136:139]
    ds_read_b64_tr_b16 a[84:85], v13 offset:6208
    v_mfma_f32_16x16x32_bf16 v[136:139], a[92:95], a[20:23], v[136:139]
    v_mfma_f32_16x16x32_bf16 v[132:135], a[92:95], a[16:19], v[132:135]
    ds_read_b64_tr_b16 a[86:87], v13 offset:7744
    v_mfma_f32_16x16x32_bf16 v[132:135], a[88:91], a[0:3], v[132:135]
    s_waitcnt lgkmcnt(8)
    v_mfma_f32_16x16x32_bf16 v[148:151], a[64:67], a[0:3], v[148:151]
    ds_read_b64_tr_b16 a[88:89], v14 offset:64
    v_mfma_f32_16x16x32_bf16 v[148:151], a[68:71], a[16:19], v[148:151]
    v_mfma_f32_16x16x32_bf16 v[152:155], a[68:71], a[20:23], v[152:155]
    ds_read_b64_tr_b16 a[90:91], v14 offset:1600
    v_mfma_f32_16x16x32_bf16 v[152:155], a[64:67], a[4:7], v[152:155]
    v_mfma_f32_16x16x32_bf16 v[156:159], a[64:67], a[8:11], v[156:159]
    ds_read_b64_tr_b16 a[92:93], v14 offset:6208
    v_mfma_f32_16x16x32_bf16 v[156:159], a[68:71], a[24:27], v[156:159]
    v_mfma_f32_16x16x32_bf16 v[160:163], a[68:71], a[28:31], v[160:163]
    ds_read_b64_tr_b16 a[94:95], v14 offset:7744
    v_mfma_f32_16x16x32_bf16 v[160:163], a[64:67], a[12:15], v[160:163]
    s_waitcnt lgkmcnt(8)
    v_mfma_f32_16x16x32_bf16 v[176:179], a[72:75], a[12:15], v[176:179]
    ds_read_b64_tr_b16 a[64:65], v13 offset:128
    v_mfma_f32_16x16x32_bf16 v[176:179], a[76:79], a[28:31], v[176:179]
    v_mfma_f32_16x16x32_bf16 v[172:175], a[76:79], a[24:27], v[172:175]
    ds_read_b64_tr_b16 a[66:67], v13 offset:1664
    v_mfma_f32_16x16x32_bf16 v[172:175], a[72:75], a[8:11], v[172:175]
    v_mfma_f32_16x16x32_bf16 v[168:171], a[72:75], a[4:7], v[168:171]
    ds_read_b64_tr_b16 a[68:69], v13 offset:6272
    v_mfma_f32_16x16x32_bf16 v[168:171], a[76:79], a[20:23], v[168:171]
    v_mfma_f32_16x16x32_bf16 v[164:167], a[76:79], a[16:19], v[164:167]
    ds_read_b64_tr_b16 a[70:71], v13 offset:7808
    v_mfma_f32_16x16x32_bf16 v[164:167], a[72:75], a[0:3], v[164:167]
    s_waitcnt vmcnt(2) lgkmcnt(8)
    v_mfma_f32_16x16x32_bf16 v[52:55], a[80:83], a[32:35], v[52:55]
    ds_read_b64_tr_b16 a[72:73], v14 offset:128
    v_mfma_f32_16x16x32_bf16 v[52:55], a[84:87], a[48:51], v[52:55]
    v_mfma_f32_16x16x32_bf16 v[56:59], a[84:87], a[52:55], v[56:59]
    ds_read_b64_tr_b16 a[74:75], v14 offset:1664
    v_mfma_f32_16x16x32_bf16 v[56:59], a[80:83], a[36:39], v[56:59]
    v_mfma_f32_16x16x32_bf16 v[60:63], a[80:83], a[40:43], v[60:63]
    ds_read_b64_tr_b16 a[76:77], v14 offset:6272
    v_mfma_f32_16x16x32_bf16 v[60:63], a[84:87], a[56:59], v[60:63]
    v_mfma_f32_16x16x32_bf16 v[64:67], a[84:87], a[60:63], v[64:67]
    ds_read_b64_tr_b16 a[78:79], v14 offset:7808
    v_mfma_f32_16x16x32_bf16 v[64:67], a[80:83], a[44:47], v[64:67]
    s_waitcnt lgkmcnt(8)
    v_mfma_f32_16x16x32_bf16 v[80:83], a[88:91], a[44:47], v[80:83]
    ds_read_b64_tr_b16 a[80:81], v15 offset:12416
    v_mfma_f32_16x16x32_bf16 v[80:83], a[92:95], a[60:63], v[80:83]
    v_mfma_f32_16x16x32_bf16 v[76:79], a[92:95], a[56:59], v[76:79]
    ds_read_b64_tr_b16 a[82:83], v15 offset:14208
    v_mfma_f32_16x16x32_bf16 v[76:79], a[88:91], a[40:43], v[76:79]
    v_mfma_f32_16x16x32_bf16 v[72:75], a[88:91], a[36:39], v[72:75]
    ds_read_b64_tr_b16 a[84:85], v15 offset:19584
    v_mfma_f32_16x16x32_bf16 v[72:75], a[92:95], a[52:55], v[72:75]
    v_mfma_f32_16x16x32_bf16 v[68:71], a[92:95], a[48:51], v[68:71]
    ds_read_b64_tr_b16 a[86:87], v15 offset:21376
    v_mfma_f32_16x16x32_bf16 v[68:71], a[88:91], a[32:35], v[68:71]
    s_waitcnt lgkmcnt(8)
    v_mfma_f32_16x16x32_bf16 v[84:87], a[32:35], a[64:67], v[84:87]
    ds_read_b64_tr_b16 a[88:89], v15 offset:12448
    v_mfma_f32_16x16x32_bf16 v[84:87], a[48:51], a[68:71], v[84:87]
    v_mfma_f32_16x16x32_bf16 v[88:91], a[52:55], a[68:71], v[88:91]
    ds_read_b64_tr_b16 a[90:91], v15 offset:14240
    v_mfma_f32_16x16x32_bf16 v[88:91], a[36:39], a[64:67], v[88:91]
    v_mfma_f32_16x16x32_bf16 v[92:95], a[40:43], a[64:67], v[92:95]
    ds_read_b64_tr_b16 a[92:93], v15 offset:19616
    v_mfma_f32_16x16x32_bf16 v[92:95], a[56:59], a[68:71], v[92:95]
    v_mfma_f32_16x16x32_bf16 v[96:99], a[60:63], a[68:71], v[96:99]
    ds_read_b64_tr_b16 a[94:95], v15 offset:21408
    v_mfma_f32_16x16x32_bf16 v[96:99], a[44:47], a[64:67], v[96:99]
    s_waitcnt lgkmcnt(8)
    v_mfma_f32_16x16x32_bf16 v[112:115], a[44:47], a[72:75], v[112:115]
    ds_read_b64_tr_b16 a[64:65], v15 offset:12480
    v_cvt_pk_bf16_f32 v52, v52, v53
    v_mfma_f32_16x16x32_bf16 v[112:115], a[60:63], a[76:79], v[112:115]
    v_cvt_pk_bf16_f32 v53, v54, v55
    v_cvt_pk_bf16_f32 v54, v68, v69
    v_mfma_f32_16x16x32_bf16 v[108:111], a[56:59], a[76:79], v[108:111]
    ds_read_b64_tr_b16 a[66:67], v15 offset:14272
    v_cvt_pk_bf16_f32 v55, v70, v71
    v_mfma_f32_16x16x32_bf16 v[108:111], a[40:43], a[72:75], v[108:111]
    v_cvt_pk_bf16_f32 v56, v56, v57
    v_cvt_pk_bf16_f32 v57, v58, v59
    v_mfma_f32_16x16x32_bf16 v[104:107], a[36:39], a[72:75], v[104:107]
    ds_read_b64_tr_b16 a[68:69], v15 offset:19648
    v_cvt_pk_bf16_f32 v58, v72, v73
    v_mfma_f32_16x16x32_bf16 v[104:107], a[52:55], a[76:79], v[104:107]
    buffer_store_dwordx4 v[52:55], v12, s[4:7], s67 offen offset:0 sc1
    v_mfma_f32_16x16x32_bf16 v[100:103], a[48:51], a[76:79], v[100:103]
    ds_read_b64_tr_b16 a[70:71], v15 offset:21440
    v_cvt_pk_bf16_f32 v59, v74, v75
    v_mfma_f32_16x16x32_bf16 v[100:103], a[32:35], a[72:75], v[100:103]
    v_cvt_pk_bf16_f32 v60, v60, v61
    v_cvt_pk_bf16_f32 v61, v62, v63
    s_waitcnt lgkmcnt(8)
    v_mfma_f32_16x16x32_bf16 v[180:183], a[80:83], a[0:3], v[180:183]
    ds_read_b64_tr_b16 a[72:73], v15 offset:26624
    v_cvt_pk_bf16_f32 v62, v76, v77
    v_mfma_f32_16x16x32_bf16 v[180:183], a[84:87], a[16:19], v[180:183]
    v_cvt_pk_bf16_f32 v63, v78, v79
    v_cvt_pk_bf16_f32 v64, v64, v65
    v_mfma_f32_16x16x32_bf16 v[184:187], a[84:87], a[20:23], v[184:187]
    ds_read_b64_tr_b16 a[74:75], v15 offset:28416
    v_cvt_pk_bf16_f32 v65, v66, v67
    v_mfma_f32_16x16x32_bf16 v[184:187], a[80:83], a[4:7], v[184:187]
    v_cvt_pk_bf16_f32 v66, v80, v81
    v_cvt_pk_bf16_f32 v67, v82, v83
    v_mfma_f32_16x16x32_bf16 v[188:191], a[80:83], a[8:11], v[188:191]
    ds_read_b64_tr_b16 a[76:77], v15 offset:33792
    v_mfma_f32_16x16x32_bf16 v[188:191], a[84:87], a[24:27], v[188:191]
    v_mfma_f32_16x16x32_bf16 v[192:195], a[84:87], a[28:31], v[192:195]
    ds_read_b64_tr_b16 a[78:79], v15 offset:35584
    v_mfma_f32_16x16x32_bf16 v[192:195], a[80:83], a[12:15], v[192:195]
    s_waitcnt lgkmcnt(8)
    v_mfma_f32_16x16x32_bf16 v[208:211], a[88:91], a[12:15], v[208:211]
    ds_read_b64_tr_b16 a[80:81], v15 offset:26656
    v_cvt_pk_bf16_f32 v84, v84, v85
    v_mfma_f32_16x16x32_bf16 v[208:211], a[92:95], a[28:31], v[208:211]
    buffer_store_dwordx4 v[56:59], v12, s[4:7], s67 offen offset:1024 sc1
    v_mfma_f32_16x16x32_bf16 v[204:207], a[92:95], a[24:27], v[204:207]
    ds_read_b64_tr_b16 a[82:83], v15 offset:28448
    v_cvt_pk_bf16_f32 v85, v86, v87
    v_mfma_f32_16x16x32_bf16 v[204:207], a[88:91], a[8:11], v[204:207]
    v_cvt_pk_bf16_f32 v86, v88, v89
    v_cvt_pk_bf16_f32 v87, v90, v91
    v_mfma_f32_16x16x32_bf16 v[200:203], a[88:91], a[4:7], v[200:203]
    ds_read_b64_tr_b16 a[84:85], v15 offset:33824
    v_cvt_pk_bf16_f32 v100, v100, v101
    v_mfma_f32_16x16x32_bf16 v[200:203], a[92:95], a[20:23], v[200:203]
    v_cvt_pk_bf16_f32 v101, v102, v103
    v_cvt_pk_bf16_f32 v102, v104, v105
    v_mfma_f32_16x16x32_bf16 v[196:199], a[92:95], a[16:19], v[196:199]
    ds_read_b64_tr_b16 a[86:87], v15 offset:35616
    v_cvt_pk_bf16_f32 v103, v106, v107
    v_mfma_f32_16x16x32_bf16 v[196:199], a[88:91], a[0:3], v[196:199]
    v_cvt_pk_bf16_f32 v92, v92, v93
    v_cvt_pk_bf16_f32 v93, v94, v95
    s_waitcnt lgkmcnt(8)
    v_mfma_f32_16x16x32_bf16 v[212:215], a[64:67], a[0:3], v[212:215]
    ds_read_b64_tr_b16 a[88:89], v15 offset:26688
    v_cvt_pk_bf16_f32 v94, v96, v97
    v_mfma_f32_16x16x32_bf16 v[212:215], a[68:71], a[16:19], v[212:215]
    v_cvt_pk_bf16_f32 v95, v98, v99
    v_cvt_pk_bf16_f32 v108, v108, v109
    v_mfma_f32_16x16x32_bf16 v[216:219], a[68:71], a[20:23], v[216:219]
    ds_read_b64_tr_b16 a[90:91], v15 offset:28480
    v_cvt_pk_bf16_f32 v109, v110, v111
    v_mfma_f32_16x16x32_bf16 v[216:219], a[64:67], a[4:7], v[216:219]
    v_cvt_pk_bf16_f32 v110, v112, v113
    v_cvt_pk_bf16_f32 v111, v114, v115
    v_mfma_f32_16x16x32_bf16 v[220:223], a[64:67], a[8:11], v[220:223]
    ds_read_b64_tr_b16 a[92:93], v15 offset:33856
    v_mfma_f32_16x16x32_bf16 v[220:223], a[68:71], a[24:27], v[220:223]
    buffer_store_dwordx4 v[60:63], v12, s[4:7], s67 offen offset:2048 sc1
    v_mfma_f32_16x16x32_bf16 v[224:227], a[68:71], a[28:31], v[224:227]
    ds_read_b64_tr_b16 a[94:95], v15 offset:35648
    v_mfma_f32_16x16x32_bf16 v[224:227], a[64:67], a[12:15], v[224:227]
    s_waitcnt lgkmcnt(8)
    v_mfma_f32_16x16x32_bf16 v[240:243], a[72:75], a[12:15], v[240:243]
    ds_read_b64_tr_b16 a[64:65], v15 offset:26720
    v_mfma_f32_16x16x32_bf16 v[240:243], a[76:79], a[28:31], v[240:243]
    v_mfma_f32_16x16x32_bf16 v[236:239], a[76:79], a[24:27], v[236:239]
    ds_read_b64_tr_b16 a[66:67], v15 offset:28512
    v_mfma_f32_16x16x32_bf16 v[236:239], a[72:75], a[8:11], v[236:239]
    v_mfma_f32_16x16x32_bf16 v[232:235], a[72:75], a[4:7], v[232:235]
    ds_read_b64_tr_b16 a[68:69], v15 offset:33888
    v_mfma_f32_16x16x32_bf16 v[232:235], a[76:79], a[20:23], v[232:235]
    v_mfma_f32_16x16x32_bf16 v[228:231], a[76:79], a[16:19], v[228:231]
    ds_read_b64_tr_b16 a[70:71], v15 offset:35680
    v_mfma_f32_16x16x32_bf16 v[228:231], a[72:75], a[0:3], v[228:231]
    s_waitcnt lgkmcnt(8)
    v_mfma_f32_16x16x32_bf16 v[244:247], a[80:83], a[0:3], v[244:247]
    ds_read_b64_tr_b16 a[72:73], v15 offset:26752
    v_mfma_f32_16x16x32_bf16 v[244:247], a[84:87], a[16:19], v[244:247]
    buffer_store_dwordx4 v[64:67], v12, s[4:7], s67 offen offset:3072 sc1
    v_mfma_f32_16x16x32_bf16 v[248:251], a[84:87], a[20:23], v[248:251]
    ds_read_b64_tr_b16 a[74:75], v15 offset:28544
    v_mfma_f32_16x16x32_bf16 v[248:251], a[80:83], a[4:7], v[248:251]
    v_mfma_f32_16x16x32_bf16 v[252:255], a[80:83], a[8:11], v[252:255]
    ds_read_b64_tr_b16 a[76:77], v15 offset:33920
    v_mfma_f32_16x16x32_bf16 v[252:255], a[84:87], a[24:27], v[252:255]
    v_mfma_f32_16x16x32_bf16 a[96:99], a[84:87], a[28:31], a[96:99]
    ds_read_b64_tr_b16 a[78:79], v15 offset:35712
    v_mfma_f32_16x16x32_bf16 a[96:99], a[80:83], a[12:15], a[96:99]
    s_waitcnt lgkmcnt(8)
    v_mfma_f32_16x16x32_bf16 a[112:115], a[88:91], a[12:15], a[112:115]
    ds_read_b64_tr_b16 a[80:81], v15 offset:26784
    v_mfma_f32_16x16x32_bf16 a[112:115], a[92:95], a[28:31], a[112:115]
    v_mfma_f32_16x16x32_bf16 a[108:111], a[92:95], a[24:27], a[108:111]
    ds_read_b64_tr_b16 a[82:83], v15 offset:28576
    v_mfma_f32_16x16x32_bf16 a[108:111], a[88:91], a[8:11], a[108:111]
    v_mfma_f32_16x16x32_bf16 a[104:107], a[88:91], a[4:7], a[104:107]
    ds_read_b64_tr_b16 a[84:85], v15 offset:33952
    v_mfma_f32_16x16x32_bf16 a[104:107], a[92:95], a[20:23], a[104:107]
    buffer_store_dwordx4 v[84:87], v12, s[4:7], s68 offen offset:0 sc1
    v_mfma_f32_16x16x32_bf16 a[100:103], a[92:95], a[16:19], a[100:103]
    ds_read_b64_tr_b16 a[86:87], v15 offset:35744
    v_mfma_f32_16x16x32_bf16 a[100:103], a[88:91], a[0:3], a[100:103]
    v_cmp_ne_u64 vcc, s[64:65], v[4:5]
    s_cmp_eq_u64 vcc, 0
    s_cbranch_scc1 L_cnt_ok_parallel_sum__sliding_block__glu_gated_swiglu__prompt_kernel
L_cnt_parallel_sum__sliding_block__glu_gated_swiglu__prompt_kernel:
    s_add_u32 s1, s1, 1
    s_cmp_gt_u32 s1, 0x400000
    s_cbranch_scc1 L_end_parallel_sum__sliding_block__glu_gated_swiglu__prompt_kernel
    buffer_load_dwordx2 v[4:5], v2, s[4:7], s79 offen sc1
    s_waitcnt vmcnt(0)
    v_cmp_ne_u64 vcc, s[64:65], v[4:5]
    s_cmp_eq_u64 vcc, 0
    s_cbranch_scc0 L_cnt_parallel_sum__sliding_block__glu_gated_swiglu__prompt_kernel
L_cnt_ok_parallel_sum__sliding_block__glu_gated_swiglu__prompt_kernel:
    s_waitcnt lgkmcnt(8)
    v_mfma_f32_16x16x32_bf16 a[116:119], a[64:67], a[0:3], a[116:119]
    ds_read_b64_tr_b16 a[88:89], v15 offset:26816
    v_mfma_f32_16x16x32_bf16 a[116:119], a[68:71], a[16:19], a[116:119]
    v_mfma_f32_16x16x32_bf16 a[120:123], a[68:71], a[20:23], a[120:123]
    ds_read_b64_tr_b16 a[90:91], v15 offset:28608
    v_mfma_f32_16x16x32_bf16 a[120:123], a[64:67], a[4:7], a[120:123]
    v_mfma_f32_16x16x32_bf16 a[124:127], a[64:67], a[8:11], a[124:127]
    ds_read_b64_tr_b16 a[92:93], v15 offset:33984
    v_mfma_f32_16x16x32_bf16 a[124:127], a[68:71], a[24:27], a[124:127]
    v_mfma_f32_16x16x32_bf16 a[128:131], a[68:71], a[28:31], a[128:131]
    ds_read_b64_tr_b16 a[94:95], v15 offset:35776
    v_mfma_f32_16x16x32_bf16 a[128:131], a[64:67], a[12:15], a[128:131]
    s_waitcnt lgkmcnt(8)
    v_mfma_f32_16x16x32_bf16 a[144:147], a[72:75], a[12:15], a[144:147]
    ds_read_b64_tr_b16 a[64:65], v13 offset:0
    v_add_u32 v15, s55, v15
    v_mfma_f32_16x16x32_bf16 a[144:147], a[76:79], a[28:31], a[144:147]
    buffer_store_dwordx4 v[100:103], v12, s[4:7], s68 offen offset:1024 sc1
    v_mfma_f32_16x16x32_bf16 a[140:143], a[76:79], a[24:27], a[140:143]
    ds_read_b64_tr_b16 a[66:67], v13 offset:1536
    v_mfma_f32_16x16x32_bf16 a[140:143], a[72:75], a[8:11], a[140:143]
    v_mfma_f32_16x16x32_bf16 a[136:139], a[72:75], a[4:7], a[136:139]
    ds_read_b64_tr_b16 a[68:69], v13 offset:6144
    v_mfma_f32_16x16x32_bf16 a[136:139], a[76:79], a[20:23], a[136:139]
    v_mfma_f32_16x16x32_bf16 a[132:135], a[76:79], a[16:19], a[132:135]
    ds_read_b64_tr_b16 a[70:71], v13 offset:7680
    v_mfma_f32_16x16x32_bf16 a[132:135], a[72:75], a[0:3], a[132:135]
    s_waitcnt lgkmcnt(8)
    v_mfma_f32_16x16x32_bf16 a[148:151], a[80:83], a[0:3], a[148:151]
    ds_read_b64_tr_b16 a[72:73], v14 offset:0
    v_mfma_f32_16x16x32_bf16 a[148:151], a[84:87], a[16:19], a[148:151]
    v_mfma_f32_16x16x32_bf16 a[152:155], a[84:87], a[20:23], a[152:155]
    ds_read_b64_tr_b16 a[74:75], v14 offset:1536
    v_mfma_f32_16x16x32_bf16 a[152:155], a[80:83], a[4:7], a[152:155]
    v_mfma_f32_16x16x32_bf16 a[156:159], a[80:83], a[8:11], a[156:159]
    ds_read_b64_tr_b16 a[76:77], v14 offset:6144
    v_mfma_f32_16x16x32_bf16 a[156:159], a[84:87], a[24:27], a[156:159]
    buffer_store_dwordx4 v[92:95], v12, s[4:7], s68 offen offset:2048 sc1
    v_mfma_f32_16x16x32_bf16 a[160:163], a[84:87], a[28:31], a[160:163]
    ds_read_b64_tr_b16 a[78:79], v14 offset:7680
    v_mfma_f32_16x16x32_bf16 a[160:163], a[80:83], a[12:15], a[160:163]
    s_waitcnt lgkmcnt(8)
    s_barrier
    v_mfma_f32_16x16x32_bf16 a[176:179], a[88:91], a[12:15], a[176:179]
    ds_read_b64_tr_b16 a[80:81], v15 offset:12288
    v_mov_b32 v14, 0
    v_mfma_f32_16x16x32_bf16 a[176:179], a[92:95], a[28:31], a[176:179]
    v_mov_b32_e64 v17, 1
    v_accvgpr_read_b32 v13, a192
    v_mfma_f32_16x16x32_bf16 a[172:175], a[92:95], a[24:27], a[172:175]
    ds_read_b64_tr_b16 a[82:83], v15 offset:14080
    v_accvgpr_read_b32 v2, a184
    v_mfma_f32_16x16x32_bf16 a[172:175], a[88:91], a[8:11], a[172:175]
    ds_write_b32 v13, a191
    v_mfma_f32_16x16x32_bf16 a[168:171], a[88:91], a[4:7], a[168:171]
    ds_read_b64_tr_b16 a[84:85], v15 offset:19456
    s_waitcnt vmcnt(7)
    v_accvgpr_read_b32 v3, a185
    v_mfma_f32_16x16x32_bf16 a[168:171], a[92:95], a[20:23], a[168:171]
    ds_write_b128 v10, v[52:55] offset:16384
    v_mfma_f32_16x16x32_bf16 a[164:167], a[92:95], a[16:19], a[164:167]
    ds_read_b64_tr_b16 a[86:87], v15 offset:21248
    v_accvgpr_read_b32 v4, a186
    v_mfma_f32_16x16x32_bf16 a[164:167], a[88:91], a[0:3], a[164:167]
    ds_write_b128 v10, v[56:59] offset:17408
    s_waitcnt lgkmcnt(11)
    v_mfma_f32_16x16x32_bf16 v[20:23], a[64:67], a[32:35], v[20:23]
    ds_read_b64_tr_b16 a[88:89], v15 offset:26624
    v_accvgpr_read_b32 v5, a187
    v_mfma_f32_16x16x32_bf16 v[20:23], a[68:71], a[48:51], v[20:23]
    buffer_store_dwordx4 v[108:111], v12, s[4:7], s68 offen offset:3072 sc1
    v_mfma_f32_16x16x32_bf16 v[24:27], a[68:71], a[52:55], v[24:27]
    ds_read_b64_tr_b16 a[90:91], v15 offset:28416
    v_mfma_f32_16x16x32_bf16 v[24:27], a[64:67], a[36:39], v[24:27]
    ds_write_b128 v10, v[60:63] offset:18432
    v_mfma_f32_16x16x32_bf16 v[28:31], a[64:67], a[40:43], v[28:31]
    ds_read_b64_tr_b16 a[92:93], v15 offset:33792
    v_mfma_f32_16x16x32_bf16 v[28:31], a[68:71], a[56:59], v[28:31]
    ds_write_b128 v10, v[64:67] offset:19456
    v_mfma_f32_16x16x32_bf16 v[32:35], a[68:71], a[60:63], v[32:35]
    ds_read_b64_tr_b16 a[94:95], v15 offset:35584
    v_mfma_f32_16x16x32_bf16 v[32:35], a[64:67], a[44:47], v[32:35]
    ds_write_b128 v11, v[84:87] offset:16384
    s_waitcnt lgkmcnt(14)
    v_mfma_f32_16x16x32_bf16 v[48:51], a[72:75], a[44:47], v[48:51]
    ds_read_b64_tr_b16 a[64:65], v15 offset:12320
    v_mfma_f32_16x16x32_bf16 v[48:51], a[76:79], a[60:63], v[48:51]
    ds_write_b128 v11, v[100:103] offset:17408
    v_mfma_f32_16x16x32_bf16 v[44:47], a[76:79], a[56:59], v[44:47]
    ds_read_b64_tr_b16 a[66:67], v15 offset:14112
    v_mfma_f32_16x16x32_bf16 v[44:47], a[72:75], a[40:43], v[44:47]
    ds_write_b128 v11, v[92:95] offset:18432
    v_mfma_f32_16x16x32_bf16 v[40:43], a[72:75], a[36:39], v[40:43]
    ds_read_b64_tr_b16 a[68:69], v15 offset:19488
    v_mfma_f32_16x16x32_bf16 v[40:43], a[76:79], a[52:55], v[40:43]
    ds_write_b128 v11, v[108:111] offset:19456
    v_mfma_f32_16x16x32_bf16 v[36:39], a[76:79], a[48:51], v[36:39]
    ds_read_b64_tr_b16 a[70:71], v15 offset:21280
    v_mfma_f32_16x16x32_bf16 v[36:39], a[72:75], a[32:35], v[36:39]
    s_waitcnt lgkmcnt(15)
    v_mfma_f32_16x16x32_bf16 v[116:119], a[80:83], a[32:35], v[116:119]
    ds_read_b64_tr_b16 a[72:73], v15 offset:26656
    v_mfma_f32_16x16x32_bf16 v[116:119], a[84:87], a[48:51], v[116:119]
    v_mfma_f32_16x16x32_bf16 v[120:123], a[84:87], a[52:55], v[120:123]
    ds_read_b64_tr_b16 a[74:75], v15 offset:28448
    v_mfma_f32_16x16x32_bf16 v[120:123], a[80:83], a[36:39], v[120:123]
    v_mfma_f32_16x16x32_bf16 v[124:127], a[80:83], a[40:43], v[124:127]
    ds_read_b64_tr_b16 a[76:77], v15 offset:33824
    v_mfma_f32_16x16x32_bf16 v[124:127], a[84:87], a[56:59], v[124:127]
    v_mfma_f32_16x16x32_bf16 v[128:131], a[84:87], a[60:63], v[128:131]
    ds_read_b64_tr_b16 a[78:79], v15 offset:35616
    v_mfma_f32_16x16x32_bf16 v[128:131], a[80:83], a[44:47], v[128:131]
    s_waitcnt lgkmcnt(12)
    v_mfma_f32_16x16x32_bf16 v[240:243], a[88:91], a[44:47], v[240:243]
    ds_read_b64_tr_b16 a[80:81], v15 offset:12352
    v_cvt_pk_bf16_f32 v20, v20, v21
    v_mfma_f32_16x16x32_bf16 v[240:243], a[92:95], a[60:63], v[240:243]
    v_cvt_pk_bf16_f32 v21, v22, v23
    v_cvt_pk_bf16_f32 v22, v36, v37
    v_mfma_f32_16x16x32_bf16 v[236:239], a[92:95], a[56:59], v[236:239]
    ds_read_b64_tr_b16 a[82:83], v15 offset:14144
    v_cvt_pk_bf16_f32 v23, v38, v39
    v_mfma_f32_16x16x32_bf16 v[236:239], a[88:91], a[40:43], v[236:239]
    v_cvt_pk_bf16_f32 v24, v24, v25
    v_cvt_pk_bf16_f32 v25, v26, v27
    v_mfma_f32_16x16x32_bf16 v[232:235], a[88:91], a[36:39], v[232:235]
    ds_read_b64_tr_b16 a[84:85], v15 offset:19520
    v_cvt_pk_bf16_f32 v26, v40, v41
    v_mfma_f32_16x16x32_bf16 v[232:235], a[92:95], a[52:55], v[232:235]
    v_cvt_pk_bf16_f32 v27, v42, v43
    v_cvt_pk_bf16_f32 v28, v28, v29
    v_mfma_f32_16x16x32_bf16 v[228:231], a[92:95], a[48:51], v[228:231]
    ds_read_b64_tr_b16 a[86:87], v15 offset:21312
    v_cvt_pk_bf16_f32 v29, v30, v31
    v_mfma_f32_16x16x32_bf16 v[228:231], a[88:91], a[32:35], v[228:231]
    v_cvt_pk_bf16_f32 v30, v44, v45
    v_cvt_pk_bf16_f32 v31, v46, v47
    s_waitcnt lgkmcnt(8)
    v_mfma_f32_16x16x32_bf16 v[144:147], a[64:67], a[44:47], v[144:147]
    ds_read_b64_tr_b16 a[88:89], v15 offset:26688
    v_cvt_pk_bf16_f32 v32, v32, v33
    v_mfma_f32_16x16x32_bf16 v[144:147], a[68:71], a[60:63], v[144:147]
    v_cvt_pk_bf16_f32 v33, v34, v35
    v_cvt_pk_bf16_f32 v34, v48, v49
    v_mfma_f32_16x16x32_bf16 v[140:143], a[68:71], a[56:59], v[140:143]
    ds_read_b64_tr_b16 a[90:91], v15 offset:28480
    v_cvt_pk_bf16_f32 v35, v50, v51
    v_mfma_f32_16x16x32_bf16 v[140:143], a[64:67], a[40:43], v[140:143]
    v_mov_b32 v46, s64
    v_mov_b32 v47, s65
    v_mfma_f32_16x16x32_bf16 v[136:139], a[64:67], a[36:39], v[136:139]
    ds_read_b64_tr_b16 a[92:93], v15 offset:33856
    v_lshlrev_b32 v45, 3, v12
    v_mfma_f32_16x16x32_bf16 v[136:139], a[68:71], a[52:55], v[136:139]
    v_accvgpr_read_b32 v36, a201
    v_xor_b32 v37, 32, v36
    v_mfma_f32_16x16x32_bf16 v[132:135], a[68:71], a[48:51], v[132:135]
    ds_read_b64_tr_b16 a[94:95], v15 offset:35648
    v_xor_b32_e64 v38, 64, v36
    v_mfma_f32_16x16x32_bf16 v[132:135], a[64:67], a[32:35], v[132:135]
    v_xor_b32 v39, 96, v36
    v_xor_b32 v40, 128, v36
    s_waitcnt lgkmcnt(8)
    v_mfma_f32_16x16x32_bf16 v[244:247], a[72:75], a[32:35], v[244:247]
    ds_read_b64_tr_b16 a[64:65], v15 offset:12384
    v_xor_b32 v41, 160, v36
    v_mfma_f32_16x16x32_bf16 v[244:247], a[76:79], a[48:51], v[244:247]
    v_xor_b32 v42, 192, v36
    v_xor_b32 v43, 224, v36
    v_mfma_f32_16x16x32_bf16 v[248:251], a[76:79], a[52:55], v[248:251]
    ds_read_b64_tr_b16 a[66:67], v15 offset:14176
    v_accvgpr_read_b32 v44, a202
    v_mfma_f32_16x16x32_bf16 v[248:251], a[72:75], a[36:39], v[248:251]
    v_accvgpr_read_b32 v49, a204
    v_accvgpr_read_b32 v50, a203
    v_mfma_f32_16x16x32_bf16 v[252:255], a[72:75], a[40:43], v[252:255]
    ds_read_b64_tr_b16 a[68:69], v15 offset:19552
    v_mfma_f32_16x16x32_bf16 v[252:255], a[76:79], a[56:59], v[252:255]
    v_mfma_f32_16x16x32_bf16 a[96:99], a[76:79], a[60:63], a[96:99]
    ds_read_b64_tr_b16 a[70:71], v15 offset:21344
    v_mfma_f32_16x16x32_bf16 a[96:99], a[72:75], a[44:47], a[96:99]
    s_waitcnt lgkmcnt(8)
    v_pk_mul_f32 v[68:69], v[116:117], s[46:47]
    v_pk_mul_f32 v[70:71], v[118:119], s[46:47]
    v_pk_mul_f32 v[76:77], v[132:133], s[46:47]
    v_pk_mul_f32 v[78:79], v[134:135], s[46:47]
    ds_read_b64_tr_b16 a[72:73], v15 offset:26720
    v_exp_f32 v68, v68
    v_mfma_f32_16x16x32_bf16 v[148:151], a[80:83], a[32:35], v[148:151]
    v_exp_f32 v69, v69
    v_mfma_f32_16x16x32_bf16 v[148:151], a[84:87], a[48:51], v[148:151]
    v_exp_f32 v70, v70
    v_mfma_f32_16x16x32_bf16 v[152:155], a[84:87], a[52:55], v[152:155]
    v_exp_f32 v71, v71
    v_mfma_f32_16x16x32_bf16 v[152:155], a[80:83], a[36:39], v[152:155]
    ds_read_b64_tr_b16 a[74:75], v15 offset:28512
    v_exp_f32 v76, v76
    v_exp_f32 v77, v77
    v_exp_f32 v78, v78
    v_exp_f32 v79, v79
    ds_read_b64_tr_b16 a[76:77], v15 offset:33888
    v_pk_mul_f32 v[72:73], v[116:117], v[228:229]
    v_pk_mul_f32 v[74:75], v[118:119], v[230:231]
    v_pk_fma_f32 v[68:69], v[68:69], s[48:49], s[48:49]
    v_pk_fma_f32 v[70:71], v[70:71], s[48:49], s[48:49]
    ds_read_b64_tr_b16 a[78:79], v15 offset:35680
    v_pk_mul_f32 v[80:81], v[132:133], v[244:245]
    v_pk_mul_f32 v[82:83], v[134:135], v[246:247]
    v_pk_fma_f32 v[76:77], v[76:77], s[48:49], s[48:49]
    v_pk_fma_f32 v[78:79], v[78:79], s[48:49], s[48:49]
    s_add_u32 m0, s66, 49152
    s_nop 0
    buffer_load_dwordx4 v6, s[24:27], s75 offen offset:0 lds
    v_rcp_f32 v68, v68
    v_mfma_f32_16x16x32_bf16 v[156:159], a[80:83], a[40:43], v[156:159]
    v_rcp_f32 v69, v69
    v_mfma_f32_16x16x32_bf16 v[156:159], a[84:87], a[56:59], v[156:159]
    v_rcp_f32 v70, v70
    v_mfma_f32_16x16x32_bf16 v[160:163], a[84:87], a[60:63], v[160:163]
    v_rcp_f32 v71, v71
    v_mfma_f32_16x16x32_bf16 v[160:163], a[80:83], a[44:47], v[160:163]
    buffer_load_dwordx4 v7, s[24:27], s75 offen offset:1024 lds
    v_rcp_f32 v76, v76
    v_rcp_f32 v77, v77
    v_rcp_f32 v78, v78
    v_rcp_f32_e64 v79, v79
    buffer_load_dwordx4 v8, s[24:27], s75 offen offset:2048 lds
    v_pk_mul_f32 v[72:73], v[72:73], v[68:69]
    v_pk_mul_f32 v[74:75], v[74:75], v[70:71]
    v_pk_mul_f32 v[80:81], v[80:81], v[76:77]
    v_pk_mul_f32 v[82:83], v[82:83], v[78:79]
    v_cvt_pk_bf16_f32 v116, v72, v73
    v_cvt_pk_bf16_f32 v117, v74, v75
    v_cvt_pk_bf16_f32 v118, v80, v81
    v_cvt_pk_bf16_f32 v119, v82, v83
    buffer_load_dwordx4 v9, s[24:27], s75 offen offset:3072 lds
    s_add_u32 s75, s75, 131072
    s_waitcnt vmcnt(4)
    s_mov_b64 exec, 1
    buffer_store_dword v17, v14, s[4:7], s69 offen offset:0 sc1
    s_mov_b64 exec, -1
    s_mov_b64 exec, 1
    buffer_store_dwordx2 v[46:47], v14, s[4:7], s80 offen sc1
    s_mov_b64 exec, -1
    s_lshl_b32 s60, s40, 2
    s_lshl_b32 s61, s40, 13
    s_cmp_eq_u32 s42, 0
    s_cselect_b32 s59, s60, 4096
    s_cselect_b32 s61, s61, 1048576
    s_cmp_eq_u32 s42, 0
    s_cselect_b32 s62, 0, 1024
    s_cselect_b32 s63, 48, 63
    s_cmp_eq_u32 s42, 0
    s_cselect_b32 s68, 2147483632, s68
    s_cselect_b32 s60, 0, 1048576
    s_sub_u32 s69, s69, s59
    s_sub_u32 s67, s67, s61
    s_sub_u32 s68, s68, s60
    v_and_b32 v45, s63, v0
    v_lshlrev_b32 v45, 4, v45
    s_waitcnt lgkmcnt(8)
    s_nop 0
    v_pk_mul_f32 v[68:69], v[120:121], s[46:47]
    v_pk_mul_f32 v[70:71], v[122:123], s[46:47]
    v_pk_mul_f32 v[76:77], v[136:137], s[46:47]
    v_pk_mul_f32 v[78:79], v[138:139], s[46:47]
    ds_read_b64_tr_b16 a[80:81], v15 offset:12480
    v_exp_f32 v68, v68
    v_mfma_f32_16x16x32_bf16 a[112:115], a[88:91], a[44:47], a[112:115]
    v_exp_f32 v69, v69
    v_mfma_f32_16x16x32_bf16 a[112:115], a[92:95], a[60:63], a[112:115]
    v_exp_f32 v70, v70
    v_mfma_f32_16x16x32_bf16 a[108:111], a[92:95], a[56:59], a[108:111]
    v_exp_f32 v71, v71
    v_mfma_f32_16x16x32_bf16 a[108:111], a[88:91], a[40:43], a[108:111]
    ds_read_b64_tr_b16 a[82:83], v15 offset:14272
    v_exp_f32 v76, v76
    v_exp_f32 v77, v77
    v_exp_f32 v78, v78
    v_exp_f32 v79, v79
    ds_read_b64_tr_b16 a[84:85], v15 offset:19648
    v_pk_mul_f32 v[72:73], v[120:121], v[232:233]
    v_pk_mul_f32 v[74:75], v[122:123], v[234:235]
    v_pk_fma_f32 v[68:69], v[68:69], s[48:49], s[48:49]
    v_pk_fma_f32 v[70:71], v[70:71], s[48:49], s[48:49]
    ds_read_b64_tr_b16 a[86:87], v15 offset:21440
    v_pk_mul_f32 v[80:81], v[136:137], v[248:249]
    v_pk_mul_f32 v[82:83], v[138:139], v[250:251]
    v_pk_fma_f32 v[76:77], v[76:77], s[48:49], s[48:49]
    v_pk_fma_f32 v[78:79], v[78:79], s[48:49], s[48:49]
    v_rcp_f32 v68, v68
    v_mfma_f32_16x16x32_bf16 a[104:107], a[88:91], a[36:39], a[104:107]
    v_rcp_f32 v69, v69
    v_mfma_f32_16x16x32_bf16 a[104:107], a[92:95], a[52:55], a[104:107]
    v_rcp_f32_e64 v70, v70
    v_mfma_f32_16x16x32_bf16 a[100:103], a[92:95], a[48:51], a[100:103]
    v_rcp_f32 v71, v71
    v_mfma_f32_16x16x32_bf16 a[100:103], a[88:91], a[32:35], a[100:103]
    v_rcp_f32 v76, v76
    v_rcp_f32 v77, v77
    v_rcp_f32 v78, v78
    v_rcp_f32_e64 v79, v79
    v_pk_mul_f32 v[72:73], v[72:73], v[68:69]
    v_pk_mul_f32 v[74:75], v[74:75], v[70:71]
    v_pk_mul_f32 v[80:81], v[80:81], v[76:77]
    v_pk_mul_f32 v[82:83], v[82:83], v[78:79]
    v_cvt_pk_bf16_f32 v120, v72, v73
    v_cvt_pk_bf16_f32 v121, v74, v75
    v_cvt_pk_bf16_f32 v122, v80, v81
    v_cvt_pk_bf16_f32 v123, v82, v83
    s_waitcnt lgkmcnt(8)
    v_pk_mul_f32 v[68:69], v[124:125], s[46:47]
    v_pk_mul_f32 v[70:71], v[126:127], s[46:47]
    v_pk_mul_f32 v[76:77], v[140:141], s[46:47]
    v_pk_mul_f32 v[78:79], v[142:143], s[46:47]
    ds_read_b64_tr_b16 a[88:89], v15 offset:26816
    v_exp_f32 v68, v68
    v_mfma_f32_16x16x32_bf16 v[176:179], a[64:67], a[44:47], v[176:179]
    v_exp_f32 v69, v69
    v_mfma_f32_16x16x32_bf16 v[176:179], a[68:71], a[60:63], v[176:179]
    v_exp_f32 v70, v70
    v_mfma_f32_16x16x32_bf16 v[172:175], a[68:71], a[56:59], v[172:175]
    v_exp_f32_e64 v71, v71
    v_mfma_f32_16x16x32_bf16 v[172:175], a[64:67], a[40:43], v[172:175]
    ds_read_b64_tr_b16 a[90:91], v15 offset:28608
    v_exp_f32 v76, v76
    v_exp_f32 v77, v77
    v_exp_f32 v78, v78
    v_exp_f32 v79, v79
    ds_read_b64_tr_b16 a[92:93], v15 offset:33984
    v_pk_mul_f32 v[72:73], v[124:125], v[236:237]
    v_pk_mul_f32 v[74:75], v[126:127], v[238:239]
    v_pk_fma_f32 v[68:69], v[68:69], s[48:49], s[48:49]
    v_pk_fma_f32 v[70:71], v[70:71], s[48:49], s[48:49]
    ds_read_b64_tr_b16 a[94:95], v15 offset:35776
    v_pk_mul_f32 v[80:81], v[140:141], v[252:253]
    v_pk_mul_f32 v[82:83], v[142:143], v[254:255]
    v_pk_fma_f32 v[76:77], v[76:77], s[48:49], s[48:49]
    v_pk_fma_f32 v[78:79], v[78:79], s[48:49], s[48:49]
    v_rcp_f32 v68, v68
    v_mfma_f32_16x16x32_bf16 v[168:171], a[64:67], a[36:39], v[168:171]
    v_rcp_f32 v69, v69
    v_mfma_f32_16x16x32_bf16 v[168:171], a[68:71], a[52:55], v[168:171]
    v_rcp_f32 v70, v70
    v_mfma_f32_16x16x32_bf16 v[164:167], a[68:71], a[48:51], v[164:167]
    v_rcp_f32 v71, v71
    v_mfma_f32_16x16x32_bf16 v[164:167], a[64:67], a[32:35], v[164:167]
    v_rcp_f32 v76, v76
    v_rcp_f32 v77, v77
    v_rcp_f32 v78, v78
    v_rcp_f32 v79, v79
    v_pk_mul_f32 v[72:73], v[72:73], v[68:69]
    v_pk_mul_f32 v[74:75], v[74:75], v[70:71]
    v_pk_mul_f32 v[80:81], v[80:81], v[76:77]
    v_pk_mul_f32 v[82:83], v[82:83], v[78:79]
    v_cvt_pk_bf16_f32 v124, v72, v73
    v_cvt_pk_bf16_f32 v125, v74, v75
    v_cvt_pk_bf16_f32 v126, v80, v81
    v_cvt_pk_bf16_f32 v127, v82, v83
    buffer_load_dword v13, v14, s[4:7], s69 offen sc1
    s_waitcnt lgkmcnt(8)
    s_nop 0
    v_pk_mul_f32 v[68:69], v[128:129], s[46:47]
    v_pk_mul_f32 v[70:71], v[130:131], s[46:47]
    v_pk_mul_f32 v[76:77], v[144:145], s[46:47]
    v_pk_mul_f32 v[78:79], v[146:147], s[46:47]
    ds_read_b64_tr_b16 a[64:65], v15 offset:12416
    v_exp_f32 v68, v68
    v_mfma_f32_16x16x32_bf16 a[116:119], a[72:75], a[32:35], a[116:119]
    v_exp_f32 v69, v69
    v_mfma_f32_16x16x32_bf16 a[116:119], a[76:79], a[48:51], a[116:119]
    v_exp_f32 v70, v70
    v_mfma_f32_16x16x32_bf16 a[120:123], a[76:79], a[52:55], a[120:123]
    v_exp_f32 v71, v71
    v_mfma_f32_16x16x32_bf16 a[120:123], a[72:75], a[36:39], a[120:123]
    ds_read_b64_tr_b16 a[66:67], v15 offset:14208
    v_exp_f32 v76, v76
    v_exp_f32 v77, v77
    v_exp_f32 v78, v78
    v_exp_f32 v79, v79
    ds_read_b64_tr_b16 a[68:69], v15 offset:19584
    v_pk_mul_f32 v[72:73], v[128:129], v[240:241]
    v_pk_mul_f32 v[74:75], v[130:131], v[242:243]
    v_pk_fma_f32 v[68:69], v[68:69], s[48:49], s[48:49]
    v_pk_fma_f32 v[70:71], v[70:71], s[48:49], s[48:49]
    ds_read_b64_tr_b16 a[70:71], v15 offset:21376
    v_accvgpr_read_b32 v80, a96
    v_accvgpr_read_b32 v81, a97
    v_accvgpr_read_b32 v82, a98
    v_accvgpr_read_b32 v83, a99
    v_pk_mul_f32 v[80:81], v[144:145], v[80:81]
    v_pk_mul_f32 v[82:83], v[146:147], v[82:83]
    v_pk_fma_f32 v[76:77], v[76:77], s[48:49], s[48:49]
    v_pk_fma_f32 v[78:79], v[78:79], s[48:49], s[48:49]
    v_rcp_f32 v68, v68
    v_mfma_f32_16x16x32_bf16 a[124:127], a[72:75], a[40:43], a[124:127]
    v_rcp_f32 v69, v69
    v_mfma_f32_16x16x32_bf16 a[124:127], a[76:79], a[56:59], a[124:127]
    v_rcp_f32_e64 v70, v70
    v_mfma_f32_16x16x32_bf16 a[128:131], a[76:79], a[60:63], a[128:131]
    v_rcp_f32 v71, v71
    v_mfma_f32_16x16x32_bf16 a[128:131], a[72:75], a[44:47], a[128:131]
    v_rcp_f32 v76, v76
    v_rcp_f32 v77, v77
    v_rcp_f32 v78, v78
    v_rcp_f32_e64 v79, v79
    v_pk_mul_f32 v[72:73], v[72:73], v[68:69]
    v_pk_mul_f32 v[74:75], v[74:75], v[70:71]
    v_pk_mul_f32 v[80:81], v[80:81], v[76:77]
    v_pk_mul_f32 v[82:83], v[82:83], v[78:79]
    v_cvt_pk_bf16_f32 v128, v72, v73
    v_cvt_pk_bf16_f32 v129, v74, v75
    v_cvt_pk_bf16_f32 v130, v80, v81
    v_cvt_pk_bf16_f32 v131, v82, v83
    s_waitcnt lgkmcnt(8)
    v_pk_mul_f32 v[68:69], v[148:149], s[46:47]
    v_pk_mul_f32 v[70:71], v[150:151], s[46:47]
    v_pk_mul_f32 v[76:77], v[164:165], s[46:47]
    v_pk_mul_f32 v[78:79], v[166:167], s[46:47]
    ds_read_b64_tr_b16 a[72:73], v15 offset:26752
    v_exp_f32 v68, v68
    v_mfma_f32_16x16x32_bf16 v[212:215], a[80:83], a[32:35], v[212:215]
    v_exp_f32 v69, v69
    v_mfma_f32_16x16x32_bf16 v[212:215], a[84:87], a[48:51], v[212:215]
    v_exp_f32 v70, v70
    v_mfma_f32_16x16x32_bf16 v[216:219], a[84:87], a[52:55], v[216:219]
    v_exp_f32_e64 v71, v71
    v_mfma_f32_16x16x32_bf16 v[216:219], a[80:83], a[36:39], v[216:219]
    ds_read_b64_tr_b16 a[74:75], v15 offset:28544
    v_exp_f32 v76, v76
    v_exp_f32 v77, v77
    v_exp_f32 v78, v78
    v_exp_f32 v79, v79
    ds_read_b64_tr_b16 a[76:77], v15 offset:33920
    v_accvgpr_read_b32 v72, a100
    v_accvgpr_read_b32 v73, a101
    v_accvgpr_read_b32 v74, a102
    v_accvgpr_read_b32 v75, a103
    v_pk_mul_f32 v[72:73], v[148:149], v[72:73]
    v_pk_mul_f32 v[74:75], v[150:151], v[74:75]
    v_pk_fma_f32 v[68:69], v[68:69], s[48:49], s[48:49]
    v_pk_fma_f32 v[70:71], v[70:71], s[48:49], s[48:49]
    ds_read_b64_tr_b16 a[78:79], v15 offset:35712
    v_accvgpr_read_b32 v80, a116
    v_accvgpr_read_b32 v81, a117
    v_accvgpr_read_b32 v82, a118
    v_accvgpr_read_b32 v83, a119
    v_pk_mul_f32 v[80:81], v[164:165], v[80:81]
    v_pk_mul_f32 v[82:83], v[166:167], v[82:83]
    v_pk_fma_f32 v[76:77], v[76:77], s[48:49], s[48:49]
    v_pk_fma_f32 v[78:79], v[78:79], s[48:49], s[48:49]
    v_rcp_f32 v68, v68
    v_mfma_f32_16x16x32_bf16 v[220:223], a[80:83], a[40:43], v[220:223]
    v_rcp_f32 v69, v69
    v_mfma_f32_16x16x32_bf16 v[220:223], a[84:87], a[56:59], v[220:223]
    v_rcp_f32 v70, v70
    v_mfma_f32_16x16x32_bf16 v[224:227], a[84:87], a[60:63], v[224:227]
    v_rcp_f32 v71, v71
    v_mfma_f32_16x16x32_bf16 v[224:227], a[80:83], a[44:47], v[224:227]
    v_rcp_f32 v76, v76
    v_rcp_f32 v77, v77
    v_rcp_f32 v78, v78
    v_rcp_f32 v79, v79
    v_pk_mul_f32 v[72:73], v[72:73], v[68:69]
    v_pk_mul_f32 v[74:75], v[74:75], v[70:71]
    v_pk_mul_f32 v[80:81], v[80:81], v[76:77]
    v_pk_mul_f32 v[82:83], v[82:83], v[78:79]
    v_cvt_pk_bf16_f32 v148, v72, v73
    v_cvt_pk_bf16_f32 v149, v74, v75
    v_cvt_pk_bf16_f32 v150, v80, v81
    v_cvt_pk_bf16_f32 v151, v82, v83
    s_waitcnt vmcnt(0)
    v_readfirstlane_b32 s59, v13
    s_cmp_eq_u32 s59, 1
    s_cbranch_scc1 L_kv_ok_parallel_sum__sliding_block__glu_gated_swiglu__prompt_kernel
L_kv_parallel_sum__sliding_block__glu_gated_swiglu__prompt_kernel:
    s_add_u32 s1, s1, 1
    s_cmp_gt_u32 s1, 0x400000
    s_cbranch_scc1 L_end_parallel_sum__sliding_block__glu_gated_swiglu__prompt_kernel
    buffer_load_dword v13, v14, s[4:7], s69 offen sc1
    s_waitcnt vmcnt(0)
    v_readfirstlane_b32 s59, v13
    s_cmp_eq_u32 s59, 1
    s_cbranch_scc0 L_kv_parallel_sum__sliding_block__glu_gated_swiglu__prompt_kernel
L_kv_ok_parallel_sum__sliding_block__glu_gated_swiglu__prompt_kernel:
    s_waitcnt lgkmcnt(8)
    v_pk_mul_f32 v[68:69], v[152:153], s[46:47]
    v_pk_mul_f32 v[70:71], v[154:155], s[46:47]
    v_pk_mul_f32 v[76:77], v[168:169], s[46:47]
    v_pk_mul_f32 v[78:79], v[170:171], s[46:47]
    ds_read_b64_tr_b16 a[80:81], v15 offset:12448
    v_exp_f32 v68, v68
    v_mfma_f32_16x16x32_bf16 a[176:179], a[88:91], a[44:47], a[176:179]
    v_exp_f32 v69, v69
    v_mfma_f32_16x16x32_bf16 a[176:179], a[92:95], a[60:63], a[176:179]
    v_exp_f32 v70, v70
    v_mfma_f32_16x16x32_bf16 a[172:175], a[92:95], a[56:59], a[172:175]
    v_exp_f32_e64 v71, v71
    v_mfma_f32_16x16x32_bf16 a[172:175], a[88:91], a[40:43], a[172:175]
    ds_read_b64_tr_b16 a[82:83], v15 offset:14240
    v_exp_f32 v76, v76
    v_exp_f32 v77, v77
    v_exp_f32 v78, v78
    v_exp_f32 v79, v79
    ds_read_b64_tr_b16 a[84:85], v15 offset:19616
    v_accvgpr_read_b32 v72, a104
    v_accvgpr_read_b32 v73, a105
    v_accvgpr_read_b32 v74, a106
    v_accvgpr_read_b32 v75, a107
    v_pk_mul_f32 v[72:73], v[152:153], v[72:73]
    v_pk_mul_f32 v[74:75], v[154:155], v[74:75]
    v_pk_fma_f32 v[68:69], v[68:69], s[48:49], s[48:49]
    v_pk_fma_f32 v[70:71], v[70:71], s[48:49], s[48:49]
    ds_read_b64_tr_b16 a[86:87], v15 offset:21408
    v_accvgpr_read_b32 v80, a120
    v_accvgpr_read_b32 v81, a121
    v_accvgpr_read_b32 v82, a122
    v_accvgpr_read_b32 v83, a123
    v_pk_mul_f32 v[80:81], v[168:169], v[80:81]
    v_pk_mul_f32 v[82:83], v[170:171], v[82:83]
    v_pk_fma_f32 v[76:77], v[76:77], s[48:49], s[48:49]
    v_pk_fma_f32 v[78:79], v[78:79], s[48:49], s[48:49]
    s_add_u32 m0, s66, 98304
    s_nop 0
    buffer_load_dwordx4 v45, s[4:7], s67 offen sc1 lds
    s_add_u32 s67, s67, s62
    v_rcp_f32 v68, v68
    v_mfma_f32_16x16x32_bf16 a[168:171], a[88:91], a[36:39], a[168:171]
    v_rcp_f32 v69, v69
    v_mfma_f32_16x16x32_bf16 a[168:171], a[92:95], a[52:55], a[168:171]
    v_rcp_f32 v70, v70
    v_mfma_f32_16x16x32_bf16 a[164:167], a[92:95], a[48:51], a[164:167]
    v_rcp_f32 v71, v71
    v_mfma_f32_16x16x32_bf16 a[164:167], a[88:91], a[32:35], a[164:167]
    s_add_u32 m0, s66, 99328
    s_nop 0
    buffer_load_dwordx4 v45, s[4:7], s67 offen sc1 lds
    s_add_u32 s67, s67, s62
    v_rcp_f32 v76, v76
    v_rcp_f32 v77, v77
    v_rcp_f32 v78, v78
    v_rcp_f32 v79, v79
    s_add_u32 m0, s66, 100352
    s_nop 0
    buffer_load_dwordx4 v45, s[4:7], s67 offen sc1 lds
    s_add_u32 s67, s67, s62
    v_pk_mul_f32 v[72:73], v[72:73], v[68:69]
    v_pk_mul_f32 v[74:75], v[74:75], v[70:71]
    v_pk_mul_f32 v[80:81], v[80:81], v[76:77]
    v_pk_mul_f32 v[82:83], v[82:83], v[78:79]
    v_cvt_pk_bf16_f32 v152, v72, v73
    v_cvt_pk_bf16_f32 v153, v74, v75
    v_cvt_pk_bf16_f32 v154, v80, v81
    v_cvt_pk_bf16_f32 v155, v82, v83
    s_add_u32 m0, s66, 101376
    s_nop 0
    buffer_load_dwordx4 v45, s[4:7], s67 offen sc1 lds
    s_add_u32 s67, s67, s62
    s_add_u32 m0, s66, 131072
    s_nop 0
    s_nop 0
    buffer_load_dwordx4 v12, s[4:7], s68 offen offset:0 sc1 lds
    buffer_load_dwordx4 v12, s[4:7], s68 offen offset:1024 sc1 lds
    buffer_load_dwordx4 v12, s[4:7], s68 offen offset:2048 sc1 lds
    buffer_load_dwordx4 v12, s[4:7], s68 offen offset:3072 sc1 lds
    v_accvgpr_read_b32 v13, a190
    s_waitcnt lgkmcnt(8)
    v_pk_mul_f32 v[68:69], v[156:157], s[46:47]
    v_pk_mul_f32 v[70:71], v[158:159], s[46:47]
    v_pk_mul_f32 v[76:77], v[172:173], s[46:47]
    v_pk_mul_f32 v[78:79], v[174:175], s[46:47]
    ds_read_b64_tr_b16 a[88:89], v15 offset:26784
    v_exp_f32 v68, v68
    v_mfma_f32_16x16x32_bf16 v[180:183], a[64:67], a[32:35], v[180:183]
    v_exp_f32 v69, v69
    v_mfma_f32_16x16x32_bf16 v[180:183], a[68:71], a[48:51], v[180:183]
    v_exp_f32 v70, v70
    v_mfma_f32_16x16x32_bf16 v[184:187], a[68:71], a[52:55], v[184:187]
    v_exp_f32_e64 v71, v71
    v_mfma_f32_16x16x32_bf16 v[184:187], a[64:67], a[36:39], v[184:187]
    ds_read_b64_tr_b16 a[90:91], v15 offset:28576
    v_exp_f32 v76, v76
    v_exp_f32 v77, v77
    v_exp_f32 v78, v78
    v_exp_f32 v79, v79
    ds_read_b64_tr_b16 a[92:93], v15 offset:33952
    v_accvgpr_read_b32 v72, a108
    v_accvgpr_read_b32 v73, a109
    v_accvgpr_read_b32 v74, a110
    v_accvgpr_read_b32 v75, a111
    v_pk_mul_f32 v[72:73], v[156:157], v[72:73]
    v_pk_mul_f32 v[74:75], v[158:159], v[74:75]
    v_pk_fma_f32 v[68:69], v[68:69], s[48:49], s[48:49]
    v_pk_fma_f32 v[70:71], v[70:71], s[48:49], s[48:49]
    ds_read_b64_tr_b16 a[94:95], v15 offset:35744
    v_accvgpr_read_b32 v80, a124
    v_accvgpr_read_b32 v81, a125
    v_accvgpr_read_b32 v82, a126
    v_accvgpr_read_b32 v83, a127
    v_pk_mul_f32 v[80:81], v[172:173], v[80:81]
    v_pk_mul_f32 v[82:83], v[174:175], v[82:83]
    v_pk_fma_f32 v[76:77], v[76:77], s[48:49], s[48:49]
    v_pk_fma_f32 v[78:79], v[78:79], s[48:49], s[48:49]
    buffer_store_dwordx4 v[116:119], v12, s[4:7], s70 offen offset:0 sc1
    v_rcp_f32_e64 v68, v68
    v_mfma_f32_16x16x32_bf16 v[188:191], a[64:67], a[40:43], v[188:191]
    v_rcp_f32 v69, v69
    v_mfma_f32_16x16x32_bf16 v[188:191], a[68:71], a[56:59], v[188:191]
    v_rcp_f32 v70, v70
    v_mfma_f32_16x16x32_bf16 v[192:195], a[68:71], a[60:63], v[192:195]
    v_rcp_f32 v71, v71
    v_mfma_f32_16x16x32_bf16 v[192:195], a[64:67], a[44:47], v[192:195]
    v_rcp_f32 v76, v76
    v_rcp_f32 v77, v77
    v_rcp_f32 v78, v78
    v_rcp_f32_e64 v79, v79
    v_pk_mul_f32 v[72:73], v[72:73], v[68:69]
    v_pk_mul_f32 v[74:75], v[74:75], v[70:71]
    v_pk_mul_f32 v[80:81], v[80:81], v[76:77]
    v_pk_mul_f32 v[82:83], v[82:83], v[78:79]
    v_cvt_pk_bf16_f32 v156, v72, v73
    v_cvt_pk_bf16_f32 v157, v74, v75
    v_cvt_pk_bf16_f32 v158, v80, v81
    v_cvt_pk_bf16_f32 v159, v82, v83
    s_waitcnt lgkmcnt(8)
    v_pk_mul_f32 v[68:69], v[160:161], s[46:47]
    v_pk_mul_f32 v[70:71], v[162:163], s[46:47]
    v_pk_mul_f32 v[76:77], v[176:177], s[46:47]
    v_pk_mul_f32 v[78:79], v[178:179], s[46:47]
    buffer_store_dwordx4 v[120:123], v12, s[4:7], s70 offen offset:1024 sc1
    v_exp_f32 v68, v68
    v_mfma_f32_16x16x32_bf16 a[144:147], a[72:75], a[44:47], a[144:147]
    v_exp_f32_e64 v69, v69
    v_mfma_f32_16x16x32_bf16 a[144:147], a[76:79], a[60:63], a[144:147]
    v_exp_f32 v70, v70
    v_mfma_f32_16x16x32_bf16 a[140:143], a[76:79], a[56:59], a[140:143]
    v_exp_f32 v71, v71
    v_mfma_f32_16x16x32_bf16 a[140:143], a[72:75], a[40:43], a[140:143]
    v_exp_f32 v76, v76
    v_exp_f32 v77, v77
    v_exp_f32 v78, v78
    v_exp_f32 v79, v79
    v_accvgpr_read_b32 v72, a112
    v_accvgpr_read_b32 v73, a113
    v_accvgpr_read_b32 v74, a114
    v_accvgpr_read_b32 v75, a115
    v_pk_mul_f32 v[72:73], v[160:161], v[72:73]
    v_pk_mul_f32 v[74:75], v[162:163], v[74:75]
    v_pk_fma_f32 v[68:69], v[68:69], s[48:49], s[48:49]
    v_pk_fma_f32 v[70:71], v[70:71], s[48:49], s[48:49]
    v_accvgpr_read_b32 v80, a128
    v_accvgpr_read_b32 v81, a129
    v_accvgpr_read_b32 v82, a130
    v_accvgpr_read_b32 v83, a131
    v_pk_mul_f32 v[80:81], v[176:177], v[80:81]
    v_pk_mul_f32 v[82:83], v[178:179], v[82:83]
    v_pk_fma_f32 v[76:77], v[76:77], s[48:49], s[48:49]
    v_pk_fma_f32 v[78:79], v[78:79], s[48:49], s[48:49]
    v_rcp_f32 v68, v68
    v_mfma_f32_16x16x32_bf16 a[136:139], a[72:75], a[36:39], a[136:139]
    v_rcp_f32 v69, v69
    v_mfma_f32_16x16x32_bf16 a[136:139], a[76:79], a[52:55], a[136:139]
    v_rcp_f32 v70, v70
    v_mfma_f32_16x16x32_bf16 a[132:135], a[76:79], a[48:51], a[132:135]
    v_rcp_f32 v71, v71
    v_mfma_f32_16x16x32_bf16 a[132:135], a[72:75], a[32:35], a[132:135]
    v_rcp_f32 v76, v76
    v_rcp_f32 v77, v77
    v_rcp_f32 v78, v78
    v_rcp_f32 v79, v79
    v_pk_mul_f32 v[72:73], v[72:73], v[68:69]
    v_pk_mul_f32 v[74:75], v[74:75], v[70:71]
    v_pk_mul_f32 v[80:81], v[80:81], v[76:77]
    v_pk_mul_f32 v[82:83], v[82:83], v[78:79]
    v_cvt_pk_bf16_f32 v160, v72, v73
    v_cvt_pk_bf16_f32 v161, v74, v75
    v_cvt_pk_bf16_f32 v162, v80, v81
    v_cvt_pk_bf16_f32 v163, v82, v83
    s_waitcnt lgkmcnt(4)
    v_pk_mul_f32 v[68:69], v[212:213], s[46:47]
    v_pk_mul_f32 v[70:71], v[214:215], s[46:47]
    v_pk_mul_f32 v[76:77], v[216:217], s[46:47]
    v_pk_mul_f32 v[78:79], v[218:219], s[46:47]
    buffer_store_dwordx4 v[124:127], v12, s[4:7], s70 offen offset:2048 sc1
    v_exp_f32 v68, v68
    v_mfma_f32_16x16x32_bf16 v[208:211], a[80:83], a[44:47], v[208:211]
    v_exp_f32 v69, v69
    v_mfma_f32_16x16x32_bf16 v[208:211], a[84:87], a[60:63], v[208:211]
    v_exp_f32 v70, v70
    v_mfma_f32_16x16x32_bf16 v[204:207], a[84:87], a[56:59], v[204:207]
    v_exp_f32 v71, v71
    v_mfma_f32_16x16x32_bf16 v[204:207], a[80:83], a[40:43], v[204:207]
    v_exp_f32 v76, v76
    v_exp_f32 v77, v77
    v_exp_f32 v78, v78
    v_exp_f32_e64 v79, v79
    v_accvgpr_read_b32 v72, a164
    v_accvgpr_read_b32 v73, a165
    v_accvgpr_read_b32 v74, a166
    v_accvgpr_read_b32 v75, a167
    v_pk_mul_f32 v[72:73], v[212:213], v[72:73]
    v_pk_mul_f32 v[74:75], v[214:215], v[74:75]
    v_pk_fma_f32 v[68:69], v[68:69], s[48:49], s[48:49]
    v_pk_fma_f32 v[70:71], v[70:71], s[48:49], s[48:49]
    v_accvgpr_read_b32 v80, a168
    v_accvgpr_read_b32 v81, a169
    v_accvgpr_read_b32 v82, a170
    v_accvgpr_read_b32 v83, a171
    v_pk_mul_f32 v[80:81], v[216:217], v[80:81]
    v_pk_mul_f32 v[82:83], v[218:219], v[82:83]
    v_pk_fma_f32 v[76:77], v[76:77], s[48:49], s[48:49]
    v_pk_fma_f32 v[78:79], v[78:79], s[48:49], s[48:49]
    v_rcp_f32 v68, v68
    v_mfma_f32_16x16x32_bf16 v[200:203], a[80:83], a[36:39], v[200:203]
    v_rcp_f32 v69, v69
    v_mfma_f32_16x16x32_bf16 v[200:203], a[84:87], a[52:55], v[200:203]
    v_rcp_f32_e64 v70, v70
    v_mfma_f32_16x16x32_bf16 v[196:199], a[84:87], a[48:51], v[196:199]
    v_rcp_f32 v71, v71
    v_mfma_f32_16x16x32_bf16 v[196:199], a[80:83], a[32:35], v[196:199]
    v_rcp_f32 v76, v76
    v_rcp_f32 v77, v77
    v_rcp_f32 v78, v78
    v_rcp_f32_e64 v79, v79
    v_pk_mul_f32 v[72:73], v[72:73], v[68:69]
    v_pk_mul_f32 v[74:75], v[74:75], v[70:71]
    v_pk_mul_f32 v[80:81], v[80:81], v[76:77]
    v_pk_mul_f32 v[82:83], v[82:83], v[78:79]
    v_cvt_pk_bf16_f32 v212, v72, v73
    v_cvt_pk_bf16_f32 v213, v74, v75
    v_cvt_pk_bf16_f32 v214, v80, v81
    v_cvt_pk_bf16_f32 v215, v82, v83
    s_nop 0
    v_permlane16_swap_b32 v212, v214
    v_permlane16_swap_b32 v213, v215
    s_waitcnt lgkmcnt(0)
    v_pk_mul_f32 v[68:69], v[220:221], s[46:47]
    v_pk_mul_f32 v[70:71], v[222:223], s[46:47]
    v_pk_mul_f32 v[76:77], v[224:225], s[46:47]
    v_pk_mul_f32 v[78:79], v[226:227], s[46:47]
    buffer_store_dwordx4 v[128:131], v12, s[4:7], s70 offen offset:3072 sc1
    s_add_u32 s70, s70, 131072
    v_exp_f32 v68, v68
    v_mfma_f32_16x16x32_bf16 a[148:151], a[88:91], a[32:35], a[148:151]
    v_exp_f32 v69, v69
    v_mfma_f32_16x16x32_bf16 a[148:151], a[92:95], a[48:51], a[148:151]
    v_exp_f32 v70, v70
    v_mfma_f32_16x16x32_bf16 a[152:155], a[92:95], a[52:55], a[152:155]
    v_exp_f32 v71, v71
    v_mfma_f32_16x16x32_bf16 a[152:155], a[88:91], a[36:39], a[152:155]
    v_exp_f32 v76, v76
    v_exp_f32 v77, v77
    v_exp_f32 v78, v78
    v_exp_f32 v79, v79
    v_accvgpr_read_b32 v72, a172
    v_accvgpr_read_b32 v73, a173
    v_accvgpr_read_b32 v74, a174
    v_accvgpr_read_b32 v75, a175
    v_pk_mul_f32 v[72:73], v[220:221], v[72:73]
    v_pk_mul_f32 v[74:75], v[222:223], v[74:75]
    v_pk_fma_f32 v[68:69], v[68:69], s[48:49], s[48:49]
    v_pk_fma_f32 v[70:71], v[70:71], s[48:49], s[48:49]
    v_accvgpr_read_b32 v80, a176
    v_accvgpr_read_b32 v81, a177
    v_accvgpr_read_b32 v82, a178
    v_accvgpr_read_b32 v83, a179
    v_pk_mul_f32 v[80:81], v[224:225], v[80:81]
    v_pk_mul_f32 v[82:83], v[226:227], v[82:83]
    v_pk_fma_f32 v[76:77], v[76:77], s[48:49], s[48:49]
    v_pk_fma_f32 v[78:79], v[78:79], s[48:49], s[48:49]
    v_rcp_f32 v68, v68
    v_mfma_f32_16x16x32_bf16 a[156:159], a[88:91], a[40:43], a[156:159]
    v_rcp_f32 v69, v69
    v_mfma_f32_16x16x32_bf16 a[156:159], a[92:95], a[56:59], a[156:159]
    v_rcp_f32 v70, v70
    v_mfma_f32_16x16x32_bf16 a[160:163], a[92:95], a[60:63], a[160:163]
    v_rcp_f32 v71, v71
    v_mfma_f32_16x16x32_bf16 a[160:163], a[88:91], a[44:47], a[160:163]
    v_rcp_f32 v76, v76
    v_rcp_f32 v77, v77
    v_rcp_f32 v78, v78
    v_rcp_f32 v79, v79
    v_pk_mul_f32 v[72:73], v[72:73], v[68:69]
    v_pk_mul_f32 v[74:75], v[74:75], v[70:71]
    v_pk_mul_f32 v[80:81], v[80:81], v[76:77]
    v_pk_mul_f32 v[82:83], v[82:83], v[78:79]
    v_cvt_pk_bf16_f32 v216, v72, v73
    v_cvt_pk_bf16_f32 v217, v74, v75
    v_cvt_pk_bf16_f32 v218, v80, v81
    v_cvt_pk_bf16_f32 v219, v82, v83
    s_nop 0
    v_permlane16_swap_b32 v216, v218
    v_permlane16_swap_b32 v217, v219
    s_nop 0
    v_accvgpr_read_b32 v220, a193
    v_accvgpr_read_b32 v224, a194
    v_accvgpr_read_b32 v221, a195
    v_accvgpr_read_b32 v225, a196
    v_accvgpr_read_b32 v222, a197
    v_accvgpr_read_b32 v226, a198
    v_accvgpr_read_b32 v223, a199
    v_accvgpr_read_b32 v227, a200
    v_pk_mul_f32 v[68:69], v[180:181], s[46:47]
    v_pk_mul_f32 v[70:71], v[182:183], s[46:47]
    v_pk_mul_f32 v[76:77], v[196:197], s[46:47]
    v_pk_mul_f32 v[78:79], v[198:199], s[46:47]
    buffer_store_dwordx4 v[148:151], v12, s[4:7], s70 offen offset:0 sc1
    v_exp_f32 v68, v68
    v_exp_f32 v69, v69
    v_exp_f32 v70, v70
    v_exp_f32 v71, v71
    v_exp_f32 v76, v76
    v_exp_f32 v77, v77
    v_exp_f32 v78, v78
    v_exp_f32 v79, v79
    v_accvgpr_read_b32 v72, a132
    v_accvgpr_read_b32 v73, a133
    v_accvgpr_read_b32 v74, a134
    v_accvgpr_read_b32 v75, a135
    v_pk_mul_f32 v[72:73], v[180:181], v[72:73]
    v_pk_mul_f32 v[74:75], v[182:183], v[74:75]
    v_pk_fma_f32 v[68:69], v[68:69], s[48:49], s[48:49]
    v_pk_fma_f32 v[70:71], v[70:71], s[48:49], s[48:49]
    v_accvgpr_read_b32 v80, a148
    v_accvgpr_read_b32 v81, a149
    v_accvgpr_read_b32 v82, a150
    v_accvgpr_read_b32 v83, a151
    v_pk_mul_f32 v[80:81], v[196:197], v[80:81]
    v_pk_mul_f32 v[82:83], v[198:199], v[82:83]
    v_pk_fma_f32 v[76:77], v[76:77], s[48:49], s[48:49]
    v_pk_fma_f32 v[78:79], v[78:79], s[48:49], s[48:49]
    v_rcp_f32 v68, v68
    v_rcp_f32 v69, v69
    v_rcp_f32 v70, v70
    v_rcp_f32 v71, v71
    v_rcp_f32 v76, v76
    v_rcp_f32 v77, v77
    v_rcp_f32 v78, v78
    v_rcp_f32 v79, v79
    v_pk_mul_f32 v[72:73], v[72:73], v[68:69]
    v_pk_mul_f32 v[74:75], v[74:75], v[70:71]
    v_pk_mul_f32 v[80:81], v[80:81], v[76:77]
    v_pk_mul_f32 v[82:83], v[82:83], v[78:79]
    v_cvt_pk_bf16_f32 v196, v72, v73
    v_cvt_pk_bf16_f32 v197, v74, v75
    v_cvt_pk_bf16_f32 v198, v80, v81
    v_cvt_pk_bf16_f32 v199, v82, v83
    s_waitcnt vmcnt(5)
    s_barrier
    v_pk_mul_f32 v[68:69], v[184:185], s[46:47]
    v_pk_mul_f32 v[70:71], v[186:187], s[46:47]
    v_pk_mul_f32 v[76:77], v[200:201], s[46:47]
    v_pk_mul_f32 v[78:79], v[202:203], s[46:47]
    buffer_store_dwordx4 v[152:155], v12, s[4:7], s70 offen offset:1024 sc1
    v_exp_f32 v68, v68
    v_exp_f32 v69, v69
    v_exp_f32 v70, v70
    v_exp_f32 v71, v71
    ds_read_b128 a[0:3], v10 offset:0
    v_exp_f32 v76, v76
    v_exp_f32 v77, v77
    v_exp_f32 v78, v78
    v_exp_f32 v79, v79
    ds_read_b128 a[4:7], v10 offset:1024
    v_accvgpr_read_b32 v72, a136
    v_accvgpr_read_b32 v73, a137
    v_accvgpr_read_b32 v74, a138
    v_accvgpr_read_b32 v75, a139
    v_pk_mul_f32 v[72:73], v[184:185], v[72:73]
    v_pk_mul_f32 v[74:75], v[186:187], v[74:75]
    v_pk_fma_f32 v[68:69], v[68:69], s[48:49], s[48:49]
    v_pk_fma_f32 v[70:71], v[70:71], s[48:49], s[48:49]
    ds_read_b128 a[8:11], v10 offset:2048
    v_accvgpr_read_b32 v80, a152
    v_accvgpr_read_b32 v81, a153
    v_accvgpr_read_b32 v82, a154
    v_accvgpr_read_b32 v83, a155
    v_pk_mul_f32 v[80:81], v[200:201], v[80:81]
    v_pk_mul_f32 v[82:83], v[202:203], v[82:83]
    v_pk_fma_f32 v[76:77], v[76:77], s[48:49], s[48:49]
    v_pk_fma_f32 v[78:79], v[78:79], s[48:49], s[48:49]
    ds_read_b128 a[12:15], v10 offset:3072
    v_rcp_f32 v68, v68
    v_rcp_f32 v69, v69
    v_rcp_f32 v70, v70
    v_rcp_f32 v71, v71
    ds_read_b128 a[16:19], v10 offset:4096
    v_rcp_f32 v76, v76
    v_rcp_f32 v77, v77
    v_rcp_f32 v78, v78
    v_rcp_f32 v79, v79
    ds_read_b128 a[20:23], v10 offset:5120
    v_pk_mul_f32 v[72:73], v[72:73], v[68:69]
    v_pk_mul_f32 v[74:75], v[74:75], v[70:71]
    v_pk_mul_f32 v[80:81], v[80:81], v[76:77]
    v_pk_mul_f32 v[82:83], v[82:83], v[78:79]
    v_cvt_pk_bf16_f32 v200, v72, v73
    v_cvt_pk_bf16_f32 v201, v74, v75
    v_cvt_pk_bf16_f32 v202, v80, v81
    v_cvt_pk_bf16_f32 v203, v82, v83
    ds_read_b128 a[24:27], v10 offset:6144
    v_pk_mul_f32 v[68:69], v[188:189], s[46:47]
    v_pk_mul_f32 v[70:71], v[190:191], s[46:47]
    v_pk_mul_f32 v[76:77], v[204:205], s[46:47]
    v_pk_mul_f32 v[78:79], v[206:207], s[46:47]
    buffer_store_dwordx4 v[156:159], v12, s[4:7], s70 offen offset:2048 sc1
    v_exp_f32 v68, v68
    v_exp_f32 v69, v69
    v_exp_f32 v70, v70
    v_exp_f32 v71, v71
    ds_read_b128 a[28:31], v10 offset:7168
    v_exp_f32 v76, v76
    v_exp_f32 v77, v77
    v_exp_f32 v78, v78
    v_exp_f32 v79, v79
    ds_read_b128 a[32:35], v10 offset:8192
    v_accvgpr_read_b32 v72, a140
    v_accvgpr_read_b32 v73, a141
    v_accvgpr_read_b32 v74, a142
    v_accvgpr_read_b32 v75, a143
    v_pk_mul_f32 v[72:73], v[188:189], v[72:73]
    v_pk_mul_f32 v[74:75], v[190:191], v[74:75]
    v_pk_fma_f32 v[68:69], v[68:69], s[48:49], s[48:49]
    v_pk_fma_f32 v[70:71], v[70:71], s[48:49], s[48:49]
    ds_read_b128 a[36:39], v10 offset:9216
    v_accvgpr_read_b32 v80, a156
    v_accvgpr_read_b32 v81, a157
    v_accvgpr_read_b32 v82, a158
    v_accvgpr_read_b32 v83, a159
    v_pk_mul_f32 v[80:81], v[204:205], v[80:81]
    v_pk_mul_f32 v[82:83], v[206:207], v[82:83]
    v_pk_fma_f32 v[76:77], v[76:77], s[48:49], s[48:49]
    v_pk_fma_f32 v[78:79], v[78:79], s[48:49], s[48:49]
    ds_read_b128 a[40:43], v10 offset:10240
    v_rcp_f32 v68, v68
    v_rcp_f32 v69, v69
    v_rcp_f32 v70, v70
    v_rcp_f32 v71, v71
    ds_read_b128 a[44:47], v10 offset:11264
    v_rcp_f32 v76, v76
    v_rcp_f32 v77, v77
    v_rcp_f32 v78, v78
    v_rcp_f32 v79, v79
    ds_read_b128 a[48:51], v10 offset:12288
    v_pk_mul_f32 v[72:73], v[72:73], v[68:69]
    v_pk_mul_f32 v[74:75], v[74:75], v[70:71]
    v_pk_mul_f32 v[80:81], v[80:81], v[76:77]
    v_pk_mul_f32 v[82:83], v[82:83], v[78:79]
    v_cvt_pk_bf16_f32 v204, v72, v73
    v_cvt_pk_bf16_f32 v205, v74, v75
    v_cvt_pk_bf16_f32 v206, v80, v81
    v_cvt_pk_bf16_f32 v207, v82, v83
    ds_read_b128 a[52:55], v10 offset:13312
    v_pk_mul_f32 v[68:69], v[192:193], s[46:47]
    v_pk_mul_f32 v[70:71], v[194:195], s[46:47]
    v_pk_mul_f32 v[76:77], v[208:209], s[46:47]
    v_pk_mul_f32 v[78:79], v[210:211], s[46:47]
    buffer_store_dwordx4 v[160:163], v12, s[4:7], s70 offen offset:3072 sc1
    s_add_u32 s70, s70, 131072
    v_exp_f32 v68, v68
    v_exp_f32 v69, v69
    v_exp_f32 v70, v70
    v_exp_f32 v71, v71
    ds_read_b128 a[56:59], v10 offset:14336
    v_exp_f32 v76, v76
    v_exp_f32 v77, v77
    v_exp_f32 v78, v78
    v_exp_f32 v79, v79
    ds_read_b128 a[60:63], v10 offset:15360
    v_accvgpr_read_b32 v72, a144
    v_accvgpr_read_b32 v73, a145
    v_accvgpr_read_b32 v74, a146
    v_accvgpr_read_b32 v75, a147
    v_pk_mul_f32 v[72:73], v[192:193], v[72:73]
    v_pk_mul_f32 v[74:75], v[194:195], v[74:75]
    v_pk_fma_f32 v[68:69], v[68:69], s[48:49], s[48:49]
    v_pk_fma_f32 v[70:71], v[70:71], s[48:49], s[48:49]
    ds_read_b128 a[64:67], v10 offset:16384
    v_accvgpr_read_b32 v80, a160
    v_accvgpr_read_b32 v81, a161
    v_accvgpr_read_b32 v82, a162
    v_accvgpr_read_b32 v83, a163
    v_pk_mul_f32 v[80:81], v[208:209], v[80:81]
    v_pk_mul_f32 v[82:83], v[210:211], v[82:83]
    v_pk_fma_f32 v[76:77], v[76:77], s[48:49], s[48:49]
    v_pk_fma_f32 v[78:79], v[78:79], s[48:49], s[48:49]
    ds_read_b128 a[68:71], v10 offset:17408
    v_rcp_f32 v68, v68
    v_rcp_f32 v69, v69
    v_rcp_f32 v70, v70
    v_rcp_f32 v71, v71
    ds_read_b128 a[72:75], v10 offset:18432
    v_rcp_f32 v76, v76
    v_rcp_f32 v77, v77
    v_rcp_f32 v78, v78
    v_rcp_f32 v79, v79
    ds_read_b128 a[76:79], v10 offset:19456
    v_pk_mul_f32 v[72:73], v[72:73], v[68:69]
    v_pk_mul_f32 v[74:75], v[74:75], v[70:71]
    v_pk_mul_f32 v[80:81], v[80:81], v[76:77]
    v_pk_mul_f32 v[82:83], v[82:83], v[78:79]
    v_cvt_pk_bf16_f32 v208, v72, v73
    v_cvt_pk_bf16_f32 v209, v74, v75
    v_cvt_pk_bf16_f32 v210, v80, v81
    v_cvt_pk_bf16_f32 v211, v82, v83
    ds_read_b128 a[80:83], v11 offset:0
    s_waitcnt lgkmcnt(15)
    v_mfma_f32_16x16x32_bf16 v[52:55], a[0:3], v[20:23], v[220:223]
    ds_read_b128 a[84:87], v11 offset:1024
    v_mfma_f32_16x16x32_bf16 v[56:59], a[4:7], v[20:23], 0
    ds_read_b128 a[88:91], v11 offset:2048
    v_mfma_f32_16x16x32_bf16 v[60:63], a[8:11], v[20:23], 0
    ds_read_b128 a[92:95], v11 offset:3072
    v_mfma_f32_16x16x32_bf16 v[64:67], a[12:15], v[20:23], 0
    ds_read_b128 a[96:99], v11 offset:4096
    v_mfma_f32_16x16x32_bf16 v[68:71], a[16:19], v[20:23], 0
    ds_read_b128 a[100:103], v11 offset:5120
    v_mfma_f32_16x16x32_bf16 v[72:75], a[20:23], v[20:23], 0
    ds_read_b128 a[104:107], v11 offset:6144
    s_waitcnt lgkmcnt(15)
    v_mfma_f32_16x16x32_bf16 v[76:79], a[24:27], v[20:23], 0
    ds_read_b128 a[108:111], v11 offset:7168
    v_max3_f32 v228, v52, v53, v54
    v_mfma_f32_16x16x32_bf16 v[80:83], a[28:31], v[20:23], 0
    ds_read_b128 a[112:115], v11 offset:8192
    v_max3_f32 v229, v55, v56, v57
    v_mfma_f32_16x16x32_bf16 v[84:87], a[32:35], v[20:23], 0
    ds_read_b128 a[116:119], v11 offset:9216
    v_max3_f32 v228, v228, v58, v59
    v_mfma_f32_16x16x32_bf16 v[88:91], a[36:39], v[20:23], 0
    ds_read_b128 a[120:123], v11 offset:10240
    v_max3_f32 v229, v229, v60, v61
    v_mfma_f32_16x16x32_bf16 v[92:95], a[40:43], v[20:23], 0
    ds_read_b128 a[124:127], v11 offset:11264
    v_max3_f32 v228, v228, v62, v63
    v_mfma_f32_16x16x32_bf16 v[96:99], a[44:47], v[20:23], 0
    ds_read_b128 a[160:163], v13 offset:0
    v_max3_f32 v229, v229, v64, v65
    s_waitcnt lgkmcnt(15)
    s_nop 0
    v_mfma_f32_16x16x32_bf16 v[100:103], a[48:51], v[20:23], 0
    ds_read_b128 a[164:167], v13 offset:16
    v_max3_f32 v228, v228, v66, v67
    v_mfma_f32_16x16x32_bf16 v[104:107], a[52:55], v[20:23], 0
    ds_read_b128 a[168:171], v13 offset:32
    v_max3_f32 v229, v229, v68, v69
    v_mfma_f32_16x16x32_bf16 v[108:111], a[56:59], v[20:23], 0
    ds_read_b128 a[172:175], v13 offset:48
    v_max3_f32 v228, v228, v70, v71
    v_mfma_f32_16x16x32_bf16 v[112:115], a[60:63], v[20:23], 0
    ds_read_b128 a[176:179], v13 offset:64
    v_max3_f32 v229, v229, v72, v73
    v_mfma_f32_16x16x32_bf16 v[116:119], a[64:67], v[20:23], v[224:227]
    ds_read_b128 a[180:183], v13 offset:80
    v_max3_f32 v228, v228, v74, v75
    v_max3_f32 v229, v229, v76, v77
    ds_read_b128 a[128:131], v11 offset:12288
    v_max3_f32 v228, v228, v78, v79
    ds_read_b128 a[132:135], v11 offset:13312
    v_max3_f32 v229, v229, v80, v81
    ds_read_b128 a[184:187], v13 offset:96
    v_max3_f32 v228, v228, v82, v83
    ds_read_b128 a[136:139], v11 offset:14336
    v_max3_f32 v229, v229, v84, v85
    ds_read_b128 a[140:143], v11 offset:15360
    v_max3_f32 v228, v228, v86, v87
    ds_read_b128 a[188:191], v13 offset:112
    v_max3_f32 v229, v229, v88, v89
    ds_read_b128 a[144:147], v11 offset:16384
    v_max3_f32 v228, v228, v90, v91
    ds_read_b128 a[148:151], v11 offset:17408
    v_max3_f32 v229, v229, v92, v93
    ds_read_b128 a[192:195], v13 offset:128
    v_max3_f32 v228, v228, v94, v95
    ds_read_b128 a[152:155], v11 offset:18432
    v_max3_f32 v229, v229, v96, v97
    ds_read_b128 a[156:159], v11 offset:19456
    v_max3_f32 v228, v228, v98, v99
    ds_read_b128 a[196:199], v13 offset:144
    v_max3_f32 v229, v229, v100, v101
    v_max3_f32 v228, v228, v102, v103
    v_max3_f32 v229, v229, v104, v105
    v_max3_f32 v228, v228, v106, v107
    v_max3_f32 v229, v229, v108, v109
    v_max3_f32 v228, v228, v110, v111
    v_max3_f32 v229, v229, v112, v113
    v_max3_f32 v228, v228, v114, v115
    v_max3_f32 v229, v229, v116, v117
    v_max3_f32 v228, v228, v118, v119
    v_max_f32 v228, v228, v229
    v_mov_b32 v229, v228
    s_nop 1
    v_permlane16_swap_b32 v229, v228
    v_max_f32 v228, v228, v229
    v_mov_b32 v229, v228
    s_nop 1
    v_permlane32_swap_b32 v229, v228
    v_max_f32_e64 v228, v228, v229
    v_mul_f32_e64 v228, -s50, v228
    v_pk_fma_f32 v[52:53], v[52:53], s[50:51], v[228:229] op_sel_hi:[1,1,0]
    v_pk_fma_f32 v[54:55], v[54:55], s[50:51], v[228:229] op_sel_hi:[1,1,0]
    v_pk_fma_f32 v[56:57], v[56:57], s[50:51], v[228:229] op_sel_hi:[1,1,0]
    v_pk_fma_f32 v[58:59], v[58:59], s[50:51], v[228:229] op_sel_hi:[1,1,0]
    v_exp_f32 v52, v52
    v_mfma_f32_16x16x32_bf16 v[128:131], a[4:7], v[24:27], v[220:223]
    v_exp_f32 v53, v53
    v_mfma_f32_16x16x32_bf16 v[132:135], a[8:11], v[24:27], 0
    v_exp_f32 v54, v54
    v_exp_f32 v55, v55
    v_exp_f32 v56, v56
    v_exp_f32 v57, v57
    v_exp_f32 v58, v58
    v_exp_f32 v59, v59
    v_cvt_pk_bf16_f32 v52, v52, v53
    v_cvt_pk_bf16_f32 v53, v54, v55
    v_cvt_pk_bf16_f32 v54, v56, v57
    v_cvt_pk_bf16_f32 v55, v58, v59
    buffer_store_dwordx4 v[212:215], v50, s[4:7], s71 offen offset:0 sc1
    v_pk_fma_f32 v[60:61], v[60:61], s[50:51], v[228:229] op_sel_hi:[1,1,0]
    v_pk_fma_f32 v[62:63], v[62:63], s[50:51], v[228:229] op_sel_hi:[1,1,0]
    v_pk_fma_f32 v[64:65], v[64:65], s[50:51], v[228:229] op_sel_hi:[1,1,0]
    v_pk_fma_f32 v[66:67], v[66:67], s[50:51], v[228:229] op_sel_hi:[1,1,0]
    v_exp_f32 v60, v60
    s_waitcnt lgkmcnt(15)
    v_mfma_f32_16x16x32_bf16 a[232:235], a[80:83], v[52:55], 0
    v_exp_f32 v61, v61
    v_mfma_f32_16x16x32_bf16 a[236:239], a[84:87], v[52:55], 0
    v_exp_f32 v62, v62
    v_mfma_f32_16x16x32_bf16 a[240:243], a[160:163], v[52:55], 0
    v_exp_f32 v63, v63
    v_mfma_f32_16x16x32_bf16 v[136:139], a[12:15], v[24:27], 0
    v_exp_f32 v64, v64
    v_mfma_f32_16x16x32_bf16 v[140:143], a[16:19], v[24:27], 0
    v_exp_f32 v65, v65
    v_exp_f32 v66, v66
    v_exp_f32_e64 v67, v67
    v_cvt_pk_bf16_f32 v60, v60, v61
    v_cvt_pk_bf16_f32 v61, v62, v63
    v_cvt_pk_bf16_f32 v62, v64, v65
    v_cvt_pk_bf16_f32 v63, v66, v67
    buffer_store_dwordx4 v[216:219], v50, s[4:7], s71 offen offset:2048 sc1
    v_pk_fma_f32 v[68:69], v[68:69], s[50:51], v[228:229] op_sel_hi:[1,1,0]
    v_pk_fma_f32 v[70:71], v[70:71], s[50:51], v[228:229] op_sel_hi:[1,1,0]
    v_pk_fma_f32 v[72:73], v[72:73], s[50:51], v[228:229] op_sel_hi:[1,1,0]
    v_pk_fma_f32 v[74:75], v[74:75], s[50:51], v[228:229] op_sel_hi:[1,1,0]
    v_exp_f32_e64 v68, v68
    v_mfma_f32_16x16x32_bf16 a[232:235], a[88:91], v[60:63], a[232:235]
    v_exp_f32 v69, v69
    v_mfma_f32_16x16x32_bf16 a[236:239], a[92:95], v[60:63], a[236:239]
    v_exp_f32 v70, v70
    v_mfma_f32_16x16x32_bf16 a[240:243], a[164:167], v[60:63], a[240:243]
    v_exp_f32 v71, v71
    v_mfma_f32_16x16x32_bf16 v[144:147], a[20:23], v[24:27], 0
    v_exp_f32 v72, v72
    v_mfma_f32_16x16x32_bf16 v[148:151], a[24:27], v[24:27], 0
    v_exp_f32 v73, v73
    v_exp_f32 v74, v74
    v_exp_f32_e64 v75, v75
    v_cvt_pk_bf16_f32 v68, v68, v69
    v_cvt_pk_bf16_f32 v69, v70, v71
    v_cvt_pk_bf16_f32 v70, v72, v73
    v_cvt_pk_bf16_f32 v71, v74, v75
    buffer_store_dwordx4 v[196:199], v12, s[4:7], s70 offen offset:0 sc1
    v_pk_fma_f32 v[76:77], v[76:77], s[50:51], v[228:229] op_sel_hi:[1,1,0]
    v_pk_fma_f32 v[78:79], v[78:79], s[50:51], v[228:229] op_sel_hi:[1,1,0]
    v_pk_fma_f32 v[80:81], v[80:81], s[50:51], v[228:229] op_sel_hi:[1,1,0]
    v_pk_fma_f32 v[82:83], v[82:83], s[50:51], v[228:229] op_sel_hi:[1,1,0]
    v_exp_f32 v76, v76
    v_mfma_f32_16x16x32_bf16 a[232:235], a[96:99], v[68:71], a[232:235]
    v_exp_f32 v77, v77
    v_mfma_f32_16x16x32_bf16 a[236:239], a[100:103], v[68:71], a[236:239]
    v_exp_f32 v78, v78
    v_mfma_f32_16x16x32_bf16 a[240:243], a[168:171], v[68:71], a[240:243]
    v_exp_f32 v79, v79
    v_mfma_f32_16x16x32_bf16 v[152:155], a[28:31], v[24:27], 0
    v_exp_f32 v80, v80
    v_mfma_f32_16x16x32_bf16 v[156:159], a[32:35], v[24:27], 0
    v_exp_f32 v81, v81
    v_exp_f32 v82, v82
    v_exp_f32 v83, v83
    v_cvt_pk_bf16_f32 v76, v76, v77
    v_cvt_pk_bf16_f32 v77, v78, v79
    v_cvt_pk_bf16_f32 v78, v80, v81
    v_cvt_pk_bf16_f32 v79, v82, v83
    buffer_store_dwordx4 v[200:203], v12, s[4:7], s70 offen offset:1024 sc1
    v_pk_fma_f32 v[84:85], v[84:85], s[50:51], v[228:229] op_sel_hi:[1,1,0]
    v_pk_fma_f32 v[86:87], v[86:87], s[50:51], v[228:229] op_sel_hi:[1,1,0]
    v_pk_fma_f32 v[88:89], v[88:89], s[50:51], v[228:229] op_sel_hi:[1,1,0]
    v_pk_fma_f32 v[90:91], v[90:91], s[50:51], v[228:229] op_sel_hi:[1,1,0]
    v_exp_f32 v84, v84
    v_mfma_f32_16x16x32_bf16 a[232:235], a[104:107], v[76:79], a[232:235]
    v_exp_f32 v85, v85
    v_mfma_f32_16x16x32_bf16 a[236:239], a[108:111], v[76:79], a[236:239]
    v_exp_f32 v86, v86
    s_waitcnt lgkmcnt(14)
    v_mfma_f32_16x16x32_bf16 a[240:243], a[172:175], v[76:79], a[240:243]
    v_exp_f32 v87, v87
    v_mfma_f32_16x16x32_bf16 v[160:163], a[36:39], v[24:27], 0
    v_exp_f32 v88, v88
    v_mfma_f32_16x16x32_bf16 v[164:167], a[40:43], v[24:27], 0
    v_exp_f32 v89, v89
    v_exp_f32 v90, v90
    v_exp_f32_e64 v91, v91
    v_cvt_pk_bf16_f32 v84, v84, v85
    v_cvt_pk_bf16_f32 v85, v86, v87
    v_cvt_pk_bf16_f32 v86, v88, v89
    v_cvt_pk_bf16_f32 v87, v90, v91
    buffer_store_dwordx4 v[204:207], v12, s[4:7], s70 offen offset:2048 sc1
    v_pk_fma_f32 v[92:93], v[92:93], s[50:51], v[228:229] op_sel_hi:[1,1,0]
    v_pk_fma_f32 v[94:95], v[94:95], s[50:51], v[228:229] op_sel_hi:[1,1,0]
    v_pk_fma_f32 v[96:97], v[96:97], s[50:51], v[228:229] op_sel_hi:[1,1,0]
    v_pk_fma_f32 v[98:99], v[98:99], s[50:51], v[228:229] op_sel_hi:[1,1,0]
    v_exp_f32_e64 v92, v92
    v_mfma_f32_16x16x32_bf16 a[232:235], a[112:115], v[84:87], a[232:235]
    v_exp_f32 v93, v93
    v_mfma_f32_16x16x32_bf16 a[236:239], a[116:119], v[84:87], a[236:239]
    v_exp_f32 v94, v94
    s_waitcnt lgkmcnt(13)
    v_mfma_f32_16x16x32_bf16 a[240:243], a[176:179], v[84:87], a[240:243]
    v_exp_f32 v95, v95
    v_mfma_f32_16x16x32_bf16 v[168:171], a[44:47], v[24:27], 0
    v_exp_f32 v96, v96
    v_mfma_f32_16x16x32_bf16 v[172:175], a[48:51], v[24:27], 0
    v_exp_f32 v97, v97
    v_exp_f32 v98, v98
    v_exp_f32 v99, v99
    v_cvt_pk_bf16_f32 v92, v92, v93
    v_cvt_pk_bf16_f32 v93, v94, v95
    v_cvt_pk_bf16_f32 v94, v96, v97
    v_cvt_pk_bf16_f32 v95, v98, v99
    buffer_store_dwordx4 v[208:211], v12, s[4:7], s70 offen offset:3072 sc1
    s_add_u32 s70, s70, 131072
    v_pk_fma_f32 v[100:101], v[100:101], s[50:51], v[228:229] op_sel_hi:[1,1,0]
    v_pk_fma_f32 v[102:103], v[102:103], s[50:51], v[228:229] op_sel_hi:[1,1,0]
    v_pk_fma_f32 v[104:105], v[104:105], s[50:51], v[228:229] op_sel_hi:[1,1,0]
    v_pk_fma_f32 v[106:107], v[106:107], s[50:51], v[228:229] op_sel_hi:[1,1,0]
    v_exp_f32_e64 v100, v100
    v_mfma_f32_16x16x32_bf16 a[232:235], a[120:123], v[92:95], a[232:235]
    v_exp_f32 v101, v101
    v_mfma_f32_16x16x32_bf16 a[236:239], a[124:127], v[92:95], a[236:239]
    v_exp_f32 v102, v102
    s_waitcnt lgkmcnt(12)
    v_mfma_f32_16x16x32_bf16 a[240:243], a[180:183], v[92:95], a[240:243]
    v_exp_f32 v103, v103
    v_mfma_f32_16x16x32_bf16 v[176:179], a[52:55], v[24:27], 0
    v_exp_f32 v104, v104
    v_mfma_f32_16x16x32_bf16 v[180:183], a[56:59], v[24:27], 0
    v_exp_f32 v105, v105
    v_exp_f32 v106, v106
    v_exp_f32 v107, v107
    v_cvt_pk_bf16_f32 v100, v100, v101
    v_cvt_pk_bf16_f32 v101, v102, v103
    v_cvt_pk_bf16_f32 v102, v104, v105
    v_cvt_pk_bf16_f32 v103, v106, v107
    v_pk_fma_f32 v[108:109], v[108:109], s[50:51], v[228:229] op_sel_hi:[1,1,0]
    v_pk_fma_f32 v[110:111], v[110:111], s[50:51], v[228:229] op_sel_hi:[1,1,0]
    v_pk_fma_f32 v[112:113], v[112:113], s[50:51], v[228:229] op_sel_hi:[1,1,0]
    v_pk_fma_f32 v[114:115], v[114:115], s[50:51], v[228:229] op_sel_hi:[1,1,0]
    v_exp_f32 v108, v108
    s_waitcnt lgkmcnt(11)
    v_mfma_f32_16x16x32_bf16 a[232:235], a[128:131], v[100:103], a[232:235]
    v_exp_f32 v109, v109
    s_waitcnt lgkmcnt(10)
    v_mfma_f32_16x16x32_bf16 a[236:239], a[132:135], v[100:103], a[236:239]
    v_exp_f32 v110, v110
    s_waitcnt lgkmcnt(9)
    v_mfma_f32_16x16x32_bf16 a[240:243], a[184:187], v[100:103], a[240:243]
    v_exp_f32_e64 v111, v111
    v_mfma_f32_16x16x32_bf16 v[184:187], a[60:63], v[24:27], 0
    v_exp_f32 v112, v112
    v_mfma_f32_16x16x32_bf16 v[188:191], a[64:67], v[24:27], 0
    v_exp_f32 v113, v113
    v_exp_f32 v114, v114
    v_exp_f32 v115, v115
    v_cvt_pk_bf16_f32 v108, v108, v109
    v_cvt_pk_bf16_f32 v109, v110, v111
    v_cvt_pk_bf16_f32 v110, v112, v113
    v_cvt_pk_bf16_f32 v111, v114, v115
    v_pk_fma_f32 v[116:117], v[116:117], s[50:51], v[228:229] op_sel_hi:[1,1,0]
    v_pk_fma_f32 v[118:119], v[118:119], s[50:51], v[228:229] op_sel_hi:[1,1,0]
    v_exp_f32 v116, v116
    s_waitcnt lgkmcnt(8)
    v_mfma_f32_16x16x32_bf16 a[232:235], a[136:139], v[108:111], a[232:235]
    s_waitcnt lgkmcnt(7)
    v_mfma_f32_16x16x32_bf16 a[236:239], a[140:143], v[108:111], a[236:239]
    v_exp_f32 v117, v117
    s_waitcnt lgkmcnt(6)
    v_mfma_f32_16x16x32_bf16 a[240:243], a[188:191], v[108:111], a[240:243]
    v_mfma_f32_16x16x32_bf16 v[192:195], a[68:71], v[24:27], v[224:227]
    v_exp_f32 v118, v118
    v_exp_f32 v119, v119
    v_cvt_pk_bf16_f32 v116, v116, v117
    v_cvt_pk_bf16_f32 v117, v118, v119
    v_mov_b32 v118, 0
    v_mov_b32 v119, 0
    s_waitcnt lgkmcnt(5)
    s_nop 0
    v_mfma_f32_16x16x32_bf16 a[232:235], a[144:147], v[116:119], a[232:235]
    s_waitcnt lgkmcnt(4)
    v_mfma_f32_16x16x32_bf16 a[236:239], a[148:151], v[116:119], a[236:239]
    s_waitcnt lgkmcnt(3)
    s_nop 0
    v_mfma_f32_16x16x32_bf16 a[240:243], a[192:195], v[116:119], a[240:243]
    v_max3_f32 v228, v128, v129, v130
    v_max3_f32 v229, v131, v132, v133
    v_max3_f32 v228, v228, v134, v135
    v_max3_f32 v229, v229, v136, v137
    v_max3_f32 v228, v228, v138, v139
    v_max3_f32 v229, v229, v140, v141
    v_max3_f32 v228, v228, v142, v143
    v_max3_f32 v229, v229, v144, v145
    v_max3_f32 v228, v228, v146, v147
    v_max3_f32 v229, v229, v148, v149
    v_max3_f32 v228, v228, v150, v151
    v_max3_f32 v229, v229, v152, v153
    v_max3_f32 v228, v228, v154, v155
    v_max3_f32 v229, v229, v156, v157
    v_max3_f32 v228, v228, v158, v159
    v_max3_f32 v229, v229, v160, v161
    v_max3_f32 v228, v228, v162, v163
    v_max3_f32 v229, v229, v164, v165
    v_max3_f32 v228, v228, v166, v167
    v_max3_f32 v229, v229, v168, v169
    v_max3_f32 v228, v228, v170, v171
    v_max3_f32 v229, v229, v172, v173
    v_max3_f32 v228, v228, v174, v175
    v_max3_f32 v229, v229, v176, v177
    v_max3_f32 v228, v228, v178, v179
    v_max3_f32 v229, v229, v180, v181
    v_max3_f32 v228, v228, v182, v183
    v_max3_f32 v229, v229, v184, v185
    v_max3_f32 v228, v228, v186, v187
    v_max3_f32 v229, v229, v188, v189
    v_max3_f32 v228, v228, v190, v191
    v_max3_f32 v229, v229, v192, v193
    v_max3_f32 v228, v228, v194, v195
    v_max_f32 v228, v228, v229
    v_mov_b32 v229, v228
    v_accvgpr_read_b32 v236, a240
    v_accvgpr_read_b32 v248, a232
    v_permlane16_swap_b32 v229, v228
    v_max_f32 v228, v228, v229
    v_mov_b32_e64 v229, v228
    v_accvgpr_read_b32 v249, a233
    v_accvgpr_read_b32 v250, a234
    v_permlane32_swap_b32 v229, v228
    v_max_f32 v228, v228, v229
    v_mul_f32_e64 v228, -s50, v228
    v_accvgpr_read_b32 v251, a235
    v_accvgpr_read_b32 v252, a236
    v_accvgpr_read_b32 v253, a237
    v_accvgpr_read_b32 v254, a238
    v_accvgpr_read_b32 v255, a239
    v_rcp_f32 v236, v236
    s_nop 0
    v_pk_mul_f32 v[248:249], v[248:249], v[236:237] op_sel_hi:[1,0]
    v_pk_mul_f32 v[250:251], v[250:251], v[236:237] op_sel_hi:[1,0]
    v_pk_mul_f32 v[252:253], v[252:253], v[236:237] op_sel_hi:[1,0]
    v_pk_mul_f32 v[254:255], v[254:255], v[236:237] op_sel_hi:[1,0]
    v_cvt_pk_bf16_f32 v240, v248, v249
    v_cvt_pk_bf16_f32 v241, v250, v251
    v_cvt_pk_bf16_f32 v242, v252, v253
    v_cvt_pk_bf16_f32 v243, v254, v255
    buffer_store_dwordx4 v[240:243], v12, s[4:7], s72 offen offset:0 sc1
    s_waitcnt vmcnt(1)
    s_mov_b64 exec, 1
    buffer_store_dword v17, v14, s[4:7], s77 offen offset:0 sc1
    s_mov_b64 exec, -1
    v_pk_fma_f32 v[128:129], v[128:129], s[50:51], v[228:229] op_sel_hi:[1,1,0]
    v_pk_fma_f32 v[130:131], v[130:131], s[50:51], v[228:229] op_sel_hi:[1,1,0]
    v_exp_f32 v128, v128
    v_mfma_f32_16x16x32_bf16 v[52:55], a[8:11], v[28:31], v[220:223]
    v_mfma_f32_16x16x32_bf16 v[56:59], a[12:15], v[28:31], 0
    v_exp_f32 v129, v129
    v_exp_f32 v130, v130
    v_exp_f32 v131, v131
    v_mov_b32 v124, 0
    v_mov_b32_e64 v125, 0
    v_cvt_pk_bf16_f32 v126, v128, v129
    v_cvt_pk_bf16_f32 v127, v130, v131
    v_pk_fma_f32 v[132:133], v[132:133], s[50:51], v[228:229] op_sel_hi:[1,1,0]
    v_pk_fma_f32 v[134:135], v[134:135], s[50:51], v[228:229] op_sel_hi:[1,1,0]
    v_pk_fma_f32 v[136:137], v[136:137], s[50:51], v[228:229] op_sel_hi:[1,1,0]
    v_pk_fma_f32 v[138:139], v[138:139], s[50:51], v[228:229] op_sel_hi:[1,1,0]
    v_exp_f32_e64 v132, v132
    v_mfma_f32_16x16x32_bf16 v[208:211], a[80:83], v[124:127], 0
    v_exp_f32 v133, v133
    v_mfma_f32_16x16x32_bf16 v[212:215], a[84:87], v[124:127], 0
    v_exp_f32 v134, v134
    v_mfma_f32_16x16x32_bf16 v[216:219], a[160:163], v[124:127], 0
    v_exp_f32 v135, v135
    v_mfma_f32_16x16x32_bf16 v[60:63], a[16:19], v[28:31], 0
    v_exp_f32 v136, v136
    v_mfma_f32_16x16x32_bf16 v[64:67], a[20:23], v[28:31], 0
    v_exp_f32 v137, v137
    v_exp_f32 v138, v138
    v_exp_f32_e64 v139, v139
    v_cvt_pk_bf16_f32 v132, v132, v133
    v_cvt_pk_bf16_f32 v133, v134, v135
    v_cvt_pk_bf16_f32 v134, v136, v137
    v_cvt_pk_bf16_f32 v135, v138, v139
    s_add_u32 m0, s66, 65536
    s_add_u32 s85, s75, s83
    buffer_load_dwordx4 v6, s[24:27], s85 offen offset:0 lds
    v_pk_fma_f32 v[140:141], v[140:141], s[50:51], v[228:229] op_sel_hi:[1,1,0]
    v_pk_fma_f32 v[142:143], v[142:143], s[50:51], v[228:229] op_sel_hi:[1,1,0]
    v_pk_fma_f32 v[144:145], v[144:145], s[50:51], v[228:229] op_sel_hi:[1,1,0]
    v_pk_fma_f32 v[146:147], v[146:147], s[50:51], v[228:229] op_sel_hi:[1,1,0]
    v_exp_f32 v140, v140
    v_mfma_f32_16x16x32_bf16 v[208:211], a[88:91], v[132:135], v[208:211]
    v_exp_f32 v141, v141
    v_mfma_f32_16x16x32_bf16 v[212:215], a[92:95], v[132:135], v[212:215]
    v_exp_f32 v142, v142
    v_mfma_f32_16x16x32_bf16 v[216:219], a[164:167], v[132:135], v[216:219]
    v_exp_f32 v143, v143
    v_mfma_f32_16x16x32_bf16 v[68:71], a[24:27], v[28:31], 0
    v_exp_f32 v144, v144
    v_mfma_f32_16x16x32_bf16 v[72:75], a[28:31], v[28:31], 0
    v_exp_f32 v145, v145
    v_exp_f32 v146, v146
    v_exp_f32_e64 v147, v147
    v_cvt_pk_bf16_f32 v140, v140, v141
    v_cvt_pk_bf16_f32 v141, v142, v143
    v_cvt_pk_bf16_f32 v142, v144, v145
    v_cvt_pk_bf16_f32 v143, v146, v147
    v_pk_fma_f32 v[148:149], v[148:149], s[50:51], v[228:229] op_sel_hi:[1,1,0]
    v_pk_fma_f32 v[150:151], v[150:151], s[50:51], v[228:229] op_sel_hi:[1,1,0]
    v_pk_fma_f32 v[152:153], v[152:153], s[50:51], v[228:229] op_sel_hi:[1,1,0]
    v_pk_fma_f32 v[154:155], v[154:155], s[50:51], v[228:229] op_sel_hi:[1,1,0]
    v_exp_f32 v148, v148
    v_mfma_f32_16x16x32_bf16 v[208:211], a[96:99], v[140:143], v[208:211]
    v_exp_f32 v149, v149
    v_mfma_f32_16x16x32_bf16 v[212:215], a[100:103], v[140:143], v[212:215]
    v_exp_f32 v150, v150
    v_mfma_f32_16x16x32_bf16 v[216:219], a[168:171], v[140:143], v[216:219]
    v_exp_f32 v151, v151
    v_mfma_f32_16x16x32_bf16 v[76:79], a[32:35], v[28:31], 0
    v_exp_f32_e64 v152, v152
    v_mfma_f32_16x16x32_bf16 v[80:83], a[36:39], v[28:31], 0
    v_exp_f32 v153, v153
    v_exp_f32 v154, v154
    v_exp_f32_e64 v155, v155
    v_cvt_pk_bf16_f32 v148, v148, v149
    v_cvt_pk_bf16_f32 v149, v150, v151
    v_cvt_pk_bf16_f32 v150, v152, v153
    v_cvt_pk_bf16_f32 v151, v154, v155
    s_add_u32 s85, s85, s84
    s_nop 0
    buffer_load_dwordx4 v7, s[24:27], s85 offen offset:1024 lds
    v_pk_fma_f32 v[156:157], v[156:157], s[50:51], v[228:229] op_sel_hi:[1,1,0]
    v_pk_fma_f32 v[158:159], v[158:159], s[50:51], v[228:229] op_sel_hi:[1,1,0]
    v_pk_fma_f32 v[160:161], v[160:161], s[50:51], v[228:229] op_sel_hi:[1,1,0]
    v_pk_fma_f32 v[162:163], v[162:163], s[50:51], v[228:229] op_sel_hi:[1,1,0]
    v_exp_f32 v156, v156
    v_mfma_f32_16x16x32_bf16 v[208:211], a[104:107], v[148:151], v[208:211]
    v_exp_f32 v157, v157
    v_mfma_f32_16x16x32_bf16 v[212:215], a[108:111], v[148:151], v[212:215]
    v_exp_f32 v158, v158
    v_mfma_f32_16x16x32_bf16 v[216:219], a[172:175], v[148:151], v[216:219]
    v_exp_f32 v159, v159
    v_mfma_f32_16x16x32_bf16 v[84:87], a[40:43], v[28:31], 0
    v_exp_f32_e64 v160, v160
    v_mfma_f32_16x16x32_bf16 v[88:91], a[44:47], v[28:31], 0
    v_exp_f32 v161, v161
    v_exp_f32 v162, v162
    v_exp_f32_e64 v163, v163
    v_cvt_pk_bf16_f32 v156, v156, v157
    v_cvt_pk_bf16_f32 v157, v158, v159
    v_cvt_pk_bf16_f32 v158, v160, v161
    v_cvt_pk_bf16_f32 v159, v162, v163
    v_pk_fma_f32 v[164:165], v[164:165], s[50:51], v[228:229] op_sel_hi:[1,1,0]
    v_pk_fma_f32 v[166:167], v[166:167], s[50:51], v[228:229] op_sel_hi:[1,1,0]
    v_pk_fma_f32 v[168:169], v[168:169], s[50:51], v[228:229] op_sel_hi:[1,1,0]
    v_pk_fma_f32 v[170:171], v[170:171], s[50:51], v[228:229] op_sel_hi:[1,1,0]
    v_exp_f32_e64 v164, v164
    v_mfma_f32_16x16x32_bf16 v[208:211], a[112:115], v[156:159], v[208:211]
    v_exp_f32 v165, v165
    v_mfma_f32_16x16x32_bf16 v[212:215], a[116:119], v[156:159], v[212:215]
    v_exp_f32 v166, v166
    v_mfma_f32_16x16x32_bf16 v[216:219], a[176:179], v[156:159], v[216:219]
    v_exp_f32 v167, v167
    v_mfma_f32_16x16x32_bf16 v[92:95], a[48:51], v[28:31], 0
    v_exp_f32 v168, v168
    v_mfma_f32_16x16x32_bf16 v[96:99], a[52:55], v[28:31], 0
    v_exp_f32 v169, v169
    v_exp_f32 v170, v170
    v_exp_f32_e64 v171, v171
    v_cvt_pk_bf16_f32 v164, v164, v165
    v_cvt_pk_bf16_f32 v165, v166, v167
    v_cvt_pk_bf16_f32 v166, v168, v169
    v_cvt_pk_bf16_f32 v167, v170, v171
    s_add_u32 s85, s85, s84
    buffer_load_dwordx4 v8, s[24:27], s85 offen offset:2048 lds
    v_pk_fma_f32 v[172:173], v[172:173], s[50:51], v[228:229] op_sel_hi:[1,1,0]
    v_pk_fma_f32 v[174:175], v[174:175], s[50:51], v[228:229] op_sel_hi:[1,1,0]
    v_pk_fma_f32 v[176:177], v[176:177], s[50:51], v[228:229] op_sel_hi:[1,1,0]
    v_pk_fma_f32 v[178:179], v[178:179], s[50:51], v[228:229] op_sel_hi:[1,1,0]
    v_exp_f32 v172, v172
    v_mfma_f32_16x16x32_bf16 v[208:211], a[120:123], v[164:167], v[208:211]
    v_exp_f32 v173, v173
    v_mfma_f32_16x16x32_bf16 v[212:215], a[124:127], v[164:167], v[212:215]
    v_exp_f32 v174, v174
    v_mfma_f32_16x16x32_bf16 v[216:219], a[180:183], v[164:167], v[216:219]
    v_exp_f32_e64 v175, v175
    v_mfma_f32_16x16x32_bf16 v[100:103], a[56:59], v[28:31], 0
    v_exp_f32 v176, v176
    v_mfma_f32_16x16x32_bf16 v[104:107], a[60:63], v[28:31], 0
    v_exp_f32 v177, v177
    v_exp_f32 v178, v178
    v_exp_f32 v179, v179
    v_cvt_pk_bf16_f32 v172, v172, v173
    v_cvt_pk_bf16_f32 v173, v174, v175
    v_cvt_pk_bf16_f32 v174, v176, v177
    v_cvt_pk_bf16_f32 v175, v178, v179
    v_pk_fma_f32 v[180:181], v[180:181], s[50:51], v[228:229] op_sel_hi:[1,1,0]
    v_pk_fma_f32 v[182:183], v[182:183], s[50:51], v[228:229] op_sel_hi:[1,1,0]
    v_pk_fma_f32 v[184:185], v[184:185], s[50:51], v[228:229] op_sel_hi:[1,1,0]
    v_pk_fma_f32 v[186:187], v[186:187], s[50:51], v[228:229] op_sel_hi:[1,1,0]
    v_exp_f32 v180, v180
    v_mfma_f32_16x16x32_bf16 v[208:211], a[128:131], v[172:175], v[208:211]
    v_exp_f32 v181, v181
    v_mfma_f32_16x16x32_bf16 v[212:215], a[132:135], v[172:175], v[212:215]
    v_exp_f32_e64 v182, v182
    v_mfma_f32_16x16x32_bf16 v[216:219], a[184:187], v[172:175], v[216:219]
    v_exp_f32 v183, v183
    v_mfma_f32_16x16x32_bf16 v[108:111], a[64:67], v[28:31], 0
    v_exp_f32 v184, v184
    v_mfma_f32_16x16x32_bf16 v[112:115], a[68:71], v[28:31], 0
    v_exp_f32 v185, v185
    v_exp_f32 v186, v186
    v_exp_f32_e64 v187, v187
    v_cvt_pk_bf16_f32 v180, v180, v181
    v_cvt_pk_bf16_f32 v181, v182, v183
    v_cvt_pk_bf16_f32 v182, v184, v185
    v_cvt_pk_bf16_f32 v183, v186, v187
    s_add_u32 s85, s85, s84
    s_nop 0
    buffer_load_dwordx4 v9, s[24:27], s85 offen offset:3072 lds
    s_add_u32 s75, s75, 131072
    v_pk_fma_f32 v[188:189], v[188:189], s[50:51], v[228:229] op_sel_hi:[1,1,0]
    v_pk_fma_f32 v[190:191], v[190:191], s[50:51], v[228:229] op_sel_hi:[1,1,0]
    v_pk_fma_f32 v[192:193], v[192:193], s[50:51], v[228:229] op_sel_hi:[1,1,0]
    v_pk_fma_f32 v[194:195], v[194:195], s[50:51], v[228:229] op_sel_hi:[1,1,0]
    v_exp_f32 v188, v188
    v_mfma_f32_16x16x32_bf16 v[208:211], a[136:139], v[180:183], v[208:211]
    v_exp_f32 v189, v189
    v_mfma_f32_16x16x32_bf16 v[212:215], a[140:143], v[180:183], v[212:215]
    v_exp_f32 v190, v190
    v_mfma_f32_16x16x32_bf16 v[216:219], a[188:191], v[180:183], v[216:219]
    v_exp_f32 v191, v191
    v_mfma_f32_16x16x32_bf16 v[116:119], a[72:75], v[28:31], v[224:227]
    v_exp_f32 v192, v192
    v_exp_f32 v193, v193
    v_exp_f32 v194, v194
    v_exp_f32 v195, v195
    v_cvt_pk_bf16_f32 v188, v188, v189
    v_cvt_pk_bf16_f32 v189, v190, v191
    v_cvt_pk_bf16_f32 v190, v192, v193
    v_cvt_pk_bf16_f32 v191, v194, v195
    s_nop 1
    s_nop 0
    v_mfma_f32_16x16x32_bf16 v[208:211], a[144:147], v[188:191], v[208:211]
    v_mfma_f32_16x16x32_bf16 v[212:215], a[148:151], v[188:191], v[212:215]
    v_mfma_f32_16x16x32_bf16 v[216:219], a[192:195], v[188:191], v[216:219]
    v_max3_f32 v228, v52, v53, v54
    v_max3_f32 v229, v55, v56, v57
    v_max3_f32 v228, v228, v58, v59
    v_max3_f32 v229, v229, v60, v61
    v_max3_f32 v228, v228, v62, v63
    v_max3_f32 v229, v229, v64, v65
    v_max3_f32 v228, v228, v66, v67
    v_max3_f32 v229, v229, v68, v69
    v_max3_f32 v228, v228, v70, v71
    v_max3_f32 v229, v229, v72, v73
    v_max3_f32 v228, v228, v74, v75
    v_max3_f32 v229, v229, v76, v77
    v_max3_f32 v228, v228, v78, v79
    v_max3_f32 v229, v229, v80, v81
    v_max3_f32 v228, v228, v82, v83
    v_max3_f32 v229, v229, v84, v85
    v_max3_f32 v228, v228, v86, v87
    v_max3_f32 v229, v229, v88, v89
    v_max3_f32 v228, v228, v90, v91
    v_max3_f32 v229, v229, v92, v93
    v_max3_f32 v228, v228, v94, v95
    v_max3_f32 v229, v229, v96, v97
    v_max3_f32 v228, v228, v98, v99
    v_max3_f32 v229, v229, v100, v101
    v_max3_f32 v228, v228, v102, v103
    v_max3_f32 v229, v229, v104, v105
    v_max3_f32 v228, v228, v106, v107
    v_max3_f32 v229, v229, v108, v109
    v_max3_f32 v228, v228, v110, v111
    v_max3_f32 v229, v229, v112, v113
    v_max3_f32 v228, v228, v114, v115
    v_max3_f32 v229, v229, v116, v117
    v_max3_f32 v228, v228, v118, v119
    v_max_f32 v228, v228, v229
    v_mov_b32 v229, v228
    v_rcp_f32 v236, v216
    s_nop 0
    v_pk_mul_f32 v[208:209], v[208:209], v[236:237] op_sel_hi:[1,0]
    v_permlane16_swap_b32 v229, v228
    v_max_f32 v228, v228, v229
    v_mov_b32_e64 v229, v228
    v_pk_mul_f32 v[210:211], v[210:211], v[236:237] op_sel_hi:[1,0]
    v_pk_mul_f32 v[212:213], v[212:213], v[236:237] op_sel_hi:[1,0]
    v_permlane32_swap_b32 v229, v228
    v_max_f32 v228, v228, v229
    v_mul_f32_e64 v228, -s50, v228
    v_pk_mul_f32 v[214:215], v[214:215], v[236:237] op_sel_hi:[1,0]
    v_cvt_pk_bf16_f32 v244, v208, v209
    v_cvt_pk_bf16_f32 v245, v210, v211
    v_cvt_pk_bf16_f32 v246, v212, v213
    v_cvt_pk_bf16_f32 v247, v214, v215
    buffer_store_dwordx4 v[244:247], v12, s[4:7], s72 offen offset:1024 sc1
    v_pk_fma_f32 v[52:53], v[52:53], s[50:51], v[228:229] op_sel_hi:[1,1,0]
    v_pk_fma_f32 v[54:55], v[54:55], s[50:51], v[228:229] op_sel_hi:[1,1,0]
    v_pk_fma_f32 v[56:57], v[56:57], s[50:51], v[228:229] op_sel_hi:[1,1,0]
    v_pk_fma_f32 v[58:59], v[58:59], s[50:51], v[228:229] op_sel_hi:[1,1,0]
    v_exp_f32 v52, v52
    v_mfma_f32_16x16x32_bf16 v[128:131], a[12:15], v[32:35], v[220:223]
    v_exp_f32 v53, v53
    v_mfma_f32_16x16x32_bf16 v[132:135], a[16:19], v[32:35], 0
    v_exp_f32 v54, v54
    v_exp_f32 v55, v55
    v_exp_f32 v56, v56
    v_exp_f32 v57, v57
    v_exp_f32 v58, v58
    v_exp_f32 v59, v59
    v_cvt_pk_bf16_f32 v52, v52, v53
    v_cvt_pk_bf16_f32 v53, v54, v55
    v_cvt_pk_bf16_f32 v54, v56, v57
    v_cvt_pk_bf16_f32 v55, v58, v59
    v_pk_fma_f32 v[60:61], v[60:61], s[50:51], v[228:229] op_sel_hi:[1,1,0]
    v_pk_fma_f32 v[62:63], v[62:63], s[50:51], v[228:229] op_sel_hi:[1,1,0]
    v_pk_fma_f32 v[64:65], v[64:65], s[50:51], v[228:229] op_sel_hi:[1,1,0]
    v_pk_fma_f32 v[66:67], v[66:67], s[50:51], v[228:229] op_sel_hi:[1,1,0]
    v_exp_f32_e64 v60, v60
    v_mfma_f32_16x16x32_bf16 v[196:199], a[88:91], v[52:55], 0
    v_exp_f32 v61, v61
    v_mfma_f32_16x16x32_bf16 v[200:203], a[92:95], v[52:55], 0
    v_exp_f32 v62, v62
    v_mfma_f32_16x16x32_bf16 v[204:207], a[164:167], v[52:55], 0
    v_exp_f32 v63, v63
    v_mfma_f32_16x16x32_bf16 v[136:139], a[20:23], v[32:35], 0
    v_exp_f32 v64, v64
    v_mfma_f32_16x16x32_bf16 v[140:143], a[24:27], v[32:35], 0
    v_exp_f32 v65, v65
    v_exp_f32 v66, v66
    v_exp_f32_e64 v67, v67
    v_cvt_pk_bf16_f32 v60, v60, v61
    v_cvt_pk_bf16_f32 v61, v62, v63
    v_cvt_pk_bf16_f32 v62, v64, v65
    v_cvt_pk_bf16_f32 v63, v66, v67
    s_add_u32 m0, s66, 81920
    s_nop 0
    buffer_load_dwordx4 v6, s[24:27], s75 offen offset:0 lds
    v_pk_fma_f32 v[68:69], v[68:69], s[50:51], v[228:229] op_sel_hi:[1,1,0]
    v_pk_fma_f32 v[70:71], v[70:71], s[50:51], v[228:229] op_sel_hi:[1,1,0]
    v_pk_fma_f32 v[72:73], v[72:73], s[50:51], v[228:229] op_sel_hi:[1,1,0]
    v_pk_fma_f32 v[74:75], v[74:75], s[50:51], v[228:229] op_sel_hi:[1,1,0]
    v_exp_f32 v68, v68
    v_mfma_f32_16x16x32_bf16 v[196:199], a[96:99], v[60:63], v[196:199]
    v_exp_f32 v69, v69
    v_mfma_f32_16x16x32_bf16 v[200:203], a[100:103], v[60:63], v[200:203]
    v_exp_f32 v70, v70
    v_mfma_f32_16x16x32_bf16 v[204:207], a[168:171], v[60:63], v[204:207]
    v_exp_f32 v71, v71
    v_mfma_f32_16x16x32_bf16 v[144:147], a[28:31], v[32:35], 0
    v_exp_f32 v72, v72
    v_mfma_f32_16x16x32_bf16 v[148:151], a[32:35], v[32:35], 0
    v_exp_f32 v73, v73
    v_exp_f32 v74, v74
    v_exp_f32_e64 v75, v75
    v_cvt_pk_bf16_f32 v68, v68, v69
    v_cvt_pk_bf16_f32 v69, v70, v71
    v_cvt_pk_bf16_f32 v70, v72, v73
    v_cvt_pk_bf16_f32 v71, v74, v75
    v_pk_fma_f32 v[76:77], v[76:77], s[50:51], v[228:229] op_sel_hi:[1,1,0]
    v_pk_fma_f32 v[78:79], v[78:79], s[50:51], v[228:229] op_sel_hi:[1,1,0]
    v_pk_fma_f32 v[80:81], v[80:81], s[50:51], v[228:229] op_sel_hi:[1,1,0]
    v_pk_fma_f32 v[82:83], v[82:83], s[50:51], v[228:229] op_sel_hi:[1,1,0]
    v_exp_f32 v76, v76
    v_mfma_f32_16x16x32_bf16 v[196:199], a[104:107], v[68:71], v[196:199]
    v_exp_f32 v77, v77
    v_mfma_f32_16x16x32_bf16 v[200:203], a[108:111], v[68:71], v[200:203]
    v_exp_f32 v78, v78
    v_mfma_f32_16x16x32_bf16 v[204:207], a[172:175], v[68:71], v[204:207]
    v_exp_f32 v79, v79
    v_mfma_f32_16x16x32_bf16 v[152:155], a[36:39], v[32:35], 0
    v_exp_f32_e64 v80, v80
    v_mfma_f32_16x16x32_bf16 v[156:159], a[40:43], v[32:35], 0
    v_exp_f32 v81, v81
    v_exp_f32 v82, v82
    v_exp_f32_e64 v83, v83
    v_cvt_pk_bf16_f32 v76, v76, v77
    v_cvt_pk_bf16_f32 v77, v78, v79
    v_cvt_pk_bf16_f32 v78, v80, v81
    v_cvt_pk_bf16_f32 v79, v82, v83
    buffer_load_dwordx4 v7, s[24:27], s75 offen offset:1024 lds
    v_pk_fma_f32 v[84:85], v[84:85], s[50:51], v[228:229] op_sel_hi:[1,1,0]
    v_pk_fma_f32 v[86:87], v[86:87], s[50:51], v[228:229] op_sel_hi:[1,1,0]
    v_pk_fma_f32 v[88:89], v[88:89], s[50:51], v[228:229] op_sel_hi:[1,1,0]
    v_pk_fma_f32 v[90:91], v[90:91], s[50:51], v[228:229] op_sel_hi:[1,1,0]
    v_exp_f32 v84, v84
    v_mfma_f32_16x16x32_bf16 v[196:199], a[112:115], v[76:79], v[196:199]
    v_exp_f32 v85, v85
    v_mfma_f32_16x16x32_bf16 v[200:203], a[116:119], v[76:79], v[200:203]
    v_exp_f32_e64 v86, v86
    v_mfma_f32_16x16x32_bf16 v[204:207], a[176:179], v[76:79], v[204:207]
    v_exp_f32 v87, v87
    v_mfma_f32_16x16x32_bf16 v[160:163], a[44:47], v[32:35], 0
    v_exp_f32 v88, v88
    v_mfma_f32_16x16x32_bf16 v[164:167], a[48:51], v[32:35], 0
    v_exp_f32 v89, v89
    v_exp_f32 v90, v90
    v_exp_f32_e64 v91, v91
    v_cvt_pk_bf16_f32 v84, v84, v85
    v_cvt_pk_bf16_f32 v85, v86, v87
    v_cvt_pk_bf16_f32 v86, v88, v89
    v_cvt_pk_bf16_f32 v87, v90, v91
    v_pk_fma_f32 v[92:93], v[92:93], s[50:51], v[228:229] op_sel_hi:[1,1,0]
    v_pk_fma_f32 v[94:95], v[94:95], s[50:51], v[228:229] op_sel_hi:[1,1,0]
    v_pk_fma_f32 v[96:97], v[96:97], s[50:51], v[228:229] op_sel_hi:[1,1,0]
    v_pk_fma_f32 v[98:99], v[98:99], s[50:51], v[228:229] op_sel_hi:[1,1,0]
    v_exp_f32 v92, v92
    v_mfma_f32_16x16x32_bf16 v[196:199], a[120:123], v[84:87], v[196:199]
    v_exp_f32 v93, v93
    v_mfma_f32_16x16x32_bf16 v[200:203], a[124:127], v[84:87], v[200:203]
    v_exp_f32 v94, v94
    v_mfma_f32_16x16x32_bf16 v[204:207], a[180:183], v[84:87], v[204:207]
    v_exp_f32 v95, v95
    v_mfma_f32_16x16x32_bf16 v[168:171], a[52:55], v[32:35], 0
    v_exp_f32 v96, v96
    v_mfma_f32_16x16x32_bf16 v[172:175], a[56:59], v[32:35], 0
    v_exp_f32 v97, v97
    v_exp_f32 v98, v98
    v_exp_f32 v99, v99
    v_cvt_pk_bf16_f32 v92, v92, v93
    v_cvt_pk_bf16_f32 v93, v94, v95
    v_cvt_pk_bf16_f32 v94, v96, v97
    v_cvt_pk_bf16_f32 v95, v98, v99
    buffer_load_dwordx4 v8, s[24:27], s75 offen offset:2048 lds
    v_pk_fma_f32 v[100:101], v[100:101], s[50:51], v[228:229] op_sel_hi:[1,1,0]
    v_pk_fma_f32 v[102:103], v[102:103], s[50:51], v[228:229] op_sel_hi:[1,1,0]
    v_pk_fma_f32 v[104:105], v[104:105], s[50:51], v[228:229] op_sel_hi:[1,1,0]
    v_pk_fma_f32 v[106:107], v[106:107], s[50:51], v[228:229] op_sel_hi:[1,1,0]
    v_exp_f32 v100, v100
    v_mfma_f32_16x16x32_bf16 v[196:199], a[128:131], v[92:95], v[196:199]
    v_exp_f32 v101, v101
    v_mfma_f32_16x16x32_bf16 v[200:203], a[132:135], v[92:95], v[200:203]
    v_exp_f32_e64 v102, v102
    v_mfma_f32_16x16x32_bf16 v[204:207], a[184:187], v[92:95], v[204:207]
    v_exp_f32 v103, v103
    v_mfma_f32_16x16x32_bf16 v[176:179], a[60:63], v[32:35], 0
    v_exp_f32 v104, v104
    v_mfma_f32_16x16x32_bf16 v[180:183], a[64:67], v[32:35], 0
    v_exp_f32 v105, v105
    v_exp_f32 v106, v106
    v_exp_f32_e64 v107, v107
    v_cvt_pk_bf16_f32 v100, v100, v101
    v_cvt_pk_bf16_f32 v101, v102, v103
    v_cvt_pk_bf16_f32 v102, v104, v105
    v_cvt_pk_bf16_f32 v103, v106, v107
    v_pk_fma_f32 v[108:109], v[108:109], s[50:51], v[228:229] op_sel_hi:[1,1,0]
    v_pk_fma_f32 v[110:111], v[110:111], s[50:51], v[228:229] op_sel_hi:[1,1,0]
    v_pk_fma_f32 v[112:113], v[112:113], s[50:51], v[228:229] op_sel_hi:[1,1,0]
    v_pk_fma_f32 v[114:115], v[114:115], s[50:51], v[228:229] op_sel_hi:[1,1,0]
    v_exp_f32 v108, v108
    v_mfma_f32_16x16x32_bf16 v[196:199], a[136:139], v[100:103], v[196:199]
    v_exp_f32 v109, v109
    v_mfma_f32_16x16x32_bf16 v[200:203], a[140:143], v[100:103], v[200:203]
    v_exp_f32 v110, v110
    v_mfma_f32_16x16x32_bf16 v[204:207], a[188:191], v[100:103], v[204:207]
    v_exp_f32 v111, v111
    v_mfma_f32_16x16x32_bf16 v[184:187], a[68:71], v[32:35], 0
    v_exp_f32 v112, v112
    v_mfma_f32_16x16x32_bf16 v[188:191], a[72:75], v[32:35], 0
    v_exp_f32 v113, v113
    v_exp_f32 v114, v114
    v_exp_f32 v115, v115
    v_cvt_pk_bf16_f32 v108, v108, v109
    v_cvt_pk_bf16_f32 v109, v110, v111
    v_cvt_pk_bf16_f32 v110, v112, v113
    v_cvt_pk_bf16_f32 v111, v114, v115
    buffer_load_dwordx4 v9, s[24:27], s75 offen offset:3072 lds
    s_add_u32 s75, s75, 131072
    v_pk_fma_f32 v[116:117], v[116:117], s[50:51], v[228:229] op_sel_hi:[1,1,0]
    v_pk_fma_f32 v[118:119], v[118:119], s[50:51], v[228:229] op_sel_hi:[1,1,0]
    v_exp_f32_e64 v116, v116
    v_mfma_f32_16x16x32_bf16 v[196:199], a[144:147], v[108:111], v[196:199]
    v_mfma_f32_16x16x32_bf16 v[200:203], a[148:151], v[108:111], v[200:203]
    v_exp_f32_e64 v117, v117
    v_mfma_f32_16x16x32_bf16 v[204:207], a[192:195], v[108:111], v[204:207]
    v_mfma_f32_16x16x32_bf16 v[192:195], a[76:79], v[32:35], v[224:227]
    v_exp_f32 v118, v118
    v_exp_f32 v119, v119
    v_cvt_pk_bf16_f32 v116, v116, v117
    v_cvt_pk_bf16_f32 v117, v118, v119
    v_mov_b32 v118, 0
    v_mov_b32 v119, 0
    buffer_load_dword v48, v49, s[4:7], s78 offen sc1
    s_waitcnt lgkmcnt(2)
    v_mfma_f32_16x16x32_bf16 v[196:199], a[152:155], v[116:119], v[196:199]
    s_waitcnt lgkmcnt(1)
    v_mfma_f32_16x16x32_bf16 v[200:203], a[156:159], v[116:119], v[200:203]
    s_waitcnt lgkmcnt(0)
    s_nop 0
    v_mfma_f32_16x16x32_bf16 v[204:207], a[196:199], v[116:119], v[204:207]
    v_max3_f32 v228, v128, v129, v130
    v_max3_f32 v229, v131, v132, v133
    v_max3_f32 v228, v228, v134, v135
    v_max3_f32 v229, v229, v136, v137
    v_max3_f32 v228, v228, v138, v139
    v_max3_f32 v229, v229, v140, v141
    v_max3_f32 v228, v228, v142, v143
    v_max3_f32 v229, v229, v144, v145
    v_max3_f32 v228, v228, v146, v147
    v_max3_f32 v229, v229, v148, v149
    v_max3_f32 v228, v228, v150, v151
    v_max3_f32 v229, v229, v152, v153
    v_max3_f32 v228, v228, v154, v155
    v_max3_f32 v229, v229, v156, v157
    v_max3_f32 v228, v228, v158, v159
    v_max3_f32 v229, v229, v160, v161
    v_max3_f32 v228, v228, v162, v163
    v_max3_f32 v229, v229, v164, v165
    v_max3_f32 v228, v228, v166, v167
    v_max3_f32 v229, v229, v168, v169
    v_max3_f32 v228, v228, v170, v171
    v_max3_f32 v229, v229, v172, v173
    v_max3_f32 v228, v228, v174, v175
    v_max3_f32 v229, v229, v176, v177
    v_max3_f32 v228, v228, v178, v179
    v_max3_f32 v229, v229, v180, v181
    v_max3_f32 v228, v228, v182, v183
    v_max3_f32 v229, v229, v184, v185
    v_max3_f32 v228, v228, v186, v187
    v_max3_f32 v229, v229, v188, v189
    v_max3_f32 v228, v228, v190, v191
    v_max3_f32 v229, v229, v192, v193
    v_max3_f32 v228, v228, v194, v195
    v_max_f32 v228, v228, v229
    v_mov_b32 v229, v228
    v_rcp_f32 v236, v204
    s_nop 0
    v_pk_mul_f32 v[196:197], v[196:197], v[236:237] op_sel_hi:[1,0]
    v_permlane16_swap_b32 v229, v228
    v_max_f32 v228, v228, v229
    v_mov_b32 v229, v228
    v_pk_mul_f32 v[198:199], v[198:199], v[236:237] op_sel_hi:[1,0]
    v_pk_mul_f32 v[200:201], v[200:201], v[236:237] op_sel_hi:[1,0]
    v_permlane32_swap_b32 v229, v228
    v_max_f32_e64 v228, v228, v229
    v_mul_f32_e64 v228, -s50, v228
    v_pk_mul_f32 v[202:203], v[202:203], v[236:237] op_sel_hi:[1,0]
    v_cvt_pk_bf16_f32 v240, v196, v197
    v_cvt_pk_bf16_f32 v241, v198, v199
    v_cvt_pk_bf16_f32 v242, v200, v201
    v_cvt_pk_bf16_f32 v243, v202, v203
    buffer_store_dwordx4 v[240:243], v12, s[4:7], s72 offen offset:2048 sc1
    s_waitcnt vmcnt(1)
    v_cmp_ne_u32 vcc, 1, v48
    s_cmp_eq_u64 vcc, 0
    s_cbranch_scc1 L_ph_ok_parallel_sum__sliding_block__glu_gated_swiglu__prompt_kernel
L_ph_parallel_sum__sliding_block__glu_gated_swiglu__prompt_kernel:
    s_add_u32 s1, s1, 1
    s_cmp_gt_u32 s1, 0x400000
    s_cbranch_scc1 L_end_parallel_sum__sliding_block__glu_gated_swiglu__prompt_kernel
    buffer_load_dword v48, v49, s[4:7], s78 offen offset:0 sc1
    s_waitcnt vmcnt(0)
    v_cmp_ne_u32 vcc, 1, v48
    s_cmp_eq_u64 vcc, 0
    s_cbranch_scc0 L_ph_parallel_sum__sliding_block__glu_gated_swiglu__prompt_kernel
L_ph_ok_parallel_sum__sliding_block__glu_gated_swiglu__prompt_kernel:
    v_pk_fma_f32 v[128:129], v[128:129], s[50:51], v[228:229] op_sel_hi:[1,1,0]
    v_pk_fma_f32 v[130:131], v[130:131], s[50:51], v[228:229] op_sel_hi:[1,1,0]
    v_exp_f32 v128, v128
    buffer_load_dwordx4 a[0:3], v2, s[4:7], s73 offen sc1
    buffer_load_dwordx4 a[4:7], v3, s[4:7], s73 offen sc1
    v_exp_f32 v129, v129
    v_exp_f32 v130, v130
    v_exp_f32 v131, v131
    v_mov_b32 v124, 0
    v_mov_b32 v125, 0
    v_cvt_pk_bf16_f32 v126, v128, v129
    v_cvt_pk_bf16_f32 v127, v130, v131
    v_pk_fma_f32 v[132:133], v[132:133], s[50:51], v[228:229] op_sel_hi:[1,1,0]
    v_pk_fma_f32 v[134:135], v[134:135], s[50:51], v[228:229] op_sel_hi:[1,1,0]
    v_pk_fma_f32 v[136:137], v[136:137], s[50:51], v[228:229] op_sel_hi:[1,1,0]
    v_pk_fma_f32 v[138:139], v[138:139], s[50:51], v[228:229] op_sel_hi:[1,1,0]
    v_exp_f32_e64 v132, v132
    v_mfma_f32_16x16x32_bf16 v[208:211], a[88:91], v[124:127], 0
    v_exp_f32 v133, v133
    v_mfma_f32_16x16x32_bf16 v[212:215], a[92:95], v[124:127], 0
    v_exp_f32 v134, v134
    v_mfma_f32_16x16x32_bf16 v[216:219], a[164:167], v[124:127], 0
    v_exp_f32 v135, v135
    buffer_load_dwordx4 a[8:11], v4, s[4:7], s73 offen sc1
    v_exp_f32 v136, v136
    buffer_load_dwordx4 a[12:15], v5, s[4:7], s73 offen sc1
    s_add_u32 s73, s73, 131072
    v_exp_f32 v137, v137
    v_exp_f32 v138, v138
    v_exp_f32_e64 v139, v139
    v_cvt_pk_bf16_f32 v132, v132, v133
    v_cvt_pk_bf16_f32 v133, v134, v135
    v_cvt_pk_bf16_f32 v134, v136, v137
    v_cvt_pk_bf16_f32 v135, v138, v139
    v_pk_fma_f32 v[140:141], v[140:141], s[50:51], v[228:229] op_sel_hi:[1,1,0]
    v_pk_fma_f32 v[142:143], v[142:143], s[50:51], v[228:229] op_sel_hi:[1,1,0]
    v_pk_fma_f32 v[144:145], v[144:145], s[50:51], v[228:229] op_sel_hi:[1,1,0]
    v_pk_fma_f32 v[146:147], v[146:147], s[50:51], v[228:229] op_sel_hi:[1,1,0]
    v_exp_f32 v140, v140
    v_mfma_f32_16x16x32_bf16 v[208:211], a[96:99], v[132:135], v[208:211]
    v_exp_f32 v141, v141
    v_mfma_f32_16x16x32_bf16 v[212:215], a[100:103], v[132:135], v[212:215]
    v_exp_f32 v142, v142
    v_mfma_f32_16x16x32_bf16 v[216:219], a[168:171], v[132:135], v[216:219]
    v_exp_f32 v143, v143
    buffer_load_dwordx4 a[16:19], v2, s[4:7], s73 offen sc1
    v_exp_f32 v144, v144
    buffer_load_dwordx4 a[20:23], v3, s[4:7], s73 offen sc1
    v_exp_f32 v145, v145
    v_exp_f32 v146, v146
    v_exp_f32 v147, v147
    v_cvt_pk_bf16_f32 v140, v140, v141
    v_cvt_pk_bf16_f32 v141, v142, v143
    v_cvt_pk_bf16_f32 v142, v144, v145
    v_cvt_pk_bf16_f32 v143, v146, v147
    v_pk_fma_f32 v[148:149], v[148:149], s[50:51], v[228:229] op_sel_hi:[1,1,0]
    v_pk_fma_f32 v[150:151], v[150:151], s[50:51], v[228:229] op_sel_hi:[1,1,0]
    v_pk_fma_f32 v[152:153], v[152:153], s[50:51], v[228:229] op_sel_hi:[1,1,0]
    v_pk_fma_f32 v[154:155], v[154:155], s[50:51], v[228:229] op_sel_hi:[1,1,0]
    v_exp_f32_e64 v148, v148
    v_mfma_f32_16x16x32_bf16 v[208:211], a[104:107], v[140:143], v[208:211]
    v_exp_f32 v149, v149
    v_mfma_f32_16x16x32_bf16 v[212:215], a[108:111], v[140:143], v[212:215]
    v_exp_f32 v150, v150
    v_mfma_f32_16x16x32_bf16 v[216:219], a[172:175], v[140:143], v[216:219]
    v_exp_f32 v151, v151
    buffer_load_dwordx4 a[24:27], v4, s[4:7], s73 offen sc1
    v_exp_f32 v152, v152
    buffer_load_dwordx4 a[28:31], v5, s[4:7], s73 offen sc1
    s_add_u32 s73, s73, 131072
    v_exp_f32 v153, v153
    v_exp_f32 v154, v154
    v_exp_f32_e64 v155, v155
    v_cvt_pk_bf16_f32 v148, v148, v149
    v_cvt_pk_bf16_f32 v149, v150, v151
    v_cvt_pk_bf16_f32 v150, v152, v153
    v_cvt_pk_bf16_f32 v151, v154, v155
    v_pk_fma_f32 v[156:157], v[156:157], s[50:51], v[228:229] op_sel_hi:[1,1,0]
    v_pk_fma_f32 v[158:159], v[158:159], s[50:51], v[228:229] op_sel_hi:[1,1,0]
    v_pk_fma_f32 v[160:161], v[160:161], s[50:51], v[228:229] op_sel_hi:[1,1,0]
    v_pk_fma_f32 v[162:163], v[162:163], s[50:51], v[228:229] op_sel_hi:[1,1,0]
    v_exp_f32 v156, v156
    v_mfma_f32_16x16x32_bf16 v[208:211], a[112:115], v[148:151], v[208:211]
    v_exp_f32 v157, v157
    v_mfma_f32_16x16x32_bf16 v[212:215], a[116:119], v[148:151], v[212:215]
    v_exp_f32 v158, v158
    v_mfma_f32_16x16x32_bf16 v[216:219], a[176:179], v[148:151], v[216:219]
    v_exp_f32 v159, v159
    buffer_load_dwordx4 a[32:35], v2, s[4:7], s73 offen sc1
    v_exp_f32 v160, v160
    buffer_load_dwordx4 a[36:39], v3, s[4:7], s73 offen sc1
    v_exp_f32 v161, v161
    v_exp_f32 v162, v162
    v_exp_f32 v163, v163
    v_cvt_pk_bf16_f32 v156, v156, v157
    v_cvt_pk_bf16_f32 v157, v158, v159
    v_cvt_pk_bf16_f32 v158, v160, v161
    v_cvt_pk_bf16_f32 v159, v162, v163
    v_pk_fma_f32 v[164:165], v[164:165], s[50:51], v[228:229] op_sel_hi:[1,1,0]
    v_pk_fma_f32 v[166:167], v[166:167], s[50:51], v[228:229] op_sel_hi:[1,1,0]
    v_pk_fma_f32 v[168:169], v[168:169], s[50:51], v[228:229] op_sel_hi:[1,1,0]
    v_pk_fma_f32 v[170:171], v[170:171], s[50:51], v[228:229] op_sel_hi:[1,1,0]
    v_exp_f32_e64 v164, v164
    v_mfma_f32_16x16x32_bf16 v[208:211], a[120:123], v[156:159], v[208:211]
    v_exp_f32 v165, v165
    v_mfma_f32_16x16x32_bf16 v[212:215], a[124:127], v[156:159], v[212:215]
    v_exp_f32 v166, v166
    v_mfma_f32_16x16x32_bf16 v[216:219], a[180:183], v[156:159], v[216:219]
    v_exp_f32 v167, v167
    buffer_load_dwordx4 a[40:43], v4, s[4:7], s73 offen sc1
    v_exp_f32 v168, v168
    buffer_load_dwordx4 a[44:47], v5, s[4:7], s73 offen sc1
    s_add_u32 s73, s73, 131072
    v_exp_f32 v169, v169
    v_exp_f32 v170, v170
    v_exp_f32_e64 v171, v171
    v_cvt_pk_bf16_f32 v164, v164, v165
    v_cvt_pk_bf16_f32 v165, v166, v167
    v_cvt_pk_bf16_f32 v166, v168, v169
    v_cvt_pk_bf16_f32 v167, v170, v171
    v_pk_fma_f32 v[172:173], v[172:173], s[50:51], v[228:229] op_sel_hi:[1,1,0]
    v_pk_fma_f32 v[174:175], v[174:175], s[50:51], v[228:229] op_sel_hi:[1,1,0]
    v_pk_fma_f32 v[176:177], v[176:177], s[50:51], v[228:229] op_sel_hi:[1,1,0]
    v_pk_fma_f32 v[178:179], v[178:179], s[50:51], v[228:229] op_sel_hi:[1,1,0]
    v_exp_f32 v172, v172
    v_mfma_f32_16x16x32_bf16 v[208:211], a[128:131], v[164:167], v[208:211]
    v_exp_f32 v173, v173
    v_mfma_f32_16x16x32_bf16 v[212:215], a[132:135], v[164:167], v[212:215]
    v_exp_f32 v174, v174
    v_mfma_f32_16x16x32_bf16 v[216:219], a[184:187], v[164:167], v[216:219]
    v_exp_f32 v175, v175
    buffer_load_dwordx4 a[48:51], v2, s[4:7], s73 offen sc1
    v_exp_f32 v176, v176
    buffer_load_dwordx4 a[52:55], v3, s[4:7], s73 offen sc1
    v_exp_f32 v177, v177
    v_exp_f32 v178, v178
    v_exp_f32 v179, v179
    v_cvt_pk_bf16_f32 v172, v172, v173
    v_cvt_pk_bf16_f32 v173, v174, v175
    v_cvt_pk_bf16_f32 v174, v176, v177
    v_cvt_pk_bf16_f32 v175, v178, v179
    v_pk_fma_f32 v[180:181], v[180:181], s[50:51], v[228:229] op_sel_hi:[1,1,0]
    v_pk_fma_f32 v[182:183], v[182:183], s[50:51], v[228:229] op_sel_hi:[1,1,0]
    v_pk_fma_f32 v[184:185], v[184:185], s[50:51], v[228:229] op_sel_hi:[1,1,0]
    v_pk_fma_f32 v[186:187], v[186:187], s[50:51], v[228:229] op_sel_hi:[1,1,0]
    v_exp_f32_e64 v180, v180
    v_mfma_f32_16x16x32_bf16 v[208:211], a[136:139], v[172:175], v[208:211]
    v_exp_f32 v181, v181
    v_mfma_f32_16x16x32_bf16 v[212:215], a[140:143], v[172:175], v[212:215]
    v_exp_f32 v182, v182
    v_mfma_f32_16x16x32_bf16 v[216:219], a[188:191], v[172:175], v[216:219]
    v_exp_f32 v183, v183
    buffer_load_dwordx4 a[56:59], v4, s[4:7], s73 offen sc1
    v_exp_f32 v184, v184
    buffer_load_dwordx4 a[60:63], v5, s[4:7], s73 offen sc1
    s_add_u32 s73, s73, 131072
    v_exp_f32 v185, v185
    v_exp_f32 v186, v186
    v_exp_f32_e64 v187, v187
    v_cvt_pk_bf16_f32 v180, v180, v181
    v_cvt_pk_bf16_f32 v181, v182, v183
    v_cvt_pk_bf16_f32 v182, v184, v185
    v_cvt_pk_bf16_f32 v183, v186, v187
    v_pk_fma_f32 v[188:189], v[188:189], s[50:51], v[228:229] op_sel_hi:[1,1,0]
    v_pk_fma_f32 v[190:191], v[190:191], s[50:51], v[228:229] op_sel_hi:[1,1,0]
    v_pk_fma_f32 v[192:193], v[192:193], s[50:51], v[228:229] op_sel_hi:[1,1,0]
    v_pk_fma_f32 v[194:195], v[194:195], s[50:51], v[228:229] op_sel_hi:[1,1,0]
    v_exp_f32 v188, v188
    v_mfma_f32_16x16x32_bf16 v[208:211], a[144:147], v[180:183], v[208:211]
    v_exp_f32 v189, v189
    v_mfma_f32_16x16x32_bf16 v[212:215], a[148:151], v[180:183], v[212:215]
    v_exp_f32 v190, v190
    v_mfma_f32_16x16x32_bf16 v[216:219], a[192:195], v[180:183], v[216:219]
    v_exp_f32 v191, v191
    v_exp_f32 v192, v192
    v_exp_f32 v193, v193
    v_exp_f32 v194, v194
    v_exp_f32 v195, v195
    v_cvt_pk_bf16_f32 v188, v188, v189
    v_cvt_pk_bf16_f32 v189, v190, v191
    v_cvt_pk_bf16_f32 v190, v192, v193
    v_cvt_pk_bf16_f32 v191, v194, v195
    s_nop 1
    v_mfma_f32_16x16x32_bf16 v[208:211], a[152:155], v[188:191], v[208:211]
    v_mfma_f32_16x16x32_bf16 v[212:215], a[156:159], v[188:191], v[212:215]
    v_mfma_f32_16x16x32_bf16 v[216:219], a[196:199], v[188:191], v[216:219]
    s_bitcmp1_b32 s2, 0
    s_cbranch_scc1 L_odd_parallel_sum__sliding_block__glu_gated_swiglu__prompt_kernel
    s_nop 0
    ds_read_b64_tr_b16 a[200:201], v36 offset:49152
    ds_read_b64_tr_b16 a[202:203], v36 offset:53248
    ds_read_b64_tr_b16 a[204:205], v36 offset:57344
    ds_read_b64_tr_b16 a[206:207], v36 offset:61440
    ds_read_b64_tr_b16 a[208:209], v37 offset:49152
    ds_read_b64_tr_b16 a[210:211], v37 offset:53248
    ds_read_b64_tr_b16 a[212:213], v37 offset:57344
    ds_read_b64_tr_b16 a[214:215], v37 offset:61440
    ds_read_b64_tr_b16 a[216:217], v38 offset:49152
    ds_read_b64_tr_b16 a[218:219], v38 offset:53248
    ds_read_b64_tr_b16 a[220:221], v38 offset:57344
    ds_read_b64_tr_b16 a[222:223], v38 offset:61440
    v_rcp_f32 v236, v216
    s_nop 0
    v_pk_mul_f32 v[208:209], v[208:209], v[236:237] op_sel_hi:[1,0]
    v_pk_mul_f32 v[210:211], v[210:211], v[236:237] op_sel_hi:[1,0]
    v_pk_mul_f32 v[212:213], v[212:213], v[236:237] op_sel_hi:[1,0]
    v_pk_mul_f32 v[214:215], v[214:215], v[236:237] op_sel_hi:[1,0]
    v_cvt_pk_bf16_f32 v244, v208, v209
    v_cvt_pk_bf16_f32 v245, v210, v211
    v_cvt_pk_bf16_f32 v246, v212, v213
    v_cvt_pk_bf16_f32 v247, v214, v215
    buffer_store_dwordx4 v[244:247], v12, s[4:7], s72 offen offset:3072 sc1
    s_waitcnt vmcnt(9) lgkmcnt(8)
    v_mfma_f32_16x16x32_bf16 v[128:131], a[200:203], a[0:3], 0
    ds_read_b64_tr_b16 a[224:225], v39 offset:49152
    v_mfma_f32_16x16x32_bf16 v[128:131], a[204:207], a[16:19], v[128:131]
    ds_read_b64_tr_b16 a[226:227], v39 offset:53248
    v_mfma_f32_16x16x32_bf16 v[132:135], a[204:207], a[20:23], 0
    ds_read_b64_tr_b16 a[228:229], v39 offset:57344
    v_add_u32 v52, 65536, v36
    v_mfma_f32_16x16x32_bf16 v[132:135], a[200:203], a[4:7], v[132:135]
    ds_read_b64_tr_b16 a[230:231], v39 offset:61440
    v_add_u32 v53, 65536, v37
    v_mfma_f32_16x16x32_bf16 v[136:139], a[200:203], a[8:11], 0
    buffer_load_dwordx4 a[64:67], v2, s[4:7], s73 offen sc1
    v_add_u32 v54, 65536, v38
    v_mfma_f32_16x16x32_bf16 v[136:139], a[204:207], a[24:27], v[136:139]
    buffer_load_dwordx4 a[68:71], v3, s[4:7], s73 offen sc1
    v_add_u32 v55, 65536, v39
    v_mfma_f32_16x16x32_bf16 v[140:143], a[204:207], a[28:31], 0
    v_add_u32 v56, 65536, v40
    v_mfma_f32_16x16x32_bf16 v[140:143], a[200:203], a[12:15], v[140:143]
    v_add_u32 v57, 65536, v41
    s_waitcnt lgkmcnt(8)
    v_mfma_f32_16x16x32_bf16 v[156:159], a[208:211], a[12:15], 0
    ds_read_b64_tr_b16 a[200:201], v40 offset:49152
    v_mfma_f32_16x16x32_bf16 v[156:159], a[212:215], a[28:31], v[156:159]
    ds_read_b64_tr_b16 a[202:203], v40 offset:53248
    v_mfma_f32_16x16x32_bf16 v[152:155], a[212:215], a[24:27], 0
    ds_read_b64_tr_b16 a[204:205], v40 offset:57344
    v_add_u32 v58, 65536, v42
    v_mfma_f32_16x16x32_bf16 v[152:155], a[208:211], a[8:11], v[152:155]
    ds_read_b64_tr_b16 a[206:207], v40 offset:61440
    v_add_u32 v59, 65536, v43
    v_mfma_f32_16x16x32_bf16 v[148:151], a[208:211], a[4:7], 0
    buffer_load_dwordx4 a[72:75], v4, s[4:7], s73 offen sc1
    v_mfma_f32_16x16x32_bf16 v[148:151], a[212:215], a[20:23], v[148:151]
    buffer_load_dwordx4 a[76:79], v5, s[4:7], s73 offen sc1
    s_add_u32 s73, s73, 131072
    v_mfma_f32_16x16x32_bf16 v[144:147], a[212:215], a[16:19], 0
    v_mfma_f32_16x16x32_bf16 v[144:147], a[208:211], a[0:3], v[144:147]
    s_waitcnt lgkmcnt(8)
    v_mfma_f32_16x16x32_bf16 v[160:163], a[216:219], a[0:3], 0
    ds_read_b64_tr_b16 a[208:209], v41 offset:49152
    v_mfma_f32_16x16x32_bf16 v[160:163], a[220:223], a[16:19], v[160:163]
    ds_read_b64_tr_b16 a[210:211], v41 offset:53248
    v_mfma_f32_16x16x32_bf16 v[164:167], a[220:223], a[20:23], 0
    ds_read_b64_tr_b16 a[212:213], v41 offset:57344
    v_mfma_f32_16x16x32_bf16 v[164:167], a[216:219], a[4:7], v[164:167]
    v_mfma_f32_16x16x32_bf16 v[168:171], a[216:219], a[8:11], 0
    ds_read_b64_tr_b16 a[214:215], v41 offset:61440
    v_mfma_f32_16x16x32_bf16 v[168:171], a[220:223], a[24:27], v[168:171]
    buffer_load_dwordx4 a[80:83], v2, s[4:7], s73 offen sc1
    v_mfma_f32_16x16x32_bf16 v[172:175], a[220:223], a[28:31], 0
    v_mfma_f32_16x16x32_bf16 v[172:175], a[216:219], a[12:15], v[172:175]
    s_waitcnt lgkmcnt(8)
    v_mfma_f32_16x16x32_bf16 v[188:191], a[224:227], a[12:15], 0
    ds_read_b64_tr_b16 a[216:217], v42 offset:49152
    v_mfma_f32_16x16x32_bf16 v[188:191], a[228:231], a[28:31], v[188:191]
    ds_read_b64_tr_b16 a[218:219], v42 offset:53248
    v_mfma_f32_16x16x32_bf16 v[184:187], a[228:231], a[24:27], 0
    ds_read_b64_tr_b16 a[220:221], v42 offset:57344
    v_mfma_f32_16x16x32_bf16 v[184:187], a[224:227], a[8:11], v[184:187]
    ds_read_b64_tr_b16 a[222:223], v42 offset:61440
    v_mfma_f32_16x16x32_bf16 v[180:183], a[224:227], a[4:7], 0
    buffer_load_dwordx4 a[84:87], v3, s[4:7], s73 offen sc1
    v_mfma_f32_16x16x32_bf16 v[180:183], a[228:231], a[20:23], v[180:183]
    buffer_load_dwordx4 a[88:91], v4, s[4:7], s73 offen sc1
    v_mfma_f32_16x16x32_bf16 v[176:179], a[228:231], a[16:19], 0
    v_mfma_f32_16x16x32_bf16 v[176:179], a[224:227], a[0:3], v[176:179]
    s_waitcnt lgkmcnt(8)
    v_mfma_f32_16x16x32_bf16 v[192:195], a[200:203], a[0:3], 0
    ds_read_b64_tr_b16 a[224:225], v43 offset:49152
    v_mfma_f32_16x16x32_bf16 v[192:195], a[204:207], a[16:19], v[192:195]
    ds_read_b64_tr_b16 a[226:227], v43 offset:53248
    v_mfma_f32_16x16x32_bf16 v[196:199], a[204:207], a[20:23], 0
    ds_read_b64_tr_b16 a[228:229], v43 offset:57344
    v_mfma_f32_16x16x32_bf16 v[196:199], a[200:203], a[4:7], v[196:199]
    ds_read_b64_tr_b16 a[230:231], v43 offset:61440
    v_mfma_f32_16x16x32_bf16 v[200:203], a[200:203], a[8:11], 0
    buffer_load_dwordx4 a[92:95], v5, s[4:7], s73 offen sc1
    s_add_u32 s73, s73, 131072
    v_mfma_f32_16x16x32_bf16 v[200:203], a[204:207], a[24:27], v[200:203]
    buffer_load_dwordx4 a[96:99], v2, s[4:7], s73 offen sc1
    v_mfma_f32_16x16x32_bf16 v[204:207], a[204:207], a[28:31], 0
    v_mfma_f32_16x16x32_bf16 v[204:207], a[200:203], a[12:15], v[204:207]
    s_waitcnt lgkmcnt(0)
    s_barrier
    v_mfma_f32_16x16x32_bf16 v[220:223], a[208:211], a[12:15], 0
    ds_read_b64_tr_b16 a[200:201], v52 offset:0
    v_mfma_f32_16x16x32_bf16 v[220:223], a[212:215], a[28:31], v[220:223]
    ds_read_b64_tr_b16 a[202:203], v52 offset:4096
    v_mfma_f32_16x16x32_bf16 v[216:219], a[212:215], a[24:27], 0
    ds_read_b64_tr_b16 a[204:205], v52 offset:8192
    v_mfma_f32_16x16x32_bf16 v[216:219], a[208:211], a[8:11], v[216:219]
    v_mfma_f32_16x16x32_bf16 v[212:215], a[208:211], a[4:7], 0
    ds_read_b64_tr_b16 a[206:207], v52 offset:12288
    v_mfma_f32_16x16x32_bf16 v[212:215], a[212:215], a[20:23], v[212:215]
    s_add_u32 m0, s66, 0
    s_nop 0
    buffer_load_dwordx4 v6, s[24:27], s75 offen offset:0 lds
    v_mfma_f32_16x16x32_bf16 v[208:211], a[212:215], a[16:19], 0
    v_mfma_f32_16x16x32_bf16 v[208:211], a[208:211], a[0:3], v[208:211]
    v_mfma_f32_16x16x32_bf16 v[224:227], a[216:219], a[0:3], 0
    ds_read_b64_tr_b16 a[208:209], v53 offset:0
    v_mfma_f32_16x16x32_bf16 v[224:227], a[220:223], a[16:19], v[224:227]
    ds_read_b64_tr_b16 a[210:211], v53 offset:4096
    v_mfma_f32_16x16x32_bf16 v[228:231], a[220:223], a[20:23], 0
    ds_read_b64_tr_b16 a[212:213], v53 offset:8192
    v_mfma_f32_16x16x32_bf16 v[228:231], a[216:219], a[4:7], v[228:231]
    ds_read_b64_tr_b16 a[214:215], v53 offset:12288
    v_mfma_f32_16x16x32_bf16 v[232:235], a[216:219], a[8:11], 0
    buffer_load_dwordx4 v7, s[24:27], s75 offen offset:1024 lds
    v_mfma_f32_16x16x32_bf16 v[232:235], a[220:223], a[24:27], v[232:235]
    buffer_load_dwordx4 v8, s[24:27], s75 offen offset:2048 lds
    v_mfma_f32_16x16x32_bf16 v[236:239], a[220:223], a[28:31], 0
    v_mfma_f32_16x16x32_bf16 v[236:239], a[216:219], a[12:15], v[236:239]
    v_mfma_f32_16x16x32_bf16 v[252:255], a[224:227], a[12:15], 0
    ds_read_b64_tr_b16 a[216:217], v54 offset:0
    v_mfma_f32_16x16x32_bf16 v[252:255], a[228:231], a[28:31], v[252:255]
    ds_read_b64_tr_b16 a[218:219], v54 offset:4096
    v_mfma_f32_16x16x32_bf16 v[248:251], a[228:231], a[24:27], 0
    ds_read_b64_tr_b16 a[220:221], v54 offset:8192
    v_mfma_f32_16x16x32_bf16 v[248:251], a[224:227], a[8:11], v[248:251]
    v_mfma_f32_16x16x32_bf16 v[244:247], a[224:227], a[4:7], 0
    ds_read_b64_tr_b16 a[222:223], v54 offset:12288
    v_mfma_f32_16x16x32_bf16 v[244:247], a[228:231], a[20:23], v[244:247]
    buffer_load_dwordx4 v9, s[24:27], s75 offen offset:3072 lds
    s_add_u32 s75, s75, 131072
    v_mfma_f32_16x16x32_bf16 v[240:243], a[228:231], a[16:19], 0
    v_mfma_f32_16x16x32_bf16 v[240:243], a[224:227], a[0:3], v[240:243]
    s_waitcnt vmcnt(14) lgkmcnt(8)
    v_mfma_f32_16x16x32_bf16 v[128:131], a[200:203], a[32:35], v[128:131]
    ds_read_b64_tr_b16 a[224:225], v55 offset:0
    v_mfma_f32_16x16x32_bf16 v[128:131], a[204:207], a[48:51], v[128:131]
    ds_read_b64_tr_b16 a[226:227], v55 offset:4096
    v_mfma_f32_16x16x32_bf16 v[132:135], a[204:207], a[52:55], v[132:135]
    ds_read_b64_tr_b16 a[228:229], v55 offset:8192
    s_sub_u32 s61, s78, 512
    v_mfma_f32_16x16x32_bf16 v[132:135], a[200:203], a[36:39], v[132:135]
    ds_read_b64_tr_b16 a[230:231], v55 offset:12288
    v_add_u32 v29, 512, v49
    v_mfma_f32_16x16x32_bf16 v[136:139], a[200:203], a[40:43], v[136:139]
    buffer_load_dwordx4 a[100:103], v3, s[4:7], s73 offen sc1
    s_bitcmp1_b32 s44, 0
    s_mov_b32 s62, 1024
    s_cselect_b32 s62, 24, s62
    v_mfma_f32_16x16x32_bf16 v[136:139], a[204:207], a[56:59], v[136:139]
    buffer_load_dwordx4 a[104:107], v4, s[4:7], s73 offen sc1
    v_subrev_u32 v28, 8, v0
    v_mfma_f32_16x16x32_bf16 v[140:143], a[204:207], a[60:63], v[140:143]
    v_cmp_gt_u32 vcc, 2, v28
    v_add_u32 v28, s62, v49
    s_nop 0
    v_cndmask_b32 v29, v29, v28, vcc
    v_mfma_f32_16x16x32_bf16 v[140:143], a[200:203], a[44:47], v[140:143]
    s_waitcnt lgkmcnt(8)
    v_mfma_f32_16x16x32_bf16 v[156:159], a[208:211], a[44:47], v[156:159]
    ds_read_b64_tr_b16 a[200:201], v56 offset:0
    v_mfma_f32_16x16x32_bf16 v[156:159], a[212:215], a[60:63], v[156:159]
    ds_read_b64_tr_b16 a[202:203], v56 offset:4096
    v_mfma_f32_16x16x32_bf16 v[152:155], a[212:215], a[56:59], v[152:155]
    ds_read_b64_tr_b16 a[204:205], v56 offset:8192
    v_mfma_f32_16x16x32_bf16 v[152:155], a[208:211], a[40:43], v[152:155]
    ds_read_b64_tr_b16 a[206:207], v56 offset:12288
    v_mfma_f32_16x16x32_bf16 v[148:151], a[208:211], a[36:39], v[148:151]
    buffer_load_dwordx4 a[108:111], v5, s[4:7], s73 offen sc1
    s_add_u32 s73, s73, 131072
    v_mfma_f32_16x16x32_bf16 v[148:151], a[212:215], a[52:55], v[148:151]
    buffer_load_dwordx4 a[112:115], v2, s[4:7], s73 offen sc1
    v_mfma_f32_16x16x32_bf16 v[144:147], a[212:215], a[48:51], v[144:147]
    v_mfma_f32_16x16x32_bf16 v[144:147], a[208:211], a[32:35], v[144:147]
    s_waitcnt lgkmcnt(8)
    v_mfma_f32_16x16x32_bf16 v[160:163], a[216:219], a[32:35], v[160:163]
    ds_read_b64_tr_b16 a[208:209], v57 offset:0
    v_mfma_f32_16x16x32_bf16 v[160:163], a[220:223], a[48:51], v[160:163]
    ds_read_b64_tr_b16 a[210:211], v57 offset:4096
    v_mfma_f32_16x16x32_bf16 v[164:167], a[220:223], a[52:55], v[164:167]
    ds_read_b64_tr_b16 a[212:213], v57 offset:8192
    v_mfma_f32_16x16x32_bf16 v[164:167], a[216:219], a[36:39], v[164:167]
    v_mfma_f32_16x16x32_bf16 v[168:171], a[216:219], a[40:43], v[168:171]
    ds_read_b64_tr_b16 a[214:215], v57 offset:12288
    v_mfma_f32_16x16x32_bf16 v[168:171], a[220:223], a[56:59], v[168:171]
    buffer_load_dwordx4 a[116:119], v3, s[4:7], s73 offen sc1
    v_mfma_f32_16x16x32_bf16 v[172:175], a[220:223], a[60:63], v[172:175]
    v_mfma_f32_16x16x32_bf16 v[172:175], a[216:219], a[44:47], v[172:175]
    s_waitcnt lgkmcnt(8)
    v_mfma_f32_16x16x32_bf16 v[188:191], a[224:227], a[44:47], v[188:191]
    ds_read_b64_tr_b16 a[216:217], v58 offset:0
    v_mfma_f32_16x16x32_bf16 v[188:191], a[228:231], a[60:63], v[188:191]
    ds_read_b64_tr_b16 a[218:219], v58 offset:4096
    v_mfma_f32_16x16x32_bf16 v[184:187], a[228:231], a[56:59], v[184:187]
    ds_read_b64_tr_b16 a[220:221], v58 offset:8192
    v_mfma_f32_16x16x32_bf16 v[184:187], a[224:227], a[40:43], v[184:187]
    ds_read_b64_tr_b16 a[222:223], v58 offset:12288
    v_mfma_f32_16x16x32_bf16 v[180:183], a[224:227], a[36:39], v[180:183]
    buffer_load_dwordx4 a[120:123], v4, s[4:7], s73 offen sc1
    v_mfma_f32_16x16x32_bf16 v[180:183], a[228:231], a[52:55], v[180:183]
    buffer_load_dwordx4 a[124:127], v5, s[4:7], s73 offen sc1
    s_add_u32 s73, s73, 131072
    v_mfma_f32_16x16x32_bf16 v[176:179], a[228:231], a[48:51], v[176:179]
    v_mfma_f32_16x16x32_bf16 v[176:179], a[224:227], a[32:35], v[176:179]
    s_waitcnt lgkmcnt(8)
    v_mfma_f32_16x16x32_bf16 v[192:195], a[200:203], a[32:35], v[192:195]
    ds_read_b64_tr_b16 a[224:225], v59 offset:0
    v_mfma_f32_16x16x32_bf16 v[192:195], a[204:207], a[48:51], v[192:195]
    ds_read_b64_tr_b16 a[226:227], v59 offset:4096
    v_mfma_f32_16x16x32_bf16 v[196:199], a[204:207], a[52:55], v[196:199]
    ds_read_b64_tr_b16 a[228:229], v59 offset:8192
    v_mfma_f32_16x16x32_bf16 v[196:199], a[200:203], a[36:39], v[196:199]
    ds_read_b64_tr_b16 a[230:231], v59 offset:12288
    v_mfma_f32_16x16x32_bf16 v[200:203], a[200:203], a[40:43], v[200:203]
    buffer_load_dwordx4 a[128:131], v2, s[4:7], s73 offen sc1
    v_mfma_f32_16x16x32_bf16 v[200:203], a[204:207], a[56:59], v[200:203]
    buffer_load_dwordx4 a[132:135], v3, s[4:7], s73 offen sc1
    v_mfma_f32_16x16x32_bf16 v[204:207], a[204:207], a[60:63], v[204:207]
    v_mfma_f32_16x16x32_bf16 v[204:207], a[200:203], a[44:47], v[204:207]
    s_waitcnt lgkmcnt(0)
    s_barrier
    v_mfma_f32_16x16x32_bf16 v[220:223], a[208:211], a[44:47], v[220:223]
    ds_read_b64_tr_b16 a[200:201], v52 offset:16384
    v_mfma_f32_16x16x32_bf16 v[220:223], a[212:215], a[60:63], v[220:223]
    ds_read_b64_tr_b16 a[202:203], v52 offset:20480
    v_mfma_f32_16x16x32_bf16 v[216:219], a[212:215], a[56:59], v[216:219]
    ds_read_b64_tr_b16 a[204:205], v52 offset:24576
    v_mfma_f32_16x16x32_bf16 v[216:219], a[208:211], a[40:43], v[216:219]
    v_mfma_f32_16x16x32_bf16 v[212:215], a[208:211], a[36:39], v[212:215]
    ds_read_b64_tr_b16 a[206:207], v52 offset:28672
    v_mfma_f32_16x16x32_bf16 v[212:215], a[212:215], a[52:55], v[212:215]
    s_add_u32 m0, s66, 16384
    s_nop 0
    buffer_load_dwordx4 v6, s[24:27], s75 offen offset:0 lds
    v_mfma_f32_16x16x32_bf16 v[208:211], a[212:215], a[48:51], v[208:211]
    v_mfma_f32_16x16x32_bf16 v[208:211], a[208:211], a[32:35], v[208:211]
    v_mfma_f32_16x16x32_bf16 v[224:227], a[216:219], a[32:35], v[224:227]
    ds_read_b64_tr_b16 a[208:209], v53 offset:16384
    v_mfma_f32_16x16x32_bf16 v[224:227], a[220:223], a[48:51], v[224:227]
    ds_read_b64_tr_b16 a[210:211], v53 offset:20480
    v_mfma_f32_16x16x32_bf16 v[228:231], a[220:223], a[52:55], v[228:231]
    ds_read_b64_tr_b16 a[212:213], v53 offset:24576
    v_mfma_f32_16x16x32_bf16 v[228:231], a[216:219], a[36:39], v[228:231]
    ds_read_b64_tr_b16 a[214:215], v53 offset:28672
    v_mfma_f32_16x16x32_bf16 v[232:235], a[216:219], a[40:43], v[232:235]
    buffer_load_dwordx4 v7, s[24:27], s75 offen offset:1024 lds
    v_mfma_f32_16x16x32_bf16 v[232:235], a[220:223], a[56:59], v[232:235]
    buffer_load_dwordx4 v8, s[24:27], s75 offen offset:2048 lds
    v_mfma_f32_16x16x32_bf16 v[236:239], a[220:223], a[60:63], v[236:239]
    v_mfma_f32_16x16x32_bf16 v[236:239], a[216:219], a[44:47], v[236:239]
    v_mfma_f32_16x16x32_bf16 v[252:255], a[224:227], a[44:47], v[252:255]
    ds_read_b64_tr_b16 a[216:217], v54 offset:16384
    v_mfma_f32_16x16x32_bf16 v[252:255], a[228:231], a[60:63], v[252:255]
    ds_read_b64_tr_b16 a[218:219], v54 offset:20480
    v_mfma_f32_16x16x32_bf16 v[248:251], a[228:231], a[56:59], v[248:251]
    ds_read_b64_tr_b16 a[220:221], v54 offset:24576
    v_mfma_f32_16x16x32_bf16 v[248:251], a[224:227], a[40:43], v[248:251]
    v_mfma_f32_16x16x32_bf16 v[244:247], a[224:227], a[36:39], v[244:247]
    ds_read_b64_tr_b16 a[222:223], v54 offset:28672
    v_mfma_f32_16x16x32_bf16 v[244:247], a[228:231], a[52:55], v[244:247]
    buffer_load_dwordx4 v9, s[24:27], s75 offen offset:3072 lds
    s_add_u32 s75, s75, 131072
    v_mfma_f32_16x16x32_bf16 v[240:243], a[228:231], a[48:51], v[240:243]
    v_mfma_f32_16x16x32_bf16 v[240:243], a[224:227], a[32:35], v[240:243]
    s_waitcnt vmcnt(26)
    s_mov_b64 exec, 1
    buffer_store_dword v17, v14, s[4:7], s77 offen offset:32 sc1
    s_mov_b64 exec, -1
    s_waitcnt vmcnt(19) lgkmcnt(8)
    v_mfma_f32_16x16x32_bf16 v[128:131], a[200:203], a[64:67], v[128:131]
    ds_read_b64_tr_b16 a[224:225], v55 offset:16384
    v_mfma_f32_16x16x32_bf16 v[128:131], a[204:207], a[80:83], v[128:131]
    ds_read_b64_tr_b16 a[226:227], v55 offset:20480
    v_mfma_f32_16x16x32_bf16 v[132:135], a[204:207], a[84:87], v[132:135]
    ds_read_b64_tr_b16 a[228:229], v55 offset:24576
    v_mfma_f32_16x16x32_bf16 v[132:135], a[200:203], a[68:71], v[132:135]
    ds_read_b64_tr_b16 a[230:231], v55 offset:28672
    v_mfma_f32_16x16x32_bf16 v[136:139], a[200:203], a[72:75], v[136:139]
    buffer_load_dwordx4 a[136:139], v4, s[4:7], s73 offen sc1
    v_mfma_f32_16x16x32_bf16 v[136:139], a[204:207], a[88:91], v[136:139]
    buffer_load_dwordx4 a[140:143], v5, s[4:7], s73 offen sc1
    s_add_u32 s73, s73, 131072
    v_mfma_f32_16x16x32_bf16 v[140:143], a[204:207], a[92:95], v[140:143]
    v_mfma_f32_16x16x32_bf16 v[140:143], a[200:203], a[76:79], v[140:143]
    s_waitcnt lgkmcnt(8)
    v_mfma_f32_16x16x32_bf16 v[156:159], a[208:211], a[76:79], v[156:159]
    ds_read_b64_tr_b16 a[200:201], v56 offset:16384
    v_mfma_f32_16x16x32_bf16 v[156:159], a[212:215], a[92:95], v[156:159]
    ds_read_b64_tr_b16 a[202:203], v56 offset:20480
    v_mfma_f32_16x16x32_bf16 v[152:155], a[212:215], a[88:91], v[152:155]
    ds_read_b64_tr_b16 a[204:205], v56 offset:24576
    v_mfma_f32_16x16x32_bf16 v[152:155], a[208:211], a[72:75], v[152:155]
    ds_read_b64_tr_b16 a[206:207], v56 offset:28672
    v_mfma_f32_16x16x32_bf16 v[148:151], a[208:211], a[68:71], v[148:151]
    buffer_load_dwordx4 a[144:147], v2, s[4:7], s73 offen sc1
    v_mfma_f32_16x16x32_bf16 v[148:151], a[212:215], a[84:87], v[148:151]
    buffer_load_dwordx4 a[148:151], v3, s[4:7], s73 offen sc1
    v_mfma_f32_16x16x32_bf16 v[144:147], a[212:215], a[80:83], v[144:147]
    v_mfma_f32_16x16x32_bf16 v[144:147], a[208:211], a[64:67], v[144:147]
    s_waitcnt lgkmcnt(8)
    v_mfma_f32_16x16x32_bf16 v[160:163], a[216:219], a[64:67], v[160:163]
    ds_read_b64_tr_b16 a[208:209], v57 offset:16384
    v_mfma_f32_16x16x32_bf16 v[160:163], a[220:223], a[80:83], v[160:163]
    ds_read_b64_tr_b16 a[210:211], v57 offset:20480
    v_mfma_f32_16x16x32_bf16 v[164:167], a[220:223], a[84:87], v[164:167]
    ds_read_b64_tr_b16 a[212:213], v57 offset:24576
    v_mfma_f32_16x16x32_bf16 v[164:167], a[216:219], a[68:71], v[164:167]
    ds_read_b64_tr_b16 a[214:215], v57 offset:28672
    v_mfma_f32_16x16x32_bf16 v[168:171], a[216:219], a[72:75], v[168:171]
    buffer_load_dwordx4 a[152:155], v4, s[4:7], s73 offen sc1
    v_mfma_f32_16x16x32_bf16 v[168:171], a[220:223], a[88:91], v[168:171]
    buffer_load_dwordx4 a[156:159], v5, s[4:7], s73 offen sc1
    s_add_u32 s73, s73, 131072
    v_mfma_f32_16x16x32_bf16 v[172:175], a[220:223], a[92:95], v[172:175]
    v_mfma_f32_16x16x32_bf16 v[172:175], a[216:219], a[76:79], v[172:175]
    s_waitcnt lgkmcnt(8)
    v_mfma_f32_16x16x32_bf16 v[188:191], a[224:227], a[76:79], v[188:191]
    ds_read_b64_tr_b16 a[216:217], v58 offset:16384
    v_mfma_f32_16x16x32_bf16 v[188:191], a[228:231], a[92:95], v[188:191]
    ds_read_b64_tr_b16 a[218:219], v58 offset:20480
    v_mfma_f32_16x16x32_bf16 v[184:187], a[228:231], a[88:91], v[184:187]
    ds_read_b64_tr_b16 a[220:221], v58 offset:24576
    v_mfma_f32_16x16x32_bf16 v[184:187], a[224:227], a[72:75], v[184:187]
    ds_read_b64_tr_b16 a[222:223], v58 offset:28672
    v_mfma_f32_16x16x32_bf16 v[180:183], a[224:227], a[68:71], v[180:183]
    buffer_load_dwordx4 a[0:3], v2, s[4:7], s73 offen sc1
    v_mfma_f32_16x16x32_bf16 v[180:183], a[228:231], a[84:87], v[180:183]
    buffer_load_dwordx4 a[4:7], v3, s[4:7], s73 offen sc1
    v_mfma_f32_16x16x32_bf16 v[176:179], a[228:231], a[80:83], v[176:179]
    v_mfma_f32_16x16x32_bf16 v[176:179], a[224:227], a[64:67], v[176:179]
    s_waitcnt lgkmcnt(8)
    v_mfma_f32_16x16x32_bf16 v[192:195], a[200:203], a[64:67], v[192:195]
    ds_read_b64_tr_b16 a[224:225], v59 offset:16384
    v_mfma_f32_16x16x32_bf16 v[192:195], a[204:207], a[80:83], v[192:195]
    ds_read_b64_tr_b16 a[226:227], v59 offset:20480
    v_mfma_f32_16x16x32_bf16 v[196:199], a[204:207], a[84:87], v[196:199]
    ds_read_b64_tr_b16 a[228:229], v59 offset:24576
    v_mfma_f32_16x16x32_bf16 v[196:199], a[200:203], a[68:71], v[196:199]
    ds_read_b64_tr_b16 a[230:231], v59 offset:28672
    v_mfma_f32_16x16x32_bf16 v[200:203], a[200:203], a[72:75], v[200:203]
    buffer_load_dwordx4 a[8:11], v4, s[4:7], s73 offen sc1
    v_mfma_f32_16x16x32_bf16 v[200:203], a[204:207], a[88:91], v[200:203]
    buffer_load_dwordx4 a[12:15], v5, s[4:7], s73 offen sc1
    s_add_u32 s73, s73, 131072
    v_mfma_f32_16x16x32_bf16 v[204:207], a[204:207], a[92:95], v[204:207]
    v_mfma_f32_16x16x32_bf16 v[204:207], a[200:203], a[76:79], v[204:207]
    s_waitcnt vmcnt(24) lgkmcnt(0)
    s_barrier
    v_mfma_f32_16x16x32_bf16 v[220:223], a[208:211], a[76:79], v[220:223]
    ds_read_b64_tr_b16 a[200:201], v36 offset:0
    v_mfma_f32_16x16x32_bf16 v[220:223], a[212:215], a[92:95], v[220:223]
    ds_read_b64_tr_b16 a[202:203], v36 offset:4096
    v_mfma_f32_16x16x32_bf16 v[216:219], a[212:215], a[88:91], v[216:219]
    ds_read_b64_tr_b16 a[204:205], v36 offset:8192
    v_mfma_f32_16x16x32_bf16 v[216:219], a[208:211], a[72:75], v[216:219]
    ds_read_b64_tr_b16 a[206:207], v36 offset:12288
    v_mfma_f32_16x16x32_bf16 v[212:215], a[208:211], a[68:71], v[212:215]
    s_add_u32 m0, s66, 32768
    s_add_u32 s85, s75, s81
    buffer_load_dwordx4 v6, s[24:27], s85 offen offset:0 lds
    v_mfma_f32_16x16x32_bf16 v[212:215], a[212:215], a[84:87], v[212:215]
    s_add_u32 s85, s85, s82
    buffer_load_dwordx4 v7, s[24:27], s85 offen offset:1024 lds
    v_mfma_f32_16x16x32_bf16 v[208:211], a[212:215], a[80:83], v[208:211]
    v_mfma_f32_16x16x32_bf16 v[208:211], a[208:211], a[64:67], v[208:211]
    v_mfma_f32_16x16x32_bf16 v[224:227], a[216:219], a[64:67], v[224:227]
    ds_read_b64_tr_b16 a[208:209], v37 offset:0
    v_mfma_f32_16x16x32_bf16 v[224:227], a[220:223], a[80:83], v[224:227]
    ds_read_b64_tr_b16 a[210:211], v37 offset:4096
    v_mfma_f32_16x16x32_bf16 v[228:231], a[220:223], a[84:87], v[228:231]
    ds_read_b64_tr_b16 a[212:213], v37 offset:8192
    v_mfma_f32_16x16x32_bf16 v[228:231], a[216:219], a[68:71], v[228:231]
    ds_read_b64_tr_b16 a[214:215], v37 offset:12288
    v_mfma_f32_16x16x32_bf16 v[232:235], a[216:219], a[72:75], v[232:235]
    s_add_u32 s85, s85, s82
    buffer_load_dwordx4 v8, s[24:27], s85 offen offset:2048 lds
    v_mfma_f32_16x16x32_bf16 v[232:235], a[220:223], a[88:91], v[232:235]
    s_add_u32 s85, s85, s82
    buffer_load_dwordx4 v9, s[24:27], s85 offen offset:3072 lds
    s_add_u32 s75, s75, 131072
    v_mfma_f32_16x16x32_bf16 v[236:239], a[220:223], a[92:95], v[236:239]
    v_mfma_f32_16x16x32_bf16 v[236:239], a[216:219], a[76:79], v[236:239]
    v_mfma_f32_16x16x32_bf16 v[252:255], a[224:227], a[76:79], v[252:255]
    ds_read_b64_tr_b16 a[216:217], v38 offset:0
    v_mfma_f32_16x16x32_bf16 v[252:255], a[228:231], a[92:95], v[252:255]
    ds_read_b64_tr_b16 a[218:219], v38 offset:4096
    v_mfma_f32_16x16x32_bf16 v[248:251], a[228:231], a[88:91], v[248:251]
    ds_read_b64_tr_b16 a[220:221], v38 offset:8192
    v_mfma_f32_16x16x32_bf16 v[248:251], a[224:227], a[72:75], v[248:251]
    v_mfma_f32_16x16x32_bf16 v[244:247], a[224:227], a[68:71], v[244:247]
    ds_read_b64_tr_b16 a[222:223], v38 offset:12288
    v_mfma_f32_16x16x32_bf16 v[244:247], a[228:231], a[84:87], v[244:247]
    s_add_u32 m0, s66, 49152
    s_nop 0
    buffer_load_dwordx4 v6, s[24:27], s75 offen offset:0 lds
    v_mfma_f32_16x16x32_bf16 v[240:243], a[228:231], a[80:83], v[240:243]
    v_mfma_f32_16x16x32_bf16 v[240:243], a[224:227], a[64:67], v[240:243]
    s_waitcnt vmcnt(22) lgkmcnt(8)
    v_mfma_f32_16x16x32_bf16 v[128:131], a[200:203], a[96:99], v[128:131]
    ds_read_b64_tr_b16 a[224:225], v39 offset:0
    v_mfma_f32_16x16x32_bf16 v[128:131], a[204:207], a[112:115], v[128:131]
    ds_read_b64_tr_b16 a[226:227], v39 offset:4096
    v_mfma_f32_16x16x32_bf16 v[132:135], a[204:207], a[116:119], v[132:135]
    ds_read_b64_tr_b16 a[228:229], v39 offset:8192
    v_mfma_f32_16x16x32_bf16 v[132:135], a[200:203], a[100:103], v[132:135]
    ds_read_b64_tr_b16 a[230:231], v39 offset:12288
    v_mfma_f32_16x16x32_bf16 v[136:139], a[200:203], a[104:107], v[136:139]
    buffer_load_dwordx4 a[16:19], v2, s[4:7], s73 offen sc1
    v_mfma_f32_16x16x32_bf16 v[136:139], a[204:207], a[120:123], v[136:139]
    buffer_load_dwordx4 a[20:23], v3, s[4:7], s73 offen sc1
    v_mfma_f32_16x16x32_bf16 v[140:143], a[204:207], a[124:127], v[140:143]
    v_mfma_f32_16x16x32_bf16 v[140:143], a[200:203], a[108:111], v[140:143]
    s_waitcnt lgkmcnt(8)
    v_mfma_f32_16x16x32_bf16 v[156:159], a[208:211], a[108:111], v[156:159]
    ds_read_b64_tr_b16 a[200:201], v40 offset:0
    v_mfma_f32_16x16x32_bf16 v[156:159], a[212:215], a[124:127], v[156:159]
    ds_read_b64_tr_b16 a[202:203], v40 offset:4096
    v_mfma_f32_16x16x32_bf16 v[152:155], a[212:215], a[120:123], v[152:155]
    ds_read_b64_tr_b16 a[204:205], v40 offset:8192
    v_mfma_f32_16x16x32_bf16 v[152:155], a[208:211], a[104:107], v[152:155]
    ds_read_b64_tr_b16 a[206:207], v40 offset:12288
    v_mfma_f32_16x16x32_bf16 v[148:151], a[208:211], a[100:103], v[148:151]
    buffer_load_dwordx4 a[24:27], v4, s[4:7], s73 offen sc1
    v_mfma_f32_16x16x32_bf16 v[148:151], a[212:215], a[116:119], v[148:151]
    buffer_load_dwordx4 a[28:31], v5, s[4:7], s73 offen sc1
    s_add_u32 s73, s73, 131072
    v_mfma_f32_16x16x32_bf16 v[144:147], a[212:215], a[112:115], v[144:147]
    v_mfma_f32_16x16x32_bf16 v[144:147], a[208:211], a[96:99], v[144:147]
    s_waitcnt lgkmcnt(8)
    v_mfma_f32_16x16x32_bf16 v[160:163], a[216:219], a[96:99], v[160:163]
    ds_read_b64_tr_b16 a[208:209], v41 offset:0
    v_mfma_f32_16x16x32_bf16 v[160:163], a[220:223], a[112:115], v[160:163]
    ds_read_b64_tr_b16 a[210:211], v41 offset:4096
    v_mfma_f32_16x16x32_bf16 v[164:167], a[220:223], a[116:119], v[164:167]
    ds_read_b64_tr_b16 a[212:213], v41 offset:8192
    v_mfma_f32_16x16x32_bf16 v[164:167], a[216:219], a[100:103], v[164:167]
    ds_read_b64_tr_b16 a[214:215], v41 offset:12288
    v_mfma_f32_16x16x32_bf16 v[168:171], a[216:219], a[104:107], v[168:171]
    buffer_load_dwordx4 a[32:35], v2, s[4:7], s73 offen sc1
    v_mfma_f32_16x16x32_bf16 v[168:171], a[220:223], a[120:123], v[168:171]
    buffer_load_dwordx4 a[36:39], v3, s[4:7], s73 offen sc1
    v_mfma_f32_16x16x32_bf16 v[172:175], a[220:223], a[124:127], v[172:175]
    v_mfma_f32_16x16x32_bf16 v[172:175], a[216:219], a[108:111], v[172:175]
    s_waitcnt lgkmcnt(8)
    v_mfma_f32_16x16x32_bf16 v[188:191], a[224:227], a[108:111], v[188:191]
    ds_read_b64_tr_b16 a[216:217], v42 offset:0
    v_mfma_f32_16x16x32_bf16 v[188:191], a[228:231], a[124:127], v[188:191]
    ds_read_b64_tr_b16 a[218:219], v42 offset:4096
    v_mfma_f32_16x16x32_bf16 v[184:187], a[228:231], a[120:123], v[184:187]
    ds_read_b64_tr_b16 a[220:221], v42 offset:8192
    v_mfma_f32_16x16x32_bf16 v[184:187], a[224:227], a[104:107], v[184:187]
    v_mfma_f32_16x16x32_bf16 v[180:183], a[224:227], a[100:103], v[180:183]
    ds_read_b64_tr_b16 a[222:223], v42 offset:12288
    v_mfma_f32_16x16x32_bf16 v[180:183], a[228:231], a[116:119], v[180:183]
    buffer_load_dwordx4 a[40:43], v4, s[4:7], s73 offen sc1
    v_mfma_f32_16x16x32_bf16 v[176:179], a[228:231], a[112:115], v[176:179]
    v_mfma_f32_16x16x32_bf16 v[176:179], a[224:227], a[96:99], v[176:179]
    s_waitcnt lgkmcnt(8)
    v_mfma_f32_16x16x32_bf16 v[192:195], a[200:203], a[96:99], v[192:195]
    ds_read_b64_tr_b16 a[224:225], v43 offset:0
    v_mfma_f32_16x16x32_bf16 v[192:195], a[204:207], a[112:115], v[192:195]
    ds_read_b64_tr_b16 a[226:227], v43 offset:4096
    v_mfma_f32_16x16x32_bf16 v[196:199], a[204:207], a[116:119], v[196:199]
    ds_read_b64_tr_b16 a[228:229], v43 offset:8192
    v_mfma_f32_16x16x32_bf16 v[196:199], a[200:203], a[100:103], v[196:199]
    ds_read_b64_tr_b16 a[230:231], v43 offset:12288
    v_mfma_f32_16x16x32_bf16 v[200:203], a[200:203], a[104:107], v[200:203]
    buffer_load_dwordx4 a[44:47], v5, s[4:7], s73 offen sc1
    s_add_u32 s73, s73, 131072
    v_mfma_f32_16x16x32_bf16 v[200:203], a[204:207], a[120:123], v[200:203]
    buffer_load_dwordx4 a[48:51], v2, s[4:7], s73 offen sc1
    v_mfma_f32_16x16x32_bf16 v[204:207], a[204:207], a[124:127], v[204:207]
    v_mfma_f32_16x16x32_bf16 v[204:207], a[200:203], a[108:111], v[204:207]
    s_waitcnt vmcnt(25) lgkmcnt(0)
    s_barrier
    v_mfma_f32_16x16x32_bf16 v[220:223], a[208:211], a[108:111], v[220:223]
    ds_read_b64_tr_b16 a[200:201], v36 offset:16384
    v_mfma_f32_16x16x32_bf16 v[220:223], a[212:215], a[124:127], v[220:223]
    ds_read_b64_tr_b16 a[202:203], v36 offset:20480
    v_mfma_f32_16x16x32_bf16 v[216:219], a[212:215], a[120:123], v[216:219]
    ds_read_b64_tr_b16 a[204:205], v36 offset:24576
    v_mfma_f32_16x16x32_bf16 v[216:219], a[208:211], a[104:107], v[216:219]
    ds_read_b64_tr_b16 a[206:207], v36 offset:28672
    v_mfma_f32_16x16x32_bf16 v[212:215], a[208:211], a[100:103], v[212:215]
    buffer_load_dwordx4 v7, s[24:27], s75 offen offset:1024 lds
    v_mfma_f32_16x16x32_bf16 v[212:215], a[212:215], a[116:119], v[212:215]
    buffer_load_dwordx4 v8, s[24:27], s75 offen offset:2048 lds
    v_mfma_f32_16x16x32_bf16 v[208:211], a[212:215], a[112:115], v[208:211]
    v_mfma_f32_16x16x32_bf16 v[208:211], a[208:211], a[96:99], v[208:211]
    v_mfma_f32_16x16x32_bf16 v[224:227], a[216:219], a[96:99], v[224:227]
    ds_read_b64_tr_b16 a[208:209], v37 offset:16384
    v_mfma_f32_16x16x32_bf16 v[224:227], a[220:223], a[112:115], v[224:227]
    ds_read_b64_tr_b16 a[210:211], v37 offset:20480
    v_mfma_f32_16x16x32_bf16 v[228:231], a[220:223], a[116:119], v[228:231]
    ds_read_b64_tr_b16 a[212:213], v37 offset:24576
    v_mfma_f32_16x16x32_bf16 v[228:231], a[216:219], a[100:103], v[228:231]
    ds_read_b64_tr_b16 a[214:215], v37 offset:28672
    v_mfma_f32_16x16x32_bf16 v[232:235], a[216:219], a[104:107], v[232:235]
    buffer_load_dwordx4 v9, s[24:27], s75 offen offset:3072 lds
    s_add_u32 s75, s75, 131072
    v_mfma_f32_16x16x32_bf16 v[232:235], a[220:223], a[120:123], v[232:235]
    s_add_u32 m0, s66, 65536
    s_nop 0
    buffer_load_dwordx4 v6, s[24:27], s75 offen offset:0 lds
    v_mfma_f32_16x16x32_bf16 v[236:239], a[220:223], a[124:127], v[236:239]
    v_mfma_f32_16x16x32_bf16 v[236:239], a[216:219], a[108:111], v[236:239]
    v_mfma_f32_16x16x32_bf16 v[252:255], a[224:227], a[108:111], v[252:255]
    ds_read_b64_tr_b16 a[216:217], v38 offset:16384
    v_mfma_f32_16x16x32_bf16 v[252:255], a[228:231], a[124:127], v[252:255]
    ds_read_b64_tr_b16 a[218:219], v38 offset:20480
    v_mfma_f32_16x16x32_bf16 v[248:251], a[228:231], a[120:123], v[248:251]
    ds_read_b64_tr_b16 a[220:221], v38 offset:24576
    v_mfma_f32_16x16x32_bf16 v[248:251], a[224:227], a[104:107], v[248:251]
    v_mfma_f32_16x16x32_bf16 v[244:247], a[224:227], a[100:103], v[244:247]
    ds_read_b64_tr_b16 a[222:223], v38 offset:28672
    v_mfma_f32_16x16x32_bf16 v[244:247], a[228:231], a[116:119], v[244:247]
    buffer_load_dwordx4 v7, s[24:27], s75 offen offset:1024 lds
    v_mfma_f32_16x16x32_bf16 v[240:243], a[228:231], a[112:115], v[240:243]
    v_mfma_f32_16x16x32_bf16 v[240:243], a[224:227], a[96:99], v[240:243]
    s_waitcnt vmcnt(23) lgkmcnt(8)
    v_mfma_f32_16x16x32_bf16 v[128:131], a[200:203], a[128:131], v[128:131]
    ds_read_b64_tr_b16 a[224:225], v39 offset:16384
    v_mfma_f32_16x16x32_bf16 v[128:131], a[204:207], a[144:147], v[128:131]
    ds_read_b64_tr_b16 a[226:227], v39 offset:20480
    v_mfma_f32_16x16x32_bf16 v[132:135], a[204:207], a[148:151], v[132:135]
    ds_read_b64_tr_b16 a[228:229], v39 offset:24576
    v_mfma_f32_16x16x32_bf16 v[132:135], a[200:203], a[132:135], v[132:135]
    ds_read_b64_tr_b16 a[230:231], v39 offset:28672
    v_mfma_f32_16x16x32_bf16 v[136:139], a[200:203], a[136:139], v[136:139]
    buffer_load_dwordx4 a[52:55], v3, s[4:7], s73 offen sc1
    v_mfma_f32_16x16x32_bf16 v[136:139], a[204:207], a[152:155], v[136:139]
    buffer_load_dwordx4 a[56:59], v4, s[4:7], s73 offen sc1
    v_mfma_f32_16x16x32_bf16 v[140:143], a[204:207], a[156:159], v[140:143]
    v_mfma_f32_16x16x32_bf16 v[140:143], a[200:203], a[140:143], v[140:143]
    s_waitcnt lgkmcnt(8)
    v_mfma_f32_16x16x32_bf16 v[156:159], a[208:211], a[140:143], v[156:159]
    ds_read_b64_tr_b16 a[200:201], v40 offset:16384
    v_mfma_f32_16x16x32_bf16 v[156:159], a[212:215], a[156:159], v[156:159]
    ds_read_b64_tr_b16 a[202:203], v40 offset:20480
    v_mfma_f32_16x16x32_bf16 v[152:155], a[212:215], a[152:155], v[152:155]
    ds_read_b64_tr_b16 a[204:205], v40 offset:24576
    v_mfma_f32_16x16x32_bf16 v[152:155], a[208:211], a[136:139], v[152:155]
    ds_read_b64_tr_b16 a[206:207], v40 offset:28672
    v_mfma_f32_16x16x32_bf16 v[148:151], a[208:211], a[132:135], v[148:151]
    buffer_load_dwordx4 a[60:63], v5, s[4:7], s73 offen sc1
    s_add_u32 s73, s73, 131072
    v_mfma_f32_16x16x32_bf16 v[148:151], a[212:215], a[148:151], v[148:151]
    buffer_load_dwordx4 a[64:67], v2, s[4:7], s73 offen sc1
    v_mfma_f32_16x16x32_bf16 v[144:147], a[212:215], a[144:147], v[144:147]
    v_mfma_f32_16x16x32_bf16 v[144:147], a[208:211], a[128:131], v[144:147]
    s_waitcnt lgkmcnt(8)
    v_mfma_f32_16x16x32_bf16 v[160:163], a[216:219], a[128:131], v[160:163]
    ds_read_b64_tr_b16 a[208:209], v41 offset:16384
    v_mfma_f32_16x16x32_bf16 v[160:163], a[220:223], a[144:147], v[160:163]
    ds_read_b64_tr_b16 a[210:211], v41 offset:20480
    v_mfma_f32_16x16x32_bf16 v[164:167], a[220:223], a[148:151], v[164:167]
    ds_read_b64_tr_b16 a[212:213], v41 offset:24576
    v_mfma_f32_16x16x32_bf16 v[164:167], a[216:219], a[132:135], v[164:167]
    v_mfma_f32_16x16x32_bf16 v[168:171], a[216:219], a[136:139], v[168:171]
    ds_read_b64_tr_b16 a[214:215], v41 offset:28672
    v_mfma_f32_16x16x32_bf16 v[168:171], a[220:223], a[152:155], v[168:171]
    buffer_load_dwordx4 a[68:71], v3, s[4:7], s73 offen sc1
    v_mfma_f32_16x16x32_bf16 v[172:175], a[220:223], a[156:159], v[172:175]
    v_mfma_f32_16x16x32_bf16 v[172:175], a[216:219], a[140:143], v[172:175]
    s_waitcnt lgkmcnt(8)
    v_mfma_f32_16x16x32_bf16 v[188:191], a[224:227], a[140:143], v[188:191]
    ds_read_b64_tr_b16 a[216:217], v42 offset:16384
    v_mfma_f32_16x16x32_bf16 v[188:191], a[228:231], a[156:159], v[188:191]
    ds_read_b64_tr_b16 a[218:219], v42 offset:20480
    v_mfma_f32_16x16x32_bf16 v[184:187], a[228:231], a[152:155], v[184:187]
    ds_read_b64_tr_b16 a[220:221], v42 offset:24576
    v_mfma_f32_16x16x32_bf16 v[184:187], a[224:227], a[136:139], v[184:187]
    ds_read_b64_tr_b16 a[222:223], v42 offset:28672
    v_mfma_f32_16x16x32_bf16 v[180:183], a[224:227], a[132:135], v[180:183]
    buffer_load_dwordx4 a[72:75], v4, s[4:7], s73 offen sc1
    v_mfma_f32_16x16x32_bf16 v[180:183], a[228:231], a[148:151], v[180:183]
    buffer_load_dwordx4 a[76:79], v5, s[4:7], s73 offen sc1
    s_add_u32 s73, s73, 131072
    v_mfma_f32_16x16x32_bf16 v[176:179], a[228:231], a[144:147], v[176:179]
    v_mfma_f32_16x16x32_bf16 v[176:179], a[224:227], a[128:131], v[176:179]
    s_waitcnt lgkmcnt(8)
    v_mfma_f32_16x16x32_bf16 v[192:195], a[200:203], a[128:131], v[192:195]
    ds_read_b64_tr_b16 a[224:225], v43 offset:16384
    v_mfma_f32_16x16x32_bf16 v[192:195], a[204:207], a[144:147], v[192:195]
    ds_read_b64_tr_b16 a[226:227], v43 offset:20480
    v_mfma_f32_16x16x32_bf16 v[196:199], a[204:207], a[148:151], v[196:199]
    ds_read_b64_tr_b16 a[228:229], v43 offset:24576
    v_mfma_f32_16x16x32_bf16 v[196:199], a[200:203], a[132:135], v[196:199]
    ds_read_b64_tr_b16 a[230:231], v43 offset:28672
    v_mfma_f32_16x16x32_bf16 v[200:203], a[200:203], a[136:139], v[200:203]
    buffer_load_dwordx4 a[80:83], v2, s[4:7], s73 offen sc1
    v_mfma_f32_16x16x32_bf16 v[200:203], a[204:207], a[152:155], v[200:203]
    buffer_load_dwordx4 a[84:87], v3, s[4:7], s73 offen sc1
    v_mfma_f32_16x16x32_bf16 v[204:207], a[204:207], a[156:159], v[204:207]
    v_mfma_f32_16x16x32_bf16 v[204:207], a[200:203], a[140:143], v[204:207]
    s_waitcnt vmcnt(24) lgkmcnt(0)
    s_barrier
    v_mfma_f32_16x16x32_bf16 v[220:223], a[208:211], a[140:143], v[220:223]
    ds_read_b64_tr_b16 a[200:201], v36 offset:32768
    v_mfma_f32_16x16x32_bf16 v[220:223], a[212:215], a[156:159], v[220:223]
    ds_read_b64_tr_b16 a[202:203], v36 offset:36864
    v_mfma_f32_16x16x32_bf16 v[216:219], a[212:215], a[152:155], v[216:219]
    ds_read_b64_tr_b16 a[204:205], v36 offset:40960
    v_mfma_f32_16x16x32_bf16 v[216:219], a[208:211], a[136:139], v[216:219]
    v_mfma_f32_16x16x32_bf16 v[212:215], a[208:211], a[132:135], v[212:215]
    ds_read_b64_tr_b16 a[206:207], v36 offset:45056
    v_mfma_f32_16x16x32_bf16 v[212:215], a[212:215], a[148:151], v[212:215]
    buffer_load_dwordx4 v8, s[24:27], s75 offen offset:2048 lds
    v_mfma_f32_16x16x32_bf16 v[208:211], a[212:215], a[144:147], v[208:211]
    v_mfma_f32_16x16x32_bf16 v[208:211], a[208:211], a[128:131], v[208:211]
    v_mfma_f32_16x16x32_bf16 v[224:227], a[216:219], a[128:131], v[224:227]
    ds_read_b64_tr_b16 a[208:209], v37 offset:32768
    v_mfma_f32_16x16x32_bf16 v[224:227], a[220:223], a[144:147], v[224:227]
    ds_read_b64_tr_b16 a[210:211], v37 offset:36864
    v_mfma_f32_16x16x32_bf16 v[228:231], a[220:223], a[148:151], v[228:231]
    ds_read_b64_tr_b16 a[212:213], v37 offset:40960
    v_mfma_f32_16x16x32_bf16 v[228:231], a[216:219], a[132:135], v[228:231]
    ds_read_b64_tr_b16 a[214:215], v37 offset:45056
    v_mfma_f32_16x16x32_bf16 v[232:235], a[216:219], a[136:139], v[232:235]
    buffer_load_dwordx4 v9, s[24:27], s75 offen offset:3072 lds
    s_add_u32 s75, s75, 131072
    v_mfma_f32_16x16x32_bf16 v[232:235], a[220:223], a[152:155], v[232:235]
    s_add_u32 m0, s66, 81920
    s_add_u32 s85, s75, s83
    buffer_load_dwordx4 v6, s[24:27], s85 offen offset:0 lds
    v_mfma_f32_16x16x32_bf16 v[236:239], a[220:223], a[156:159], v[236:239]
    v_mfma_f32_16x16x32_bf16 v[236:239], a[216:219], a[140:143], v[236:239]
    v_mfma_f32_16x16x32_bf16 v[252:255], a[224:227], a[140:143], v[252:255]
    ds_read_b64_tr_b16 a[216:217], v38 offset:32768
    v_mfma_f32_16x16x32_bf16 v[252:255], a[228:231], a[156:159], v[252:255]
    ds_read_b64_tr_b16 a[218:219], v38 offset:36864
    v_mfma_f32_16x16x32_bf16 v[248:251], a[228:231], a[152:155], v[248:251]
    ds_read_b64_tr_b16 a[220:221], v38 offset:40960
    v_mfma_f32_16x16x32_bf16 v[248:251], a[224:227], a[136:139], v[248:251]
    v_mfma_f32_16x16x32_bf16 v[244:247], a[224:227], a[132:135], v[244:247]
    ds_read_b64_tr_b16 a[222:223], v38 offset:45056
    v_mfma_f32_16x16x32_bf16 v[244:247], a[228:231], a[148:151], v[244:247]
    s_add_u32 s85, s85, s84
    buffer_load_dwordx4 v7, s[24:27], s85 offen offset:1024 lds
    v_mfma_f32_16x16x32_bf16 v[240:243], a[228:231], a[144:147], v[240:243]
    v_mfma_f32_16x16x32_bf16 v[240:243], a[224:227], a[128:131], v[240:243]
    s_waitcnt vmcnt(23) lgkmcnt(8)
    v_mfma_f32_16x16x32_bf16 v[128:131], a[200:203], a[0:3], v[128:131]
    ds_read_b64_tr_b16 a[224:225], v39 offset:32768
    v_mfma_f32_16x16x32_bf16 v[128:131], a[204:207], a[16:19], v[128:131]
    ds_read_b64_tr_b16 a[226:227], v39 offset:36864
    v_mfma_f32_16x16x32_bf16 v[132:135], a[204:207], a[20:23], v[132:135]
    ds_read_b64_tr_b16 a[228:229], v39 offset:40960
    v_mfma_f32_16x16x32_bf16 v[132:135], a[200:203], a[4:7], v[132:135]
    ds_read_b64_tr_b16 a[230:231], v39 offset:45056
    v_mfma_f32_16x16x32_bf16 v[136:139], a[200:203], a[8:11], v[136:139]
    buffer_load_dwordx4 a[88:91], v4, s[4:7], s73 offen sc1
    v_mfma_f32_16x16x32_bf16 v[136:139], a[204:207], a[24:27], v[136:139]
    buffer_load_dwordx4 a[92:95], v5, s[4:7], s73 offen sc1
    s_add_u32 s73, s73, 131072
    v_mfma_f32_16x16x32_bf16 v[140:143], a[204:207], a[28:31], v[140:143]
    v_mfma_f32_16x16x32_bf16 v[140:143], a[200:203], a[12:15], v[140:143]
    s_waitcnt lgkmcnt(8)
    v_mfma_f32_16x16x32_bf16 v[156:159], a[208:211], a[12:15], v[156:159]
    ds_read_b64_tr_b16 a[200:201], v40 offset:32768
    v_mfma_f32_16x16x32_bf16 v[156:159], a[212:215], a[28:31], v[156:159]
    ds_read_b64_tr_b16 a[202:203], v40 offset:36864
    v_mfma_f32_16x16x32_bf16 v[152:155], a[212:215], a[24:27], v[152:155]
    ds_read_b64_tr_b16 a[204:205], v40 offset:40960
    v_mfma_f32_16x16x32_bf16 v[152:155], a[208:211], a[8:11], v[152:155]
    ds_read_b64_tr_b16 a[206:207], v40 offset:45056
    v_mfma_f32_16x16x32_bf16 v[148:151], a[208:211], a[4:7], v[148:151]
    buffer_load_dwordx4 a[96:99], v2, s[4:7], s73 offen sc1
    v_mfma_f32_16x16x32_bf16 v[148:151], a[212:215], a[20:23], v[148:151]
    buffer_load_dwordx4 a[100:103], v3, s[4:7], s73 offen sc1
    v_mfma_f32_16x16x32_bf16 v[144:147], a[212:215], a[16:19], v[144:147]
    v_mfma_f32_16x16x32_bf16 v[144:147], a[208:211], a[0:3], v[144:147]
    s_waitcnt lgkmcnt(8)
    v_mfma_f32_16x16x32_bf16 v[160:163], a[216:219], a[0:3], v[160:163]
    ds_read_b64_tr_b16 a[208:209], v41 offset:32768
    v_mfma_f32_16x16x32_bf16 v[160:163], a[220:223], a[16:19], v[160:163]
    ds_read_b64_tr_b16 a[210:211], v41 offset:36864
    v_mfma_f32_16x16x32_bf16 v[164:167], a[220:223], a[20:23], v[164:167]
    ds_read_b64_tr_b16 a[212:213], v41 offset:40960
    v_mfma_f32_16x16x32_bf16 v[164:167], a[216:219], a[4:7], v[164:167]
    ds_read_b64_tr_b16 a[214:215], v41 offset:45056
    v_mfma_f32_16x16x32_bf16 v[168:171], a[216:219], a[8:11], v[168:171]
    buffer_load_dwordx4 a[104:107], v4, s[4:7], s73 offen sc1
    v_mfma_f32_16x16x32_bf16 v[168:171], a[220:223], a[24:27], v[168:171]
    buffer_load_dwordx4 a[108:111], v5, s[4:7], s73 offen sc1
    s_add_u32 s73, s73, 131072
    v_mfma_f32_16x16x32_bf16 v[172:175], a[220:223], a[28:31], v[172:175]
    v_mfma_f32_16x16x32_bf16 v[172:175], a[216:219], a[12:15], v[172:175]
    s_waitcnt lgkmcnt(8)
    v_mfma_f32_16x16x32_bf16 v[188:191], a[224:227], a[12:15], v[188:191]
    ds_read_b64_tr_b16 a[216:217], v42 offset:32768
    v_mfma_f32_16x16x32_bf16 v[188:191], a[228:231], a[28:31], v[188:191]
    ds_read_b64_tr_b16 a[218:219], v42 offset:36864
    v_mfma_f32_16x16x32_bf16 v[184:187], a[228:231], a[24:27], v[184:187]
    ds_read_b64_tr_b16 a[220:221], v42 offset:40960
    v_mfma_f32_16x16x32_bf16 v[184:187], a[224:227], a[8:11], v[184:187]
    ds_read_b64_tr_b16 a[222:223], v42 offset:45056
    v_mfma_f32_16x16x32_bf16 v[180:183], a[224:227], a[4:7], v[180:183]
    buffer_load_dwordx4 a[112:115], v2, s[4:7], s73 offen sc1
    v_mfma_f32_16x16x32_bf16 v[180:183], a[228:231], a[20:23], v[180:183]
    buffer_load_dwordx4 a[116:119], v3, s[4:7], s73 offen sc1
    v_mfma_f32_16x16x32_bf16 v[176:179], a[228:231], a[16:19], v[176:179]
    v_mfma_f32_16x16x32_bf16 v[176:179], a[224:227], a[0:3], v[176:179]
    s_waitcnt lgkmcnt(8)
    v_mfma_f32_16x16x32_bf16 v[192:195], a[200:203], a[0:3], v[192:195]
    ds_read_b64_tr_b16 a[224:225], v43 offset:32768
    v_mfma_f32_16x16x32_bf16 v[192:195], a[204:207], a[16:19], v[192:195]
    ds_read_b64_tr_b16 a[226:227], v43 offset:36864
    v_mfma_f32_16x16x32_bf16 v[196:199], a[204:207], a[20:23], v[196:199]
    ds_read_b64_tr_b16 a[228:229], v43 offset:40960
    v_mfma_f32_16x16x32_bf16 v[196:199], a[200:203], a[4:7], v[196:199]
    ds_read_b64_tr_b16 a[230:231], v43 offset:45056
    v_mfma_f32_16x16x32_bf16 v[200:203], a[200:203], a[8:11], v[200:203]
    buffer_load_dwordx4 a[120:123], v4, s[4:7], s73 offen sc1
    v_mfma_f32_16x16x32_bf16 v[200:203], a[204:207], a[24:27], v[200:203]
    buffer_load_dwordx4 a[124:127], v5, s[4:7], s73 offen sc1
    s_add_u32 s73, s73, 131072
    v_mfma_f32_16x16x32_bf16 v[204:207], a[204:207], a[28:31], v[204:207]
    v_mfma_f32_16x16x32_bf16 v[204:207], a[200:203], a[12:15], v[204:207]
    s_waitcnt vmcnt(25) lgkmcnt(0)
    s_barrier
    v_mfma_f32_16x16x32_bf16 v[220:223], a[208:211], a[12:15], v[220:223]
    ds_read_b64_tr_b16 a[200:201], v36 offset:49152
    v_mfma_f32_16x16x32_bf16 v[220:223], a[212:215], a[28:31], v[220:223]
    ds_read_b64_tr_b16 a[202:203], v36 offset:53248
    v_mfma_f32_16x16x32_bf16 v[216:219], a[212:215], a[24:27], v[216:219]
    ds_read_b64_tr_b16 a[204:205], v36 offset:57344
    v_mfma_f32_16x16x32_bf16 v[216:219], a[208:211], a[8:11], v[216:219]
    ds_read_b64_tr_b16 a[206:207], v36 offset:61440
    v_mfma_f32_16x16x32_bf16 v[212:215], a[208:211], a[4:7], v[212:215]
    s_add_u32 s85, s85, s84
    buffer_load_dwordx4 v8, s[24:27], s85 offen offset:2048 lds
    v_mfma_f32_16x16x32_bf16 v[212:215], a[212:215], a[20:23], v[212:215]
    s_add_u32 s85, s85, s84
    buffer_load_dwordx4 v9, s[24:27], s85 offen offset:3072 lds
    s_add_u32 s75, s75, 131072
    v_mfma_f32_16x16x32_bf16 v[208:211], a[212:215], a[16:19], v[208:211]
    v_mfma_f32_16x16x32_bf16 v[208:211], a[208:211], a[0:3], v[208:211]
    v_mfma_f32_16x16x32_bf16 v[224:227], a[216:219], a[0:3], v[224:227]
    ds_read_b64_tr_b16 a[208:209], v37 offset:49152
    v_mfma_f32_16x16x32_bf16 v[224:227], a[220:223], a[16:19], v[224:227]
    ds_read_b64_tr_b16 a[210:211], v37 offset:53248
    v_mfma_f32_16x16x32_bf16 v[228:231], a[220:223], a[20:23], v[228:231]
    ds_read_b64_tr_b16 a[212:213], v37 offset:57344
    v_mfma_f32_16x16x32_bf16 v[228:231], a[216:219], a[4:7], v[228:231]
    ds_read_b64_tr_b16 a[214:215], v37 offset:61440
    v_mfma_f32_16x16x32_bf16 v[232:235], a[216:219], a[8:11], v[232:235]
    s_add_u32 m0, s66, 0
    s_nop 0
    buffer_load_dwordx4 v6, s[24:27], s75 offen offset:0 lds
    v_mfma_f32_16x16x32_bf16 v[232:235], a[220:223], a[24:27], v[232:235]
    buffer_load_dwordx4 v7, s[24:27], s75 offen offset:1024 lds
    v_mfma_f32_16x16x32_bf16 v[236:239], a[220:223], a[28:31], v[236:239]
    v_mfma_f32_16x16x32_bf16 v[236:239], a[216:219], a[12:15], v[236:239]
    v_mfma_f32_16x16x32_bf16 v[252:255], a[224:227], a[12:15], v[252:255]
    ds_read_b64_tr_b16 a[216:217], v38 offset:49152
    v_mfma_f32_16x16x32_bf16 v[252:255], a[228:231], a[28:31], v[252:255]
    ds_read_b64_tr_b16 a[218:219], v38 offset:53248
    v_mfma_f32_16x16x32_bf16 v[248:251], a[228:231], a[24:27], v[248:251]
    ds_read_b64_tr_b16 a[220:221], v38 offset:57344
    v_mfma_f32_16x16x32_bf16 v[248:251], a[224:227], a[8:11], v[248:251]
    v_mfma_f32_16x16x32_bf16 v[244:247], a[224:227], a[4:7], v[244:247]
    ds_read_b64_tr_b16 a[222:223], v38 offset:61440
    v_mfma_f32_16x16x32_bf16 v[244:247], a[228:231], a[20:23], v[244:247]
    buffer_load_dwordx4 v8, s[24:27], s75 offen offset:2048 lds
    v_mfma_f32_16x16x32_bf16 v[240:243], a[228:231], a[16:19], v[240:243]
    v_mfma_f32_16x16x32_bf16 v[240:243], a[224:227], a[0:3], v[240:243]
    s_waitcnt vmcnt(25) lgkmcnt(8)
    v_mfma_f32_16x16x32_bf16 v[128:131], a[200:203], a[32:35], v[128:131]
    ds_read_b64_tr_b16 a[224:225], v39 offset:49152
    v_mfma_f32_16x16x32_bf16 v[128:131], a[204:207], a[48:51], v[128:131]
    ds_read_b64_tr_b16 a[226:227], v39 offset:53248
    v_mfma_f32_16x16x32_bf16 v[132:135], a[204:207], a[52:55], v[132:135]
    ds_read_b64_tr_b16 a[228:229], v39 offset:57344
    v_mfma_f32_16x16x32_bf16 v[132:135], a[200:203], a[36:39], v[132:135]
    ds_read_b64_tr_b16 a[230:231], v39 offset:61440
    v_mfma_f32_16x16x32_bf16 v[136:139], a[200:203], a[40:43], v[136:139]
    buffer_load_dwordx4 a[128:131], v2, s[4:7], s73 offen sc1
    v_mfma_f32_16x16x32_bf16 v[136:139], a[204:207], a[56:59], v[136:139]
    buffer_load_dwordx4 a[132:135], v3, s[4:7], s73 offen sc1
    v_mfma_f32_16x16x32_bf16 v[140:143], a[204:207], a[60:63], v[140:143]
    v_mfma_f32_16x16x32_bf16 v[140:143], a[200:203], a[44:47], v[140:143]
    s_waitcnt lgkmcnt(8)
    v_mfma_f32_16x16x32_bf16 v[156:159], a[208:211], a[44:47], v[156:159]
    ds_read_b64_tr_b16 a[200:201], v40 offset:49152
    v_mfma_f32_16x16x32_bf16 v[156:159], a[212:215], a[60:63], v[156:159]
    ds_read_b64_tr_b16 a[202:203], v40 offset:53248
    v_mfma_f32_16x16x32_bf16 v[152:155], a[212:215], a[56:59], v[152:155]
    ds_read_b64_tr_b16 a[204:205], v40 offset:57344
    v_mfma_f32_16x16x32_bf16 v[152:155], a[208:211], a[40:43], v[152:155]
    ds_read_b64_tr_b16 a[206:207], v40 offset:61440
    v_mfma_f32_16x16x32_bf16 v[148:151], a[208:211], a[36:39], v[148:151]
    buffer_load_dwordx4 a[136:139], v4, s[4:7], s73 offen sc1
    v_mfma_f32_16x16x32_bf16 v[148:151], a[212:215], a[52:55], v[148:151]
    buffer_load_dwordx4 a[140:143], v5, s[4:7], s73 offen sc1
    s_add_u32 s73, s73, 131072
    v_mfma_f32_16x16x32_bf16 v[144:147], a[212:215], a[48:51], v[144:147]
    v_mfma_f32_16x16x32_bf16 v[144:147], a[208:211], a[32:35], v[144:147]
    s_waitcnt lgkmcnt(8)
    v_mfma_f32_16x16x32_bf16 v[160:163], a[216:219], a[32:35], v[160:163]
    ds_read_b64_tr_b16 a[208:209], v41 offset:49152
    v_mfma_f32_16x16x32_bf16 v[160:163], a[220:223], a[48:51], v[160:163]
    ds_read_b64_tr_b16 a[210:211], v41 offset:53248
    v_mfma_f32_16x16x32_bf16 v[164:167], a[220:223], a[52:55], v[164:167]
    ds_read_b64_tr_b16 a[212:213], v41 offset:57344
    v_mfma_f32_16x16x32_bf16 v[164:167], a[216:219], a[36:39], v[164:167]
    ds_read_b64_tr_b16 a[214:215], v41 offset:61440
    v_mfma_f32_16x16x32_bf16 v[168:171], a[216:219], a[40:43], v[168:171]
    buffer_load_dwordx4 a[144:147], v2, s[4:7], s73 offen sc1
    v_mfma_f32_16x16x32_bf16 v[168:171], a[220:223], a[56:59], v[168:171]
    buffer_load_dwordx4 a[148:151], v3, s[4:7], s73 offen sc1
    v_mfma_f32_16x16x32_bf16 v[172:175], a[220:223], a[60:63], v[172:175]
    v_mfma_f32_16x16x32_bf16 v[172:175], a[216:219], a[44:47], v[172:175]
    s_waitcnt lgkmcnt(8)
    v_mfma_f32_16x16x32_bf16 v[188:191], a[224:227], a[44:47], v[188:191]
    ds_read_b64_tr_b16 a[216:217], v42 offset:49152
    v_mfma_f32_16x16x32_bf16 v[188:191], a[228:231], a[60:63], v[188:191]
    ds_read_b64_tr_b16 a[218:219], v42 offset:53248
    v_mfma_f32_16x16x32_bf16 v[184:187], a[228:231], a[56:59], v[184:187]
    ds_read_b64_tr_b16 a[220:221], v42 offset:57344
    v_mfma_f32_16x16x32_bf16 v[184:187], a[224:227], a[40:43], v[184:187]
    v_mfma_f32_16x16x32_bf16 v[180:183], a[224:227], a[36:39], v[180:183]
    ds_read_b64_tr_b16 a[222:223], v42 offset:61440
    v_mfma_f32_16x16x32_bf16 v[180:183], a[228:231], a[52:55], v[180:183]
    buffer_load_dwordx4 a[152:155], v4, s[4:7], s73 offen sc1
    v_mfma_f32_16x16x32_bf16 v[176:179], a[228:231], a[48:51], v[176:179]
    v_mfma_f32_16x16x32_bf16 v[176:179], a[224:227], a[32:35], v[176:179]
    s_waitcnt lgkmcnt(8)
    v_mfma_f32_16x16x32_bf16 v[192:195], a[200:203], a[32:35], v[192:195]
    ds_read_b64_tr_b16 a[224:225], v43 offset:49152
    v_mfma_f32_16x16x32_bf16 v[192:195], a[204:207], a[48:51], v[192:195]
    ds_read_b64_tr_b16 a[226:227], v43 offset:53248
    v_mfma_f32_16x16x32_bf16 v[196:199], a[204:207], a[52:55], v[196:199]
    ds_read_b64_tr_b16 a[228:229], v43 offset:57344
    v_mfma_f32_16x16x32_bf16 v[196:199], a[200:203], a[36:39], v[196:199]
    ds_read_b64_tr_b16 a[230:231], v43 offset:61440
    v_mfma_f32_16x16x32_bf16 v[200:203], a[200:203], a[40:43], v[200:203]
    buffer_load_dwordx4 a[156:159], v5, s[4:7], s73 offen sc1
    s_add_u32 s73, s73, 131072
    v_mfma_f32_16x16x32_bf16 v[200:203], a[204:207], a[56:59], v[200:203]
    buffer_load_dwordx4 a[0:3], v2, s[4:7], s73 offen sc1
    v_mfma_f32_16x16x32_bf16 v[204:207], a[204:207], a[60:63], v[204:207]
    v_mfma_f32_16x16x32_bf16 v[204:207], a[200:203], a[44:47], v[204:207]
    s_waitcnt vmcnt(26) lgkmcnt(0)
    s_barrier
    v_mfma_f32_16x16x32_bf16 v[220:223], a[208:211], a[44:47], v[220:223]
    ds_read_b64_tr_b16 a[200:201], v52 offset:0
    v_mfma_f32_16x16x32_bf16 v[220:223], a[212:215], a[60:63], v[220:223]
    ds_read_b64_tr_b16 a[202:203], v52 offset:4096
    v_mfma_f32_16x16x32_bf16 v[216:219], a[212:215], a[56:59], v[216:219]
    ds_read_b64_tr_b16 a[204:205], v52 offset:8192
    v_mfma_f32_16x16x32_bf16 v[216:219], a[208:211], a[40:43], v[216:219]
    ds_read_b64_tr_b16 a[206:207], v52 offset:12288
    v_mfma_f32_16x16x32_bf16 v[212:215], a[208:211], a[36:39], v[212:215]
    buffer_load_dwordx4 v9, s[24:27], s75 offen offset:3072 lds
    s_add_u32 s75, s75, 131072
    v_mfma_f32_16x16x32_bf16 v[212:215], a[212:215], a[52:55], v[212:215]
    s_add_u32 m0, s66, 16384
    s_nop 0
    buffer_load_dwordx4 v6, s[24:27], s75 offen offset:0 lds
    v_mfma_f32_16x16x32_bf16 v[208:211], a[212:215], a[48:51], v[208:211]
    v_mfma_f32_16x16x32_bf16 v[208:211], a[208:211], a[32:35], v[208:211]
    v_mfma_f32_16x16x32_bf16 v[224:227], a[216:219], a[32:35], v[224:227]
    ds_read_b64_tr_b16 a[208:209], v53 offset:0
    v_mfma_f32_16x16x32_bf16 v[224:227], a[220:223], a[48:51], v[224:227]
    ds_read_b64_tr_b16 a[210:211], v53 offset:4096
    v_mfma_f32_16x16x32_bf16 v[228:231], a[220:223], a[52:55], v[228:231]
    ds_read_b64_tr_b16 a[212:213], v53 offset:8192
    v_mfma_f32_16x16x32_bf16 v[228:231], a[216:219], a[36:39], v[228:231]
    ds_read_b64_tr_b16 a[214:215], v53 offset:12288
    v_mfma_f32_16x16x32_bf16 v[232:235], a[216:219], a[40:43], v[232:235]
    buffer_load_dwordx4 v7, s[24:27], s75 offen offset:1024 lds
    v_mfma_f32_16x16x32_bf16 v[232:235], a[220:223], a[56:59], v[232:235]
    buffer_load_dwordx4 v8, s[24:27], s75 offen offset:2048 lds
    v_mfma_f32_16x16x32_bf16 v[236:239], a[220:223], a[60:63], v[236:239]
    v_mfma_f32_16x16x32_bf16 v[236:239], a[216:219], a[44:47], v[236:239]
    v_mfma_f32_16x16x32_bf16 v[252:255], a[224:227], a[44:47], v[252:255]
    ds_read_b64_tr_b16 a[216:217], v54 offset:0
    v_mfma_f32_16x16x32_bf16 v[252:255], a[228:231], a[60:63], v[252:255]
    ds_read_b64_tr_b16 a[218:219], v54 offset:4096
    v_mfma_f32_16x16x32_bf16 v[248:251], a[228:231], a[56:59], v[248:251]
    ds_read_b64_tr_b16 a[220:221], v54 offset:8192
    v_mfma_f32_16x16x32_bf16 v[248:251], a[224:227], a[40:43], v[248:251]
    v_mfma_f32_16x16x32_bf16 v[244:247], a[224:227], a[36:39], v[244:247]
    ds_read_b64_tr_b16 a[222:223], v54 offset:12288
    v_mfma_f32_16x16x32_bf16 v[244:247], a[228:231], a[52:55], v[244:247]
    buffer_load_dwordx4 v9, s[24:27], s75 offen offset:3072 lds
    s_add_u32 s75, s75, 131072
    v_mfma_f32_16x16x32_bf16 v[240:243], a[228:231], a[48:51], v[240:243]
    v_mfma_f32_16x16x32_bf16 v[240:243], a[224:227], a[32:35], v[240:243]
    s_waitcnt vmcnt(27) lgkmcnt(8)
    v_mfma_f32_16x16x32_bf16 v[128:131], a[200:203], a[64:67], v[128:131]
    ds_read_b64_tr_b16 a[224:225], v55 offset:0
    v_mfma_f32_16x16x32_bf16 v[128:131], a[204:207], a[80:83], v[128:131]
    ds_read_b64_tr_b16 a[226:227], v55 offset:4096
    v_mfma_f32_16x16x32_bf16 v[132:135], a[204:207], a[84:87], v[132:135]
    ds_read_b64_tr_b16 a[228:229], v55 offset:8192
    v_mfma_f32_16x16x32_bf16 v[132:135], a[200:203], a[68:71], v[132:135]
    ds_read_b64_tr_b16 a[230:231], v55 offset:12288
    v_mfma_f32_16x16x32_bf16 v[136:139], a[200:203], a[72:75], v[136:139]
    buffer_load_dwordx4 a[4:7], v3, s[4:7], s73 offen sc1
    v_mfma_f32_16x16x32_bf16 v[136:139], a[204:207], a[88:91], v[136:139]
    buffer_load_dwordx4 a[8:11], v4, s[4:7], s73 offen sc1
    v_mfma_f32_16x16x32_bf16 v[140:143], a[204:207], a[92:95], v[140:143]
    v_mfma_f32_16x16x32_bf16 v[140:143], a[200:203], a[76:79], v[140:143]
    s_waitcnt lgkmcnt(8)
    v_mfma_f32_16x16x32_bf16 v[156:159], a[208:211], a[76:79], v[156:159]
    ds_read_b64_tr_b16 a[200:201], v56 offset:0
    v_mfma_f32_16x16x32_bf16 v[156:159], a[212:215], a[92:95], v[156:159]
    ds_read_b64_tr_b16 a[202:203], v56 offset:4096
    v_mfma_f32_16x16x32_bf16 v[152:155], a[212:215], a[88:91], v[152:155]
    ds_read_b64_tr_b16 a[204:205], v56 offset:8192
    v_mfma_f32_16x16x32_bf16 v[152:155], a[208:211], a[72:75], v[152:155]
    ds_read_b64_tr_b16 a[206:207], v56 offset:12288
    v_mfma_f32_16x16x32_bf16 v[148:151], a[208:211], a[68:71], v[148:151]
    buffer_load_dwordx4 a[12:15], v5, s[4:7], s73 offen sc1
    s_add_u32 s73, s73, 131072
    v_mfma_f32_16x16x32_bf16 v[148:151], a[212:215], a[84:87], v[148:151]
    buffer_load_dwordx4 a[16:19], v2, s[4:7], s73 offen sc1
    v_mfma_f32_16x16x32_bf16 v[144:147], a[212:215], a[80:83], v[144:147]
    v_mfma_f32_16x16x32_bf16 v[144:147], a[208:211], a[64:67], v[144:147]
    s_waitcnt lgkmcnt(8)
    v_mfma_f32_16x16x32_bf16 v[160:163], a[216:219], a[64:67], v[160:163]
    ds_read_b64_tr_b16 a[208:209], v57 offset:0
    v_mfma_f32_16x16x32_bf16 v[160:163], a[220:223], a[80:83], v[160:163]
    ds_read_b64_tr_b16 a[210:211], v57 offset:4096
    v_mfma_f32_16x16x32_bf16 v[164:167], a[220:223], a[84:87], v[164:167]
    ds_read_b64_tr_b16 a[212:213], v57 offset:8192
    v_mfma_f32_16x16x32_bf16 v[164:167], a[216:219], a[68:71], v[164:167]
    ds_read_b64_tr_b16 a[214:215], v57 offset:12288
    v_mfma_f32_16x16x32_bf16 v[168:171], a[216:219], a[72:75], v[168:171]
    buffer_load_dwordx4 a[20:23], v3, s[4:7], s73 offen sc1
    v_mfma_f32_16x16x32_bf16 v[168:171], a[220:223], a[88:91], v[168:171]
    buffer_load_dwordx4 a[24:27], v4, s[4:7], s73 offen sc1
    v_mfma_f32_16x16x32_bf16 v[172:175], a[220:223], a[92:95], v[172:175]
    v_mfma_f32_16x16x32_bf16 v[172:175], a[216:219], a[76:79], v[172:175]
    s_waitcnt lgkmcnt(8)
    v_mfma_f32_16x16x32_bf16 v[188:191], a[224:227], a[76:79], v[188:191]
    ds_read_b64_tr_b16 a[216:217], v58 offset:0
    v_mfma_f32_16x16x32_bf16 v[188:191], a[228:231], a[92:95], v[188:191]
    ds_read_b64_tr_b16 a[218:219], v58 offset:4096
    v_mfma_f32_16x16x32_bf16 v[184:187], a[228:231], a[88:91], v[184:187]
    ds_read_b64_tr_b16 a[220:221], v58 offset:8192
    v_mfma_f32_16x16x32_bf16 v[184:187], a[224:227], a[72:75], v[184:187]
    v_mfma_f32_16x16x32_bf16 v[180:183], a[224:227], a[68:71], v[180:183]
    ds_read_b64_tr_b16 a[222:223], v58 offset:12288
    v_mfma_f32_16x16x32_bf16 v[180:183], a[228:231], a[84:87], v[180:183]
    buffer_load_dwordx4 a[28:31], v5, s[4:7], s73 offen sc1
    s_add_u32 s73, s73, 131072
    v_mfma_f32_16x16x32_bf16 v[176:179], a[228:231], a[80:83], v[176:179]
    v_mfma_f32_16x16x32_bf16 v[176:179], a[224:227], a[64:67], v[176:179]
    s_waitcnt lgkmcnt(8)
    v_mfma_f32_16x16x32_bf16 v[192:195], a[200:203], a[64:67], v[192:195]
    ds_read_b64_tr_b16 a[224:225], v59 offset:0
    v_mfma_f32_16x16x32_bf16 v[192:195], a[204:207], a[80:83], v[192:195]
    ds_read_b64_tr_b16 a[226:227], v59 offset:4096
    v_mfma_f32_16x16x32_bf16 v[196:199], a[204:207], a[84:87], v[196:199]
    ds_read_b64_tr_b16 a[228:229], v59 offset:8192
    v_mfma_f32_16x16x32_bf16 v[196:199], a[200:203], a[68:71], v[196:199]
    ds_read_b64_tr_b16 a[230:231], v59 offset:12288
    v_mfma_f32_16x16x32_bf16 v[200:203], a[200:203], a[72:75], v[200:203]
    buffer_load_dwordx4 a[32:35], v2, s[4:7], s73 offen sc1
    v_mfma_f32_16x16x32_bf16 v[200:203], a[204:207], a[88:91], v[200:203]
    buffer_load_dwordx4 a[36:39], v3, s[4:7], s73 offen sc1
    v_mfma_f32_16x16x32_bf16 v[204:207], a[204:207], a[92:95], v[204:207]
    v_mfma_f32_16x16x32_bf16 v[204:207], a[200:203], a[76:79], v[204:207]
    s_waitcnt vmcnt(26) lgkmcnt(0)
    s_barrier
    v_mfma_f32_16x16x32_bf16 v[220:223], a[208:211], a[76:79], v[220:223]
    ds_read_b64_tr_b16 a[200:201], v52 offset:16384
    v_mfma_f32_16x16x32_bf16 v[220:223], a[212:215], a[92:95], v[220:223]
    ds_read_b64_tr_b16 a[202:203], v52 offset:20480
    v_mfma_f32_16x16x32_bf16 v[216:219], a[212:215], a[88:91], v[216:219]
    ds_read_b64_tr_b16 a[204:205], v52 offset:24576
    v_mfma_f32_16x16x32_bf16 v[216:219], a[208:211], a[72:75], v[216:219]
    ds_read_b64_tr_b16 a[206:207], v52 offset:28672
    v_mfma_f32_16x16x32_bf16 v[212:215], a[208:211], a[68:71], v[212:215]
    s_add_u32 m0, s66, 32768
    s_nop 0
    buffer_load_dwordx4 v6, s[24:27], s75 offen offset:0 lds
    v_mfma_f32_16x16x32_bf16 v[212:215], a[212:215], a[84:87], v[212:215]
    buffer_load_dwordx4 v7, s[24:27], s75 offen offset:1024 lds
    v_mfma_f32_16x16x32_bf16 v[208:211], a[212:215], a[80:83], v[208:211]
    v_mfma_f32_16x16x32_bf16 v[208:211], a[208:211], a[64:67], v[208:211]
    v_mfma_f32_16x16x32_bf16 v[224:227], a[216:219], a[64:67], v[224:227]
    ds_read_b64_tr_b16 a[208:209], v53 offset:16384
    v_mfma_f32_16x16x32_bf16 v[224:227], a[220:223], a[80:83], v[224:227]
    ds_read_b64_tr_b16 a[210:211], v53 offset:20480
    v_mfma_f32_16x16x32_bf16 v[228:231], a[220:223], a[84:87], v[228:231]
    ds_read_b64_tr_b16 a[212:213], v53 offset:24576
    v_mfma_f32_16x16x32_bf16 v[228:231], a[216:219], a[68:71], v[228:231]
    ds_read_b64_tr_b16 a[214:215], v53 offset:28672
    v_mfma_f32_16x16x32_bf16 v[232:235], a[216:219], a[72:75], v[232:235]
    buffer_load_dwordx4 v8, s[24:27], s75 offen offset:2048 lds
    v_mfma_f32_16x16x32_bf16 v[232:235], a[220:223], a[88:91], v[232:235]
    buffer_load_dwordx4 v9, s[24:27], s75 offen offset:3072 lds
    s_add_u32 s75, s75, 131072
    v_mfma_f32_16x16x32_bf16 v[236:239], a[220:223], a[92:95], v[236:239]
    v_mfma_f32_16x16x32_bf16 v[236:239], a[216:219], a[76:79], v[236:239]
    v_mfma_f32_16x16x32_bf16 v[252:255], a[224:227], a[76:79], v[252:255]
    ds_read_b64_tr_b16 a[216:217], v54 offset:16384
    v_mfma_f32_16x16x32_bf16 v[252:255], a[228:231], a[92:95], v[252:255]
    ds_read_b64_tr_b16 a[218:219], v54 offset:20480
    v_mfma_f32_16x16x32_bf16 v[248:251], a[228:231], a[88:91], v[248:251]
    ds_read_b64_tr_b16 a[220:221], v54 offset:24576
    v_mfma_f32_16x16x32_bf16 v[248:251], a[224:227], a[72:75], v[248:251]
    v_mfma_f32_16x16x32_bf16 v[244:247], a[224:227], a[68:71], v[244:247]
    ds_read_b64_tr_b16 a[222:223], v54 offset:28672
    v_mfma_f32_16x16x32_bf16 v[244:247], a[228:231], a[84:87], v[244:247]
    s_add_u32 m0, s66, 49152
    s_add_u32 s85, s75, s81
    buffer_load_dwordx4 v6, s[24:27], s85 offen offset:0 lds
    v_mfma_f32_16x16x32_bf16 v[240:243], a[228:231], a[80:83], v[240:243]
    v_mfma_f32_16x16x32_bf16 v[240:243], a[224:227], a[64:67], v[240:243]
    buffer_load_dword v48, v29, s[4:7], s61 offen offset:32 sc1
    s_waitcnt lgkmcnt(8)
    v_mfma_f32_16x16x32_bf16 v[128:131], a[200:203], a[96:99], v[128:131]
    ds_read_b64_tr_b16 a[224:225], v55 offset:16384
    v_mfma_f32_16x16x32_bf16 v[128:131], a[204:207], a[112:115], v[128:131]
    ds_read_b64_tr_b16 a[226:227], v55 offset:20480
    v_mfma_f32_16x16x32_bf16 v[132:135], a[204:207], a[116:119], v[132:135]
    ds_read_b64_tr_b16 a[228:229], v55 offset:24576
    v_mfma_f32_16x16x32_bf16 v[132:135], a[200:203], a[100:103], v[132:135]
    ds_read_b64_tr_b16 a[230:231], v55 offset:28672
    v_mfma_f32_16x16x32_bf16 v[136:139], a[200:203], a[104:107], v[136:139]
    buffer_load_dwordx4 a[40:43], v4, s[4:7], s73 offen sc1
    v_mfma_f32_16x16x32_bf16 v[136:139], a[204:207], a[120:123], v[136:139]
    buffer_load_dwordx4 a[44:47], v5, s[4:7], s73 offen sc1
    s_add_u32 s73, s73, 131072
    v_mfma_f32_16x16x32_bf16 v[140:143], a[204:207], a[124:127], v[140:143]
    v_mfma_f32_16x16x32_bf16 v[140:143], a[200:203], a[108:111], v[140:143]
    s_waitcnt lgkmcnt(8)
    v_mfma_f32_16x16x32_bf16 v[156:159], a[208:211], a[108:111], v[156:159]
    ds_read_b64_tr_b16 a[200:201], v56 offset:16384
    v_mfma_f32_16x16x32_bf16 v[156:159], a[212:215], a[124:127], v[156:159]
    ds_read_b64_tr_b16 a[202:203], v56 offset:20480
    v_mfma_f32_16x16x32_bf16 v[152:155], a[212:215], a[120:123], v[152:155]
    ds_read_b64_tr_b16 a[204:205], v56 offset:24576
    v_mfma_f32_16x16x32_bf16 v[152:155], a[208:211], a[104:107], v[152:155]
    ds_read_b64_tr_b16 a[206:207], v56 offset:28672
    v_mfma_f32_16x16x32_bf16 v[148:151], a[208:211], a[100:103], v[148:151]
    buffer_load_dwordx4 a[48:51], v2, s[4:7], s73 offen sc1
    v_mfma_f32_16x16x32_bf16 v[148:151], a[212:215], a[116:119], v[148:151]
    buffer_load_dwordx4 a[52:55], v3, s[4:7], s73 offen sc1
    v_mfma_f32_16x16x32_bf16 v[144:147], a[212:215], a[112:115], v[144:147]
    v_mfma_f32_16x16x32_bf16 v[144:147], a[208:211], a[96:99], v[144:147]
    s_waitcnt lgkmcnt(8)
    v_mfma_f32_16x16x32_bf16 v[160:163], a[216:219], a[96:99], v[160:163]
    ds_read_b64_tr_b16 a[208:209], v57 offset:16384
    v_mfma_f32_16x16x32_bf16 v[160:163], a[220:223], a[112:115], v[160:163]
    ds_read_b64_tr_b16 a[210:211], v57 offset:20480
    v_mfma_f32_16x16x32_bf16 v[164:167], a[220:223], a[116:119], v[164:167]
    ds_read_b64_tr_b16 a[212:213], v57 offset:24576
    v_mfma_f32_16x16x32_bf16 v[164:167], a[216:219], a[100:103], v[164:167]
    ds_read_b64_tr_b16 a[214:215], v57 offset:28672
    v_mfma_f32_16x16x32_bf16 v[168:171], a[216:219], a[104:107], v[168:171]
    buffer_load_dwordx4 a[56:59], v4, s[4:7], s73 offen sc1
    v_mfma_f32_16x16x32_bf16 v[168:171], a[220:223], a[120:123], v[168:171]
    buffer_load_dwordx4 a[60:63], v5, s[4:7], s73 offen sc1
    s_add_u32 s73, s73, 131072
    v_mfma_f32_16x16x32_bf16 v[172:175], a[220:223], a[124:127], v[172:175]
    v_mfma_f32_16x16x32_bf16 v[172:175], a[216:219], a[108:111], v[172:175]
    s_waitcnt lgkmcnt(8)
    v_mfma_f32_16x16x32_bf16 v[188:191], a[224:227], a[108:111], v[188:191]
    ds_read_b64_tr_b16 a[216:217], v58 offset:16384
    v_mfma_f32_16x16x32_bf16 v[188:191], a[228:231], a[124:127], v[188:191]
    ds_read_b64_tr_b16 a[218:219], v58 offset:20480
    v_mfma_f32_16x16x32_bf16 v[184:187], a[228:231], a[120:123], v[184:187]
    ds_read_b64_tr_b16 a[220:221], v58 offset:24576
    v_mfma_f32_16x16x32_bf16 v[184:187], a[224:227], a[104:107], v[184:187]
    v_mfma_f32_16x16x32_bf16 v[180:183], a[224:227], a[100:103], v[180:183]
    ds_read_b64_tr_b16 a[222:223], v58 offset:28672
    v_mfma_f32_16x16x32_bf16 v[180:183], a[228:231], a[116:119], v[180:183]
    buffer_load_dwordx4 a[64:67], v2, s[4:7], s73 offen sc1
    v_mfma_f32_16x16x32_bf16 v[176:179], a[228:231], a[112:115], v[176:179]
    v_mfma_f32_16x16x32_bf16 v[176:179], a[224:227], a[96:99], v[176:179]
    s_waitcnt lgkmcnt(8)
    v_mfma_f32_16x16x32_bf16 v[192:195], a[200:203], a[96:99], v[192:195]
    ds_read_b64_tr_b16 a[224:225], v59 offset:16384
    v_mfma_f32_16x16x32_bf16 v[192:195], a[204:207], a[112:115], v[192:195]
    ds_read_b64_tr_b16 a[226:227], v59 offset:20480
    v_mfma_f32_16x16x32_bf16 v[196:199], a[204:207], a[116:119], v[196:199]
    ds_read_b64_tr_b16 a[228:229], v59 offset:24576
    v_mfma_f32_16x16x32_bf16 v[196:199], a[200:203], a[100:103], v[196:199]
    ds_read_b64_tr_b16 a[230:231], v59 offset:28672
    v_mfma_f32_16x16x32_bf16 v[200:203], a[200:203], a[104:107], v[200:203]
    buffer_load_dwordx4 a[68:71], v3, s[4:7], s73 offen sc1
    v_mfma_f32_16x16x32_bf16 v[200:203], a[204:207], a[120:123], v[200:203]
    buffer_load_dwordx4 a[72:75], v4, s[4:7], s73 offen sc1
    v_mfma_f32_16x16x32_bf16 v[204:207], a[204:207], a[124:127], v[204:207]
    v_mfma_f32_16x16x32_bf16 v[204:207], a[200:203], a[108:111], v[204:207]
    s_waitcnt vmcnt(28) lgkmcnt(0)
    s_barrier
    v_mfma_f32_16x16x32_bf16 v[220:223], a[208:211], a[108:111], v[220:223]
    ds_read_b64_tr_b16 a[200:201], v36 offset:0
    v_mfma_f32_16x16x32_bf16 v[220:223], a[212:215], a[124:127], v[220:223]
    ds_read_b64_tr_b16 a[202:203], v36 offset:4096
    v_mfma_f32_16x16x32_bf16 v[216:219], a[212:215], a[120:123], v[216:219]
    ds_read_b64_tr_b16 a[204:205], v36 offset:8192
    v_mfma_f32_16x16x32_bf16 v[216:219], a[208:211], a[104:107], v[216:219]
    ds_read_b64_tr_b16 a[206:207], v36 offset:12288
    v_mfma_f32_16x16x32_bf16 v[212:215], a[208:211], a[100:103], v[212:215]
    buffer_load_dwordx4 a[76:79], v5, s[4:7], s73 offen sc1
    s_add_u32 s73, s73, 131072
    v_mfma_f32_16x16x32_bf16 v[212:215], a[212:215], a[116:119], v[212:215]
    s_add_u32 s85, s85, s82
    buffer_load_dwordx4 v7, s[24:27], s85 offen offset:1024 lds
    v_mfma_f32_16x16x32_bf16 v[208:211], a[212:215], a[112:115], v[208:211]
    v_mfma_f32_16x16x32_bf16 v[208:211], a[208:211], a[96:99], v[208:211]
    v_mfma_f32_16x16x32_bf16 v[224:227], a[216:219], a[96:99], v[224:227]
    ds_read_b64_tr_b16 a[208:209], v37 offset:0
    v_mfma_f32_16x16x32_bf16 v[224:227], a[220:223], a[112:115], v[224:227]
    ds_read_b64_tr_b16 a[210:211], v37 offset:4096
    v_mfma_f32_16x16x32_bf16 v[228:231], a[220:223], a[116:119], v[228:231]
    ds_read_b64_tr_b16 a[212:213], v37 offset:8192
    v_mfma_f32_16x16x32_bf16 v[228:231], a[216:219], a[100:103], v[228:231]
    ds_read_b64_tr_b16 a[214:215], v37 offset:12288
    v_mfma_f32_16x16x32_bf16 v[232:235], a[216:219], a[104:107], v[232:235]
    s_add_u32 s85, s85, s82
    buffer_load_dwordx4 v8, s[24:27], s85 offen offset:2048 lds
    v_mfma_f32_16x16x32_bf16 v[232:235], a[220:223], a[120:123], v[232:235]
    s_add_u32 s85, s85, s82
    buffer_load_dwordx4 v9, s[24:27], s85 offen offset:3072 lds
    s_add_u32 s75, s75, 131072
    v_mfma_f32_16x16x32_bf16 v[236:239], a[220:223], a[124:127], v[236:239]
    v_mfma_f32_16x16x32_bf16 v[236:239], a[216:219], a[108:111], v[236:239]
    v_mfma_f32_16x16x32_bf16 v[252:255], a[224:227], a[108:111], v[252:255]
    ds_read_b64_tr_b16 a[216:217], v38 offset:0
    v_mfma_f32_16x16x32_bf16 v[252:255], a[228:231], a[124:127], v[252:255]
    ds_read_b64_tr_b16 a[218:219], v38 offset:4096
    v_mfma_f32_16x16x32_bf16 v[248:251], a[228:231], a[120:123], v[248:251]
    ds_read_b64_tr_b16 a[220:221], v38 offset:8192
    v_mfma_f32_16x16x32_bf16 v[248:251], a[224:227], a[104:107], v[248:251]
    v_mfma_f32_16x16x32_bf16 v[244:247], a[224:227], a[100:103], v[244:247]
    ds_read_b64_tr_b16 a[222:223], v38 offset:12288
    v_mfma_f32_16x16x32_bf16 v[244:247], a[228:231], a[116:119], v[244:247]
    s_add_u32 m0, s66, 65536
    s_nop 0
    buffer_load_dwordx4 v6, s[24:27], s75 offen offset:0 lds
    v_mfma_f32_16x16x32_bf16 v[240:243], a[228:231], a[112:115], v[240:243]
    v_mfma_f32_16x16x32_bf16 v[240:243], a[224:227], a[96:99], v[240:243]
    s_waitcnt lgkmcnt(8)
    v_mfma_f32_16x16x32_bf16 v[128:131], a[200:203], a[128:131], v[128:131]
    ds_read_b64_tr_b16 a[224:225], v39 offset:0
    v_mfma_f32_16x16x32_bf16 v[128:131], a[204:207], a[144:147], v[128:131]
    ds_read_b64_tr_b16 a[226:227], v39 offset:4096
    v_mfma_f32_16x16x32_bf16 v[132:135], a[204:207], a[148:151], v[132:135]
    ds_read_b64_tr_b16 a[228:229], v39 offset:8192
    v_mfma_f32_16x16x32_bf16 v[132:135], a[200:203], a[132:135], v[132:135]
    ds_read_b64_tr_b16 a[230:231], v39 offset:12288
    v_mfma_f32_16x16x32_bf16 v[136:139], a[200:203], a[136:139], v[136:139]
    buffer_load_dwordx4 a[80:83], v2, s[4:7], s73 offen sc1
    v_mfma_f32_16x16x32_bf16 v[136:139], a[204:207], a[152:155], v[136:139]
    buffer_load_dwordx4 a[84:87], v3, s[4:7], s73 offen sc1
    v_mfma_f32_16x16x32_bf16 v[140:143], a[204:207], a[156:159], v[140:143]
    v_mfma_f32_16x16x32_bf16 v[140:143], a[200:203], a[140:143], v[140:143]
    s_waitcnt lgkmcnt(8)
    v_mfma_f32_16x16x32_bf16 v[156:159], a[208:211], a[140:143], v[156:159]
    ds_read_b64_tr_b16 a[200:201], v40 offset:0
    v_mfma_f32_16x16x32_bf16 v[156:159], a[212:215], a[156:159], v[156:159]
    ds_read_b64_tr_b16 a[202:203], v40 offset:4096
    v_mfma_f32_16x16x32_bf16 v[152:155], a[212:215], a[152:155], v[152:155]
    ds_read_b64_tr_b16 a[204:205], v40 offset:8192
    v_mfma_f32_16x16x32_bf16 v[152:155], a[208:211], a[136:139], v[152:155]
    ds_read_b64_tr_b16 a[206:207], v40 offset:12288
    v_mfma_f32_16x16x32_bf16 v[148:151], a[208:211], a[132:135], v[148:151]
    buffer_load_dwordx4 a[88:91], v4, s[4:7], s73 offen sc1
    v_mfma_f32_16x16x32_bf16 v[148:151], a[212:215], a[148:151], v[148:151]
    buffer_load_dwordx4 a[92:95], v5, s[4:7], s73 offen sc1
    s_add_u32 s73, s73, 131072
    v_mfma_f32_16x16x32_bf16 v[144:147], a[212:215], a[144:147], v[144:147]
    v_mfma_f32_16x16x32_bf16 v[144:147], a[208:211], a[128:131], v[144:147]
    s_waitcnt lgkmcnt(8)
    v_mfma_f32_16x16x32_bf16 v[160:163], a[216:219], a[128:131], v[160:163]
    ds_read_b64_tr_b16 a[208:209], v41 offset:0
    v_mfma_f32_16x16x32_bf16 v[160:163], a[220:223], a[144:147], v[160:163]
    ds_read_b64_tr_b16 a[210:211], v41 offset:4096
    v_mfma_f32_16x16x32_bf16 v[164:167], a[220:223], a[148:151], v[164:167]
    ds_read_b64_tr_b16 a[212:213], v41 offset:8192
    v_mfma_f32_16x16x32_bf16 v[164:167], a[216:219], a[132:135], v[164:167]
    ds_read_b64_tr_b16 a[214:215], v41 offset:12288
    v_mfma_f32_16x16x32_bf16 v[168:171], a[216:219], a[136:139], v[168:171]
    buffer_load_dwordx4 a[96:99], v2, s[4:7], s73 offen sc1
    v_mfma_f32_16x16x32_bf16 v[168:171], a[220:223], a[152:155], v[168:171]
    buffer_load_dwordx4 a[100:103], v3, s[4:7], s73 offen sc1
    v_mfma_f32_16x16x32_bf16 v[172:175], a[220:223], a[156:159], v[172:175]
    v_mfma_f32_16x16x32_bf16 v[172:175], a[216:219], a[140:143], v[172:175]
    s_waitcnt lgkmcnt(8)
    v_mfma_f32_16x16x32_bf16 v[188:191], a[224:227], a[140:143], v[188:191]
    ds_read_b64_tr_b16 a[216:217], v42 offset:0
    v_mfma_f32_16x16x32_bf16 v[188:191], a[228:231], a[156:159], v[188:191]
    ds_read_b64_tr_b16 a[218:219], v42 offset:4096
    v_mfma_f32_16x16x32_bf16 v[184:187], a[228:231], a[152:155], v[184:187]
    ds_read_b64_tr_b16 a[220:221], v42 offset:8192
    v_mfma_f32_16x16x32_bf16 v[184:187], a[224:227], a[136:139], v[184:187]
    v_mfma_f32_16x16x32_bf16 v[180:183], a[224:227], a[132:135], v[180:183]
    ds_read_b64_tr_b16 a[222:223], v42 offset:12288
    v_mfma_f32_16x16x32_bf16 v[180:183], a[228:231], a[148:151], v[180:183]
    buffer_load_dwordx4 a[104:107], v4, s[4:7], s73 offen sc1
    v_mfma_f32_16x16x32_bf16 v[176:179], a[228:231], a[144:147], v[176:179]
    v_mfma_f32_16x16x32_bf16 v[176:179], a[224:227], a[128:131], v[176:179]
    s_waitcnt lgkmcnt(8)
    v_mfma_f32_16x16x32_bf16 v[192:195], a[200:203], a[128:131], v[192:195]
    ds_read_b64_tr_b16 a[224:225], v43 offset:0
    v_mfma_f32_16x16x32_bf16 v[192:195], a[204:207], a[144:147], v[192:195]
    ds_read_b64_tr_b16 a[226:227], v43 offset:4096
    v_mfma_f32_16x16x32_bf16 v[196:199], a[204:207], a[148:151], v[196:199]
    ds_read_b64_tr_b16 a[228:229], v43 offset:8192
    v_mfma_f32_16x16x32_bf16 v[196:199], a[200:203], a[132:135], v[196:199]
    ds_read_b64_tr_b16 a[230:231], v43 offset:12288
    v_mfma_f32_16x16x32_bf16 v[200:203], a[200:203], a[136:139], v[200:203]
    buffer_load_dwordx4 a[108:111], v5, s[4:7], s73 offen sc1
    s_add_u32 s73, s73, 131072
    v_mfma_f32_16x16x32_bf16 v[200:203], a[204:207], a[152:155], v[200:203]
    buffer_load_dwordx4 a[112:115], v2, s[4:7], s73 offen sc1
    v_mfma_f32_16x16x32_bf16 v[204:207], a[204:207], a[156:159], v[204:207]
    v_mfma_f32_16x16x32_bf16 v[204:207], a[200:203], a[140:143], v[204:207]
    s_waitcnt vmcnt(38) lgkmcnt(0)
    s_barrier
    v_mfma_f32_16x16x32_bf16 v[220:223], a[208:211], a[140:143], v[220:223]
    ds_read_b64_tr_b16 a[200:201], v36 offset:16384
    v_mfma_f32_16x16x32_bf16 v[220:223], a[212:215], a[156:159], v[220:223]
    ds_read_b64_tr_b16 a[202:203], v36 offset:20480
    v_mfma_f32_16x16x32_bf16 v[216:219], a[212:215], a[152:155], v[216:219]
    ds_read_b64_tr_b16 a[204:205], v36 offset:24576
    v_mfma_f32_16x16x32_bf16 v[216:219], a[208:211], a[136:139], v[216:219]
    ds_read_b64_tr_b16 a[206:207], v36 offset:28672
    v_mfma_f32_16x16x32_bf16 v[212:215], a[208:211], a[132:135], v[212:215]
    buffer_load_dwordx4 v7, s[24:27], s75 offen offset:1024 lds
    v_mfma_f32_16x16x32_bf16 v[212:215], a[212:215], a[148:151], v[212:215]
    buffer_load_dwordx4 v8, s[24:27], s75 offen offset:2048 lds
    v_mfma_f32_16x16x32_bf16 v[208:211], a[212:215], a[144:147], v[208:211]
    v_mfma_f32_16x16x32_bf16 v[208:211], a[208:211], a[128:131], v[208:211]
    v_mfma_f32_16x16x32_bf16 v[224:227], a[216:219], a[128:131], v[224:227]
    ds_read_b64_tr_b16 a[208:209], v37 offset:16384
    v_mfma_f32_16x16x32_bf16 v[224:227], a[220:223], a[144:147], v[224:227]
    ds_read_b64_tr_b16 a[210:211], v37 offset:20480
    v_mfma_f32_16x16x32_bf16 v[228:231], a[220:223], a[148:151], v[228:231]
    ds_read_b64_tr_b16 a[212:213], v37 offset:24576
    v_mfma_f32_16x16x32_bf16 v[228:231], a[216:219], a[132:135], v[228:231]
    ds_read_b64_tr_b16 a[214:215], v37 offset:28672
    v_mfma_f32_16x16x32_bf16 v[232:235], a[216:219], a[136:139], v[232:235]
    buffer_load_dwordx4 v9, s[24:27], s75 offen offset:3072 lds
    s_mov_b32 s75, s76
    v_mfma_f32_16x16x32_bf16 v[232:235], a[220:223], a[152:155], v[232:235]
    s_add_u32 m0, s66, 81920
    s_nop 0
    buffer_load_dwordx4 v6, s[28:31], s75 offen offset:0 lds
    v_mfma_f32_16x16x32_bf16 v[236:239], a[220:223], a[156:159], v[236:239]
    v_mfma_f32_16x16x32_bf16 v[236:239], a[216:219], a[140:143], v[236:239]
    v_mfma_f32_16x16x32_bf16 v[252:255], a[224:227], a[140:143], v[252:255]
    ds_read_b64_tr_b16 a[216:217], v38 offset:16384
    v_mfma_f32_16x16x32_bf16 v[252:255], a[228:231], a[156:159], v[252:255]
    ds_read_b64_tr_b16 a[218:219], v38 offset:20480
    v_mfma_f32_16x16x32_bf16 v[248:251], a[228:231], a[152:155], v[248:251]
    ds_read_b64_tr_b16 a[220:221], v38 offset:24576
    v_mfma_f32_16x16x32_bf16 v[248:251], a[224:227], a[136:139], v[248:251]
    v_mfma_f32_16x16x32_bf16 v[244:247], a[224:227], a[132:135], v[244:247]
    ds_read_b64_tr_b16 a[222:223], v38 offset:28672
    v_mfma_f32_16x16x32_bf16 v[244:247], a[228:231], a[148:151], v[244:247]
    buffer_load_dwordx4 v7, s[28:31], s75 offen offset:1024 lds
    v_mfma_f32_16x16x32_bf16 v[240:243], a[228:231], a[144:147], v[240:243]
    v_mfma_f32_16x16x32_bf16 v[240:243], a[224:227], a[128:131], v[240:243]
    s_waitcnt vmcnt(28)
    v_cmp_ne_u32 vcc, 1, v48
    s_cmp_eq_u64 vcc, 0
    s_cbranch_scc1 L_poe_ok_parallel_sum__sliding_block__glu_gated_swiglu__prompt_kernel
L_poe_parallel_sum__sliding_block__glu_gated_swiglu__prompt_kernel:
    s_add_u32 s1, s1, 1
    s_cmp_gt_u32 s1, 0x400000
    s_cbranch_scc1 L_end_parallel_sum__sliding_block__glu_gated_swiglu__prompt_kernel
    buffer_load_dword v48, v29, s[4:7], s61 offen offset:32 sc1
    s_waitcnt vmcnt(0)
    v_cmp_ne_u32 vcc, 1, v48
    s_cmp_eq_u64 vcc, 0
    s_cbranch_scc0 L_poe_parallel_sum__sliding_block__glu_gated_swiglu__prompt_kernel
L_poe_ok_parallel_sum__sliding_block__glu_gated_swiglu__prompt_kernel:
    s_waitcnt lgkmcnt(8)
    v_mfma_f32_16x16x32_bf16 v[128:131], a[200:203], a[0:3], v[128:131]
    ds_read_b64_tr_b16 a[224:225], v39 offset:16384
    v_mfma_f32_16x16x32_bf16 v[128:131], a[204:207], a[16:19], v[128:131]
    ds_read_b64_tr_b16 a[226:227], v39 offset:20480
    v_mfma_f32_16x16x32_bf16 v[132:135], a[204:207], a[20:23], v[132:135]
    ds_read_b64_tr_b16 a[228:229], v39 offset:24576
    v_mfma_f32_16x16x32_bf16 v[132:135], a[200:203], a[4:7], v[132:135]
    ds_read_b64_tr_b16 a[230:231], v39 offset:28672
    v_mfma_f32_16x16x32_bf16 v[136:139], a[200:203], a[8:11], v[136:139]
    buffer_load_dwordx4 a[116:119], v3, s[4:7], s73 offen sc1
    v_mfma_f32_16x16x32_bf16 v[136:139], a[204:207], a[24:27], v[136:139]
    buffer_load_dwordx4 a[120:123], v4, s[4:7], s73 offen sc1
    v_mfma_f32_16x16x32_bf16 v[140:143], a[204:207], a[28:31], v[140:143]
    v_mfma_f32_16x16x32_bf16 v[140:143], a[200:203], a[12:15], v[140:143]
    s_waitcnt lgkmcnt(8)
    v_mfma_f32_16x16x32_bf16 v[156:159], a[208:211], a[12:15], v[156:159]
    ds_read_b64_tr_b16 a[200:201], v40 offset:16384
    v_mfma_f32_16x16x32_bf16 v[156:159], a[212:215], a[28:31], v[156:159]
    ds_read_b64_tr_b16 a[202:203], v40 offset:20480
    v_mfma_f32_16x16x32_bf16 v[152:155], a[212:215], a[24:27], v[152:155]
    ds_read_b64_tr_b16 a[204:205], v40 offset:24576
    v_mfma_f32_16x16x32_bf16 v[152:155], a[208:211], a[8:11], v[152:155]
    ds_read_b64_tr_b16 a[206:207], v40 offset:28672
    v_mfma_f32_16x16x32_bf16 v[148:151], a[208:211], a[4:7], v[148:151]
    buffer_load_dwordx4 a[124:127], v5, s[4:7], s73 offen sc1
    s_mov_b32 s73, s74
    v_mfma_f32_16x16x32_bf16 v[148:151], a[212:215], a[20:23], v[148:151]
    buffer_load_dwordx4 a[128:131], v2, s[4:7], s73 offen sc1
    v_mfma_f32_16x16x32_bf16 v[144:147], a[212:215], a[16:19], v[144:147]
    v_mfma_f32_16x16x32_bf16 v[144:147], a[208:211], a[0:3], v[144:147]
    s_waitcnt lgkmcnt(8)
    v_mfma_f32_16x16x32_bf16 v[160:163], a[216:219], a[0:3], v[160:163]
    ds_read_b64_tr_b16 a[208:209], v41 offset:16384
    v_mfma_f32_16x16x32_bf16 v[160:163], a[220:223], a[16:19], v[160:163]
    ds_read_b64_tr_b16 a[210:211], v41 offset:20480
    v_mfma_f32_16x16x32_bf16 v[164:167], a[220:223], a[20:23], v[164:167]
    ds_read_b64_tr_b16 a[212:213], v41 offset:24576
    v_mfma_f32_16x16x32_bf16 v[164:167], a[216:219], a[4:7], v[164:167]
    ds_read_b64_tr_b16 a[214:215], v41 offset:28672
    v_mfma_f32_16x16x32_bf16 v[168:171], a[216:219], a[8:11], v[168:171]
    buffer_load_dwordx4 a[132:135], v3, s[4:7], s73 offen sc1
    v_mfma_f32_16x16x32_bf16 v[168:171], a[220:223], a[24:27], v[168:171]
    buffer_load_dwordx4 a[136:139], v4, s[4:7], s73 offen sc1
    v_mfma_f32_16x16x32_bf16 v[172:175], a[220:223], a[28:31], v[172:175]
    v_mfma_f32_16x16x32_bf16 v[172:175], a[216:219], a[12:15], v[172:175]
    s_waitcnt lgkmcnt(8)
    v_mfma_f32_16x16x32_bf16 v[188:191], a[224:227], a[12:15], v[188:191]
    ds_read_b64_tr_b16 a[216:217], v42 offset:16384
    v_mfma_f32_16x16x32_bf16 v[188:191], a[228:231], a[28:31], v[188:191]
    ds_read_b64_tr_b16 a[218:219], v42 offset:20480
    v_mfma_f32_16x16x32_bf16 v[184:187], a[228:231], a[24:27], v[184:187]
    ds_read_b64_tr_b16 a[220:221], v42 offset:24576
    v_mfma_f32_16x16x32_bf16 v[184:187], a[224:227], a[8:11], v[184:187]
    v_mfma_f32_16x16x32_bf16 v[180:183], a[224:227], a[4:7], v[180:183]
    ds_read_b64_tr_b16 a[222:223], v42 offset:28672
    v_mfma_f32_16x16x32_bf16 v[180:183], a[228:231], a[20:23], v[180:183]
    buffer_load_dwordx4 a[140:143], v5, s[4:7], s73 offen sc1
    s_add_u32 s73, s73, 131072
    v_mfma_f32_16x16x32_bf16 v[176:179], a[228:231], a[16:19], v[176:179]
    v_mfma_f32_16x16x32_bf16 v[176:179], a[224:227], a[0:3], v[176:179]
    s_waitcnt lgkmcnt(8)
    v_mfma_f32_16x16x32_bf16 v[192:195], a[200:203], a[0:3], v[192:195]
    ds_read_b64_tr_b16 a[224:225], v43 offset:16384
    v_mfma_f32_16x16x32_bf16 v[192:195], a[204:207], a[16:19], v[192:195]
    ds_read_b64_tr_b16 a[226:227], v43 offset:20480
    v_mfma_f32_16x16x32_bf16 v[196:199], a[204:207], a[20:23], v[196:199]
    ds_read_b64_tr_b16 a[228:229], v43 offset:24576
    v_mfma_f32_16x16x32_bf16 v[196:199], a[200:203], a[4:7], v[196:199]
    ds_read_b64_tr_b16 a[230:231], v43 offset:28672
    v_mfma_f32_16x16x32_bf16 v[200:203], a[200:203], a[8:11], v[200:203]
    buffer_load_dwordx4 a[144:147], v2, s[4:7], s73 offen sc1
    v_mfma_f32_16x16x32_bf16 v[200:203], a[204:207], a[24:27], v[200:203]
    buffer_load_dwordx4 a[148:151], v3, s[4:7], s73 offen sc1
    v_mfma_f32_16x16x32_bf16 v[204:207], a[204:207], a[28:31], v[204:207]
    v_mfma_f32_16x16x32_bf16 v[204:207], a[200:203], a[12:15], v[204:207]
    s_waitcnt lgkmcnt(0)
    s_barrier
    v_mfma_f32_16x16x32_bf16 v[220:223], a[208:211], a[12:15], v[220:223]
    ds_read_b64_tr_b16 a[200:201], v36 offset:32768
    v_mfma_f32_16x16x32_bf16 v[220:223], a[212:215], a[28:31], v[220:223]
    ds_read_b64_tr_b16 a[202:203], v36 offset:36864
    v_mfma_f32_16x16x32_bf16 v[216:219], a[212:215], a[24:27], v[216:219]
    ds_read_b64_tr_b16 a[204:205], v36 offset:40960
    v_mfma_f32_16x16x32_bf16 v[216:219], a[208:211], a[8:11], v[216:219]
    ds_read_b64_tr_b16 a[206:207], v36 offset:45056
    v_mfma_f32_16x16x32_bf16 v[212:215], a[208:211], a[4:7], v[212:215]
    buffer_load_dwordx4 v8, s[28:31], s75 offen offset:2048 lds
    v_mfma_f32_16x16x32_bf16 v[212:215], a[212:215], a[20:23], v[212:215]
    buffer_load_dwordx4 v9, s[28:31], s75 offen offset:3072 lds
    s_add_u32 s75, s75, 131072
    v_mfma_f32_16x16x32_bf16 v[208:211], a[212:215], a[16:19], v[208:211]
    v_mfma_f32_16x16x32_bf16 v[208:211], a[208:211], a[0:3], v[208:211]
    v_mfma_f32_16x16x32_bf16 v[224:227], a[216:219], a[0:3], v[224:227]
    ds_read_b64_tr_b16 a[208:209], v37 offset:32768
    v_mfma_f32_16x16x32_bf16 v[224:227], a[220:223], a[16:19], v[224:227]
    ds_read_b64_tr_b16 a[210:211], v37 offset:36864
    v_mfma_f32_16x16x32_bf16 v[228:231], a[220:223], a[20:23], v[228:231]
    ds_read_b64_tr_b16 a[212:213], v37 offset:40960
    v_mfma_f32_16x16x32_bf16 v[228:231], a[216:219], a[4:7], v[228:231]
    ds_read_b64_tr_b16 a[214:215], v37 offset:45056
    v_mfma_f32_16x16x32_bf16 v[232:235], a[216:219], a[8:11], v[232:235]
    s_add_u32 m0, s66, 0
    s_nop 0
    buffer_load_dwordx4 v6, s[28:31], s75 offen offset:0 lds
    v_mfma_f32_16x16x32_bf16 v[232:235], a[220:223], a[24:27], v[232:235]
    buffer_load_dwordx4 v7, s[28:31], s75 offen offset:1024 lds
    v_mfma_f32_16x16x32_bf16 v[236:239], a[220:223], a[28:31], v[236:239]
    v_mfma_f32_16x16x32_bf16 v[236:239], a[216:219], a[12:15], v[236:239]
    v_mfma_f32_16x16x32_bf16 v[252:255], a[224:227], a[12:15], v[252:255]
    ds_read_b64_tr_b16 a[216:217], v38 offset:32768
    v_mfma_f32_16x16x32_bf16 v[252:255], a[228:231], a[28:31], v[252:255]
    ds_read_b64_tr_b16 a[218:219], v38 offset:36864
    v_mfma_f32_16x16x32_bf16 v[248:251], a[228:231], a[24:27], v[248:251]
    ds_read_b64_tr_b16 a[220:221], v38 offset:40960
    v_mfma_f32_16x16x32_bf16 v[248:251], a[224:227], a[8:11], v[248:251]
    v_mfma_f32_16x16x32_bf16 v[244:247], a[224:227], a[4:7], v[244:247]
    ds_read_b64_tr_b16 a[222:223], v38 offset:45056
    v_mfma_f32_16x16x32_bf16 v[244:247], a[228:231], a[20:23], v[244:247]
    buffer_load_dwordx4 v8, s[28:31], s75 offen offset:2048 lds
    v_mfma_f32_16x16x32_bf16 v[240:243], a[228:231], a[16:19], v[240:243]
    v_mfma_f32_16x16x32_bf16 v[240:243], a[224:227], a[0:3], v[240:243]
    s_waitcnt vmcnt(36) lgkmcnt(8)
    v_mfma_f32_16x16x32_bf16 v[128:131], a[200:203], a[32:35], v[128:131]
    ds_read_b64_tr_b16 a[224:225], v39 offset:32768
    v_mfma_f32_16x16x32_bf16 v[128:131], a[204:207], a[48:51], v[128:131]
    ds_read_b64_tr_b16 a[226:227], v39 offset:36864
    v_mfma_f32_16x16x32_bf16 v[132:135], a[204:207], a[52:55], v[132:135]
    ds_read_b64_tr_b16 a[228:229], v39 offset:40960
    v_mfma_f32_16x16x32_bf16 v[132:135], a[200:203], a[36:39], v[132:135]
    ds_read_b64_tr_b16 a[230:231], v39 offset:45056
    v_mfma_f32_16x16x32_bf16 v[136:139], a[200:203], a[40:43], v[136:139]
    buffer_load_dwordx4 a[152:155], v4, s[4:7], s73 offen sc1
    v_mfma_f32_16x16x32_bf16 v[136:139], a[204:207], a[56:59], v[136:139]
    buffer_load_dwordx4 a[156:159], v5, s[4:7], s73 offen sc1
    s_add_u32 s73, s73, 131072
    v_mfma_f32_16x16x32_bf16 v[140:143], a[204:207], a[60:63], v[140:143]
    v_mfma_f32_16x16x32_bf16 v[140:143], a[200:203], a[44:47], v[140:143]
    s_waitcnt lgkmcnt(8)
    v_mfma_f32_16x16x32_bf16 v[156:159], a[208:211], a[44:47], v[156:159]
    ds_read_b64_tr_b16 a[200:201], v40 offset:32768
    v_mfma_f32_16x16x32_bf16 v[156:159], a[212:215], a[60:63], v[156:159]
    ds_read_b64_tr_b16 a[202:203], v40 offset:36864
    v_mfma_f32_16x16x32_bf16 v[152:155], a[212:215], a[56:59], v[152:155]
    ds_read_b64_tr_b16 a[204:205], v40 offset:40960
    v_mfma_f32_16x16x32_bf16 v[152:155], a[208:211], a[40:43], v[152:155]
    ds_read_b64_tr_b16 a[206:207], v40 offset:45056
    v_mfma_f32_16x16x32_bf16 v[148:151], a[208:211], a[36:39], v[148:151]
    buffer_load_dwordx4 a[0:3], v2, s[4:7], s73 offen sc1
    v_mfma_f32_16x16x32_bf16 v[148:151], a[212:215], a[52:55], v[148:151]
    buffer_load_dwordx4 a[4:7], v3, s[4:7], s73 offen sc1
    v_mfma_f32_16x16x32_bf16 v[144:147], a[212:215], a[48:51], v[144:147]
    v_mfma_f32_16x16x32_bf16 v[144:147], a[208:211], a[32:35], v[144:147]
    s_waitcnt lgkmcnt(8)
    v_mfma_f32_16x16x32_bf16 v[160:163], a[216:219], a[32:35], v[160:163]
    ds_read_b64_tr_b16 a[208:209], v41 offset:32768
    v_mfma_f32_16x16x32_bf16 v[160:163], a[220:223], a[48:51], v[160:163]
    ds_read_b64_tr_b16 a[210:211], v41 offset:36864
    v_mfma_f32_16x16x32_bf16 v[164:167], a[220:223], a[52:55], v[164:167]
    ds_read_b64_tr_b16 a[212:213], v41 offset:40960
    v_mfma_f32_16x16x32_bf16 v[164:167], a[216:219], a[36:39], v[164:167]
    ds_read_b64_tr_b16 a[214:215], v41 offset:45056
    v_mfma_f32_16x16x32_bf16 v[168:171], a[216:219], a[40:43], v[168:171]
    buffer_load_dwordx4 a[8:11], v4, s[4:7], s73 offen sc1
    v_mfma_f32_16x16x32_bf16 v[168:171], a[220:223], a[56:59], v[168:171]
    buffer_load_dwordx4 a[12:15], v5, s[4:7], s73 offen sc1
    s_add_u32 s73, s73, 131072
    v_mfma_f32_16x16x32_bf16 v[172:175], a[220:223], a[60:63], v[172:175]
    v_mfma_f32_16x16x32_bf16 v[172:175], a[216:219], a[44:47], v[172:175]
    s_waitcnt lgkmcnt(8)
    v_mfma_f32_16x16x32_bf16 v[188:191], a[224:227], a[44:47], v[188:191]
    ds_read_b64_tr_b16 a[216:217], v42 offset:32768
    v_mfma_f32_16x16x32_bf16 v[188:191], a[228:231], a[60:63], v[188:191]
    ds_read_b64_tr_b16 a[218:219], v42 offset:36864
    v_mfma_f32_16x16x32_bf16 v[184:187], a[228:231], a[56:59], v[184:187]
    ds_read_b64_tr_b16 a[220:221], v42 offset:40960
    v_mfma_f32_16x16x32_bf16 v[184:187], a[224:227], a[40:43], v[184:187]
    ds_read_b64_tr_b16 a[222:223], v42 offset:45056
    v_mfma_f32_16x16x32_bf16 v[180:183], a[224:227], a[36:39], v[180:183]
    buffer_load_dwordx4 a[16:19], v2, s[4:7], s73 offen sc1
    v_mfma_f32_16x16x32_bf16 v[180:183], a[228:231], a[52:55], v[180:183]
    buffer_load_dwordx4 a[20:23], v3, s[4:7], s73 offen sc1
    v_mfma_f32_16x16x32_bf16 v[176:179], a[228:231], a[48:51], v[176:179]
    v_mfma_f32_16x16x32_bf16 v[176:179], a[224:227], a[32:35], v[176:179]
    s_waitcnt lgkmcnt(8)
    v_mfma_f32_16x16x32_bf16 v[192:195], a[200:203], a[32:35], v[192:195]
    ds_read_b64_tr_b16 a[224:225], v43 offset:32768
    v_mfma_f32_16x16x32_bf16 v[192:195], a[204:207], a[48:51], v[192:195]
    ds_read_b64_tr_b16 a[226:227], v43 offset:36864
    v_mfma_f32_16x16x32_bf16 v[196:199], a[204:207], a[52:55], v[196:199]
    ds_read_b64_tr_b16 a[228:229], v43 offset:40960
    v_mfma_f32_16x16x32_bf16 v[196:199], a[200:203], a[36:39], v[196:199]
    ds_read_b64_tr_b16 a[230:231], v43 offset:45056
    v_mfma_f32_16x16x32_bf16 v[200:203], a[200:203], a[40:43], v[200:203]
    buffer_load_dwordx4 a[24:27], v4, s[4:7], s73 offen sc1
    v_mfma_f32_16x16x32_bf16 v[200:203], a[204:207], a[56:59], v[200:203]
    buffer_load_dwordx4 a[28:31], v5, s[4:7], s73 offen sc1
    s_add_u32 s73, s73, 131072
    v_mfma_f32_16x16x32_bf16 v[204:207], a[204:207], a[60:63], v[204:207]
    v_mfma_f32_16x16x32_bf16 v[204:207], a[200:203], a[44:47], v[204:207]
    s_waitcnt vmcnt(39) lgkmcnt(0)
    s_barrier
    v_mfma_f32_16x16x32_bf16 v[220:223], a[208:211], a[44:47], v[220:223]
    ds_read_b64_tr_b16 a[200:201], v36 offset:49152
    v_mfma_f32_16x16x32_bf16 v[220:223], a[212:215], a[60:63], v[220:223]
    ds_read_b64_tr_b16 a[202:203], v36 offset:53248
    v_mfma_f32_16x16x32_bf16 v[216:219], a[212:215], a[56:59], v[216:219]
    ds_read_b64_tr_b16 a[204:205], v36 offset:57344
    v_mfma_f32_16x16x32_bf16 v[216:219], a[208:211], a[40:43], v[216:219]
    ds_read_b64_tr_b16 a[206:207], v36 offset:61440
    v_mfma_f32_16x16x32_bf16 v[212:215], a[208:211], a[36:39], v[212:215]
    buffer_load_dwordx4 v9, s[28:31], s75 offen offset:3072 lds
    s_add_u32 s75, s75, 131072
    v_mfma_f32_16x16x32_bf16 v[212:215], a[212:215], a[52:55], v[212:215]
    s_add_u32 m0, s66, 16384
    s_nop 0
    buffer_load_dwordx4 v6, s[28:31], s75 offen offset:0 lds
    v_mfma_f32_16x16x32_bf16 v[208:211], a[212:215], a[48:51], v[208:211]
    v_mfma_f32_16x16x32_bf16 v[208:211], a[208:211], a[32:35], v[208:211]
    v_mfma_f32_16x16x32_bf16 v[224:227], a[216:219], a[32:35], v[224:227]
    ds_read_b64_tr_b16 a[208:209], v37 offset:49152
    v_mfma_f32_16x16x32_bf16 v[224:227], a[220:223], a[48:51], v[224:227]
    ds_read_b64_tr_b16 a[210:211], v37 offset:53248
    v_mfma_f32_16x16x32_bf16 v[228:231], a[220:223], a[52:55], v[228:231]
    ds_read_b64_tr_b16 a[212:213], v37 offset:57344
    v_mfma_f32_16x16x32_bf16 v[228:231], a[216:219], a[36:39], v[228:231]
    ds_read_b64_tr_b16 a[214:215], v37 offset:61440
    v_mfma_f32_16x16x32_bf16 v[232:235], a[216:219], a[40:43], v[232:235]
    buffer_load_dwordx4 v7, s[28:31], s75 offen offset:1024 lds
    v_mfma_f32_16x16x32_bf16 v[232:235], a[220:223], a[56:59], v[232:235]
    buffer_load_dwordx4 v8, s[28:31], s75 offen offset:2048 lds
    v_mfma_f32_16x16x32_bf16 v[236:239], a[220:223], a[60:63], v[236:239]
    v_mfma_f32_16x16x32_bf16 v[236:239], a[216:219], a[44:47], v[236:239]
    v_mfma_f32_16x16x32_bf16 v[252:255], a[224:227], a[44:47], v[252:255]
    ds_read_b64_tr_b16 a[216:217], v38 offset:49152
    v_mfma_f32_16x16x32_bf16 v[252:255], a[228:231], a[60:63], v[252:255]
    ds_read_b64_tr_b16 a[218:219], v38 offset:53248
    v_mfma_f32_16x16x32_bf16 v[248:251], a[228:231], a[56:59], v[248:251]
    ds_read_b64_tr_b16 a[220:221], v38 offset:57344
    v_mfma_f32_16x16x32_bf16 v[248:251], a[224:227], a[40:43], v[248:251]
    v_mfma_f32_16x16x32_bf16 v[244:247], a[224:227], a[36:39], v[244:247]
    ds_read_b64_tr_b16 a[222:223], v38 offset:61440
    v_mfma_f32_16x16x32_bf16 v[244:247], a[228:231], a[52:55], v[244:247]
    buffer_load_dwordx4 v9, s[28:31], s75 offen offset:3072 lds
    s_add_u32 s75, s75, 131072
    v_mfma_f32_16x16x32_bf16 v[240:243], a[228:231], a[48:51], v[240:243]
    v_mfma_f32_16x16x32_bf16 v[240:243], a[224:227], a[32:35], v[240:243]
    s_waitcnt vmcnt(39) lgkmcnt(8)
    v_mfma_f32_16x16x32_bf16 v[128:131], a[200:203], a[64:67], v[128:131]
    ds_read_b64_tr_b16 a[224:225], v39 offset:49152
    v_mfma_f32_16x16x32_bf16 v[128:131], a[204:207], a[80:83], v[128:131]
    ds_read_b64_tr_b16 a[226:227], v39 offset:53248
    v_mfma_f32_16x16x32_bf16 v[132:135], a[204:207], a[84:87], v[132:135]
    ds_read_b64_tr_b16 a[228:229], v39 offset:57344
    v_mfma_f32_16x16x32_bf16 v[132:135], a[200:203], a[68:71], v[132:135]
    ds_read_b64_tr_b16 a[230:231], v39 offset:61440
    v_mfma_f32_16x16x32_bf16 v[136:139], a[200:203], a[72:75], v[136:139]
    buffer_load_dwordx4 a[32:35], v2, s[4:7], s73 offen sc1
    v_mfma_f32_16x16x32_bf16 v[136:139], a[204:207], a[88:91], v[136:139]
    buffer_load_dwordx4 a[36:39], v3, s[4:7], s73 offen sc1
    v_mfma_f32_16x16x32_bf16 v[140:143], a[204:207], a[92:95], v[140:143]
    v_mfma_f32_16x16x32_bf16 v[140:143], a[200:203], a[76:79], v[140:143]
    s_waitcnt lgkmcnt(8)
    v_mfma_f32_16x16x32_bf16 v[156:159], a[208:211], a[76:79], v[156:159]
    ds_read_b64_tr_b16 a[200:201], v40 offset:49152
    v_mfma_f32_16x16x32_bf16 v[156:159], a[212:215], a[92:95], v[156:159]
    ds_read_b64_tr_b16 a[202:203], v40 offset:53248
    v_mfma_f32_16x16x32_bf16 v[152:155], a[212:215], a[88:91], v[152:155]
    ds_read_b64_tr_b16 a[204:205], v40 offset:57344
    v_mfma_f32_16x16x32_bf16 v[152:155], a[208:211], a[72:75], v[152:155]
    v_mfma_f32_16x16x32_bf16 v[148:151], a[208:211], a[68:71], v[148:151]
    ds_read_b64_tr_b16 a[206:207], v40 offset:61440
    v_mfma_f32_16x16x32_bf16 v[148:151], a[212:215], a[84:87], v[148:151]
    buffer_load_dwordx4 a[40:43], v4, s[4:7], s73 offen sc1
    v_mfma_f32_16x16x32_bf16 v[144:147], a[212:215], a[80:83], v[144:147]
    v_mfma_f32_16x16x32_bf16 v[144:147], a[208:211], a[64:67], v[144:147]
    s_waitcnt lgkmcnt(8)
    v_mfma_f32_16x16x32_bf16 v[160:163], a[216:219], a[64:67], v[160:163]
    ds_read_b64_tr_b16 a[208:209], v41 offset:49152
    v_mfma_f32_16x16x32_bf16 v[160:163], a[220:223], a[80:83], v[160:163]
    ds_read_b64_tr_b16 a[210:211], v41 offset:53248
    v_mfma_f32_16x16x32_bf16 v[164:167], a[220:223], a[84:87], v[164:167]
    ds_read_b64_tr_b16 a[212:213], v41 offset:57344
    v_mfma_f32_16x16x32_bf16 v[164:167], a[216:219], a[68:71], v[164:167]
    ds_read_b64_tr_b16 a[214:215], v41 offset:61440
    v_mfma_f32_16x16x32_bf16 v[168:171], a[216:219], a[72:75], v[168:171]
    buffer_load_dwordx4 a[44:47], v5, s[4:7], s73 offen sc1
    s_add_u32 s73, s73, 131072
    v_mfma_f32_16x16x32_bf16 v[168:171], a[220:223], a[88:91], v[168:171]
    buffer_load_dwordx4 a[48:51], v2, s[4:7], s73 offen sc1
    v_mfma_f32_16x16x32_bf16 v[172:175], a[220:223], a[92:95], v[172:175]
    v_mfma_f32_16x16x32_bf16 v[172:175], a[216:219], a[76:79], v[172:175]
    s_waitcnt lgkmcnt(8)
    v_mfma_f32_16x16x32_bf16 v[188:191], a[224:227], a[76:79], v[188:191]
    ds_read_b64_tr_b16 a[216:217], v42 offset:49152
    v_mfma_f32_16x16x32_bf16 v[188:191], a[228:231], a[92:95], v[188:191]
    ds_read_b64_tr_b16 a[218:219], v42 offset:53248
    v_mfma_f32_16x16x32_bf16 v[184:187], a[228:231], a[88:91], v[184:187]
    ds_read_b64_tr_b16 a[220:221], v42 offset:57344
    v_mfma_f32_16x16x32_bf16 v[184:187], a[224:227], a[72:75], v[184:187]
    v_mfma_f32_16x16x32_bf16 v[180:183], a[224:227], a[68:71], v[180:183]
    ds_read_b64_tr_b16 a[222:223], v42 offset:61440
    v_mfma_f32_16x16x32_bf16 v[180:183], a[228:231], a[84:87], v[180:183]
    buffer_load_dwordx4 a[52:55], v3, s[4:7], s73 offen sc1
    v_mfma_f32_16x16x32_bf16 v[176:179], a[228:231], a[80:83], v[176:179]
    v_mfma_f32_16x16x32_bf16 v[176:179], a[224:227], a[64:67], v[176:179]
    s_waitcnt lgkmcnt(8)
    v_mfma_f32_16x16x32_bf16 v[192:195], a[200:203], a[64:67], v[192:195]
    ds_read_b64_tr_b16 a[224:225], v43 offset:49152
    v_mfma_f32_16x16x32_bf16 v[192:195], a[204:207], a[80:83], v[192:195]
    ds_read_b64_tr_b16 a[226:227], v43 offset:53248
    v_mfma_f32_16x16x32_bf16 v[196:199], a[204:207], a[84:87], v[196:199]
    ds_read_b64_tr_b16 a[228:229], v43 offset:57344
    v_mfma_f32_16x16x32_bf16 v[196:199], a[200:203], a[68:71], v[196:199]
    ds_read_b64_tr_b16 a[230:231], v43 offset:61440
    v_mfma_f32_16x16x32_bf16 v[200:203], a[200:203], a[72:75], v[200:203]
    buffer_load_dwordx4 a[56:59], v4, s[4:7], s73 offen sc1
    v_mfma_f32_16x16x32_bf16 v[200:203], a[204:207], a[88:91], v[200:203]
    buffer_load_dwordx4 a[60:63], v5, s[4:7], s73 offen sc1
    s_add_u32 s73, s73, 131072
    v_mfma_f32_16x16x32_bf16 v[204:207], a[204:207], a[92:95], v[204:207]
    v_mfma_f32_16x16x32_bf16 v[204:207], a[200:203], a[76:79], v[204:207]
    s_waitcnt vmcnt(39) lgkmcnt(0)
    s_barrier
    v_mfma_f32_16x16x32_bf16 v[220:223], a[208:211], a[76:79], v[220:223]
    ds_read_b64_tr_b16 a[200:201], v52 offset:0
    v_mfma_f32_16x16x32_bf16 v[220:223], a[212:215], a[92:95], v[220:223]
    ds_read_b64_tr_b16 a[202:203], v52 offset:4096
    v_mfma_f32_16x16x32_bf16 v[216:219], a[212:215], a[88:91], v[216:219]
    ds_read_b64_tr_b16 a[204:205], v52 offset:8192
    v_mfma_f32_16x16x32_bf16 v[216:219], a[208:211], a[72:75], v[216:219]
    v_mfma_f32_16x16x32_bf16 v[212:215], a[208:211], a[68:71], v[212:215]
    ds_read_b64_tr_b16 a[206:207], v52 offset:12288
    v_mfma_f32_16x16x32_bf16 v[212:215], a[212:215], a[84:87], v[212:215]
    s_add_u32 m0, s66, 32768
    s_nop 0
    buffer_load_dwordx4 v6, s[28:31], s75 offen offset:0 lds
    v_mfma_f32_16x16x32_bf16 v[208:211], a[212:215], a[80:83], v[208:211]
    v_mfma_f32_16x16x32_bf16 v[208:211], a[208:211], a[64:67], v[208:211]
    v_mfma_f32_16x16x32_bf16 v[224:227], a[216:219], a[64:67], v[224:227]
    ds_read_b64_tr_b16 a[208:209], v53 offset:0
    v_mfma_f32_16x16x32_bf16 v[224:227], a[220:223], a[80:83], v[224:227]
    ds_read_b64_tr_b16 a[210:211], v53 offset:4096
    v_mfma_f32_16x16x32_bf16 v[228:231], a[220:223], a[84:87], v[228:231]
    ds_read_b64_tr_b16 a[212:213], v53 offset:8192
    v_mfma_f32_16x16x32_bf16 v[228:231], a[216:219], a[68:71], v[228:231]
    ds_read_b64_tr_b16 a[214:215], v53 offset:12288
    v_mfma_f32_16x16x32_bf16 v[232:235], a[216:219], a[72:75], v[232:235]
    buffer_load_dwordx4 v7, s[28:31], s75 offen offset:1024 lds
    v_mfma_f32_16x16x32_bf16 v[232:235], a[220:223], a[88:91], v[232:235]
    buffer_load_dwordx4 v8, s[28:31], s75 offen offset:2048 lds
    v_mfma_f32_16x16x32_bf16 v[236:239], a[220:223], a[92:95], v[236:239]
    v_mfma_f32_16x16x32_bf16 v[236:239], a[216:219], a[76:79], v[236:239]
    v_mfma_f32_16x16x32_bf16 v[252:255], a[224:227], a[76:79], v[252:255]
    ds_read_b64_tr_b16 a[216:217], v54 offset:0
    v_mfma_f32_16x16x32_bf16 v[252:255], a[228:231], a[92:95], v[252:255]
    ds_read_b64_tr_b16 a[218:219], v54 offset:4096
    v_mfma_f32_16x16x32_bf16 v[248:251], a[228:231], a[88:91], v[248:251]
    ds_read_b64_tr_b16 a[220:221], v54 offset:8192
    v_mfma_f32_16x16x32_bf16 v[248:251], a[224:227], a[72:75], v[248:251]
    v_mfma_f32_16x16x32_bf16 v[244:247], a[224:227], a[68:71], v[244:247]
    ds_read_b64_tr_b16 a[222:223], v54 offset:12288
    v_mfma_f32_16x16x32_bf16 v[244:247], a[228:231], a[84:87], v[244:247]
    buffer_load_dwordx4 v9, s[28:31], s75 offen offset:3072 lds
    s_add_u32 s75, s75, 131072
    v_mfma_f32_16x16x32_bf16 v[240:243], a[228:231], a[80:83], v[240:243]
    v_mfma_f32_16x16x32_bf16 v[240:243], a[224:227], a[64:67], v[240:243]
    s_waitcnt vmcnt(38) lgkmcnt(8)
    v_mfma_f32_16x16x32_bf16 v[128:131], a[200:203], a[96:99], v[128:131]
    ds_read_b64_tr_b16 a[224:225], v55 offset:0
    v_mfma_f32_16x16x32_bf16 v[128:131], a[204:207], a[112:115], v[128:131]
    ds_read_b64_tr_b16 a[226:227], v55 offset:4096
    v_mfma_f32_16x16x32_bf16 v[132:135], a[204:207], a[116:119], v[132:135]
    ds_read_b64_tr_b16 a[228:229], v55 offset:8192
    v_mfma_f32_16x16x32_bf16 v[132:135], a[200:203], a[100:103], v[132:135]
    ds_read_b64_tr_b16 a[230:231], v55 offset:12288
    v_mfma_f32_16x16x32_bf16 v[136:139], a[200:203], a[104:107], v[136:139]
    buffer_load_dwordx4 a[64:67], v2, s[4:7], s73 offen sc1
    v_mfma_f32_16x16x32_bf16 v[136:139], a[204:207], a[120:123], v[136:139]
    buffer_load_dwordx4 a[68:71], v3, s[4:7], s73 offen sc1
    v_mfma_f32_16x16x32_bf16 v[140:143], a[204:207], a[124:127], v[140:143]
    v_mfma_f32_16x16x32_bf16 v[140:143], a[200:203], a[108:111], v[140:143]
    s_waitcnt lgkmcnt(8)
    v_mfma_f32_16x16x32_bf16 v[156:159], a[208:211], a[108:111], v[156:159]
    ds_read_b64_tr_b16 a[200:201], v56 offset:0
    v_mfma_f32_16x16x32_bf16 v[156:159], a[212:215], a[124:127], v[156:159]
    ds_read_b64_tr_b16 a[202:203], v56 offset:4096
    v_mfma_f32_16x16x32_bf16 v[152:155], a[212:215], a[120:123], v[152:155]
    ds_read_b64_tr_b16 a[204:205], v56 offset:8192
    v_mfma_f32_16x16x32_bf16 v[152:155], a[208:211], a[104:107], v[152:155]
    v_mfma_f32_16x16x32_bf16 v[148:151], a[208:211], a[100:103], v[148:151]
    ds_read_b64_tr_b16 a[206:207], v56 offset:12288
    v_mfma_f32_16x16x32_bf16 v[148:151], a[212:215], a[116:119], v[148:151]
    buffer_load_dwordx4 a[72:75], v4, s[4:7], s73 offen sc1
    v_mfma_f32_16x16x32_bf16 v[144:147], a[212:215], a[112:115], v[144:147]
    v_mfma_f32_16x16x32_bf16 v[144:147], a[208:211], a[96:99], v[144:147]
    s_waitcnt lgkmcnt(8)
    v_mfma_f32_16x16x32_bf16 v[160:163], a[216:219], a[96:99], v[160:163]
    ds_read_b64_tr_b16 a[208:209], v57 offset:0
    v_mfma_f32_16x16x32_bf16 v[160:163], a[220:223], a[112:115], v[160:163]
    ds_read_b64_tr_b16 a[210:211], v57 offset:4096
    v_mfma_f32_16x16x32_bf16 v[164:167], a[220:223], a[116:119], v[164:167]
    ds_read_b64_tr_b16 a[212:213], v57 offset:8192
    v_mfma_f32_16x16x32_bf16 v[164:167], a[216:219], a[100:103], v[164:167]
    ds_read_b64_tr_b16 a[214:215], v57 offset:12288
    v_mfma_f32_16x16x32_bf16 v[168:171], a[216:219], a[104:107], v[168:171]
    buffer_load_dwordx4 a[76:79], v5, s[4:7], s73 offen sc1
    s_add_u32 s73, s73, 131072
    v_mfma_f32_16x16x32_bf16 v[168:171], a[220:223], a[120:123], v[168:171]
    buffer_load_dwordx4 a[80:83], v2, s[4:7], s73 offen sc1
    v_mfma_f32_16x16x32_bf16 v[172:175], a[220:223], a[124:127], v[172:175]
    v_mfma_f32_16x16x32_bf16 v[172:175], a[216:219], a[108:111], v[172:175]
    s_waitcnt lgkmcnt(8)
    v_mfma_f32_16x16x32_bf16 v[188:191], a[224:227], a[108:111], v[188:191]
    ds_read_b64_tr_b16 a[216:217], v58 offset:0
    v_mfma_f32_16x16x32_bf16 v[188:191], a[228:231], a[124:127], v[188:191]
    ds_read_b64_tr_b16 a[218:219], v58 offset:4096
    v_mfma_f32_16x16x32_bf16 v[184:187], a[228:231], a[120:123], v[184:187]
    ds_read_b64_tr_b16 a[220:221], v58 offset:8192
    v_mfma_f32_16x16x32_bf16 v[184:187], a[224:227], a[104:107], v[184:187]
    v_mfma_f32_16x16x32_bf16 v[180:183], a[224:227], a[100:103], v[180:183]
    ds_read_b64_tr_b16 a[222:223], v58 offset:12288
    v_mfma_f32_16x16x32_bf16 v[180:183], a[228:231], a[116:119], v[180:183]
    buffer_load_dwordx4 a[84:87], v3, s[4:7], s73 offen sc1
    v_mfma_f32_16x16x32_bf16 v[176:179], a[228:231], a[112:115], v[176:179]
    v_mfma_f32_16x16x32_bf16 v[176:179], a[224:227], a[96:99], v[176:179]
    s_waitcnt lgkmcnt(8)
    v_mfma_f32_16x16x32_bf16 v[192:195], a[200:203], a[96:99], v[192:195]
    ds_read_b64_tr_b16 a[224:225], v59 offset:0
    v_mfma_f32_16x16x32_bf16 v[192:195], a[204:207], a[112:115], v[192:195]
    ds_read_b64_tr_b16 a[226:227], v59 offset:4096
    v_mfma_f32_16x16x32_bf16 v[196:199], a[204:207], a[116:119], v[196:199]
    ds_read_b64_tr_b16 a[228:229], v59 offset:8192
    v_mfma_f32_16x16x32_bf16 v[196:199], a[200:203], a[100:103], v[196:199]
    ds_read_b64_tr_b16 a[230:231], v59 offset:12288
    v_mfma_f32_16x16x32_bf16 v[200:203], a[200:203], a[104:107], v[200:203]
    buffer_load_dwordx4 a[88:91], v4, s[4:7], s73 offen sc1
    v_mfma_f32_16x16x32_bf16 v[200:203], a[204:207], a[120:123], v[200:203]
    buffer_load_dwordx4 a[92:95], v5, s[4:7], s73 offen sc1
    s_add_u32 s73, s73, 131072
    v_mfma_f32_16x16x32_bf16 v[204:207], a[204:207], a[124:127], v[204:207]
    v_mfma_f32_16x16x32_bf16 v[204:207], a[200:203], a[108:111], v[204:207]
    s_waitcnt vmcnt(38) lgkmcnt(0)
    s_barrier
    v_mfma_f32_16x16x32_bf16 v[220:223], a[208:211], a[108:111], v[220:223]
    ds_read_b64_tr_b16 a[200:201], v52 offset:16384
    v_mfma_f32_16x16x32_bf16 v[220:223], a[212:215], a[124:127], v[220:223]
    ds_read_b64_tr_b16 a[202:203], v52 offset:20480
    v_mfma_f32_16x16x32_bf16 v[216:219], a[212:215], a[120:123], v[216:219]
    ds_read_b64_tr_b16 a[204:205], v52 offset:24576
    v_mfma_f32_16x16x32_bf16 v[216:219], a[208:211], a[104:107], v[216:219]
    v_mfma_f32_16x16x32_bf16 v[212:215], a[208:211], a[100:103], v[212:215]
    ds_read_b64_tr_b16 a[206:207], v52 offset:28672
    v_mfma_f32_16x16x32_bf16 v[212:215], a[212:215], a[116:119], v[212:215]
    s_add_u32 m0, s66, 49152
    s_nop 0
    buffer_load_dwordx4 v6, s[28:31], s75 offen offset:0 lds
    v_mfma_f32_16x16x32_bf16 v[208:211], a[212:215], a[112:115], v[208:211]
    v_mfma_f32_16x16x32_bf16 v[208:211], a[208:211], a[96:99], v[208:211]
    v_mfma_f32_16x16x32_bf16 v[224:227], a[216:219], a[96:99], v[224:227]
    ds_read_b64_tr_b16 a[208:209], v53 offset:16384
    v_mfma_f32_16x16x32_bf16 v[224:227], a[220:223], a[112:115], v[224:227]
    ds_read_b64_tr_b16 a[210:211], v53 offset:20480
    v_mfma_f32_16x16x32_bf16 v[228:231], a[220:223], a[116:119], v[228:231]
    ds_read_b64_tr_b16 a[212:213], v53 offset:24576
    v_mfma_f32_16x16x32_bf16 v[228:231], a[216:219], a[100:103], v[228:231]
    ds_read_b64_tr_b16 a[214:215], v53 offset:28672
    v_mfma_f32_16x16x32_bf16 v[232:235], a[216:219], a[104:107], v[232:235]
    buffer_load_dwordx4 v7, s[28:31], s75 offen offset:1024 lds
    v_mfma_f32_16x16x32_bf16 v[232:235], a[220:223], a[120:123], v[232:235]
    buffer_load_dwordx4 v8, s[28:31], s75 offen offset:2048 lds
    v_mfma_f32_16x16x32_bf16 v[236:239], a[220:223], a[124:127], v[236:239]
    v_mfma_f32_16x16x32_bf16 v[236:239], a[216:219], a[108:111], v[236:239]
    v_mfma_f32_16x16x32_bf16 v[252:255], a[224:227], a[108:111], v[252:255]
    ds_read_b64_tr_b16 a[216:217], v54 offset:16384
    v_mfma_f32_16x16x32_bf16 v[252:255], a[228:231], a[124:127], v[252:255]
    ds_read_b64_tr_b16 a[218:219], v54 offset:20480
    v_mfma_f32_16x16x32_bf16 v[248:251], a[228:231], a[120:123], v[248:251]
    ds_read_b64_tr_b16 a[220:221], v54 offset:24576
    v_mfma_f32_16x16x32_bf16 v[248:251], a[224:227], a[104:107], v[248:251]
    v_mfma_f32_16x16x32_bf16 v[244:247], a[224:227], a[100:103], v[244:247]
    ds_read_b64_tr_b16 a[222:223], v54 offset:28672
    v_mfma_f32_16x16x32_bf16 v[244:247], a[228:231], a[116:119], v[244:247]
    buffer_load_dwordx4 v9, s[28:31], s75 offen offset:3072 lds
    s_add_u32 s75, s75, 131072
    v_mfma_f32_16x16x32_bf16 v[240:243], a[228:231], a[112:115], v[240:243]
    v_mfma_f32_16x16x32_bf16 v[240:243], a[224:227], a[96:99], v[240:243]
    s_waitcnt vmcnt(37) lgkmcnt(8)
    v_mfma_f32_16x16x32_bf16 v[128:131], a[200:203], a[128:131], v[128:131]
    ds_read_b64_tr_b16 a[224:225], v55 offset:16384
    v_mfma_f32_16x16x32_bf16 v[128:131], a[204:207], a[144:147], v[128:131]
    ds_read_b64_tr_b16 a[226:227], v55 offset:20480
    v_mfma_f32_16x16x32_bf16 v[132:135], a[204:207], a[148:151], v[132:135]
    ds_read_b64_tr_b16 a[228:229], v55 offset:24576
    v_mfma_f32_16x16x32_bf16 v[132:135], a[200:203], a[132:135], v[132:135]
    ds_read_b64_tr_b16 a[230:231], v55 offset:28672
    v_mfma_f32_16x16x32_bf16 v[136:139], a[200:203], a[136:139], v[136:139]
    buffer_load_dwordx4 a[96:99], v2, s[4:7], s73 offen sc1
    v_mfma_f32_16x16x32_bf16 v[136:139], a[204:207], a[152:155], v[136:139]
    buffer_load_dwordx4 a[100:103], v3, s[4:7], s73 offen sc1
    v_mfma_f32_16x16x32_bf16 v[140:143], a[204:207], a[156:159], v[140:143]
    v_mfma_f32_16x16x32_bf16 v[140:143], a[200:203], a[140:143], v[140:143]
    s_waitcnt lgkmcnt(8)
    v_mfma_f32_16x16x32_bf16 v[156:159], a[208:211], a[140:143], v[156:159]
    ds_read_b64_tr_b16 a[200:201], v56 offset:16384
    v_mfma_f32_16x16x32_bf16 v[156:159], a[212:215], a[156:159], v[156:159]
    ds_read_b64_tr_b16 a[202:203], v56 offset:20480
    v_mfma_f32_16x16x32_bf16 v[152:155], a[212:215], a[152:155], v[152:155]
    ds_read_b64_tr_b16 a[204:205], v56 offset:24576
    v_mfma_f32_16x16x32_bf16 v[152:155], a[208:211], a[136:139], v[152:155]
    v_mfma_f32_16x16x32_bf16 v[148:151], a[208:211], a[132:135], v[148:151]
    ds_read_b64_tr_b16 a[206:207], v56 offset:28672
    v_mfma_f32_16x16x32_bf16 v[148:151], a[212:215], a[148:151], v[148:151]
    buffer_load_dwordx4 a[104:107], v4, s[4:7], s73 offen sc1
    v_mfma_f32_16x16x32_bf16 v[144:147], a[212:215], a[144:147], v[144:147]
    v_mfma_f32_16x16x32_bf16 v[144:147], a[208:211], a[128:131], v[144:147]
    s_waitcnt lgkmcnt(8)
    v_mfma_f32_16x16x32_bf16 v[160:163], a[216:219], a[128:131], v[160:163]
    ds_read_b64_tr_b16 a[208:209], v57 offset:16384
    v_mfma_f32_16x16x32_bf16 v[160:163], a[220:223], a[144:147], v[160:163]
    ds_read_b64_tr_b16 a[210:211], v57 offset:20480
    v_mfma_f32_16x16x32_bf16 v[164:167], a[220:223], a[148:151], v[164:167]
    ds_read_b64_tr_b16 a[212:213], v57 offset:24576
    v_mfma_f32_16x16x32_bf16 v[164:167], a[216:219], a[132:135], v[164:167]
    ds_read_b64_tr_b16 a[214:215], v57 offset:28672
    v_mfma_f32_16x16x32_bf16 v[168:171], a[216:219], a[136:139], v[168:171]
    buffer_load_dwordx4 a[108:111], v5, s[4:7], s73 offen sc1
    s_add_u32 s73, s73, 131072
    v_mfma_f32_16x16x32_bf16 v[168:171], a[220:223], a[152:155], v[168:171]
    buffer_load_dwordx4 a[112:115], v2, s[4:7], s73 offen sc1
    v_mfma_f32_16x16x32_bf16 v[172:175], a[220:223], a[156:159], v[172:175]
    v_mfma_f32_16x16x32_bf16 v[172:175], a[216:219], a[140:143], v[172:175]
    s_waitcnt lgkmcnt(8)
    v_mfma_f32_16x16x32_bf16 v[188:191], a[224:227], a[140:143], v[188:191]
    ds_read_b64_tr_b16 a[216:217], v58 offset:16384
    v_mfma_f32_16x16x32_bf16 v[188:191], a[228:231], a[156:159], v[188:191]
    ds_read_b64_tr_b16 a[218:219], v58 offset:20480
    v_mfma_f32_16x16x32_bf16 v[184:187], a[228:231], a[152:155], v[184:187]
    ds_read_b64_tr_b16 a[220:221], v58 offset:24576
    v_mfma_f32_16x16x32_bf16 v[184:187], a[224:227], a[136:139], v[184:187]
    v_mfma_f32_16x16x32_bf16 v[180:183], a[224:227], a[132:135], v[180:183]
    ds_read_b64_tr_b16 a[222:223], v58 offset:28672
    v_mfma_f32_16x16x32_bf16 v[180:183], a[228:231], a[148:151], v[180:183]
    buffer_load_dwordx4 a[116:119], v3, s[4:7], s73 offen sc1
    v_mfma_f32_16x16x32_bf16 v[176:179], a[228:231], a[144:147], v[176:179]
    v_mfma_f32_16x16x32_bf16 v[176:179], a[224:227], a[128:131], v[176:179]
    s_waitcnt lgkmcnt(8)
    v_mfma_f32_16x16x32_bf16 v[192:195], a[200:203], a[128:131], v[192:195]
    ds_read_b64_tr_b16 a[224:225], v59 offset:16384
    v_mfma_f32_16x16x32_bf16 v[192:195], a[204:207], a[144:147], v[192:195]
    ds_read_b64_tr_b16 a[226:227], v59 offset:20480
    v_mfma_f32_16x16x32_bf16 v[196:199], a[204:207], a[148:151], v[196:199]
    ds_read_b64_tr_b16 a[228:229], v59 offset:24576
    v_mfma_f32_16x16x32_bf16 v[196:199], a[200:203], a[132:135], v[196:199]
    ds_read_b64_tr_b16 a[230:231], v59 offset:28672
    v_mfma_f32_16x16x32_bf16 v[200:203], a[200:203], a[136:139], v[200:203]
    buffer_load_dwordx4 a[120:123], v4, s[4:7], s73 offen sc1
    v_mfma_f32_16x16x32_bf16 v[200:203], a[204:207], a[152:155], v[200:203]
    buffer_load_dwordx4 a[124:127], v5, s[4:7], s73 offen sc1
    s_add_u32 s73, s73, 131072
    v_mfma_f32_16x16x32_bf16 v[204:207], a[204:207], a[156:159], v[204:207]
    v_mfma_f32_16x16x32_bf16 v[204:207], a[200:203], a[140:143], v[204:207]
    s_waitcnt vmcnt(8) lgkmcnt(0)
    s_barrier
    v_mfma_f32_16x16x32_bf16 v[220:223], a[208:211], a[140:143], v[220:223]
    ds_read_b64_tr_b16 a[200:201], v36 offset:0
    v_mfma_f32_16x16x32_bf16 v[220:223], a[212:215], a[156:159], v[220:223]
    ds_read_b64_tr_b16 a[202:203], v36 offset:4096
    v_mfma_f32_16x16x32_bf16 v[216:219], a[212:215], a[152:155], v[216:219]
    ds_read_b64_tr_b16 a[204:205], v36 offset:8192
    v_mfma_f32_16x16x32_bf16 v[216:219], a[208:211], a[136:139], v[216:219]
    v_mfma_f32_16x16x32_bf16 v[212:215], a[208:211], a[132:135], v[212:215]
    ds_read_b64_tr_b16 a[206:207], v36 offset:12288
    v_mfma_f32_16x16x32_bf16 v[212:215], a[212:215], a[148:151], v[212:215]
    buffer_load_dwordx4 v[100:103], v44, s[16:19], 0 offen offset:0
    v_mfma_f32_16x16x32_bf16 v[208:211], a[212:215], a[144:147], v[208:211]
    v_mfma_f32_16x16x32_bf16 v[208:211], a[208:211], a[128:131], v[208:211]
    v_mfma_f32_16x16x32_bf16 v[224:227], a[216:219], a[128:131], v[224:227]
    ds_read_b64_tr_b16 a[208:209], v36 offset:16384
    v_mfma_f32_16x16x32_bf16 v[224:227], a[220:223], a[144:147], v[224:227]
    ds_read_b64_tr_b16 a[210:211], v36 offset:20480
    v_mfma_f32_16x16x32_bf16 v[228:231], a[220:223], a[148:151], v[228:231]
    ds_read_b64_tr_b16 a[212:213], v36 offset:24576
    v_mfma_f32_16x16x32_bf16 v[228:231], a[216:219], a[132:135], v[228:231]
    ds_read_b64_tr_b16 a[214:215], v36 offset:28672
    v_mfma_f32_16x16x32_bf16 v[232:235], a[216:219], a[136:139], v[232:235]
    buffer_load_dwordx4 v[104:107], v44, s[16:19], 0 offen offset:64
    v_mfma_f32_16x16x32_bf16 v[232:235], a[220:223], a[152:155], v[232:235]
    buffer_load_dwordx4 v[108:111], v44, s[16:19], 0 offen offset:128
    v_mfma_f32_16x16x32_bf16 v[236:239], a[220:223], a[156:159], v[236:239]
    v_mfma_f32_16x16x32_bf16 v[236:239], a[216:219], a[140:143], v[236:239]
    v_mfma_f32_16x16x32_bf16 v[252:255], a[224:227], a[140:143], v[252:255]
    ds_read_b64_tr_b16 a[216:217], v36 offset:32768
    v_mfma_f32_16x16x32_bf16 v[252:255], a[228:231], a[156:159], v[252:255]
    ds_read_b64_tr_b16 a[218:219], v36 offset:36864
    v_mfma_f32_16x16x32_bf16 v[248:251], a[228:231], a[152:155], v[248:251]
    ds_read_b64_tr_b16 a[220:221], v36 offset:40960
    v_mfma_f32_16x16x32_bf16 v[248:251], a[224:227], a[136:139], v[248:251]
    v_mfma_f32_16x16x32_bf16 v[244:247], a[224:227], a[132:135], v[244:247]
    ds_read_b64_tr_b16 a[222:223], v36 offset:45056
    v_mfma_f32_16x16x32_bf16 v[244:247], a[228:231], a[148:151], v[244:247]
    buffer_load_dwordx4 v[112:115], v44, s[16:19], 0 offen offset:192
    v_mfma_f32_16x16x32_bf16 v[240:243], a[228:231], a[144:147], v[240:243]
    v_mfma_f32_16x16x32_bf16 v[240:243], a[224:227], a[128:131], v[240:243]
    s_waitcnt lgkmcnt(8)
    v_mfma_f32_16x16x32_bf16 v[128:131], a[200:203], a[0:3], v[128:131]
    ds_read_b64_tr_b16 a[224:225], v36 offset:49152
    v_mfma_f32_16x16x32_bf16 v[128:131], a[204:207], a[16:19], v[128:131]
    ds_read_b64_tr_b16 a[226:227], v36 offset:53248
    v_mfma_f32_16x16x32_bf16 v[132:135], a[204:207], a[20:23], v[132:135]
    v_mfma_f32_16x16x32_bf16 v[132:135], a[200:203], a[4:7], v[132:135]
    ds_read_b64_tr_b16 a[228:229], v36 offset:57344
    v_mfma_f32_16x16x32_bf16 v[136:139], a[200:203], a[8:11], v[136:139]
    v_mfma_f32_16x16x32_bf16 v[136:139], a[204:207], a[24:27], v[136:139]
    ds_read_b64_tr_b16 a[230:231], v36 offset:61440
    v_mfma_f32_16x16x32_bf16 v[140:143], a[204:207], a[28:31], v[140:143]
    v_mfma_f32_16x16x32_bf16 v[140:143], a[200:203], a[12:15], v[140:143]
    s_waitcnt lgkmcnt(8)
    v_mfma_f32_16x16x32_bf16 v[140:143], a[208:211], a[44:47], v[140:143]
    ds_read_b64_tr_b16 a[200:201], v37 offset:0
    v_mfma_f32_16x16x32_bf16 v[140:143], a[212:215], a[60:63], v[140:143]
    ds_read_b64_tr_b16 a[202:203], v37 offset:4096
    v_mfma_f32_16x16x32_bf16 v[136:139], a[212:215], a[56:59], v[136:139]
    v_mfma_f32_16x16x32_bf16 v[136:139], a[208:211], a[40:43], v[136:139]
    ds_read_b64_tr_b16 a[204:205], v37 offset:8192
    v_mfma_f32_16x16x32_bf16 v[132:135], a[208:211], a[36:39], v[132:135]
    v_mfma_f32_16x16x32_bf16 v[132:135], a[212:215], a[52:55], v[132:135]
    ds_read_b64_tr_b16 a[206:207], v37 offset:12288
    v_mfma_f32_16x16x32_bf16 v[128:131], a[212:215], a[48:51], v[128:131]
    v_mfma_f32_16x16x32_bf16 v[128:131], a[208:211], a[32:35], v[128:131]
    s_waitcnt lgkmcnt(8)
    v_mfma_f32_16x16x32_bf16 v[128:131], a[216:219], a[64:67], v[128:131]
    ds_read_b64_tr_b16 a[208:209], v37 offset:16384
    v_mfma_f32_16x16x32_bf16 v[128:131], a[220:223], a[80:83], v[128:131]
    ds_read_b64_tr_b16 a[210:211], v37 offset:20480
    v_mfma_f32_16x16x32_bf16 v[132:135], a[220:223], a[84:87], v[132:135]
    v_mfma_f32_16x16x32_bf16 v[132:135], a[216:219], a[68:71], v[132:135]
    ds_read_b64_tr_b16 a[212:213], v37 offset:24576
    v_mfma_f32_16x16x32_bf16 v[136:139], a[216:219], a[72:75], v[136:139]
    v_mfma_f32_16x16x32_bf16 v[136:139], a[220:223], a[88:91], v[136:139]
    ds_read_b64_tr_b16 a[214:215], v37 offset:28672
    v_mfma_f32_16x16x32_bf16 v[140:143], a[220:223], a[92:95], v[140:143]
    v_mfma_f32_16x16x32_bf16 v[140:143], a[216:219], a[76:79], v[140:143]
    s_waitcnt vmcnt(4) lgkmcnt(8)
    v_mfma_f32_16x16x32_bf16 v[140:143], a[224:227], a[108:111], v[140:143]
    ds_read_b64_tr_b16 a[216:217], v37 offset:32768
    v_mfma_f32_16x16x32_bf16 v[140:143], a[228:231], a[124:127], v[140:143]
    ds_read_b64_tr_b16 a[218:219], v37 offset:36864
    v_mfma_f32_16x16x32_bf16 v[136:139], a[228:231], a[120:123], v[136:139]
    v_mfma_f32_16x16x32_bf16 v[136:139], a[224:227], a[104:107], v[136:139]
    ds_read_b64_tr_b16 a[220:221], v37 offset:40960
    v_mfma_f32_16x16x32_bf16 v[132:135], a[224:227], a[100:103], v[132:135]
    v_mfma_f32_16x16x32_bf16 v[132:135], a[228:231], a[116:119], v[132:135]
    ds_read_b64_tr_b16 a[222:223], v37 offset:45056
    v_mfma_f32_16x16x32_bf16 v[128:131], a[228:231], a[112:115], v[128:131]
    v_mfma_f32_16x16x32_bf16 v[128:131], a[224:227], a[96:99], v[128:131]
    s_waitcnt lgkmcnt(8)
    v_mfma_f32_16x16x32_bf16 v[144:147], a[200:203], a[0:3], v[144:147]
    ds_read_b64_tr_b16 a[224:225], v37 offset:49152
    v_mfma_f32_16x16x32_bf16 v[144:147], a[204:207], a[16:19], v[144:147]
    ds_read_b64_tr_b16 a[226:227], v37 offset:53248
    v_mfma_f32_16x16x32_bf16 v[148:151], a[204:207], a[20:23], v[148:151]
    v_mfma_f32_16x16x32_bf16 v[148:151], a[200:203], a[4:7], v[148:151]
    ds_read_b64_tr_b16 a[228:229], v37 offset:57344
    v_mfma_f32_16x16x32_bf16 v[152:155], a[200:203], a[8:11], v[152:155]
    v_mfma_f32_16x16x32_bf16 v[152:155], a[204:207], a[24:27], v[152:155]
    ds_read_b64_tr_b16 a[230:231], v37 offset:61440
    v_mfma_f32_16x16x32_bf16 v[156:159], a[204:207], a[28:31], v[156:159]
    v_mfma_f32_16x16x32_bf16 v[156:159], a[200:203], a[12:15], v[156:159]
    s_waitcnt lgkmcnt(8)
    v_mfma_f32_16x16x32_bf16 v[156:159], a[208:211], a[44:47], v[156:159]
    ds_read_b64_tr_b16 a[200:201], v38 offset:0
    v_mfma_f32_16x16x32_bf16 v[156:159], a[212:215], a[60:63], v[156:159]
    ds_read_b64_tr_b16 a[202:203], v38 offset:4096
    v_mfma_f32_16x16x32_bf16 v[152:155], a[212:215], a[56:59], v[152:155]
    v_mfma_f32_16x16x32_bf16 v[152:155], a[208:211], a[40:43], v[152:155]
    ds_read_b64_tr_b16 a[204:205], v38 offset:8192
    v_mfma_f32_16x16x32_bf16 v[148:151], a[208:211], a[36:39], v[148:151]
    v_mfma_f32_16x16x32_bf16 v[148:151], a[212:215], a[52:55], v[148:151]
    ds_read_b64_tr_b16 a[206:207], v38 offset:12288
    v_mfma_f32_16x16x32_bf16 v[144:147], a[212:215], a[48:51], v[144:147]
    v_mfma_f32_16x16x32_bf16 v[144:147], a[208:211], a[32:35], v[144:147]
    s_waitcnt lgkmcnt(8)
    v_mfma_f32_16x16x32_bf16 v[144:147], a[216:219], a[64:67], v[144:147]
    ds_read_b64_tr_b16 a[208:209], v38 offset:16384
    v_mfma_f32_16x16x32_bf16 v[144:147], a[220:223], a[80:83], v[144:147]
    ds_read_b64_tr_b16 a[210:211], v38 offset:20480
    v_mfma_f32_16x16x32_bf16 v[148:151], a[220:223], a[84:87], v[148:151]
    v_mfma_f32_16x16x32_bf16 v[148:151], a[216:219], a[68:71], v[148:151]
    ds_read_b64_tr_b16 a[212:213], v38 offset:24576
    v_mfma_f32_16x16x32_bf16 v[152:155], a[216:219], a[72:75], v[152:155]
    v_mfma_f32_16x16x32_bf16 v[152:155], a[220:223], a[88:91], v[152:155]
    ds_read_b64_tr_b16 a[214:215], v38 offset:28672
    v_mfma_f32_16x16x32_bf16 v[156:159], a[220:223], a[92:95], v[156:159]
    v_mfma_f32_16x16x32_bf16 v[156:159], a[216:219], a[76:79], v[156:159]
    s_waitcnt lgkmcnt(8)
    v_mfma_f32_16x16x32_bf16 v[156:159], a[224:227], a[108:111], v[156:159]
    ds_read_b64_tr_b16 a[216:217], v38 offset:32768
    v_mfma_f32_16x16x32_bf16 v[156:159], a[228:231], a[124:127], v[156:159]
    ds_read_b64_tr_b16 a[218:219], v38 offset:36864
    v_mfma_f32_16x16x32_bf16 v[152:155], a[228:231], a[120:123], v[152:155]
    v_mfma_f32_16x16x32_bf16 v[152:155], a[224:227], a[104:107], v[152:155]
    ds_read_b64_tr_b16 a[220:221], v38 offset:40960
    v_mfma_f32_16x16x32_bf16 v[148:151], a[224:227], a[100:103], v[148:151]
    v_mfma_f32_16x16x32_bf16 v[148:151], a[228:231], a[116:119], v[148:151]
    ds_read_b64_tr_b16 a[222:223], v38 offset:45056
    v_mfma_f32_16x16x32_bf16 v[144:147], a[228:231], a[112:115], v[144:147]
    v_mfma_f32_16x16x32_bf16 v[144:147], a[224:227], a[96:99], v[144:147]
    s_waitcnt lgkmcnt(8)
    v_mfma_f32_16x16x32_bf16 v[160:163], a[200:203], a[0:3], v[160:163]
    ds_read_b64_tr_b16 a[224:225], v38 offset:49152
    v_mfma_f32_16x16x32_bf16 v[160:163], a[204:207], a[16:19], v[160:163]
    ds_read_b64_tr_b16 a[226:227], v38 offset:53248
    v_mfma_f32_16x16x32_bf16 v[164:167], a[204:207], a[20:23], v[164:167]
    v_cvt_pk_bf16_f32 v132, v132, v133
    v_mfma_f32_16x16x32_bf16 v[164:167], a[200:203], a[4:7], v[164:167]
    ds_read_b64_tr_b16 a[228:229], v38 offset:57344
    v_cvt_pk_bf16_f32 v133, v134, v135
    v_mfma_f32_16x16x32_bf16 v[168:171], a[200:203], a[8:11], v[168:171]
    v_cvt_pk_bf16_f32 v134, v148, v149
    v_mfma_f32_16x16x32_bf16 v[168:171], a[204:207], a[24:27], v[168:171]
    ds_read_b64_tr_b16 a[230:231], v38 offset:61440
    v_cvt_pk_bf16_f32 v135, v150, v151
    v_mfma_f32_16x16x32_bf16 v[172:175], a[204:207], a[28:31], v[172:175]
    buffer_store_dwordx4 v[132:135], v12, s[4:7], s86 offen offset:0 sc1
    v_mfma_f32_16x16x32_bf16 v[172:175], a[200:203], a[12:15], v[172:175]
    v_cvt_pk_bf16_f32 v136, v136, v137
    s_waitcnt lgkmcnt(8)
    v_mfma_f32_16x16x32_bf16 v[172:175], a[208:211], a[44:47], v[172:175]
    ds_read_b64_tr_b16 a[200:201], v39 offset:0
    v_mfma_f32_16x16x32_bf16 v[172:175], a[212:215], a[60:63], v[172:175]
    ds_read_b64_tr_b16 a[202:203], v39 offset:4096
    v_mfma_f32_16x16x32_bf16 v[168:171], a[212:215], a[56:59], v[168:171]
    v_cvt_pk_bf16_f32 v137, v138, v139
    v_mfma_f32_16x16x32_bf16 v[168:171], a[208:211], a[40:43], v[168:171]
    ds_read_b64_tr_b16 a[204:205], v39 offset:8192
    v_cvt_pk_bf16_f32 v138, v152, v153
    v_mfma_f32_16x16x32_bf16 v[164:167], a[208:211], a[36:39], v[164:167]
    v_cvt_pk_bf16_f32 v139, v154, v155
    v_mfma_f32_16x16x32_bf16 v[164:167], a[212:215], a[52:55], v[164:167]
    ds_read_b64_tr_b16 a[206:207], v39 offset:12288
    buffer_store_dwordx4 v[136:139], v12, s[4:7], s87 offen offset:0 sc1
    v_mfma_f32_16x16x32_bf16 v[160:163], a[212:215], a[48:51], v[160:163]
    v_cvt_pk_bf16_f32 v140, v140, v141
    v_mfma_f32_16x16x32_bf16 v[160:163], a[208:211], a[32:35], v[160:163]
    v_cvt_pk_bf16_f32 v141, v142, v143
    s_waitcnt lgkmcnt(8)
    v_mfma_f32_16x16x32_bf16 v[160:163], a[216:219], a[64:67], v[160:163]
    ds_read_b64_tr_b16 a[208:209], v39 offset:16384
    v_mfma_f32_16x16x32_bf16 v[160:163], a[220:223], a[80:83], v[160:163]
    ds_read_b64_tr_b16 a[210:211], v39 offset:20480
    v_mfma_f32_16x16x32_bf16 v[164:167], a[220:223], a[84:87], v[164:167]
    v_cvt_pk_bf16_f32 v142, v156, v157
    v_mfma_f32_16x16x32_bf16 v[164:167], a[216:219], a[68:71], v[164:167]
    ds_read_b64_tr_b16 a[212:213], v39 offset:24576
    v_cvt_pk_bf16_f32 v143, v158, v159
    v_mfma_f32_16x16x32_bf16 v[168:171], a[216:219], a[72:75], v[168:171]
    buffer_store_dwordx4 v[140:143], v12, s[4:7], s88 offen offset:0 sc1
    v_mfma_f32_16x16x32_bf16 v[168:171], a[220:223], a[88:91], v[168:171]
    ds_read_b64_tr_b16 a[214:215], v39 offset:28672
    v_mfma_f32_16x16x32_bf16 v[172:175], a[220:223], a[92:95], v[172:175]
    v_mfma_f32_16x16x32_bf16 v[172:175], a[216:219], a[76:79], v[172:175]
    s_waitcnt lgkmcnt(8)
    v_mfma_f32_16x16x32_bf16 v[172:175], a[224:227], a[108:111], v[172:175]
    ds_read_b64_tr_b16 a[216:217], v39 offset:32768
    v_mfma_f32_16x16x32_bf16 v[172:175], a[228:231], a[124:127], v[172:175]
    ds_read_b64_tr_b16 a[218:219], v39 offset:36864
    v_mfma_f32_16x16x32_bf16 v[168:171], a[228:231], a[120:123], v[168:171]
    v_mfma_f32_16x16x32_bf16 v[168:171], a[224:227], a[104:107], v[168:171]
    ds_read_b64_tr_b16 a[220:221], v39 offset:40960
    v_mfma_f32_16x16x32_bf16 v[164:167], a[224:227], a[100:103], v[164:167]
    v_mfma_f32_16x16x32_bf16 v[164:167], a[228:231], a[116:119], v[164:167]
    ds_read_b64_tr_b16 a[222:223], v39 offset:45056
    v_mfma_f32_16x16x32_bf16 v[160:163], a[228:231], a[112:115], v[160:163]
    v_mfma_f32_16x16x32_bf16 v[160:163], a[224:227], a[96:99], v[160:163]
    s_waitcnt lgkmcnt(8)
    v_mfma_f32_16x16x32_bf16 v[176:179], a[200:203], a[0:3], v[176:179]
    ds_read_b64_tr_b16 a[224:225], v39 offset:49152
    v_mfma_f32_16x16x32_bf16 v[176:179], a[204:207], a[16:19], v[176:179]
    ds_read_b64_tr_b16 a[226:227], v39 offset:53248
    v_mfma_f32_16x16x32_bf16 v[180:183], a[204:207], a[20:23], v[180:183]
    v_mfma_f32_16x16x32_bf16 v[180:183], a[200:203], a[4:7], v[180:183]
    ds_read_b64_tr_b16 a[228:229], v39 offset:57344
    v_mfma_f32_16x16x32_bf16 v[184:187], a[200:203], a[8:11], v[184:187]
    v_mfma_f32_16x16x32_bf16 v[184:187], a[204:207], a[24:27], v[184:187]
    ds_read_b64_tr_b16 a[230:231], v39 offset:61440
    v_mfma_f32_16x16x32_bf16 v[188:191], a[204:207], a[28:31], v[188:191]
    v_mfma_f32_16x16x32_bf16 v[188:191], a[200:203], a[12:15], v[188:191]
    s_waitcnt lgkmcnt(8)
    v_mfma_f32_16x16x32_bf16 v[188:191], a[208:211], a[44:47], v[188:191]
    ds_read_b64_tr_b16 a[200:201], v40 offset:0
    v_mfma_f32_16x16x32_bf16 v[188:191], a[212:215], a[60:63], v[188:191]
    ds_read_b64_tr_b16 a[202:203], v40 offset:4096
    v_mfma_f32_16x16x32_bf16 v[184:187], a[212:215], a[56:59], v[184:187]
    v_mfma_f32_16x16x32_bf16 v[184:187], a[208:211], a[40:43], v[184:187]
    ds_read_b64_tr_b16 a[204:205], v40 offset:8192
    v_mfma_f32_16x16x32_bf16 v[180:183], a[208:211], a[36:39], v[180:183]
    v_mfma_f32_16x16x32_bf16 v[180:183], a[212:215], a[52:55], v[180:183]
    ds_read_b64_tr_b16 a[206:207], v40 offset:12288
    v_mfma_f32_16x16x32_bf16 v[176:179], a[212:215], a[48:51], v[176:179]
    v_mfma_f32_16x16x32_bf16 v[176:179], a[208:211], a[32:35], v[176:179]
    s_waitcnt lgkmcnt(8)
    v_mfma_f32_16x16x32_bf16 v[176:179], a[216:219], a[64:67], v[176:179]
    ds_read_b64_tr_b16 a[208:209], v40 offset:16384
    v_mfma_f32_16x16x32_bf16 v[176:179], a[220:223], a[80:83], v[176:179]
    ds_read_b64_tr_b16 a[210:211], v40 offset:20480
    v_mfma_f32_16x16x32_bf16 v[180:183], a[220:223], a[84:87], v[180:183]
    v_mfma_f32_16x16x32_bf16 v[180:183], a[216:219], a[68:71], v[180:183]
    ds_read_b64_tr_b16 a[212:213], v40 offset:24576
    v_mfma_f32_16x16x32_bf16 v[184:187], a[216:219], a[72:75], v[184:187]
    v_mfma_f32_16x16x32_bf16 v[184:187], a[220:223], a[88:91], v[184:187]
    ds_read_b64_tr_b16 a[214:215], v40 offset:28672
    v_mfma_f32_16x16x32_bf16 v[188:191], a[220:223], a[92:95], v[188:191]
    v_mfma_f32_16x16x32_bf16 v[188:191], a[216:219], a[76:79], v[188:191]
    s_waitcnt lgkmcnt(8)
    v_mfma_f32_16x16x32_bf16 v[188:191], a[224:227], a[108:111], v[188:191]
    ds_read_b64_tr_b16 a[216:217], v40 offset:32768
    v_mfma_f32_16x16x32_bf16 v[188:191], a[228:231], a[124:127], v[188:191]
    ds_read_b64_tr_b16 a[218:219], v40 offset:36864
    v_mfma_f32_16x16x32_bf16 v[184:187], a[228:231], a[120:123], v[184:187]
    v_mfma_f32_16x16x32_bf16 v[184:187], a[224:227], a[104:107], v[184:187]
    ds_read_b64_tr_b16 a[220:221], v40 offset:40960
    v_mfma_f32_16x16x32_bf16 v[180:183], a[224:227], a[100:103], v[180:183]
    v_mfma_f32_16x16x32_bf16 v[180:183], a[228:231], a[116:119], v[180:183]
    ds_read_b64_tr_b16 a[222:223], v40 offset:45056
    v_mfma_f32_16x16x32_bf16 v[176:179], a[228:231], a[112:115], v[176:179]
    v_mfma_f32_16x16x32_bf16 v[176:179], a[224:227], a[96:99], v[176:179]
    s_waitcnt lgkmcnt(8)
    v_mfma_f32_16x16x32_bf16 v[192:195], a[200:203], a[0:3], v[192:195]
    ds_read_b64_tr_b16 a[224:225], v40 offset:49152
    v_mfma_f32_16x16x32_bf16 v[192:195], a[204:207], a[16:19], v[192:195]
    ds_read_b64_tr_b16 a[226:227], v40 offset:53248
    v_mfma_f32_16x16x32_bf16 v[196:199], a[204:207], a[20:23], v[196:199]
    v_cvt_pk_bf16_f32 v164, v164, v165
    v_mfma_f32_16x16x32_bf16 v[196:199], a[200:203], a[4:7], v[196:199]
    ds_read_b64_tr_b16 a[228:229], v40 offset:57344
    v_cvt_pk_bf16_f32 v165, v166, v167
    v_mfma_f32_16x16x32_bf16 v[200:203], a[200:203], a[8:11], v[200:203]
    v_cvt_pk_bf16_f32 v166, v180, v181
    v_mfma_f32_16x16x32_bf16 v[200:203], a[204:207], a[24:27], v[200:203]
    ds_read_b64_tr_b16 a[230:231], v40 offset:61440
    v_cvt_pk_bf16_f32 v167, v182, v183
    v_mfma_f32_16x16x32_bf16 v[204:207], a[204:207], a[28:31], v[204:207]
    buffer_store_dwordx4 v[164:167], v12, s[4:7], s86 offen offset:1024 sc1
    v_mfma_f32_16x16x32_bf16 v[204:207], a[200:203], a[12:15], v[204:207]
    v_cvt_pk_bf16_f32 v168, v168, v169
    s_waitcnt lgkmcnt(8)
    v_mfma_f32_16x16x32_bf16 v[204:207], a[208:211], a[44:47], v[204:207]
    ds_read_b64_tr_b16 a[200:201], v41 offset:0
    v_mfma_f32_16x16x32_bf16 v[204:207], a[212:215], a[60:63], v[204:207]
    ds_read_b64_tr_b16 a[202:203], v41 offset:4096
    v_mfma_f32_16x16x32_bf16 v[200:203], a[212:215], a[56:59], v[200:203]
    v_cvt_pk_bf16_f32 v169, v170, v171
    v_mfma_f32_16x16x32_bf16 v[200:203], a[208:211], a[40:43], v[200:203]
    ds_read_b64_tr_b16 a[204:205], v41 offset:8192
    v_cvt_pk_bf16_f32 v170, v184, v185
    v_mfma_f32_16x16x32_bf16 v[196:199], a[208:211], a[36:39], v[196:199]
    v_cvt_pk_bf16_f32 v171, v186, v187
    v_mfma_f32_16x16x32_bf16 v[196:199], a[212:215], a[52:55], v[196:199]
    ds_read_b64_tr_b16 a[206:207], v41 offset:12288
    buffer_store_dwordx4 v[168:171], v12, s[4:7], s87 offen offset:1024 sc1
    v_mfma_f32_16x16x32_bf16 v[192:195], a[212:215], a[48:51], v[192:195]
    v_cvt_pk_bf16_f32 v172, v172, v173
    v_mfma_f32_16x16x32_bf16 v[192:195], a[208:211], a[32:35], v[192:195]
    v_cvt_pk_bf16_f32 v173, v174, v175
    s_waitcnt lgkmcnt(8)
    v_mfma_f32_16x16x32_bf16 v[192:195], a[216:219], a[64:67], v[192:195]
    ds_read_b64_tr_b16 a[208:209], v41 offset:16384
    v_mfma_f32_16x16x32_bf16 v[192:195], a[220:223], a[80:83], v[192:195]
    ds_read_b64_tr_b16 a[210:211], v41 offset:20480
    v_mfma_f32_16x16x32_bf16 v[196:199], a[220:223], a[84:87], v[196:199]
    v_cvt_pk_bf16_f32 v174, v188, v189
    v_mfma_f32_16x16x32_bf16 v[196:199], a[216:219], a[68:71], v[196:199]
    ds_read_b64_tr_b16 a[212:213], v41 offset:24576
    v_cvt_pk_bf16_f32 v175, v190, v191
    v_mfma_f32_16x16x32_bf16 v[200:203], a[216:219], a[72:75], v[200:203]
    buffer_store_dwordx4 v[172:175], v12, s[4:7], s88 offen offset:1024 sc1
    v_mfma_f32_16x16x32_bf16 v[200:203], a[220:223], a[88:91], v[200:203]
    ds_read_b64_tr_b16 a[214:215], v41 offset:28672
    v_mfma_f32_16x16x32_bf16 v[204:207], a[220:223], a[92:95], v[204:207]
    v_mfma_f32_16x16x32_bf16 v[204:207], a[216:219], a[76:79], v[204:207]
    s_waitcnt lgkmcnt(8)
    v_mfma_f32_16x16x32_bf16 v[204:207], a[224:227], a[108:111], v[204:207]
    ds_read_b64_tr_b16 a[216:217], v41 offset:32768
    v_mfma_f32_16x16x32_bf16 v[204:207], a[228:231], a[124:127], v[204:207]
    ds_read_b64_tr_b16 a[218:219], v41 offset:36864
    v_mfma_f32_16x16x32_bf16 v[200:203], a[228:231], a[120:123], v[200:203]
    v_mfma_f32_16x16x32_bf16 v[200:203], a[224:227], a[104:107], v[200:203]
    ds_read_b64_tr_b16 a[220:221], v41 offset:40960
    v_mfma_f32_16x16x32_bf16 v[196:199], a[224:227], a[100:103], v[196:199]
    v_mfma_f32_16x16x32_bf16 v[196:199], a[228:231], a[116:119], v[196:199]
    ds_read_b64_tr_b16 a[222:223], v41 offset:45056
    v_mfma_f32_16x16x32_bf16 v[192:195], a[228:231], a[112:115], v[192:195]
    v_mfma_f32_16x16x32_bf16 v[192:195], a[224:227], a[96:99], v[192:195]
    s_waitcnt lgkmcnt(8)
    v_mfma_f32_16x16x32_bf16 v[208:211], a[200:203], a[0:3], v[208:211]
    ds_read_b64_tr_b16 a[224:225], v41 offset:49152
    v_mfma_f32_16x16x32_bf16 v[208:211], a[204:207], a[16:19], v[208:211]
    ds_read_b64_tr_b16 a[226:227], v41 offset:53248
    v_mfma_f32_16x16x32_bf16 v[212:215], a[204:207], a[20:23], v[212:215]
    v_mfma_f32_16x16x32_bf16 v[212:215], a[200:203], a[4:7], v[212:215]
    ds_read_b64_tr_b16 a[228:229], v41 offset:57344
    v_mfma_f32_16x16x32_bf16 v[216:219], a[200:203], a[8:11], v[216:219]
    v_mfma_f32_16x16x32_bf16 v[216:219], a[204:207], a[24:27], v[216:219]
    ds_read_b64_tr_b16 a[230:231], v41 offset:61440
    v_mfma_f32_16x16x32_bf16 v[220:223], a[204:207], a[28:31], v[220:223]
    v_mfma_f32_16x16x32_bf16 v[220:223], a[200:203], a[12:15], v[220:223]
    s_waitcnt lgkmcnt(8)
    v_mfma_f32_16x16x32_bf16 v[220:223], a[208:211], a[44:47], v[220:223]
    ds_read_b64_tr_b16 a[200:201], v42 offset:0
    v_mfma_f32_16x16x32_bf16 v[220:223], a[212:215], a[60:63], v[220:223]
    ds_read_b64_tr_b16 a[202:203], v42 offset:4096
    v_mfma_f32_16x16x32_bf16 v[216:219], a[212:215], a[56:59], v[216:219]
    v_mfma_f32_16x16x32_bf16 v[216:219], a[208:211], a[40:43], v[216:219]
    ds_read_b64_tr_b16 a[204:205], v42 offset:8192
    v_mfma_f32_16x16x32_bf16 v[212:215], a[208:211], a[36:39], v[212:215]
    v_mfma_f32_16x16x32_bf16 v[212:215], a[212:215], a[52:55], v[212:215]
    ds_read_b64_tr_b16 a[206:207], v42 offset:12288
    v_mfma_f32_16x16x32_bf16 v[208:211], a[212:215], a[48:51], v[208:211]
    v_mfma_f32_16x16x32_bf16 v[208:211], a[208:211], a[32:35], v[208:211]
    s_waitcnt lgkmcnt(8)
    v_mfma_f32_16x16x32_bf16 v[208:211], a[216:219], a[64:67], v[208:211]
    ds_read_b64_tr_b16 a[208:209], v42 offset:16384
    v_mfma_f32_16x16x32_bf16 v[208:211], a[220:223], a[80:83], v[208:211]
    ds_read_b64_tr_b16 a[210:211], v42 offset:20480
    v_mfma_f32_16x16x32_bf16 v[212:215], a[220:223], a[84:87], v[212:215]
    v_mfma_f32_16x16x32_bf16 v[212:215], a[216:219], a[68:71], v[212:215]
    ds_read_b64_tr_b16 a[212:213], v42 offset:24576
    v_mfma_f32_16x16x32_bf16 v[216:219], a[216:219], a[72:75], v[216:219]
    v_mfma_f32_16x16x32_bf16 v[216:219], a[220:223], a[88:91], v[216:219]
    ds_read_b64_tr_b16 a[214:215], v42 offset:28672
    v_mfma_f32_16x16x32_bf16 v[220:223], a[220:223], a[92:95], v[220:223]
    v_mfma_f32_16x16x32_bf16 v[220:223], a[216:219], a[76:79], v[220:223]
    s_waitcnt lgkmcnt(8)
    v_mfma_f32_16x16x32_bf16 v[220:223], a[224:227], a[108:111], v[220:223]
    ds_read_b64_tr_b16 a[216:217], v42 offset:32768
    v_mfma_f32_16x16x32_bf16 v[220:223], a[228:231], a[124:127], v[220:223]
    ds_read_b64_tr_b16 a[218:219], v42 offset:36864
    v_mfma_f32_16x16x32_bf16 v[216:219], a[228:231], a[120:123], v[216:219]
    v_mfma_f32_16x16x32_bf16 v[216:219], a[224:227], a[104:107], v[216:219]
    ds_read_b64_tr_b16 a[220:221], v42 offset:40960
    v_mfma_f32_16x16x32_bf16 v[212:215], a[224:227], a[100:103], v[212:215]
    v_mfma_f32_16x16x32_bf16 v[212:215], a[228:231], a[116:119], v[212:215]
    ds_read_b64_tr_b16 a[222:223], v42 offset:45056
    v_mfma_f32_16x16x32_bf16 v[208:211], a[228:231], a[112:115], v[208:211]
    v_mfma_f32_16x16x32_bf16 v[208:211], a[224:227], a[96:99], v[208:211]
    s_waitcnt lgkmcnt(8)
    v_mfma_f32_16x16x32_bf16 v[224:227], a[200:203], a[0:3], v[224:227]
    ds_read_b64_tr_b16 a[224:225], v42 offset:49152
    v_mfma_f32_16x16x32_bf16 v[224:227], a[204:207], a[16:19], v[224:227]
    ds_read_b64_tr_b16 a[226:227], v42 offset:53248
    v_mfma_f32_16x16x32_bf16 v[228:231], a[204:207], a[20:23], v[228:231]
    v_cvt_pk_bf16_f32 v196, v196, v197
    v_mfma_f32_16x16x32_bf16 v[228:231], a[200:203], a[4:7], v[228:231]
    ds_read_b64_tr_b16 a[228:229], v42 offset:57344
    v_cvt_pk_bf16_f32 v197, v198, v199
    v_mfma_f32_16x16x32_bf16 v[232:235], a[200:203], a[8:11], v[232:235]
    v_cvt_pk_bf16_f32 v198, v212, v213
    v_mfma_f32_16x16x32_bf16 v[232:235], a[204:207], a[24:27], v[232:235]
    ds_read_b64_tr_b16 a[230:231], v42 offset:61440
    v_cvt_pk_bf16_f32 v199, v214, v215
    v_mfma_f32_16x16x32_bf16 v[236:239], a[204:207], a[28:31], v[236:239]
    buffer_store_dwordx4 v[196:199], v12, s[4:7], s86 offen offset:2048 sc1
    v_mfma_f32_16x16x32_bf16 v[236:239], a[200:203], a[12:15], v[236:239]
    v_cvt_pk_bf16_f32 v200, v200, v201
    s_waitcnt lgkmcnt(8)
    v_mfma_f32_16x16x32_bf16 v[236:239], a[208:211], a[44:47], v[236:239]
    ds_read_b64_tr_b16 a[200:201], v43 offset:0
    v_mfma_f32_16x16x32_bf16 v[236:239], a[212:215], a[60:63], v[236:239]
    ds_read_b64_tr_b16 a[202:203], v43 offset:4096
    v_mfma_f32_16x16x32_bf16 v[232:235], a[212:215], a[56:59], v[232:235]
    v_cvt_pk_bf16_f32 v201, v202, v203
    v_mfma_f32_16x16x32_bf16 v[232:235], a[208:211], a[40:43], v[232:235]
    ds_read_b64_tr_b16 a[204:205], v43 offset:8192
    v_cvt_pk_bf16_f32 v202, v216, v217
    v_mfma_f32_16x16x32_bf16 v[228:231], a[208:211], a[36:39], v[228:231]
    v_cvt_pk_bf16_f32 v203, v218, v219
    v_mfma_f32_16x16x32_bf16 v[228:231], a[212:215], a[52:55], v[228:231]
    ds_read_b64_tr_b16 a[206:207], v43 offset:12288
    buffer_store_dwordx4 v[200:203], v12, s[4:7], s87 offen offset:2048 sc1
    v_mfma_f32_16x16x32_bf16 v[224:227], a[212:215], a[48:51], v[224:227]
    v_cvt_pk_bf16_f32 v204, v204, v205
    v_mfma_f32_16x16x32_bf16 v[224:227], a[208:211], a[32:35], v[224:227]
    v_cvt_pk_bf16_f32 v205, v206, v207
    s_waitcnt lgkmcnt(8)
    v_mfma_f32_16x16x32_bf16 v[224:227], a[216:219], a[64:67], v[224:227]
    ds_read_b64_tr_b16 a[208:209], v43 offset:16384
    v_mfma_f32_16x16x32_bf16 v[224:227], a[220:223], a[80:83], v[224:227]
    ds_read_b64_tr_b16 a[210:211], v43 offset:20480
    v_mfma_f32_16x16x32_bf16 v[228:231], a[220:223], a[84:87], v[228:231]
    v_cvt_pk_bf16_f32 v206, v220, v221
    v_mfma_f32_16x16x32_bf16 v[228:231], a[216:219], a[68:71], v[228:231]
    ds_read_b64_tr_b16 a[212:213], v43 offset:24576
    v_cvt_pk_bf16_f32 v207, v222, v223
    v_mfma_f32_16x16x32_bf16 v[232:235], a[216:219], a[72:75], v[232:235]
    buffer_store_dwordx4 v[204:207], v12, s[4:7], s88 offen offset:2048 sc1
    v_mfma_f32_16x16x32_bf16 v[232:235], a[220:223], a[88:91], v[232:235]
    ds_read_b64_tr_b16 a[214:215], v43 offset:28672
    v_mfma_f32_16x16x32_bf16 v[236:239], a[220:223], a[92:95], v[236:239]
    v_mfma_f32_16x16x32_bf16 v[236:239], a[216:219], a[76:79], v[236:239]
    s_waitcnt lgkmcnt(8)
    v_mfma_f32_16x16x32_bf16 v[236:239], a[224:227], a[108:111], v[236:239]
    ds_read_b64_tr_b16 a[216:217], v43 offset:32768
    v_mfma_f32_16x16x32_bf16 v[236:239], a[228:231], a[124:127], v[236:239]
    ds_read_b64_tr_b16 a[218:219], v43 offset:36864
    v_mfma_f32_16x16x32_bf16 v[232:235], a[228:231], a[120:123], v[232:235]
    v_mfma_f32_16x16x32_bf16 v[232:235], a[224:227], a[104:107], v[232:235]
    ds_read_b64_tr_b16 a[220:221], v43 offset:40960
    v_mfma_f32_16x16x32_bf16 v[228:231], a[224:227], a[100:103], v[228:231]
    v_mfma_f32_16x16x32_bf16 v[228:231], a[228:231], a[116:119], v[228:231]
    ds_read_b64_tr_b16 a[222:223], v43 offset:45056
    v_mfma_f32_16x16x32_bf16 v[224:227], a[228:231], a[112:115], v[224:227]
    v_mfma_f32_16x16x32_bf16 v[224:227], a[224:227], a[96:99], v[224:227]
    s_waitcnt lgkmcnt(8)
    s_waitcnt vmcnt(3)
    s_mov_b64 exec, 1
    buffer_store_dword v17, v14, s[4:7], s89 offen offset:0 sc1
    buffer_store_dword v17, v14, s[4:7], s90 offen offset:0 sc1
    buffer_store_dword v17, v14, s[4:7], s91 offen offset:0 sc1
    s_mov_b64 exec, -1
    v_mfma_f32_16x16x32_bf16 v[240:243], a[200:203], a[0:3], v[240:243]
    ds_read_b64_tr_b16 a[224:225], v43 offset:49152
    v_mfma_f32_16x16x32_bf16 v[240:243], a[204:207], a[16:19], v[240:243]
    ds_read_b64_tr_b16 a[226:227], v43 offset:53248
    v_mfma_f32_16x16x32_bf16 v[244:247], a[204:207], a[20:23], v[244:247]
    v_mfma_f32_16x16x32_bf16 v[244:247], a[200:203], a[4:7], v[244:247]
    ds_read_b64_tr_b16 a[228:229], v43 offset:57344
    v_mfma_f32_16x16x32_bf16 v[248:251], a[200:203], a[8:11], v[248:251]
    v_mfma_f32_16x16x32_bf16 v[248:251], a[204:207], a[24:27], v[248:251]
    ds_read_b64_tr_b16 a[230:231], v43 offset:61440
    v_mfma_f32_16x16x32_bf16 v[252:255], a[204:207], a[28:31], v[252:255]
    v_mfma_f32_16x16x32_bf16 v[252:255], a[200:203], a[12:15], v[252:255]
    s_waitcnt lgkmcnt(8)
    v_mfma_f32_16x16x32_bf16 v[252:255], a[208:211], a[44:47], v[252:255]
    v_mfma_f32_16x16x32_bf16 v[252:255], a[212:215], a[60:63], v[252:255]
    v_mfma_f32_16x16x32_bf16 v[248:251], a[212:215], a[56:59], v[248:251]
    v_mfma_f32_16x16x32_bf16 v[248:251], a[208:211], a[40:43], v[248:251]
    v_mfma_f32_16x16x32_bf16 v[244:247], a[208:211], a[36:39], v[244:247]
    v_mfma_f32_16x16x32_bf16 v[244:247], a[212:215], a[52:55], v[244:247]
    v_mfma_f32_16x16x32_bf16 v[240:243], a[212:215], a[48:51], v[240:243]
    v_mfma_f32_16x16x32_bf16 v[240:243], a[208:211], a[32:35], v[240:243]
    s_waitcnt lgkmcnt(4)
    v_mfma_f32_16x16x32_bf16 v[240:243], a[216:219], a[64:67], v[240:243]
    v_mfma_f32_16x16x32_bf16 v[240:243], a[220:223], a[80:83], v[240:243]
    v_mfma_f32_16x16x32_bf16 v[244:247], a[220:223], a[84:87], v[244:247]
    v_mfma_f32_16x16x32_bf16 v[244:247], a[216:219], a[68:71], v[244:247]
    v_mfma_f32_16x16x32_bf16 v[248:251], a[216:219], a[72:75], v[248:251]
    v_mfma_f32_16x16x32_bf16 v[248:251], a[220:223], a[88:91], v[248:251]
    v_mfma_f32_16x16x32_bf16 v[252:255], a[220:223], a[92:95], v[252:255]
    v_mfma_f32_16x16x32_bf16 v[252:255], a[216:219], a[76:79], v[252:255]
    s_waitcnt lgkmcnt(0)
    v_mfma_f32_16x16x32_bf16 v[252:255], a[224:227], a[108:111], v[252:255]
    v_mfma_f32_16x16x32_bf16 v[252:255], a[228:231], a[124:127], v[252:255]
    v_mfma_f32_16x16x32_bf16 v[248:251], a[228:231], a[120:123], v[248:251]
    v_mfma_f32_16x16x32_bf16 v[248:251], a[224:227], a[104:107], v[248:251]
    v_mfma_f32_16x16x32_bf16 v[244:247], a[224:227], a[100:103], v[244:247]
    v_mfma_f32_16x16x32_bf16 v[244:247], a[228:231], a[116:119], v[244:247]
    v_mfma_f32_16x16x32_bf16 v[240:243], a[228:231], a[112:115], v[240:243]
    v_mfma_f32_16x16x32_bf16 v[240:243], a[224:227], a[96:99], v[240:243]
    v_cvt_pk_bf16_f32 v228, v228, v229
    v_cvt_pk_bf16_f32 v229, v230, v231
    s_nop 3
    s_nop 0
    v_cvt_pk_bf16_f32 v230, v244, v245
    v_cvt_pk_bf16_f32 v231, v246, v247
    buffer_store_dwordx4 v[228:231], v12, s[4:7], s86 offen offset:3072 sc1
    v_cvt_pk_bf16_f32 v232, v232, v233
    v_cvt_pk_bf16_f32 v233, v234, v235
    v_cvt_pk_bf16_f32 v234, v248, v249
    v_cvt_pk_bf16_f32 v235, v250, v251
    buffer_store_dwordx4 v[232:235], v12, s[4:7], s87 offen offset:3072 sc1
    v_cvt_pk_bf16_f32 v236, v236, v237
    v_cvt_pk_bf16_f32 v237, v238, v239
    v_cvt_pk_bf16_f32 v238, v252, v253
    v_cvt_pk_bf16_f32 v239, v254, v255
    buffer_store_dwordx4 v[236:239], v12, s[4:7], s88 offen offset:3072 sc1
    s_branch L_p2end_parallel_sum__sliding_block__glu_gated_swiglu__prompt_kernel
L_odd_parallel_sum__sliding_block__glu_gated_swiglu__prompt_kernel:
    s_nop 0
    ds_read_b64_tr_b16 a[200:201], v36 offset:49152
    ds_read_b64_tr_b16 a[202:203], v36 offset:53248
    ds_read_b64_tr_b16 a[204:205], v36 offset:57344
    ds_read_b64_tr_b16 a[206:207], v36 offset:61440
    ds_read_b64_tr_b16 a[208:209], v37 offset:49152
    ds_read_b64_tr_b16 a[210:211], v37 offset:53248
    ds_read_b64_tr_b16 a[212:213], v37 offset:57344
    ds_read_b64_tr_b16 a[214:215], v37 offset:61440
    ds_read_b64_tr_b16 a[216:217], v38 offset:49152
    ds_read_b64_tr_b16 a[218:219], v38 offset:53248
    ds_read_b64_tr_b16 a[220:221], v38 offset:57344
    ds_read_b64_tr_b16 a[222:223], v38 offset:61440
    v_rcp_f32 v236, v216
    s_nop 0
    v_pk_mul_f32 v[208:209], v[208:209], v[236:237] op_sel_hi:[1,0]
    v_pk_mul_f32 v[210:211], v[210:211], v[236:237] op_sel_hi:[1,0]
    v_pk_mul_f32 v[212:213], v[212:213], v[236:237] op_sel_hi:[1,0]
    v_pk_mul_f32 v[214:215], v[214:215], v[236:237] op_sel_hi:[1,0]
    v_cvt_pk_bf16_f32 v244, v208, v209
    v_cvt_pk_bf16_f32 v245, v210, v211
    v_cvt_pk_bf16_f32 v246, v212, v213
    v_cvt_pk_bf16_f32 v247, v214, v215
    buffer_store_dwordx4 v[244:247], v12, s[4:7], s72 offen offset:3072 sc1
    s_waitcnt vmcnt(9) lgkmcnt(8)
    v_mfma_f32_16x16x32_bf16 v[128:131], a[200:203], a[0:3], 0
    ds_read_b64_tr_b16 a[224:225], v39 offset:49152
    v_mfma_f32_16x16x32_bf16 v[128:131], a[204:207], a[16:19], v[128:131]
    ds_read_b64_tr_b16 a[226:227], v39 offset:53248
    v_mfma_f32_16x16x32_bf16 v[132:135], a[204:207], a[20:23], 0
    ds_read_b64_tr_b16 a[228:229], v39 offset:57344
    v_add_u32 v52, 65536, v36
    v_mfma_f32_16x16x32_bf16 v[132:135], a[200:203], a[4:7], v[132:135]
    ds_read_b64_tr_b16 a[230:231], v39 offset:61440
    v_add_u32 v53, 65536, v37
    v_mfma_f32_16x16x32_bf16 v[136:139], a[200:203], a[8:11], 0
    buffer_load_dwordx4 a[64:67], v2, s[4:7], s73 offen sc1
    v_add_u32 v54, 65536, v38
    v_mfma_f32_16x16x32_bf16 v[136:139], a[204:207], a[24:27], v[136:139]
    buffer_load_dwordx4 a[68:71], v3, s[4:7], s73 offen sc1
    v_add_u32 v55, 65536, v39
    v_mfma_f32_16x16x32_bf16 v[140:143], a[204:207], a[28:31], 0
    v_add_u32 v56, 65536, v40
    v_mfma_f32_16x16x32_bf16 v[140:143], a[200:203], a[12:15], v[140:143]
    v_add_u32 v57, 65536, v41
    s_waitcnt lgkmcnt(8)
    v_mfma_f32_16x16x32_bf16 v[156:159], a[208:211], a[12:15], 0
    ds_read_b64_tr_b16 a[200:201], v40 offset:49152
    v_mfma_f32_16x16x32_bf16 v[156:159], a[212:215], a[28:31], v[156:159]
    ds_read_b64_tr_b16 a[202:203], v40 offset:53248
    v_mfma_f32_16x16x32_bf16 v[152:155], a[212:215], a[24:27], 0
    ds_read_b64_tr_b16 a[204:205], v40 offset:57344
    v_add_u32 v58, 65536, v42
    v_mfma_f32_16x16x32_bf16 v[152:155], a[208:211], a[8:11], v[152:155]
    ds_read_b64_tr_b16 a[206:207], v40 offset:61440
    v_add_u32 v59, 65536, v43
    v_mfma_f32_16x16x32_bf16 v[148:151], a[208:211], a[4:7], 0
    buffer_load_dwordx4 a[72:75], v4, s[4:7], s73 offen sc1
    v_mfma_f32_16x16x32_bf16 v[148:151], a[212:215], a[20:23], v[148:151]
    buffer_load_dwordx4 a[76:79], v5, s[4:7], s73 offen sc1
    s_add_u32 s73, s73, 131072
    v_mfma_f32_16x16x32_bf16 v[144:147], a[212:215], a[16:19], 0
    v_mfma_f32_16x16x32_bf16 v[144:147], a[208:211], a[0:3], v[144:147]
    s_waitcnt lgkmcnt(8)
    v_mfma_f32_16x16x32_bf16 v[160:163], a[216:219], a[0:3], 0
    ds_read_b64_tr_b16 a[208:209], v41 offset:49152
    v_mfma_f32_16x16x32_bf16 v[160:163], a[220:223], a[16:19], v[160:163]
    ds_read_b64_tr_b16 a[210:211], v41 offset:53248
    v_mfma_f32_16x16x32_bf16 v[164:167], a[220:223], a[20:23], 0
    ds_read_b64_tr_b16 a[212:213], v41 offset:57344
    v_mfma_f32_16x16x32_bf16 v[164:167], a[216:219], a[4:7], v[164:167]
    v_mfma_f32_16x16x32_bf16 v[168:171], a[216:219], a[8:11], 0
    ds_read_b64_tr_b16 a[214:215], v41 offset:61440
    v_mfma_f32_16x16x32_bf16 v[168:171], a[220:223], a[24:27], v[168:171]
    buffer_load_dwordx4 a[80:83], v2, s[4:7], s73 offen sc1
    v_mfma_f32_16x16x32_bf16 v[172:175], a[220:223], a[28:31], 0
    v_mfma_f32_16x16x32_bf16 v[172:175], a[216:219], a[12:15], v[172:175]
    s_waitcnt lgkmcnt(8)
    v_mfma_f32_16x16x32_bf16 v[188:191], a[224:227], a[12:15], 0
    ds_read_b64_tr_b16 a[216:217], v42 offset:49152
    v_mfma_f32_16x16x32_bf16 v[188:191], a[228:231], a[28:31], v[188:191]
    ds_read_b64_tr_b16 a[218:219], v42 offset:53248
    v_mfma_f32_16x16x32_bf16 v[184:187], a[228:231], a[24:27], 0
    ds_read_b64_tr_b16 a[220:221], v42 offset:57344
    v_mfma_f32_16x16x32_bf16 v[184:187], a[224:227], a[8:11], v[184:187]
    ds_read_b64_tr_b16 a[222:223], v42 offset:61440
    v_mfma_f32_16x16x32_bf16 v[180:183], a[224:227], a[4:7], 0
    buffer_load_dwordx4 a[84:87], v3, s[4:7], s73 offen sc1
    v_mfma_f32_16x16x32_bf16 v[180:183], a[228:231], a[20:23], v[180:183]
    buffer_load_dwordx4 a[88:91], v4, s[4:7], s73 offen sc1
    v_mfma_f32_16x16x32_bf16 v[176:179], a[228:231], a[16:19], 0
    v_mfma_f32_16x16x32_bf16 v[176:179], a[224:227], a[0:3], v[176:179]
    s_waitcnt lgkmcnt(8)
    v_mfma_f32_16x16x32_bf16 v[192:195], a[200:203], a[0:3], 0
    ds_read_b64_tr_b16 a[224:225], v43 offset:49152
    v_mfma_f32_16x16x32_bf16 v[192:195], a[204:207], a[16:19], v[192:195]
    ds_read_b64_tr_b16 a[226:227], v43 offset:53248
    v_mfma_f32_16x16x32_bf16 v[196:199], a[204:207], a[20:23], 0
    ds_read_b64_tr_b16 a[228:229], v43 offset:57344
    v_mfma_f32_16x16x32_bf16 v[196:199], a[200:203], a[4:7], v[196:199]
    ds_read_b64_tr_b16 a[230:231], v43 offset:61440
    v_mfma_f32_16x16x32_bf16 v[200:203], a[200:203], a[8:11], 0
    buffer_load_dwordx4 a[92:95], v5, s[4:7], s73 offen sc1
    s_add_u32 s73, s73, 131072
    v_mfma_f32_16x16x32_bf16 v[200:203], a[204:207], a[24:27], v[200:203]
    buffer_load_dwordx4 a[96:99], v2, s[4:7], s73 offen sc1
    v_mfma_f32_16x16x32_bf16 v[204:207], a[204:207], a[28:31], 0
    v_mfma_f32_16x16x32_bf16 v[204:207], a[200:203], a[12:15], v[204:207]
    s_waitcnt lgkmcnt(0)
    s_barrier
    v_mfma_f32_16x16x32_bf16 v[220:223], a[208:211], a[12:15], 0
    ds_read_b64_tr_b16 a[200:201], v52 offset:0
    v_mfma_f32_16x16x32_bf16 v[220:223], a[212:215], a[28:31], v[220:223]
    ds_read_b64_tr_b16 a[202:203], v52 offset:4096
    v_mfma_f32_16x16x32_bf16 v[216:219], a[212:215], a[24:27], 0
    ds_read_b64_tr_b16 a[204:205], v52 offset:8192
    v_mfma_f32_16x16x32_bf16 v[216:219], a[208:211], a[8:11], v[216:219]
    v_mfma_f32_16x16x32_bf16 v[212:215], a[208:211], a[4:7], 0
    ds_read_b64_tr_b16 a[206:207], v52 offset:12288
    v_mfma_f32_16x16x32_bf16 v[212:215], a[212:215], a[20:23], v[212:215]
    s_add_u32 m0, s66, 0
    s_nop 0
    buffer_load_dwordx4 v6, s[24:27], s75 offen offset:0 lds
    v_mfma_f32_16x16x32_bf16 v[208:211], a[212:215], a[16:19], 0
    v_mfma_f32_16x16x32_bf16 v[208:211], a[208:211], a[0:3], v[208:211]
    v_mfma_f32_16x16x32_bf16 v[224:227], a[216:219], a[0:3], 0
    ds_read_b64_tr_b16 a[208:209], v53 offset:0
    v_mfma_f32_16x16x32_bf16 v[224:227], a[220:223], a[16:19], v[224:227]
    ds_read_b64_tr_b16 a[210:211], v53 offset:4096
    v_mfma_f32_16x16x32_bf16 v[228:231], a[220:223], a[20:23], 0
    ds_read_b64_tr_b16 a[212:213], v53 offset:8192
    v_mfma_f32_16x16x32_bf16 v[228:231], a[216:219], a[4:7], v[228:231]
    ds_read_b64_tr_b16 a[214:215], v53 offset:12288
    v_mfma_f32_16x16x32_bf16 v[232:235], a[216:219], a[8:11], 0
    buffer_load_dwordx4 v7, s[24:27], s75 offen offset:1024 lds
    v_mfma_f32_16x16x32_bf16 v[232:235], a[220:223], a[24:27], v[232:235]
    buffer_load_dwordx4 v8, s[24:27], s75 offen offset:2048 lds
    v_mfma_f32_16x16x32_bf16 v[236:239], a[220:223], a[28:31], 0
    v_mfma_f32_16x16x32_bf16 v[236:239], a[216:219], a[12:15], v[236:239]
    v_mfma_f32_16x16x32_bf16 v[252:255], a[224:227], a[12:15], 0
    ds_read_b64_tr_b16 a[216:217], v54 offset:0
    v_mfma_f32_16x16x32_bf16 v[252:255], a[228:231], a[28:31], v[252:255]
    ds_read_b64_tr_b16 a[218:219], v54 offset:4096
    v_mfma_f32_16x16x32_bf16 v[248:251], a[228:231], a[24:27], 0
    ds_read_b64_tr_b16 a[220:221], v54 offset:8192
    v_mfma_f32_16x16x32_bf16 v[248:251], a[224:227], a[8:11], v[248:251]
    v_mfma_f32_16x16x32_bf16 v[244:247], a[224:227], a[4:7], 0
    ds_read_b64_tr_b16 a[222:223], v54 offset:12288
    v_mfma_f32_16x16x32_bf16 v[244:247], a[228:231], a[20:23], v[244:247]
    buffer_load_dwordx4 v9, s[24:27], s75 offen offset:3072 lds
    s_add_u32 s75, s75, 131072
    v_mfma_f32_16x16x32_bf16 v[240:243], a[228:231], a[16:19], 0
    v_mfma_f32_16x16x32_bf16 v[240:243], a[224:227], a[0:3], v[240:243]
    s_waitcnt vmcnt(14) lgkmcnt(8)
    v_mfma_f32_16x16x32_bf16 v[128:131], a[200:203], a[32:35], v[128:131]
    ds_read_b64_tr_b16 a[224:225], v55 offset:0
    v_mfma_f32_16x16x32_bf16 v[128:131], a[204:207], a[48:51], v[128:131]
    ds_read_b64_tr_b16 a[226:227], v55 offset:4096
    v_mfma_f32_16x16x32_bf16 v[132:135], a[204:207], a[52:55], v[132:135]
    ds_read_b64_tr_b16 a[228:229], v55 offset:8192
    s_sub_u32 s61, s78, 512
    v_mfma_f32_16x16x32_bf16 v[132:135], a[200:203], a[36:39], v[132:135]
    ds_read_b64_tr_b16 a[230:231], v55 offset:12288
    v_add_u32 v29, 512, v49
    v_mfma_f32_16x16x32_bf16 v[136:139], a[200:203], a[40:43], v[136:139]
    buffer_load_dwordx4 a[100:103], v3, s[4:7], s73 offen sc1
    v_mfma_f32_16x16x32_bf16 v[136:139], a[204:207], a[56:59], v[136:139]
    buffer_load_dwordx4 a[104:107], v4, s[4:7], s73 offen sc1
    v_mfma_f32_16x16x32_bf16 v[140:143], a[204:207], a[60:63], v[140:143]
    v_mfma_f32_16x16x32_bf16 v[140:143], a[200:203], a[44:47], v[140:143]
    s_waitcnt lgkmcnt(8)
    v_mfma_f32_16x16x32_bf16 v[156:159], a[208:211], a[44:47], v[156:159]
    ds_read_b64_tr_b16 a[200:201], v56 offset:0
    v_mfma_f32_16x16x32_bf16 v[156:159], a[212:215], a[60:63], v[156:159]
    ds_read_b64_tr_b16 a[202:203], v56 offset:4096
    v_mfma_f32_16x16x32_bf16 v[152:155], a[212:215], a[56:59], v[152:155]
    ds_read_b64_tr_b16 a[204:205], v56 offset:8192
    v_mfma_f32_16x16x32_bf16 v[152:155], a[208:211], a[40:43], v[152:155]
    ds_read_b64_tr_b16 a[206:207], v56 offset:12288
    v_mfma_f32_16x16x32_bf16 v[148:151], a[208:211], a[36:39], v[148:151]
    buffer_load_dwordx4 a[108:111], v5, s[4:7], s73 offen sc1
    s_add_u32 s73, s73, 131072
    v_mfma_f32_16x16x32_bf16 v[148:151], a[212:215], a[52:55], v[148:151]
    buffer_load_dwordx4 a[112:115], v2, s[4:7], s73 offen sc1
    v_mfma_f32_16x16x32_bf16 v[144:147], a[212:215], a[48:51], v[144:147]
    v_mfma_f32_16x16x32_bf16 v[144:147], a[208:211], a[32:35], v[144:147]
    s_waitcnt lgkmcnt(8)
    v_mfma_f32_16x16x32_bf16 v[160:163], a[216:219], a[32:35], v[160:163]
    ds_read_b64_tr_b16 a[208:209], v57 offset:0
    v_mfma_f32_16x16x32_bf16 v[160:163], a[220:223], a[48:51], v[160:163]
    ds_read_b64_tr_b16 a[210:211], v57 offset:4096
    v_mfma_f32_16x16x32_bf16 v[164:167], a[220:223], a[52:55], v[164:167]
    ds_read_b64_tr_b16 a[212:213], v57 offset:8192
    v_mfma_f32_16x16x32_bf16 v[164:167], a[216:219], a[36:39], v[164:167]
    ds_read_b64_tr_b16 a[214:215], v57 offset:12288
    v_mfma_f32_16x16x32_bf16 v[168:171], a[216:219], a[40:43], v[168:171]
    buffer_load_dwordx4 a[116:119], v3, s[4:7], s73 offen sc1
    v_mfma_f32_16x16x32_bf16 v[168:171], a[220:223], a[56:59], v[168:171]
    buffer_load_dwordx4 a[120:123], v4, s[4:7], s73 offen sc1
    v_mfma_f32_16x16x32_bf16 v[172:175], a[220:223], a[60:63], v[172:175]
    v_mfma_f32_16x16x32_bf16 v[172:175], a[216:219], a[44:47], v[172:175]
    s_waitcnt lgkmcnt(8)
    v_mfma_f32_16x16x32_bf16 v[188:191], a[224:227], a[44:47], v[188:191]
    ds_read_b64_tr_b16 a[216:217], v58 offset:0
    v_mfma_f32_16x16x32_bf16 v[188:191], a[228:231], a[60:63], v[188:191]
    ds_read_b64_tr_b16 a[218:219], v58 offset:4096
    v_mfma_f32_16x16x32_bf16 v[184:187], a[228:231], a[56:59], v[184:187]
    ds_read_b64_tr_b16 a[220:221], v58 offset:8192
    v_mfma_f32_16x16x32_bf16 v[184:187], a[224:227], a[40:43], v[184:187]
    v_mfma_f32_16x16x32_bf16 v[180:183], a[224:227], a[36:39], v[180:183]
    ds_read_b64_tr_b16 a[222:223], v58 offset:12288
    v_mfma_f32_16x16x32_bf16 v[180:183], a[228:231], a[52:55], v[180:183]
    buffer_load_dwordx4 a[124:127], v5, s[4:7], s73 offen sc1
    s_add_u32 s73, s73, 131072
    v_mfma_f32_16x16x32_bf16 v[176:179], a[228:231], a[48:51], v[176:179]
    v_mfma_f32_16x16x32_bf16 v[176:179], a[224:227], a[32:35], v[176:179]
    s_waitcnt lgkmcnt(8)
    v_mfma_f32_16x16x32_bf16 v[192:195], a[200:203], a[32:35], v[192:195]
    ds_read_b64_tr_b16 a[224:225], v59 offset:0
    v_mfma_f32_16x16x32_bf16 v[192:195], a[204:207], a[48:51], v[192:195]
    ds_read_b64_tr_b16 a[226:227], v59 offset:4096
    v_mfma_f32_16x16x32_bf16 v[196:199], a[204:207], a[52:55], v[196:199]
    ds_read_b64_tr_b16 a[228:229], v59 offset:8192
    v_mfma_f32_16x16x32_bf16 v[196:199], a[200:203], a[36:39], v[196:199]
    ds_read_b64_tr_b16 a[230:231], v59 offset:12288
    v_mfma_f32_16x16x32_bf16 v[200:203], a[200:203], a[40:43], v[200:203]
    buffer_load_dwordx4 a[128:131], v2, s[4:7], s73 offen sc1
    v_mfma_f32_16x16x32_bf16 v[200:203], a[204:207], a[56:59], v[200:203]
    buffer_load_dwordx4 a[132:135], v3, s[4:7], s73 offen sc1
    v_mfma_f32_16x16x32_bf16 v[204:207], a[204:207], a[60:63], v[204:207]
    v_mfma_f32_16x16x32_bf16 v[204:207], a[200:203], a[44:47], v[204:207]
    s_waitcnt lgkmcnt(0)
    s_barrier
    v_mfma_f32_16x16x32_bf16 v[220:223], a[208:211], a[44:47], v[220:223]
    ds_read_b64_tr_b16 a[200:201], v52 offset:16384
    v_mfma_f32_16x16x32_bf16 v[220:223], a[212:215], a[60:63], v[220:223]
    ds_read_b64_tr_b16 a[202:203], v52 offset:20480
    v_mfma_f32_16x16x32_bf16 v[216:219], a[212:215], a[56:59], v[216:219]
    ds_read_b64_tr_b16 a[204:205], v52 offset:24576
    v_mfma_f32_16x16x32_bf16 v[216:219], a[208:211], a[40:43], v[216:219]
    ds_read_b64_tr_b16 a[206:207], v52 offset:28672
    v_mfma_f32_16x16x32_bf16 v[212:215], a[208:211], a[36:39], v[212:215]
    buffer_load_dwordx4 a[136:139], v4, s[4:7], s73 offen sc1
    v_mfma_f32_16x16x32_bf16 v[212:215], a[212:215], a[52:55], v[212:215]
    s_add_u32 m0, s66, 16384
    s_nop 0
    buffer_load_dwordx4 v6, s[24:27], s75 offen offset:0 lds
    v_mfma_f32_16x16x32_bf16 v[208:211], a[212:215], a[48:51], v[208:211]
    v_mfma_f32_16x16x32_bf16 v[208:211], a[208:211], a[32:35], v[208:211]
    v_mfma_f32_16x16x32_bf16 v[224:227], a[216:219], a[32:35], v[224:227]
    ds_read_b64_tr_b16 a[208:209], v53 offset:16384
    v_mfma_f32_16x16x32_bf16 v[224:227], a[220:223], a[48:51], v[224:227]
    ds_read_b64_tr_b16 a[210:211], v53 offset:20480
    v_mfma_f32_16x16x32_bf16 v[228:231], a[220:223], a[52:55], v[228:231]
    ds_read_b64_tr_b16 a[212:213], v53 offset:24576
    v_mfma_f32_16x16x32_bf16 v[228:231], a[216:219], a[36:39], v[228:231]
    ds_read_b64_tr_b16 a[214:215], v53 offset:28672
    v_mfma_f32_16x16x32_bf16 v[232:235], a[216:219], a[40:43], v[232:235]
    buffer_load_dwordx4 v7, s[24:27], s75 offen offset:1024 lds
    v_mfma_f32_16x16x32_bf16 v[232:235], a[220:223], a[56:59], v[232:235]
    buffer_load_dwordx4 v8, s[24:27], s75 offen offset:2048 lds
    v_mfma_f32_16x16x32_bf16 v[236:239], a[220:223], a[60:63], v[236:239]
    v_mfma_f32_16x16x32_bf16 v[236:239], a[216:219], a[44:47], v[236:239]
    v_mfma_f32_16x16x32_bf16 v[252:255], a[224:227], a[44:47], v[252:255]
    ds_read_b64_tr_b16 a[216:217], v54 offset:16384
    v_mfma_f32_16x16x32_bf16 v[252:255], a[228:231], a[60:63], v[252:255]
    ds_read_b64_tr_b16 a[218:219], v54 offset:20480
    v_mfma_f32_16x16x32_bf16 v[248:251], a[228:231], a[56:59], v[248:251]
    ds_read_b64_tr_b16 a[220:221], v54 offset:24576
    v_mfma_f32_16x16x32_bf16 v[248:251], a[224:227], a[40:43], v[248:251]
    v_mfma_f32_16x16x32_bf16 v[244:247], a[224:227], a[36:39], v[244:247]
    ds_read_b64_tr_b16 a[222:223], v54 offset:28672
    v_mfma_f32_16x16x32_bf16 v[244:247], a[228:231], a[52:55], v[244:247]
    buffer_load_dwordx4 v9, s[24:27], s75 offen offset:3072 lds
    s_add_u32 s75, s75, 131072
    v_mfma_f32_16x16x32_bf16 v[240:243], a[228:231], a[48:51], v[240:243]
    v_mfma_f32_16x16x32_bf16 v[240:243], a[224:227], a[32:35], v[240:243]
    s_waitcnt vmcnt(27)
    s_mov_b64 exec, 1
    buffer_store_dword v17, v14, s[4:7], s77 offen offset:32 sc1
    s_mov_b64 exec, -1
    s_waitcnt vmcnt(20) lgkmcnt(8)
    v_mfma_f32_16x16x32_bf16 v[128:131], a[200:203], a[64:67], v[128:131]
    ds_read_b64_tr_b16 a[224:225], v55 offset:16384
    v_mfma_f32_16x16x32_bf16 v[128:131], a[204:207], a[80:83], v[128:131]
    ds_read_b64_tr_b16 a[226:227], v55 offset:20480
    v_mfma_f32_16x16x32_bf16 v[132:135], a[204:207], a[84:87], v[132:135]
    ds_read_b64_tr_b16 a[228:229], v55 offset:24576
    v_mfma_f32_16x16x32_bf16 v[132:135], a[200:203], a[68:71], v[132:135]
    ds_read_b64_tr_b16 a[230:231], v55 offset:28672
    v_mfma_f32_16x16x32_bf16 v[136:139], a[200:203], a[72:75], v[136:139]
    buffer_load_dwordx4 a[140:143], v5, s[4:7], s73 offen sc1
    s_add_u32 s73, s73, 131072
    v_mfma_f32_16x16x32_bf16 v[136:139], a[204:207], a[88:91], v[136:139]
    buffer_load_dwordx4 a[144:147], v2, s[4:7], s73 offen sc1
    v_mfma_f32_16x16x32_bf16 v[140:143], a[204:207], a[92:95], v[140:143]
    v_mfma_f32_16x16x32_bf16 v[140:143], a[200:203], a[76:79], v[140:143]
    s_waitcnt lgkmcnt(8)
    v_mfma_f32_16x16x32_bf16 v[156:159], a[208:211], a[76:79], v[156:159]
    ds_read_b64_tr_b16 a[200:201], v56 offset:16384
    v_mfma_f32_16x16x32_bf16 v[156:159], a[212:215], a[92:95], v[156:159]
    ds_read_b64_tr_b16 a[202:203], v56 offset:20480
    v_mfma_f32_16x16x32_bf16 v[152:155], a[212:215], a[88:91], v[152:155]
    ds_read_b64_tr_b16 a[204:205], v56 offset:24576
    v_mfma_f32_16x16x32_bf16 v[152:155], a[208:211], a[72:75], v[152:155]
    ds_read_b64_tr_b16 a[206:207], v56 offset:28672
    v_mfma_f32_16x16x32_bf16 v[148:151], a[208:211], a[68:71], v[148:151]
    buffer_load_dwordx4 a[148:151], v3, s[4:7], s73 offen sc1
    v_mfma_f32_16x16x32_bf16 v[148:151], a[212:215], a[84:87], v[148:151]
    buffer_load_dwordx4 a[152:155], v4, s[4:7], s73 offen sc1
    v_mfma_f32_16x16x32_bf16 v[144:147], a[212:215], a[80:83], v[144:147]
    v_mfma_f32_16x16x32_bf16 v[144:147], a[208:211], a[64:67], v[144:147]
    s_waitcnt lgkmcnt(8)
    v_mfma_f32_16x16x32_bf16 v[160:163], a[216:219], a[64:67], v[160:163]
    ds_read_b64_tr_b16 a[208:209], v57 offset:16384
    v_mfma_f32_16x16x32_bf16 v[160:163], a[220:223], a[80:83], v[160:163]
    ds_read_b64_tr_b16 a[210:211], v57 offset:20480
    v_mfma_f32_16x16x32_bf16 v[164:167], a[220:223], a[84:87], v[164:167]
    ds_read_b64_tr_b16 a[212:213], v57 offset:24576
    v_mfma_f32_16x16x32_bf16 v[164:167], a[216:219], a[68:71], v[164:167]
    ds_read_b64_tr_b16 a[214:215], v57 offset:28672
    v_mfma_f32_16x16x32_bf16 v[168:171], a[216:219], a[72:75], v[168:171]
    buffer_load_dwordx4 a[156:159], v5, s[4:7], s73 offen sc1
    s_add_u32 s73, s73, 131072
    v_mfma_f32_16x16x32_bf16 v[168:171], a[220:223], a[88:91], v[168:171]
    buffer_load_dwordx4 a[0:3], v2, s[4:7], s73 offen sc1
    v_mfma_f32_16x16x32_bf16 v[172:175], a[220:223], a[92:95], v[172:175]
    v_mfma_f32_16x16x32_bf16 v[172:175], a[216:219], a[76:79], v[172:175]
    s_waitcnt lgkmcnt(8)
    v_mfma_f32_16x16x32_bf16 v[188:191], a[224:227], a[76:79], v[188:191]
    ds_read_b64_tr_b16 a[216:217], v58 offset:16384
    v_mfma_f32_16x16x32_bf16 v[188:191], a[228:231], a[92:95], v[188:191]
    ds_read_b64_tr_b16 a[218:219], v58 offset:20480
    v_mfma_f32_16x16x32_bf16 v[184:187], a[228:231], a[88:91], v[184:187]
    ds_read_b64_tr_b16 a[220:221], v58 offset:24576
    v_mfma_f32_16x16x32_bf16 v[184:187], a[224:227], a[72:75], v[184:187]
    v_mfma_f32_16x16x32_bf16 v[180:183], a[224:227], a[68:71], v[180:183]
    ds_read_b64_tr_b16 a[222:223], v58 offset:28672
    v_mfma_f32_16x16x32_bf16 v[180:183], a[228:231], a[84:87], v[180:183]
    buffer_load_dwordx4 a[4:7], v3, s[4:7], s73 offen sc1
    v_mfma_f32_16x16x32_bf16 v[176:179], a[228:231], a[80:83], v[176:179]
    v_mfma_f32_16x16x32_bf16 v[176:179], a[224:227], a[64:67], v[176:179]
    s_waitcnt lgkmcnt(8)
    v_mfma_f32_16x16x32_bf16 v[192:195], a[200:203], a[64:67], v[192:195]
    ds_read_b64_tr_b16 a[224:225], v59 offset:16384
    v_mfma_f32_16x16x32_bf16 v[192:195], a[204:207], a[80:83], v[192:195]
    ds_read_b64_tr_b16 a[226:227], v59 offset:20480
    v_mfma_f32_16x16x32_bf16 v[196:199], a[204:207], a[84:87], v[196:199]
    ds_read_b64_tr_b16 a[228:229], v59 offset:24576
    v_mfma_f32_16x16x32_bf16 v[196:199], a[200:203], a[68:71], v[196:199]
    ds_read_b64_tr_b16 a[230:231], v59 offset:28672
    v_mfma_f32_16x16x32_bf16 v[200:203], a[200:203], a[72:75], v[200:203]
    buffer_load_dwordx4 a[8:11], v4, s[4:7], s73 offen sc1
    v_mfma_f32_16x16x32_bf16 v[200:203], a[204:207], a[88:91], v[200:203]
    buffer_load_dwordx4 a[12:15], v5, s[4:7], s73 offen sc1
    s_add_u32 s73, s73, 131072
    v_mfma_f32_16x16x32_bf16 v[204:207], a[204:207], a[92:95], v[204:207]
    v_mfma_f32_16x16x32_bf16 v[204:207], a[200:203], a[76:79], v[204:207]
    s_waitcnt vmcnt(24) lgkmcnt(0)
    s_barrier
    v_mfma_f32_16x16x32_bf16 v[220:223], a[208:211], a[76:79], v[220:223]
    ds_read_b64_tr_b16 a[200:201], v36 offset:0
    v_mfma_f32_16x16x32_bf16 v[220:223], a[212:215], a[92:95], v[220:223]
    ds_read_b64_tr_b16 a[202:203], v36 offset:4096
    v_mfma_f32_16x16x32_bf16 v[216:219], a[212:215], a[88:91], v[216:219]
    ds_read_b64_tr_b16 a[204:205], v36 offset:8192
    v_mfma_f32_16x16x32_bf16 v[216:219], a[208:211], a[72:75], v[216:219]
    ds_read_b64_tr_b16 a[206:207], v36 offset:12288
    v_mfma_f32_16x16x32_bf16 v[212:215], a[208:211], a[68:71], v[212:215]
    s_add_u32 m0, s66, 32768
    s_add_u32 s85, s75, s81
    buffer_load_dwordx4 v6, s[24:27], s85 offen offset:0 lds
    v_mfma_f32_16x16x32_bf16 v[212:215], a[212:215], a[84:87], v[212:215]
    s_add_u32 s85, s85, s82
    buffer_load_dwordx4 v7, s[24:27], s85 offen offset:1024 lds
    v_mfma_f32_16x16x32_bf16 v[208:211], a[212:215], a[80:83], v[208:211]
    v_mfma_f32_16x16x32_bf16 v[208:211], a[208:211], a[64:67], v[208:211]
    v_mfma_f32_16x16x32_bf16 v[224:227], a[216:219], a[64:67], v[224:227]
    ds_read_b64_tr_b16 a[208:209], v37 offset:0
    v_mfma_f32_16x16x32_bf16 v[224:227], a[220:223], a[80:83], v[224:227]
    ds_read_b64_tr_b16 a[210:211], v37 offset:4096
    v_mfma_f32_16x16x32_bf16 v[228:231], a[220:223], a[84:87], v[228:231]
    ds_read_b64_tr_b16 a[212:213], v37 offset:8192
    v_mfma_f32_16x16x32_bf16 v[228:231], a[216:219], a[68:71], v[228:231]
    ds_read_b64_tr_b16 a[214:215], v37 offset:12288
    v_mfma_f32_16x16x32_bf16 v[232:235], a[216:219], a[72:75], v[232:235]
    s_add_u32 s85, s85, s82
    buffer_load_dwordx4 v8, s[24:27], s85 offen offset:2048 lds
    v_mfma_f32_16x16x32_bf16 v[232:235], a[220:223], a[88:91], v[232:235]
    s_add_u32 s85, s85, s82
    buffer_load_dwordx4 v9, s[24:27], s85 offen offset:3072 lds
    s_add_u32 s75, s75, 131072
    v_mfma_f32_16x16x32_bf16 v[236:239], a[220:223], a[92:95], v[236:239]
    v_mfma_f32_16x16x32_bf16 v[236:239], a[216:219], a[76:79], v[236:239]
    v_mfma_f32_16x16x32_bf16 v[252:255], a[224:227], a[76:79], v[252:255]
    ds_read_b64_tr_b16 a[216:217], v38 offset:0
    v_mfma_f32_16x16x32_bf16 v[252:255], a[228:231], a[92:95], v[252:255]
    ds_read_b64_tr_b16 a[218:219], v38 offset:4096
    v_mfma_f32_16x16x32_bf16 v[248:251], a[228:231], a[88:91], v[248:251]
    ds_read_b64_tr_b16 a[220:221], v38 offset:8192
    v_mfma_f32_16x16x32_bf16 v[248:251], a[224:227], a[72:75], v[248:251]
    v_mfma_f32_16x16x32_bf16 v[244:247], a[224:227], a[68:71], v[244:247]
    ds_read_b64_tr_b16 a[222:223], v38 offset:12288
    v_mfma_f32_16x16x32_bf16 v[244:247], a[228:231], a[84:87], v[244:247]
    s_add_u32 m0, s66, 49152
    s_nop 0
    buffer_load_dwordx4 v6, s[24:27], s75 offen offset:0 lds
    v_mfma_f32_16x16x32_bf16 v[240:243], a[228:231], a[80:83], v[240:243]
    v_mfma_f32_16x16x32_bf16 v[240:243], a[224:227], a[64:67], v[240:243]
    s_waitcnt vmcnt(22) lgkmcnt(8)
    v_mfma_f32_16x16x32_bf16 v[128:131], a[200:203], a[96:99], v[128:131]
    ds_read_b64_tr_b16 a[224:225], v39 offset:0
    v_mfma_f32_16x16x32_bf16 v[128:131], a[204:207], a[112:115], v[128:131]
    ds_read_b64_tr_b16 a[226:227], v39 offset:4096
    v_mfma_f32_16x16x32_bf16 v[132:135], a[204:207], a[116:119], v[132:135]
    ds_read_b64_tr_b16 a[228:229], v39 offset:8192
    v_mfma_f32_16x16x32_bf16 v[132:135], a[200:203], a[100:103], v[132:135]
    ds_read_b64_tr_b16 a[230:231], v39 offset:12288
    v_mfma_f32_16x16x32_bf16 v[136:139], a[200:203], a[104:107], v[136:139]
    buffer_load_dwordx4 a[16:19], v2, s[4:7], s73 offen sc1
    v_mfma_f32_16x16x32_bf16 v[136:139], a[204:207], a[120:123], v[136:139]
    buffer_load_dwordx4 a[20:23], v3, s[4:7], s73 offen sc1
    v_mfma_f32_16x16x32_bf16 v[140:143], a[204:207], a[124:127], v[140:143]
    v_mfma_f32_16x16x32_bf16 v[140:143], a[200:203], a[108:111], v[140:143]
    s_waitcnt lgkmcnt(8)
    v_mfma_f32_16x16x32_bf16 v[156:159], a[208:211], a[108:111], v[156:159]
    ds_read_b64_tr_b16 a[200:201], v40 offset:0
    v_mfma_f32_16x16x32_bf16 v[156:159], a[212:215], a[124:127], v[156:159]
    ds_read_b64_tr_b16 a[202:203], v40 offset:4096
    v_mfma_f32_16x16x32_bf16 v[152:155], a[212:215], a[120:123], v[152:155]
    ds_read_b64_tr_b16 a[204:205], v40 offset:8192
    v_mfma_f32_16x16x32_bf16 v[152:155], a[208:211], a[104:107], v[152:155]
    ds_read_b64_tr_b16 a[206:207], v40 offset:12288
    v_mfma_f32_16x16x32_bf16 v[148:151], a[208:211], a[100:103], v[148:151]
    buffer_load_dwordx4 a[24:27], v4, s[4:7], s73 offen sc1
    v_mfma_f32_16x16x32_bf16 v[148:151], a[212:215], a[116:119], v[148:151]
    buffer_load_dwordx4 a[28:31], v5, s[4:7], s73 offen sc1
    s_add_u32 s73, s73, 131072
    v_mfma_f32_16x16x32_bf16 v[144:147], a[212:215], a[112:115], v[144:147]
    v_mfma_f32_16x16x32_bf16 v[144:147], a[208:211], a[96:99], v[144:147]
    s_waitcnt lgkmcnt(8)
    v_mfma_f32_16x16x32_bf16 v[160:163], a[216:219], a[96:99], v[160:163]
    ds_read_b64_tr_b16 a[208:209], v41 offset:0
    v_mfma_f32_16x16x32_bf16 v[160:163], a[220:223], a[112:115], v[160:163]
    ds_read_b64_tr_b16 a[210:211], v41 offset:4096
    v_mfma_f32_16x16x32_bf16 v[164:167], a[220:223], a[116:119], v[164:167]
    ds_read_b64_tr_b16 a[212:213], v41 offset:8192
    v_mfma_f32_16x16x32_bf16 v[164:167], a[216:219], a[100:103], v[164:167]
    ds_read_b64_tr_b16 a[214:215], v41 offset:12288
    v_mfma_f32_16x16x32_bf16 v[168:171], a[216:219], a[104:107], v[168:171]
    buffer_load_dwordx4 a[32:35], v2, s[4:7], s73 offen sc1
    v_mfma_f32_16x16x32_bf16 v[168:171], a[220:223], a[120:123], v[168:171]
    buffer_load_dwordx4 a[36:39], v3, s[4:7], s73 offen sc1
    v_mfma_f32_16x16x32_bf16 v[172:175], a[220:223], a[124:127], v[172:175]
    v_mfma_f32_16x16x32_bf16 v[172:175], a[216:219], a[108:111], v[172:175]
    s_waitcnt lgkmcnt(8)
    v_mfma_f32_16x16x32_bf16 v[188:191], a[224:227], a[108:111], v[188:191]
    ds_read_b64_tr_b16 a[216:217], v42 offset:0
    v_mfma_f32_16x16x32_bf16 v[188:191], a[228:231], a[124:127], v[188:191]
    ds_read_b64_tr_b16 a[218:219], v42 offset:4096
    v_mfma_f32_16x16x32_bf16 v[184:187], a[228:231], a[120:123], v[184:187]
    ds_read_b64_tr_b16 a[220:221], v42 offset:8192
    v_mfma_f32_16x16x32_bf16 v[184:187], a[224:227], a[104:107], v[184:187]
    ds_read_b64_tr_b16 a[222:223], v42 offset:12288
    v_mfma_f32_16x16x32_bf16 v[180:183], a[224:227], a[100:103], v[180:183]
    buffer_load_dwordx4 a[40:43], v4, s[4:7], s73 offen sc1
    v_mfma_f32_16x16x32_bf16 v[180:183], a[228:231], a[116:119], v[180:183]
    buffer_load_dwordx4 a[44:47], v5, s[4:7], s73 offen sc1
    s_add_u32 s73, s73, 131072
    v_mfma_f32_16x16x32_bf16 v[176:179], a[228:231], a[112:115], v[176:179]
    v_mfma_f32_16x16x32_bf16 v[176:179], a[224:227], a[96:99], v[176:179]
    s_waitcnt lgkmcnt(8)
    v_mfma_f32_16x16x32_bf16 v[192:195], a[200:203], a[96:99], v[192:195]
    ds_read_b64_tr_b16 a[224:225], v43 offset:0
    v_mfma_f32_16x16x32_bf16 v[192:195], a[204:207], a[112:115], v[192:195]
    ds_read_b64_tr_b16 a[226:227], v43 offset:4096
    v_mfma_f32_16x16x32_bf16 v[196:199], a[204:207], a[116:119], v[196:199]
    ds_read_b64_tr_b16 a[228:229], v43 offset:8192
    v_mfma_f32_16x16x32_bf16 v[196:199], a[200:203], a[100:103], v[196:199]
    ds_read_b64_tr_b16 a[230:231], v43 offset:12288
    v_mfma_f32_16x16x32_bf16 v[200:203], a[200:203], a[104:107], v[200:203]
    buffer_load_dwordx4 a[48:51], v2, s[4:7], s73 offen sc1
    v_mfma_f32_16x16x32_bf16 v[200:203], a[204:207], a[120:123], v[200:203]
    buffer_load_dwordx4 a[52:55], v3, s[4:7], s73 offen sc1
    v_mfma_f32_16x16x32_bf16 v[204:207], a[204:207], a[124:127], v[204:207]
    v_mfma_f32_16x16x32_bf16 v[204:207], a[200:203], a[108:111], v[204:207]
    s_waitcnt vmcnt(25) lgkmcnt(0)
    s_barrier
    v_mfma_f32_16x16x32_bf16 v[220:223], a[208:211], a[108:111], v[220:223]
    ds_read_b64_tr_b16 a[200:201], v36 offset:16384
    v_mfma_f32_16x16x32_bf16 v[220:223], a[212:215], a[124:127], v[220:223]
    ds_read_b64_tr_b16 a[202:203], v36 offset:20480
    v_mfma_f32_16x16x32_bf16 v[216:219], a[212:215], a[120:123], v[216:219]
    ds_read_b64_tr_b16 a[204:205], v36 offset:24576
    v_mfma_f32_16x16x32_bf16 v[216:219], a[208:211], a[104:107], v[216:219]
    ds_read_b64_tr_b16 a[206:207], v36 offset:28672
    v_mfma_f32_16x16x32_bf16 v[212:215], a[208:211], a[100:103], v[212:215]
    buffer_load_dwordx4 v7, s[24:27], s75 offen offset:1024 lds
    v_mfma_f32_16x16x32_bf16 v[212:215], a[212:215], a[116:119], v[212:215]
    buffer_load_dwordx4 v8, s[24:27], s75 offen offset:2048 lds
    v_mfma_f32_16x16x32_bf16 v[208:211], a[212:215], a[112:115], v[208:211]
    v_mfma_f32_16x16x32_bf16 v[208:211], a[208:211], a[96:99], v[208:211]
    v_mfma_f32_16x16x32_bf16 v[224:227], a[216:219], a[96:99], v[224:227]
    ds_read_b64_tr_b16 a[208:209], v37 offset:16384
    v_mfma_f32_16x16x32_bf16 v[224:227], a[220:223], a[112:115], v[224:227]
    ds_read_b64_tr_b16 a[210:211], v37 offset:20480
    v_mfma_f32_16x16x32_bf16 v[228:231], a[220:223], a[116:119], v[228:231]
    ds_read_b64_tr_b16 a[212:213], v37 offset:24576
    v_mfma_f32_16x16x32_bf16 v[228:231], a[216:219], a[100:103], v[228:231]
    ds_read_b64_tr_b16 a[214:215], v37 offset:28672
    v_mfma_f32_16x16x32_bf16 v[232:235], a[216:219], a[104:107], v[232:235]
    buffer_load_dwordx4 v9, s[24:27], s75 offen offset:3072 lds
    s_add_u32 s75, s75, 131072
    v_mfma_f32_16x16x32_bf16 v[232:235], a[220:223], a[120:123], v[232:235]
    s_add_u32 m0, s66, 65536
    s_nop 0
    buffer_load_dwordx4 v6, s[24:27], s75 offen offset:0 lds
    v_mfma_f32_16x16x32_bf16 v[236:239], a[220:223], a[124:127], v[236:239]
    v_mfma_f32_16x16x32_bf16 v[236:239], a[216:219], a[108:111], v[236:239]
    v_mfma_f32_16x16x32_bf16 v[252:255], a[224:227], a[108:111], v[252:255]
    ds_read_b64_tr_b16 a[216:217], v38 offset:16384
    v_mfma_f32_16x16x32_bf16 v[252:255], a[228:231], a[124:127], v[252:255]
    ds_read_b64_tr_b16 a[218:219], v38 offset:20480
    v_mfma_f32_16x16x32_bf16 v[248:251], a[228:231], a[120:123], v[248:251]
    ds_read_b64_tr_b16 a[220:221], v38 offset:24576
    v_mfma_f32_16x16x32_bf16 v[248:251], a[224:227], a[104:107], v[248:251]
    v_mfma_f32_16x16x32_bf16 v[244:247], a[224:227], a[100:103], v[244:247]
    ds_read_b64_tr_b16 a[222:223], v38 offset:28672
    v_mfma_f32_16x16x32_bf16 v[244:247], a[228:231], a[116:119], v[244:247]
    buffer_load_dwordx4 v7, s[24:27], s75 offen offset:1024 lds
    v_mfma_f32_16x16x32_bf16 v[240:243], a[228:231], a[112:115], v[240:243]
    v_mfma_f32_16x16x32_bf16 v[240:243], a[224:227], a[96:99], v[240:243]
    s_waitcnt vmcnt(24) lgkmcnt(8)
    v_mfma_f32_16x16x32_bf16 v[128:131], a[200:203], a[128:131], v[128:131]
    ds_read_b64_tr_b16 a[224:225], v39 offset:16384
    v_mfma_f32_16x16x32_bf16 v[128:131], a[204:207], a[144:147], v[128:131]
    ds_read_b64_tr_b16 a[226:227], v39 offset:20480
    v_mfma_f32_16x16x32_bf16 v[132:135], a[204:207], a[148:151], v[132:135]
    ds_read_b64_tr_b16 a[228:229], v39 offset:24576
    v_mfma_f32_16x16x32_bf16 v[132:135], a[200:203], a[132:135], v[132:135]
    ds_read_b64_tr_b16 a[230:231], v39 offset:28672
    v_mfma_f32_16x16x32_bf16 v[136:139], a[200:203], a[136:139], v[136:139]
    buffer_load_dwordx4 a[56:59], v4, s[4:7], s73 offen sc1
    v_mfma_f32_16x16x32_bf16 v[136:139], a[204:207], a[152:155], v[136:139]
    buffer_load_dwordx4 a[60:63], v5, s[4:7], s73 offen sc1
    s_add_u32 s73, s73, 131072
    v_mfma_f32_16x16x32_bf16 v[140:143], a[204:207], a[156:159], v[140:143]
    v_mfma_f32_16x16x32_bf16 v[140:143], a[200:203], a[140:143], v[140:143]
    s_waitcnt lgkmcnt(8)
    v_mfma_f32_16x16x32_bf16 v[156:159], a[208:211], a[140:143], v[156:159]
    ds_read_b64_tr_b16 a[200:201], v40 offset:16384
    v_mfma_f32_16x16x32_bf16 v[156:159], a[212:215], a[156:159], v[156:159]
    ds_read_b64_tr_b16 a[202:203], v40 offset:20480
    v_mfma_f32_16x16x32_bf16 v[152:155], a[212:215], a[152:155], v[152:155]
    ds_read_b64_tr_b16 a[204:205], v40 offset:24576
    v_mfma_f32_16x16x32_bf16 v[152:155], a[208:211], a[136:139], v[152:155]
    ds_read_b64_tr_b16 a[206:207], v40 offset:28672
    v_mfma_f32_16x16x32_bf16 v[148:151], a[208:211], a[132:135], v[148:151]
    buffer_load_dwordx4 a[64:67], v2, s[4:7], s73 offen sc1
    v_mfma_f32_16x16x32_bf16 v[148:151], a[212:215], a[148:151], v[148:151]
    buffer_load_dwordx4 a[68:71], v3, s[4:7], s73 offen sc1
    v_mfma_f32_16x16x32_bf16 v[144:147], a[212:215], a[144:147], v[144:147]
    v_mfma_f32_16x16x32_bf16 v[144:147], a[208:211], a[128:131], v[144:147]
    s_waitcnt lgkmcnt(8)
    v_mfma_f32_16x16x32_bf16 v[160:163], a[216:219], a[128:131], v[160:163]
    ds_read_b64_tr_b16 a[208:209], v41 offset:16384
    v_mfma_f32_16x16x32_bf16 v[160:163], a[220:223], a[144:147], v[160:163]
    ds_read_b64_tr_b16 a[210:211], v41 offset:20480
    v_mfma_f32_16x16x32_bf16 v[164:167], a[220:223], a[148:151], v[164:167]
    ds_read_b64_tr_b16 a[212:213], v41 offset:24576
    v_mfma_f32_16x16x32_bf16 v[164:167], a[216:219], a[132:135], v[164:167]
    ds_read_b64_tr_b16 a[214:215], v41 offset:28672
    v_mfma_f32_16x16x32_bf16 v[168:171], a[216:219], a[136:139], v[168:171]
    buffer_load_dwordx4 a[72:75], v4, s[4:7], s73 offen sc1
    v_mfma_f32_16x16x32_bf16 v[168:171], a[220:223], a[152:155], v[168:171]
    buffer_load_dwordx4 a[76:79], v5, s[4:7], s73 offen sc1
    s_add_u32 s73, s73, 131072
    v_mfma_f32_16x16x32_bf16 v[172:175], a[220:223], a[156:159], v[172:175]
    v_mfma_f32_16x16x32_bf16 v[172:175], a[216:219], a[140:143], v[172:175]
    s_waitcnt lgkmcnt(8)
    v_mfma_f32_16x16x32_bf16 v[188:191], a[224:227], a[140:143], v[188:191]
    ds_read_b64_tr_b16 a[216:217], v42 offset:16384
    v_mfma_f32_16x16x32_bf16 v[188:191], a[228:231], a[156:159], v[188:191]
    ds_read_b64_tr_b16 a[218:219], v42 offset:20480
    v_mfma_f32_16x16x32_bf16 v[184:187], a[228:231], a[152:155], v[184:187]
    ds_read_b64_tr_b16 a[220:221], v42 offset:24576
    v_mfma_f32_16x16x32_bf16 v[184:187], a[224:227], a[136:139], v[184:187]
    ds_read_b64_tr_b16 a[222:223], v42 offset:28672
    v_mfma_f32_16x16x32_bf16 v[180:183], a[224:227], a[132:135], v[180:183]
    buffer_load_dwordx4 a[80:83], v2, s[4:7], s73 offen sc1
    v_mfma_f32_16x16x32_bf16 v[180:183], a[228:231], a[148:151], v[180:183]
    buffer_load_dwordx4 a[84:87], v3, s[4:7], s73 offen sc1
    v_mfma_f32_16x16x32_bf16 v[176:179], a[228:231], a[144:147], v[176:179]
    v_mfma_f32_16x16x32_bf16 v[176:179], a[224:227], a[128:131], v[176:179]
    s_waitcnt lgkmcnt(8)
    v_mfma_f32_16x16x32_bf16 v[192:195], a[200:203], a[128:131], v[192:195]
    ds_read_b64_tr_b16 a[224:225], v43 offset:16384
    v_mfma_f32_16x16x32_bf16 v[192:195], a[204:207], a[144:147], v[192:195]
    ds_read_b64_tr_b16 a[226:227], v43 offset:20480
    v_mfma_f32_16x16x32_bf16 v[196:199], a[204:207], a[148:151], v[196:199]
    ds_read_b64_tr_b16 a[228:229], v43 offset:24576
    v_mfma_f32_16x16x32_bf16 v[196:199], a[200:203], a[132:135], v[196:199]
    ds_read_b64_tr_b16 a[230:231], v43 offset:28672
    v_mfma_f32_16x16x32_bf16 v[200:203], a[200:203], a[136:139], v[200:203]
    buffer_load_dwordx4 a[88:91], v4, s[4:7], s73 offen sc1
    v_mfma_f32_16x16x32_bf16 v[200:203], a[204:207], a[152:155], v[200:203]
    buffer_load_dwordx4 a[92:95], v5, s[4:7], s73 offen sc1
    s_add_u32 s73, s73, 131072
    v_mfma_f32_16x16x32_bf16 v[204:207], a[204:207], a[156:159], v[204:207]
    v_mfma_f32_16x16x32_bf16 v[204:207], a[200:203], a[140:143], v[204:207]
    s_waitcnt vmcnt(26) lgkmcnt(0)
    s_barrier
    v_mfma_f32_16x16x32_bf16 v[220:223], a[208:211], a[140:143], v[220:223]
    ds_read_b64_tr_b16 a[200:201], v36 offset:32768
    v_mfma_f32_16x16x32_bf16 v[220:223], a[212:215], a[156:159], v[220:223]
    ds_read_b64_tr_b16 a[202:203], v36 offset:36864
    v_mfma_f32_16x16x32_bf16 v[216:219], a[212:215], a[152:155], v[216:219]
    ds_read_b64_tr_b16 a[204:205], v36 offset:40960
    v_mfma_f32_16x16x32_bf16 v[216:219], a[208:211], a[136:139], v[216:219]
    ds_read_b64_tr_b16 a[206:207], v36 offset:45056
    v_mfma_f32_16x16x32_bf16 v[212:215], a[208:211], a[132:135], v[212:215]
    buffer_load_dwordx4 v8, s[24:27], s75 offen offset:2048 lds
    v_mfma_f32_16x16x32_bf16 v[212:215], a[212:215], a[148:151], v[212:215]
    buffer_load_dwordx4 v9, s[24:27], s75 offen offset:3072 lds
    s_add_u32 s75, s75, 131072
    v_mfma_f32_16x16x32_bf16 v[208:211], a[212:215], a[144:147], v[208:211]
    v_mfma_f32_16x16x32_bf16 v[208:211], a[208:211], a[128:131], v[208:211]
    v_mfma_f32_16x16x32_bf16 v[224:227], a[216:219], a[128:131], v[224:227]
    ds_read_b64_tr_b16 a[208:209], v37 offset:32768
    v_mfma_f32_16x16x32_bf16 v[224:227], a[220:223], a[144:147], v[224:227]
    ds_read_b64_tr_b16 a[210:211], v37 offset:36864
    v_mfma_f32_16x16x32_bf16 v[228:231], a[220:223], a[148:151], v[228:231]
    ds_read_b64_tr_b16 a[212:213], v37 offset:40960
    v_mfma_f32_16x16x32_bf16 v[228:231], a[216:219], a[132:135], v[228:231]
    ds_read_b64_tr_b16 a[214:215], v37 offset:45056
    v_mfma_f32_16x16x32_bf16 v[232:235], a[216:219], a[136:139], v[232:235]
    s_add_u32 m0, s66, 81920
    s_add_u32 s85, s75, s83
    buffer_load_dwordx4 v6, s[24:27], s85 offen offset:0 lds
    v_mfma_f32_16x16x32_bf16 v[232:235], a[220:223], a[152:155], v[232:235]
    s_add_u32 s85, s85, s84
    buffer_load_dwordx4 v7, s[24:27], s85 offen offset:1024 lds
    v_mfma_f32_16x16x32_bf16 v[236:239], a[220:223], a[156:159], v[236:239]
    v_mfma_f32_16x16x32_bf16 v[236:239], a[216:219], a[140:143], v[236:239]
    v_mfma_f32_16x16x32_bf16 v[252:255], a[224:227], a[140:143], v[252:255]
    ds_read_b64_tr_b16 a[216:217], v38 offset:32768
    v_mfma_f32_16x16x32_bf16 v[252:255], a[228:231], a[156:159], v[252:255]
    ds_read_b64_tr_b16 a[218:219], v38 offset:36864
    v_mfma_f32_16x16x32_bf16 v[248:251], a[228:231], a[152:155], v[248:251]
    ds_read_b64_tr_b16 a[220:221], v38 offset:40960
    v_mfma_f32_16x16x32_bf16 v[248:251], a[224:227], a[136:139], v[248:251]
    v_mfma_f32_16x16x32_bf16 v[244:247], a[224:227], a[132:135], v[244:247]
    ds_read_b64_tr_b16 a[222:223], v38 offset:45056
    v_mfma_f32_16x16x32_bf16 v[244:247], a[228:231], a[148:151], v[244:247]
    s_add_u32 s85, s85, s84
    buffer_load_dwordx4 v8, s[24:27], s85 offen offset:2048 lds
    v_mfma_f32_16x16x32_bf16 v[240:243], a[228:231], a[144:147], v[240:243]
    v_mfma_f32_16x16x32_bf16 v[240:243], a[224:227], a[128:131], v[240:243]
    s_waitcnt vmcnt(26) lgkmcnt(8)
    v_mfma_f32_16x16x32_bf16 v[128:131], a[200:203], a[0:3], v[128:131]
    ds_read_b64_tr_b16 a[224:225], v39 offset:32768
    v_mfma_f32_16x16x32_bf16 v[128:131], a[204:207], a[16:19], v[128:131]
    ds_read_b64_tr_b16 a[226:227], v39 offset:36864
    v_mfma_f32_16x16x32_bf16 v[132:135], a[204:207], a[20:23], v[132:135]
    ds_read_b64_tr_b16 a[228:229], v39 offset:40960
    v_mfma_f32_16x16x32_bf16 v[132:135], a[200:203], a[4:7], v[132:135]
    ds_read_b64_tr_b16 a[230:231], v39 offset:45056
    v_mfma_f32_16x16x32_bf16 v[136:139], a[200:203], a[8:11], v[136:139]
    buffer_load_dwordx4 a[96:99], v2, s[4:7], s73 offen sc1
    v_mfma_f32_16x16x32_bf16 v[136:139], a[204:207], a[24:27], v[136:139]
    buffer_load_dwordx4 a[100:103], v3, s[4:7], s73 offen sc1
    v_mfma_f32_16x16x32_bf16 v[140:143], a[204:207], a[28:31], v[140:143]
    v_mfma_f32_16x16x32_bf16 v[140:143], a[200:203], a[12:15], v[140:143]
    s_waitcnt lgkmcnt(8)
    v_mfma_f32_16x16x32_bf16 v[156:159], a[208:211], a[12:15], v[156:159]
    ds_read_b64_tr_b16 a[200:201], v40 offset:32768
    v_mfma_f32_16x16x32_bf16 v[156:159], a[212:215], a[28:31], v[156:159]
    ds_read_b64_tr_b16 a[202:203], v40 offset:36864
    v_mfma_f32_16x16x32_bf16 v[152:155], a[212:215], a[24:27], v[152:155]
    ds_read_b64_tr_b16 a[204:205], v40 offset:40960
    v_mfma_f32_16x16x32_bf16 v[152:155], a[208:211], a[8:11], v[152:155]
    ds_read_b64_tr_b16 a[206:207], v40 offset:45056
    v_mfma_f32_16x16x32_bf16 v[148:151], a[208:211], a[4:7], v[148:151]
    buffer_load_dwordx4 a[104:107], v4, s[4:7], s73 offen sc1
    v_mfma_f32_16x16x32_bf16 v[148:151], a[212:215], a[20:23], v[148:151]
    buffer_load_dwordx4 a[108:111], v5, s[4:7], s73 offen sc1
    s_add_u32 s73, s73, 131072
    v_mfma_f32_16x16x32_bf16 v[144:147], a[212:215], a[16:19], v[144:147]
    v_mfma_f32_16x16x32_bf16 v[144:147], a[208:211], a[0:3], v[144:147]
    s_waitcnt lgkmcnt(8)
    v_mfma_f32_16x16x32_bf16 v[160:163], a[216:219], a[0:3], v[160:163]
    ds_read_b64_tr_b16 a[208:209], v41 offset:32768
    v_mfma_f32_16x16x32_bf16 v[160:163], a[220:223], a[16:19], v[160:163]
    ds_read_b64_tr_b16 a[210:211], v41 offset:36864
    v_mfma_f32_16x16x32_bf16 v[164:167], a[220:223], a[20:23], v[164:167]
    ds_read_b64_tr_b16 a[212:213], v41 offset:40960
    v_mfma_f32_16x16x32_bf16 v[164:167], a[216:219], a[4:7], v[164:167]
    ds_read_b64_tr_b16 a[214:215], v41 offset:45056
    v_mfma_f32_16x16x32_bf16 v[168:171], a[216:219], a[8:11], v[168:171]
    buffer_load_dwordx4 a[112:115], v2, s[4:7], s73 offen sc1
    v_mfma_f32_16x16x32_bf16 v[168:171], a[220:223], a[24:27], v[168:171]
    buffer_load_dwordx4 a[116:119], v3, s[4:7], s73 offen sc1
    v_mfma_f32_16x16x32_bf16 v[172:175], a[220:223], a[28:31], v[172:175]
    v_mfma_f32_16x16x32_bf16 v[172:175], a[216:219], a[12:15], v[172:175]
    s_waitcnt lgkmcnt(8)
    v_mfma_f32_16x16x32_bf16 v[188:191], a[224:227], a[12:15], v[188:191]
    ds_read_b64_tr_b16 a[216:217], v42 offset:32768
    v_mfma_f32_16x16x32_bf16 v[188:191], a[228:231], a[28:31], v[188:191]
    ds_read_b64_tr_b16 a[218:219], v42 offset:36864
    v_mfma_f32_16x16x32_bf16 v[184:187], a[228:231], a[24:27], v[184:187]
    ds_read_b64_tr_b16 a[220:221], v42 offset:40960
    v_mfma_f32_16x16x32_bf16 v[184:187], a[224:227], a[8:11], v[184:187]
    v_mfma_f32_16x16x32_bf16 v[180:183], a[224:227], a[4:7], v[180:183]
    ds_read_b64_tr_b16 a[222:223], v42 offset:45056
    v_mfma_f32_16x16x32_bf16 v[180:183], a[228:231], a[20:23], v[180:183]
    buffer_load_dwordx4 a[120:123], v4, s[4:7], s73 offen sc1
    v_mfma_f32_16x16x32_bf16 v[176:179], a[228:231], a[16:19], v[176:179]
    v_mfma_f32_16x16x32_bf16 v[176:179], a[224:227], a[0:3], v[176:179]
    s_waitcnt lgkmcnt(8)
    v_mfma_f32_16x16x32_bf16 v[192:195], a[200:203], a[0:3], v[192:195]
    ds_read_b64_tr_b16 a[224:225], v43 offset:32768
    v_mfma_f32_16x16x32_bf16 v[192:195], a[204:207], a[16:19], v[192:195]
    ds_read_b64_tr_b16 a[226:227], v43 offset:36864
    v_mfma_f32_16x16x32_bf16 v[196:199], a[204:207], a[20:23], v[196:199]
    ds_read_b64_tr_b16 a[228:229], v43 offset:40960
    v_mfma_f32_16x16x32_bf16 v[196:199], a[200:203], a[4:7], v[196:199]
    ds_read_b64_tr_b16 a[230:231], v43 offset:45056
    v_mfma_f32_16x16x32_bf16 v[200:203], a[200:203], a[8:11], v[200:203]
    buffer_load_dwordx4 a[124:127], v5, s[4:7], s73 offen sc1
    s_add_u32 s73, s73, 131072
    v_mfma_f32_16x16x32_bf16 v[200:203], a[204:207], a[24:27], v[200:203]
    buffer_load_dwordx4 a[128:131], v2, s[4:7], s73 offen sc1
    v_mfma_f32_16x16x32_bf16 v[204:207], a[204:207], a[28:31], v[204:207]
    v_mfma_f32_16x16x32_bf16 v[204:207], a[200:203], a[12:15], v[204:207]
    s_waitcnt vmcnt(26) lgkmcnt(0)
    s_barrier
    v_mfma_f32_16x16x32_bf16 v[220:223], a[208:211], a[12:15], v[220:223]
    ds_read_b64_tr_b16 a[200:201], v36 offset:49152
    v_mfma_f32_16x16x32_bf16 v[220:223], a[212:215], a[28:31], v[220:223]
    ds_read_b64_tr_b16 a[202:203], v36 offset:53248
    v_mfma_f32_16x16x32_bf16 v[216:219], a[212:215], a[24:27], v[216:219]
    ds_read_b64_tr_b16 a[204:205], v36 offset:57344
    v_mfma_f32_16x16x32_bf16 v[216:219], a[208:211], a[8:11], v[216:219]
    ds_read_b64_tr_b16 a[206:207], v36 offset:61440
    v_mfma_f32_16x16x32_bf16 v[212:215], a[208:211], a[4:7], v[212:215]
    s_add_u32 s85, s85, s84
    buffer_load_dwordx4 v9, s[24:27], s85 offen offset:3072 lds
    s_add_u32 s75, s75, 131072
    v_mfma_f32_16x16x32_bf16 v[212:215], a[212:215], a[20:23], v[212:215]
    s_add_u32 m0, s66, 0
    s_nop 0
    buffer_load_dwordx4 v6, s[24:27], s75 offen offset:0 lds
    v_mfma_f32_16x16x32_bf16 v[208:211], a[212:215], a[16:19], v[208:211]
    v_mfma_f32_16x16x32_bf16 v[208:211], a[208:211], a[0:3], v[208:211]
    v_mfma_f32_16x16x32_bf16 v[224:227], a[216:219], a[0:3], v[224:227]
    ds_read_b64_tr_b16 a[208:209], v37 offset:49152
    v_mfma_f32_16x16x32_bf16 v[224:227], a[220:223], a[16:19], v[224:227]
    ds_read_b64_tr_b16 a[210:211], v37 offset:53248
    v_mfma_f32_16x16x32_bf16 v[228:231], a[220:223], a[20:23], v[228:231]
    ds_read_b64_tr_b16 a[212:213], v37 offset:57344
    v_mfma_f32_16x16x32_bf16 v[228:231], a[216:219], a[4:7], v[228:231]
    ds_read_b64_tr_b16 a[214:215], v37 offset:61440
    v_mfma_f32_16x16x32_bf16 v[232:235], a[216:219], a[8:11], v[232:235]
    buffer_load_dwordx4 v7, s[24:27], s75 offen offset:1024 lds
    v_mfma_f32_16x16x32_bf16 v[232:235], a[220:223], a[24:27], v[232:235]
    buffer_load_dwordx4 v8, s[24:27], s75 offen offset:2048 lds
    v_mfma_f32_16x16x32_bf16 v[236:239], a[220:223], a[28:31], v[236:239]
    v_mfma_f32_16x16x32_bf16 v[236:239], a[216:219], a[12:15], v[236:239]
    v_mfma_f32_16x16x32_bf16 v[252:255], a[224:227], a[12:15], v[252:255]
    ds_read_b64_tr_b16 a[216:217], v38 offset:49152
    v_mfma_f32_16x16x32_bf16 v[252:255], a[228:231], a[28:31], v[252:255]
    ds_read_b64_tr_b16 a[218:219], v38 offset:53248
    v_mfma_f32_16x16x32_bf16 v[248:251], a[228:231], a[24:27], v[248:251]
    ds_read_b64_tr_b16 a[220:221], v38 offset:57344
    v_mfma_f32_16x16x32_bf16 v[248:251], a[224:227], a[8:11], v[248:251]
    v_mfma_f32_16x16x32_bf16 v[244:247], a[224:227], a[4:7], v[244:247]
    ds_read_b64_tr_b16 a[222:223], v38 offset:61440
    v_mfma_f32_16x16x32_bf16 v[244:247], a[228:231], a[20:23], v[244:247]
    buffer_load_dwordx4 v9, s[24:27], s75 offen offset:3072 lds
    s_add_u32 s75, s75, 131072
    v_mfma_f32_16x16x32_bf16 v[240:243], a[228:231], a[16:19], v[240:243]
    v_mfma_f32_16x16x32_bf16 v[240:243], a[224:227], a[0:3], v[240:243]
    s_waitcnt vmcnt(27) lgkmcnt(8)
    v_mfma_f32_16x16x32_bf16 v[128:131], a[200:203], a[32:35], v[128:131]
    ds_read_b64_tr_b16 a[224:225], v39 offset:49152
    v_mfma_f32_16x16x32_bf16 v[128:131], a[204:207], a[48:51], v[128:131]
    ds_read_b64_tr_b16 a[226:227], v39 offset:53248
    v_mfma_f32_16x16x32_bf16 v[132:135], a[204:207], a[52:55], v[132:135]
    ds_read_b64_tr_b16 a[228:229], v39 offset:57344
    v_mfma_f32_16x16x32_bf16 v[132:135], a[200:203], a[36:39], v[132:135]
    ds_read_b64_tr_b16 a[230:231], v39 offset:61440
    v_mfma_f32_16x16x32_bf16 v[136:139], a[200:203], a[40:43], v[136:139]
    buffer_load_dwordx4 a[132:135], v3, s[4:7], s73 offen sc1
    v_mfma_f32_16x16x32_bf16 v[136:139], a[204:207], a[56:59], v[136:139]
    buffer_load_dwordx4 a[136:139], v4, s[4:7], s73 offen sc1
    v_mfma_f32_16x16x32_bf16 v[140:143], a[204:207], a[60:63], v[140:143]
    v_mfma_f32_16x16x32_bf16 v[140:143], a[200:203], a[44:47], v[140:143]
    s_waitcnt lgkmcnt(8)
    v_mfma_f32_16x16x32_bf16 v[156:159], a[208:211], a[44:47], v[156:159]
    ds_read_b64_tr_b16 a[200:201], v40 offset:49152
    v_mfma_f32_16x16x32_bf16 v[156:159], a[212:215], a[60:63], v[156:159]
    ds_read_b64_tr_b16 a[202:203], v40 offset:53248
    v_mfma_f32_16x16x32_bf16 v[152:155], a[212:215], a[56:59], v[152:155]
    ds_read_b64_tr_b16 a[204:205], v40 offset:57344
    v_mfma_f32_16x16x32_bf16 v[152:155], a[208:211], a[40:43], v[152:155]
    ds_read_b64_tr_b16 a[206:207], v40 offset:61440
    v_mfma_f32_16x16x32_bf16 v[148:151], a[208:211], a[36:39], v[148:151]
    buffer_load_dwordx4 a[140:143], v5, s[4:7], s73 offen sc1
    s_add_u32 s73, s73, 131072
    v_mfma_f32_16x16x32_bf16 v[148:151], a[212:215], a[52:55], v[148:151]
    buffer_load_dwordx4 a[144:147], v2, s[4:7], s73 offen sc1
    v_mfma_f32_16x16x32_bf16 v[144:147], a[212:215], a[48:51], v[144:147]
    v_mfma_f32_16x16x32_bf16 v[144:147], a[208:211], a[32:35], v[144:147]
    s_waitcnt lgkmcnt(8)
    v_mfma_f32_16x16x32_bf16 v[160:163], a[216:219], a[32:35], v[160:163]
    ds_read_b64_tr_b16 a[208:209], v41 offset:49152
    v_mfma_f32_16x16x32_bf16 v[160:163], a[220:223], a[48:51], v[160:163]
    ds_read_b64_tr_b16 a[210:211], v41 offset:53248
    v_mfma_f32_16x16x32_bf16 v[164:167], a[220:223], a[52:55], v[164:167]
    ds_read_b64_tr_b16 a[212:213], v41 offset:57344
    v_mfma_f32_16x16x32_bf16 v[164:167], a[216:219], a[36:39], v[164:167]
    ds_read_b64_tr_b16 a[214:215], v41 offset:61440
    v_mfma_f32_16x16x32_bf16 v[168:171], a[216:219], a[40:43], v[168:171]
    buffer_load_dwordx4 a[148:151], v3, s[4:7], s73 offen sc1
    v_mfma_f32_16x16x32_bf16 v[168:171], a[220:223], a[56:59], v[168:171]
    buffer_load_dwordx4 a[152:155], v4, s[4:7], s73 offen sc1
    v_mfma_f32_16x16x32_bf16 v[172:175], a[220:223], a[60:63], v[172:175]
    v_mfma_f32_16x16x32_bf16 v[172:175], a[216:219], a[44:47], v[172:175]
    s_waitcnt lgkmcnt(8)
    v_mfma_f32_16x16x32_bf16 v[188:191], a[224:227], a[44:47], v[188:191]
    ds_read_b64_tr_b16 a[216:217], v42 offset:49152
    v_mfma_f32_16x16x32_bf16 v[188:191], a[228:231], a[60:63], v[188:191]
    ds_read_b64_tr_b16 a[218:219], v42 offset:53248
    v_mfma_f32_16x16x32_bf16 v[184:187], a[228:231], a[56:59], v[184:187]
    ds_read_b64_tr_b16 a[220:221], v42 offset:57344
    v_mfma_f32_16x16x32_bf16 v[184:187], a[224:227], a[40:43], v[184:187]
    ds_read_b64_tr_b16 a[222:223], v42 offset:61440
    v_mfma_f32_16x16x32_bf16 v[180:183], a[224:227], a[36:39], v[180:183]
    buffer_load_dwordx4 a[156:159], v5, s[4:7], s73 offen sc1
    s_add_u32 s73, s73, 131072
    v_mfma_f32_16x16x32_bf16 v[180:183], a[228:231], a[52:55], v[180:183]
    buffer_load_dwordx4 a[0:3], v2, s[4:7], s73 offen sc1
    v_mfma_f32_16x16x32_bf16 v[176:179], a[228:231], a[48:51], v[176:179]
    v_mfma_f32_16x16x32_bf16 v[176:179], a[224:227], a[32:35], v[176:179]
    s_waitcnt lgkmcnt(8)
    v_mfma_f32_16x16x32_bf16 v[192:195], a[200:203], a[32:35], v[192:195]
    ds_read_b64_tr_b16 a[224:225], v43 offset:49152
    v_mfma_f32_16x16x32_bf16 v[192:195], a[204:207], a[48:51], v[192:195]
    ds_read_b64_tr_b16 a[226:227], v43 offset:53248
    v_mfma_f32_16x16x32_bf16 v[196:199], a[204:207], a[52:55], v[196:199]
    ds_read_b64_tr_b16 a[228:229], v43 offset:57344
    v_mfma_f32_16x16x32_bf16 v[196:199], a[200:203], a[36:39], v[196:199]
    ds_read_b64_tr_b16 a[230:231], v43 offset:61440
    v_mfma_f32_16x16x32_bf16 v[200:203], a[200:203], a[40:43], v[200:203]
    buffer_load_dwordx4 a[4:7], v3, s[4:7], s73 offen sc1
    v_mfma_f32_16x16x32_bf16 v[200:203], a[204:207], a[56:59], v[200:203]
    buffer_load_dwordx4 a[8:11], v4, s[4:7], s73 offen sc1
    v_mfma_f32_16x16x32_bf16 v[204:207], a[204:207], a[60:63], v[204:207]
    v_mfma_f32_16x16x32_bf16 v[204:207], a[200:203], a[44:47], v[204:207]
    s_waitcnt vmcnt(27) lgkmcnt(0)
    s_barrier
    v_mfma_f32_16x16x32_bf16 v[220:223], a[208:211], a[44:47], v[220:223]
    ds_read_b64_tr_b16 a[200:201], v52 offset:0
    v_mfma_f32_16x16x32_bf16 v[220:223], a[212:215], a[60:63], v[220:223]
    ds_read_b64_tr_b16 a[202:203], v52 offset:4096
    v_mfma_f32_16x16x32_bf16 v[216:219], a[212:215], a[56:59], v[216:219]
    ds_read_b64_tr_b16 a[204:205], v52 offset:8192
    v_mfma_f32_16x16x32_bf16 v[216:219], a[208:211], a[40:43], v[216:219]
    ds_read_b64_tr_b16 a[206:207], v52 offset:12288
    v_mfma_f32_16x16x32_bf16 v[212:215], a[208:211], a[36:39], v[212:215]
    s_add_u32 m0, s66, 16384
    s_nop 0
    buffer_load_dwordx4 v6, s[24:27], s75 offen offset:0 lds
    v_mfma_f32_16x16x32_bf16 v[212:215], a[212:215], a[52:55], v[212:215]
    buffer_load_dwordx4 v7, s[24:27], s75 offen offset:1024 lds
    v_mfma_f32_16x16x32_bf16 v[208:211], a[212:215], a[48:51], v[208:211]
    v_mfma_f32_16x16x32_bf16 v[208:211], a[208:211], a[32:35], v[208:211]
    v_mfma_f32_16x16x32_bf16 v[224:227], a[216:219], a[32:35], v[224:227]
    ds_read_b64_tr_b16 a[208:209], v53 offset:0
    v_mfma_f32_16x16x32_bf16 v[224:227], a[220:223], a[48:51], v[224:227]
    ds_read_b64_tr_b16 a[210:211], v53 offset:4096
    v_mfma_f32_16x16x32_bf16 v[228:231], a[220:223], a[52:55], v[228:231]
    ds_read_b64_tr_b16 a[212:213], v53 offset:8192
    v_mfma_f32_16x16x32_bf16 v[228:231], a[216:219], a[36:39], v[228:231]
    ds_read_b64_tr_b16 a[214:215], v53 offset:12288
    v_mfma_f32_16x16x32_bf16 v[232:235], a[216:219], a[40:43], v[232:235]
    buffer_load_dwordx4 v8, s[24:27], s75 offen offset:2048 lds
    v_mfma_f32_16x16x32_bf16 v[232:235], a[220:223], a[56:59], v[232:235]
    buffer_load_dwordx4 v9, s[24:27], s75 offen offset:3072 lds
    s_add_u32 s75, s75, 131072
    v_mfma_f32_16x16x32_bf16 v[236:239], a[220:223], a[60:63], v[236:239]
    v_mfma_f32_16x16x32_bf16 v[236:239], a[216:219], a[44:47], v[236:239]
    v_mfma_f32_16x16x32_bf16 v[252:255], a[224:227], a[44:47], v[252:255]
    ds_read_b64_tr_b16 a[216:217], v54 offset:0
    v_mfma_f32_16x16x32_bf16 v[252:255], a[228:231], a[60:63], v[252:255]
    ds_read_b64_tr_b16 a[218:219], v54 offset:4096
    v_mfma_f32_16x16x32_bf16 v[248:251], a[228:231], a[56:59], v[248:251]
    ds_read_b64_tr_b16 a[220:221], v54 offset:8192
    v_mfma_f32_16x16x32_bf16 v[248:251], a[224:227], a[40:43], v[248:251]
    v_mfma_f32_16x16x32_bf16 v[244:247], a[224:227], a[36:39], v[244:247]
    ds_read_b64_tr_b16 a[222:223], v54 offset:12288
    v_mfma_f32_16x16x32_bf16 v[244:247], a[228:231], a[52:55], v[244:247]
    s_add_u32 m0, s66, 32768
    s_nop 0
    buffer_load_dwordx4 v6, s[24:27], s75 offen offset:0 lds
    v_mfma_f32_16x16x32_bf16 v[240:243], a[228:231], a[48:51], v[240:243]
    v_mfma_f32_16x16x32_bf16 v[240:243], a[224:227], a[32:35], v[240:243]
    s_waitcnt lgkmcnt(8)
    v_mfma_f32_16x16x32_bf16 v[128:131], a[200:203], a[64:67], v[128:131]
    ds_read_b64_tr_b16 a[224:225], v55 offset:0
    v_mfma_f32_16x16x32_bf16 v[128:131], a[204:207], a[80:83], v[128:131]
    ds_read_b64_tr_b16 a[226:227], v55 offset:4096
    v_mfma_f32_16x16x32_bf16 v[132:135], a[204:207], a[84:87], v[132:135]
    ds_read_b64_tr_b16 a[228:229], v55 offset:8192
    v_mfma_f32_16x16x32_bf16 v[132:135], a[200:203], a[68:71], v[132:135]
    ds_read_b64_tr_b16 a[230:231], v55 offset:12288
    v_mfma_f32_16x16x32_bf16 v[136:139], a[200:203], a[72:75], v[136:139]
    buffer_load_dwordx4 a[12:15], v5, s[4:7], s73 offen sc1
    s_add_u32 s73, s73, 131072
    v_mfma_f32_16x16x32_bf16 v[136:139], a[204:207], a[88:91], v[136:139]
    buffer_load_dwordx4 a[16:19], v2, s[4:7], s73 offen sc1
    v_mfma_f32_16x16x32_bf16 v[140:143], a[204:207], a[92:95], v[140:143]
    v_mfma_f32_16x16x32_bf16 v[140:143], a[200:203], a[76:79], v[140:143]
    s_waitcnt lgkmcnt(8)
    v_mfma_f32_16x16x32_bf16 v[156:159], a[208:211], a[76:79], v[156:159]
    ds_read_b64_tr_b16 a[200:201], v56 offset:0
    v_mfma_f32_16x16x32_bf16 v[156:159], a[212:215], a[92:95], v[156:159]
    ds_read_b64_tr_b16 a[202:203], v56 offset:4096
    v_mfma_f32_16x16x32_bf16 v[152:155], a[212:215], a[88:91], v[152:155]
    ds_read_b64_tr_b16 a[204:205], v56 offset:8192
    v_mfma_f32_16x16x32_bf16 v[152:155], a[208:211], a[72:75], v[152:155]
    ds_read_b64_tr_b16 a[206:207], v56 offset:12288
    v_mfma_f32_16x16x32_bf16 v[148:151], a[208:211], a[68:71], v[148:151]
    buffer_load_dwordx4 a[20:23], v3, s[4:7], s73 offen sc1
    v_mfma_f32_16x16x32_bf16 v[148:151], a[212:215], a[84:87], v[148:151]
    buffer_load_dwordx4 a[24:27], v4, s[4:7], s73 offen sc1
    v_mfma_f32_16x16x32_bf16 v[144:147], a[212:215], a[80:83], v[144:147]
    v_mfma_f32_16x16x32_bf16 v[144:147], a[208:211], a[64:67], v[144:147]
    s_waitcnt lgkmcnt(8)
    v_mfma_f32_16x16x32_bf16 v[160:163], a[216:219], a[64:67], v[160:163]
    ds_read_b64_tr_b16 a[208:209], v57 offset:0
    v_mfma_f32_16x16x32_bf16 v[160:163], a[220:223], a[80:83], v[160:163]
    ds_read_b64_tr_b16 a[210:211], v57 offset:4096
    v_mfma_f32_16x16x32_bf16 v[164:167], a[220:223], a[84:87], v[164:167]
    ds_read_b64_tr_b16 a[212:213], v57 offset:8192
    v_mfma_f32_16x16x32_bf16 v[164:167], a[216:219], a[68:71], v[164:167]
    ds_read_b64_tr_b16 a[214:215], v57 offset:12288
    v_mfma_f32_16x16x32_bf16 v[168:171], a[216:219], a[72:75], v[168:171]
    buffer_load_dwordx4 a[28:31], v5, s[4:7], s73 offen sc1
    s_add_u32 s73, s73, 131072
    v_mfma_f32_16x16x32_bf16 v[168:171], a[220:223], a[88:91], v[168:171]
    buffer_load_dwordx4 a[32:35], v2, s[4:7], s73 offen sc1
    v_mfma_f32_16x16x32_bf16 v[172:175], a[220:223], a[92:95], v[172:175]
    v_mfma_f32_16x16x32_bf16 v[172:175], a[216:219], a[76:79], v[172:175]
    s_waitcnt lgkmcnt(8)
    v_mfma_f32_16x16x32_bf16 v[188:191], a[224:227], a[76:79], v[188:191]
    ds_read_b64_tr_b16 a[216:217], v58 offset:0
    v_mfma_f32_16x16x32_bf16 v[188:191], a[228:231], a[92:95], v[188:191]
    ds_read_b64_tr_b16 a[218:219], v58 offset:4096
    v_mfma_f32_16x16x32_bf16 v[184:187], a[228:231], a[88:91], v[184:187]
    ds_read_b64_tr_b16 a[220:221], v58 offset:8192
    v_mfma_f32_16x16x32_bf16 v[184:187], a[224:227], a[72:75], v[184:187]
    v_mfma_f32_16x16x32_bf16 v[180:183], a[224:227], a[68:71], v[180:183]
    ds_read_b64_tr_b16 a[222:223], v58 offset:12288
    v_mfma_f32_16x16x32_bf16 v[180:183], a[228:231], a[84:87], v[180:183]
    buffer_load_dwordx4 a[36:39], v3, s[4:7], s73 offen sc1
    v_mfma_f32_16x16x32_bf16 v[176:179], a[228:231], a[80:83], v[176:179]
    v_mfma_f32_16x16x32_bf16 v[176:179], a[224:227], a[64:67], v[176:179]
    s_waitcnt lgkmcnt(8)
    v_mfma_f32_16x16x32_bf16 v[192:195], a[200:203], a[64:67], v[192:195]
    ds_read_b64_tr_b16 a[224:225], v59 offset:0
    v_mfma_f32_16x16x32_bf16 v[192:195], a[204:207], a[80:83], v[192:195]
    ds_read_b64_tr_b16 a[226:227], v59 offset:4096
    v_mfma_f32_16x16x32_bf16 v[196:199], a[204:207], a[84:87], v[196:199]
    ds_read_b64_tr_b16 a[228:229], v59 offset:8192
    v_mfma_f32_16x16x32_bf16 v[196:199], a[200:203], a[68:71], v[196:199]
    ds_read_b64_tr_b16 a[230:231], v59 offset:12288
    v_mfma_f32_16x16x32_bf16 v[200:203], a[200:203], a[72:75], v[200:203]
    buffer_load_dwordx4 a[40:43], v4, s[4:7], s73 offen sc1
    v_mfma_f32_16x16x32_bf16 v[200:203], a[204:207], a[88:91], v[200:203]
    buffer_load_dwordx4 a[44:47], v5, s[4:7], s73 offen sc1
    s_add_u32 s73, s73, 131072
    v_mfma_f32_16x16x32_bf16 v[204:207], a[204:207], a[92:95], v[204:207]
    v_mfma_f32_16x16x32_bf16 v[204:207], a[200:203], a[76:79], v[204:207]
    s_waitcnt vmcnt(28) lgkmcnt(0)
    s_barrier
    v_mfma_f32_16x16x32_bf16 v[220:223], a[208:211], a[76:79], v[220:223]
    ds_read_b64_tr_b16 a[200:201], v52 offset:16384
    v_mfma_f32_16x16x32_bf16 v[220:223], a[212:215], a[92:95], v[220:223]
    ds_read_b64_tr_b16 a[202:203], v52 offset:20480
    v_mfma_f32_16x16x32_bf16 v[216:219], a[212:215], a[88:91], v[216:219]
    ds_read_b64_tr_b16 a[204:205], v52 offset:24576
    v_mfma_f32_16x16x32_bf16 v[216:219], a[208:211], a[72:75], v[216:219]
    ds_read_b64_tr_b16 a[206:207], v52 offset:28672
    v_mfma_f32_16x16x32_bf16 v[212:215], a[208:211], a[68:71], v[212:215]
    buffer_load_dwordx4 v7, s[24:27], s75 offen offset:1024 lds
    v_mfma_f32_16x16x32_bf16 v[212:215], a[212:215], a[84:87], v[212:215]
    buffer_load_dwordx4 v8, s[24:27], s75 offen offset:2048 lds
    v_mfma_f32_16x16x32_bf16 v[208:211], a[212:215], a[80:83], v[208:211]
    v_mfma_f32_16x16x32_bf16 v[208:211], a[208:211], a[64:67], v[208:211]
    v_mfma_f32_16x16x32_bf16 v[224:227], a[216:219], a[64:67], v[224:227]
    ds_read_b64_tr_b16 a[208:209], v53 offset:16384
    v_mfma_f32_16x16x32_bf16 v[224:227], a[220:223], a[80:83], v[224:227]
    ds_read_b64_tr_b16 a[210:211], v53 offset:20480
    v_mfma_f32_16x16x32_bf16 v[228:231], a[220:223], a[84:87], v[228:231]
    ds_read_b64_tr_b16 a[212:213], v53 offset:24576
    v_mfma_f32_16x16x32_bf16 v[228:231], a[216:219], a[68:71], v[228:231]
    ds_read_b64_tr_b16 a[214:215], v53 offset:28672
    v_mfma_f32_16x16x32_bf16 v[232:235], a[216:219], a[72:75], v[232:235]
    buffer_load_dwordx4 v9, s[24:27], s75 offen offset:3072 lds
    s_add_u32 s75, s75, 131072
    v_mfma_f32_16x16x32_bf16 v[232:235], a[220:223], a[88:91], v[232:235]
    s_add_u32 m0, s66, 49152
    s_add_u32 s85, s75, s81
    buffer_load_dwordx4 v6, s[24:27], s85 offen offset:0 lds
    v_mfma_f32_16x16x32_bf16 v[236:239], a[220:223], a[92:95], v[236:239]
    v_mfma_f32_16x16x32_bf16 v[236:239], a[216:219], a[76:79], v[236:239]
    v_mfma_f32_16x16x32_bf16 v[252:255], a[224:227], a[76:79], v[252:255]
    ds_read_b64_tr_b16 a[216:217], v54 offset:16384
    v_mfma_f32_16x16x32_bf16 v[252:255], a[228:231], a[92:95], v[252:255]
    ds_read_b64_tr_b16 a[218:219], v54 offset:20480
    v_mfma_f32_16x16x32_bf16 v[248:251], a[228:231], a[88:91], v[248:251]
    ds_read_b64_tr_b16 a[220:221], v54 offset:24576
    v_mfma_f32_16x16x32_bf16 v[248:251], a[224:227], a[72:75], v[248:251]
    v_mfma_f32_16x16x32_bf16 v[244:247], a[224:227], a[68:71], v[244:247]
    ds_read_b64_tr_b16 a[222:223], v54 offset:28672
    v_mfma_f32_16x16x32_bf16 v[244:247], a[228:231], a[84:87], v[244:247]
    s_add_u32 s85, s85, s82
    buffer_load_dwordx4 v7, s[24:27], s85 offen offset:1024 lds
    v_mfma_f32_16x16x32_bf16 v[240:243], a[228:231], a[80:83], v[240:243]
    v_mfma_f32_16x16x32_bf16 v[240:243], a[224:227], a[64:67], v[240:243]
    buffer_load_dword v48, v29, s[4:7], s61 offen offset:32 sc1
    s_waitcnt lgkmcnt(8)
    v_mfma_f32_16x16x32_bf16 v[128:131], a[200:203], a[96:99], v[128:131]
    ds_read_b64_tr_b16 a[224:225], v55 offset:16384
    v_mfma_f32_16x16x32_bf16 v[128:131], a[204:207], a[112:115], v[128:131]
    ds_read_b64_tr_b16 a[226:227], v55 offset:20480
    v_mfma_f32_16x16x32_bf16 v[132:135], a[204:207], a[116:119], v[132:135]
    ds_read_b64_tr_b16 a[228:229], v55 offset:24576
    v_mfma_f32_16x16x32_bf16 v[132:135], a[200:203], a[100:103], v[132:135]
    ds_read_b64_tr_b16 a[230:231], v55 offset:28672
    v_mfma_f32_16x16x32_bf16 v[136:139], a[200:203], a[104:107], v[136:139]
    buffer_load_dwordx4 a[48:51], v2, s[4:7], s73 offen sc1
    v_mfma_f32_16x16x32_bf16 v[136:139], a[204:207], a[120:123], v[136:139]
    buffer_load_dwordx4 a[52:55], v3, s[4:7], s73 offen sc1
    v_mfma_f32_16x16x32_bf16 v[140:143], a[204:207], a[124:127], v[140:143]
    v_mfma_f32_16x16x32_bf16 v[140:143], a[200:203], a[108:111], v[140:143]
    s_waitcnt lgkmcnt(8)
    v_mfma_f32_16x16x32_bf16 v[156:159], a[208:211], a[108:111], v[156:159]
    ds_read_b64_tr_b16 a[200:201], v56 offset:16384
    v_mfma_f32_16x16x32_bf16 v[156:159], a[212:215], a[124:127], v[156:159]
    ds_read_b64_tr_b16 a[202:203], v56 offset:20480
    v_mfma_f32_16x16x32_bf16 v[152:155], a[212:215], a[120:123], v[152:155]
    ds_read_b64_tr_b16 a[204:205], v56 offset:24576
    v_mfma_f32_16x16x32_bf16 v[152:155], a[208:211], a[104:107], v[152:155]
    ds_read_b64_tr_b16 a[206:207], v56 offset:28672
    v_mfma_f32_16x16x32_bf16 v[148:151], a[208:211], a[100:103], v[148:151]
    buffer_load_dwordx4 a[56:59], v4, s[4:7], s73 offen sc1
    v_mfma_f32_16x16x32_bf16 v[148:151], a[212:215], a[116:119], v[148:151]
    buffer_load_dwordx4 a[60:63], v5, s[4:7], s73 offen sc1
    s_add_u32 s73, s73, 131072
    v_mfma_f32_16x16x32_bf16 v[144:147], a[212:215], a[112:115], v[144:147]
    v_mfma_f32_16x16x32_bf16 v[144:147], a[208:211], a[96:99], v[144:147]
    s_waitcnt lgkmcnt(8)
    v_mfma_f32_16x16x32_bf16 v[160:163], a[216:219], a[96:99], v[160:163]
    ds_read_b64_tr_b16 a[208:209], v57 offset:16384
    v_mfma_f32_16x16x32_bf16 v[160:163], a[220:223], a[112:115], v[160:163]
    ds_read_b64_tr_b16 a[210:211], v57 offset:20480
    v_mfma_f32_16x16x32_bf16 v[164:167], a[220:223], a[116:119], v[164:167]
    ds_read_b64_tr_b16 a[212:213], v57 offset:24576
    v_mfma_f32_16x16x32_bf16 v[164:167], a[216:219], a[100:103], v[164:167]
    ds_read_b64_tr_b16 a[214:215], v57 offset:28672
    v_mfma_f32_16x16x32_bf16 v[168:171], a[216:219], a[104:107], v[168:171]
    buffer_load_dwordx4 a[64:67], v2, s[4:7], s73 offen sc1
    v_mfma_f32_16x16x32_bf16 v[168:171], a[220:223], a[120:123], v[168:171]
    buffer_load_dwordx4 a[68:71], v3, s[4:7], s73 offen sc1
    v_mfma_f32_16x16x32_bf16 v[172:175], a[220:223], a[124:127], v[172:175]
    v_mfma_f32_16x16x32_bf16 v[172:175], a[216:219], a[108:111], v[172:175]
    s_waitcnt lgkmcnt(8)
    v_mfma_f32_16x16x32_bf16 v[188:191], a[224:227], a[108:111], v[188:191]
    ds_read_b64_tr_b16 a[216:217], v58 offset:16384
    v_mfma_f32_16x16x32_bf16 v[188:191], a[228:231], a[124:127], v[188:191]
    ds_read_b64_tr_b16 a[218:219], v58 offset:20480
    v_mfma_f32_16x16x32_bf16 v[184:187], a[228:231], a[120:123], v[184:187]
    ds_read_b64_tr_b16 a[220:221], v58 offset:24576
    v_mfma_f32_16x16x32_bf16 v[184:187], a[224:227], a[104:107], v[184:187]
    ds_read_b64_tr_b16 a[222:223], v58 offset:28672
    v_mfma_f32_16x16x32_bf16 v[180:183], a[224:227], a[100:103], v[180:183]
    buffer_load_dwordx4 a[72:75], v4, s[4:7], s73 offen sc1
    v_mfma_f32_16x16x32_bf16 v[180:183], a[228:231], a[116:119], v[180:183]
    buffer_load_dwordx4 a[76:79], v5, s[4:7], s73 offen sc1
    s_add_u32 s73, s73, 131072
    v_mfma_f32_16x16x32_bf16 v[176:179], a[228:231], a[112:115], v[176:179]
    v_mfma_f32_16x16x32_bf16 v[176:179], a[224:227], a[96:99], v[176:179]
    s_waitcnt lgkmcnt(8)
    v_mfma_f32_16x16x32_bf16 v[192:195], a[200:203], a[96:99], v[192:195]
    ds_read_b64_tr_b16 a[224:225], v59 offset:16384
    v_mfma_f32_16x16x32_bf16 v[192:195], a[204:207], a[112:115], v[192:195]
    ds_read_b64_tr_b16 a[226:227], v59 offset:20480
    v_mfma_f32_16x16x32_bf16 v[196:199], a[204:207], a[116:119], v[196:199]
    ds_read_b64_tr_b16 a[228:229], v59 offset:24576
    v_mfma_f32_16x16x32_bf16 v[196:199], a[200:203], a[100:103], v[196:199]
    ds_read_b64_tr_b16 a[230:231], v59 offset:28672
    v_mfma_f32_16x16x32_bf16 v[200:203], a[200:203], a[104:107], v[200:203]
    buffer_load_dwordx4 a[80:83], v2, s[4:7], s73 offen sc1
    v_mfma_f32_16x16x32_bf16 v[200:203], a[204:207], a[120:123], v[200:203]
    buffer_load_dwordx4 a[84:87], v3, s[4:7], s73 offen sc1
    v_mfma_f32_16x16x32_bf16 v[204:207], a[204:207], a[124:127], v[204:207]
    v_mfma_f32_16x16x32_bf16 v[204:207], a[200:203], a[108:111], v[204:207]
    s_waitcnt vmcnt(40) lgkmcnt(0)
    s_barrier
    v_mfma_f32_16x16x32_bf16 v[220:223], a[208:211], a[108:111], v[220:223]
    ds_read_b64_tr_b16 a[200:201], v36 offset:0
    v_mfma_f32_16x16x32_bf16 v[220:223], a[212:215], a[124:127], v[220:223]
    ds_read_b64_tr_b16 a[202:203], v36 offset:4096
    v_mfma_f32_16x16x32_bf16 v[216:219], a[212:215], a[120:123], v[216:219]
    ds_read_b64_tr_b16 a[204:205], v36 offset:8192
    v_mfma_f32_16x16x32_bf16 v[216:219], a[208:211], a[104:107], v[216:219]
    ds_read_b64_tr_b16 a[206:207], v36 offset:12288
    v_mfma_f32_16x16x32_bf16 v[212:215], a[208:211], a[100:103], v[212:215]
    s_add_u32 s85, s85, s82
    buffer_load_dwordx4 v8, s[24:27], s85 offen offset:2048 lds
    v_mfma_f32_16x16x32_bf16 v[212:215], a[212:215], a[116:119], v[212:215]
    s_add_u32 s85, s85, s82
    buffer_load_dwordx4 v9, s[24:27], s85 offen offset:3072 lds
    s_add_u32 s75, s75, 131072
    v_mfma_f32_16x16x32_bf16 v[208:211], a[212:215], a[112:115], v[208:211]
    v_mfma_f32_16x16x32_bf16 v[208:211], a[208:211], a[96:99], v[208:211]
    v_mfma_f32_16x16x32_bf16 v[224:227], a[216:219], a[96:99], v[224:227]
    ds_read_b64_tr_b16 a[208:209], v37 offset:0
    v_mfma_f32_16x16x32_bf16 v[224:227], a[220:223], a[112:115], v[224:227]
    ds_read_b64_tr_b16 a[210:211], v37 offset:4096
    v_mfma_f32_16x16x32_bf16 v[228:231], a[220:223], a[116:119], v[228:231]
    ds_read_b64_tr_b16 a[212:213], v37 offset:8192
    v_mfma_f32_16x16x32_bf16 v[228:231], a[216:219], a[100:103], v[228:231]
    ds_read_b64_tr_b16 a[214:215], v37 offset:12288
    v_mfma_f32_16x16x32_bf16 v[232:235], a[216:219], a[104:107], v[232:235]
    s_add_u32 m0, s66, 65536
    s_nop 0
    buffer_load_dwordx4 v6, s[24:27], s75 offen offset:0 lds
    v_mfma_f32_16x16x32_bf16 v[232:235], a[220:223], a[120:123], v[232:235]
    buffer_load_dwordx4 v7, s[24:27], s75 offen offset:1024 lds
    v_mfma_f32_16x16x32_bf16 v[236:239], a[220:223], a[124:127], v[236:239]
    v_mfma_f32_16x16x32_bf16 v[236:239], a[216:219], a[108:111], v[236:239]
    v_mfma_f32_16x16x32_bf16 v[252:255], a[224:227], a[108:111], v[252:255]
    ds_read_b64_tr_b16 a[216:217], v38 offset:0
    v_mfma_f32_16x16x32_bf16 v[252:255], a[228:231], a[124:127], v[252:255]
    ds_read_b64_tr_b16 a[218:219], v38 offset:4096
    v_mfma_f32_16x16x32_bf16 v[248:251], a[228:231], a[120:123], v[248:251]
    ds_read_b64_tr_b16 a[220:221], v38 offset:8192
    v_mfma_f32_16x16x32_bf16 v[248:251], a[224:227], a[104:107], v[248:251]
    v_mfma_f32_16x16x32_bf16 v[244:247], a[224:227], a[100:103], v[244:247]
    ds_read_b64_tr_b16 a[222:223], v38 offset:12288
    v_mfma_f32_16x16x32_bf16 v[244:247], a[228:231], a[116:119], v[244:247]
    buffer_load_dwordx4 v8, s[24:27], s75 offen offset:2048 lds
    v_mfma_f32_16x16x32_bf16 v[240:243], a[228:231], a[112:115], v[240:243]
    v_mfma_f32_16x16x32_bf16 v[240:243], a[224:227], a[96:99], v[240:243]
    s_waitcnt vmcnt(38) lgkmcnt(8)
    v_mfma_f32_16x16x32_bf16 v[128:131], a[200:203], a[128:131], v[128:131]
    ds_read_b64_tr_b16 a[224:225], v39 offset:0
    v_mfma_f32_16x16x32_bf16 v[128:131], a[204:207], a[144:147], v[128:131]
    ds_read_b64_tr_b16 a[226:227], v39 offset:4096
    v_mfma_f32_16x16x32_bf16 v[132:135], a[204:207], a[148:151], v[132:135]
    ds_read_b64_tr_b16 a[228:229], v39 offset:8192
    v_mfma_f32_16x16x32_bf16 v[132:135], a[200:203], a[132:135], v[132:135]
    ds_read_b64_tr_b16 a[230:231], v39 offset:12288
    v_mfma_f32_16x16x32_bf16 v[136:139], a[200:203], a[136:139], v[136:139]
    buffer_load_dwordx4 a[88:91], v4, s[4:7], s73 offen sc1
    v_mfma_f32_16x16x32_bf16 v[136:139], a[204:207], a[152:155], v[136:139]
    buffer_load_dwordx4 a[92:95], v5, s[4:7], s73 offen sc1
    s_add_u32 s73, s73, 131072
    v_mfma_f32_16x16x32_bf16 v[140:143], a[204:207], a[156:159], v[140:143]
    v_mfma_f32_16x16x32_bf16 v[140:143], a[200:203], a[140:143], v[140:143]
    s_waitcnt lgkmcnt(8)
    v_mfma_f32_16x16x32_bf16 v[156:159], a[208:211], a[140:143], v[156:159]
    ds_read_b64_tr_b16 a[200:201], v40 offset:0
    v_mfma_f32_16x16x32_bf16 v[156:159], a[212:215], a[156:159], v[156:159]
    ds_read_b64_tr_b16 a[202:203], v40 offset:4096
    v_mfma_f32_16x16x32_bf16 v[152:155], a[212:215], a[152:155], v[152:155]
    ds_read_b64_tr_b16 a[204:205], v40 offset:8192
    v_mfma_f32_16x16x32_bf16 v[152:155], a[208:211], a[136:139], v[152:155]
    ds_read_b64_tr_b16 a[206:207], v40 offset:12288
    v_mfma_f32_16x16x32_bf16 v[148:151], a[208:211], a[132:135], v[148:151]
    buffer_load_dwordx4 a[96:99], v2, s[4:7], s73 offen sc1
    v_mfma_f32_16x16x32_bf16 v[148:151], a[212:215], a[148:151], v[148:151]
    buffer_load_dwordx4 a[100:103], v3, s[4:7], s73 offen sc1
    v_mfma_f32_16x16x32_bf16 v[144:147], a[212:215], a[144:147], v[144:147]
    v_mfma_f32_16x16x32_bf16 v[144:147], a[208:211], a[128:131], v[144:147]
    s_waitcnt lgkmcnt(8)
    v_mfma_f32_16x16x32_bf16 v[160:163], a[216:219], a[128:131], v[160:163]
    ds_read_b64_tr_b16 a[208:209], v41 offset:0
    v_mfma_f32_16x16x32_bf16 v[160:163], a[220:223], a[144:147], v[160:163]
    ds_read_b64_tr_b16 a[210:211], v41 offset:4096
    v_mfma_f32_16x16x32_bf16 v[164:167], a[220:223], a[148:151], v[164:167]
    ds_read_b64_tr_b16 a[212:213], v41 offset:8192
    v_mfma_f32_16x16x32_bf16 v[164:167], a[216:219], a[132:135], v[164:167]
    ds_read_b64_tr_b16 a[214:215], v41 offset:12288
    v_mfma_f32_16x16x32_bf16 v[168:171], a[216:219], a[136:139], v[168:171]
    buffer_load_dwordx4 a[104:107], v4, s[4:7], s73 offen sc1
    v_mfma_f32_16x16x32_bf16 v[168:171], a[220:223], a[152:155], v[168:171]
    buffer_load_dwordx4 a[108:111], v5, s[4:7], s73 offen sc1
    s_add_u32 s73, s73, 131072
    v_mfma_f32_16x16x32_bf16 v[172:175], a[220:223], a[156:159], v[172:175]
    v_mfma_f32_16x16x32_bf16 v[172:175], a[216:219], a[140:143], v[172:175]
    s_waitcnt lgkmcnt(8)
    v_mfma_f32_16x16x32_bf16 v[188:191], a[224:227], a[140:143], v[188:191]
    ds_read_b64_tr_b16 a[216:217], v42 offset:0
    v_mfma_f32_16x16x32_bf16 v[188:191], a[228:231], a[156:159], v[188:191]
    ds_read_b64_tr_b16 a[218:219], v42 offset:4096
    v_mfma_f32_16x16x32_bf16 v[184:187], a[228:231], a[152:155], v[184:187]
    ds_read_b64_tr_b16 a[220:221], v42 offset:8192
    v_mfma_f32_16x16x32_bf16 v[184:187], a[224:227], a[136:139], v[184:187]
    ds_read_b64_tr_b16 a[222:223], v42 offset:12288
    v_mfma_f32_16x16x32_bf16 v[180:183], a[224:227], a[132:135], v[180:183]
    buffer_load_dwordx4 a[112:115], v2, s[4:7], s73 offen sc1
    v_mfma_f32_16x16x32_bf16 v[180:183], a[228:231], a[148:151], v[180:183]
    buffer_load_dwordx4 a[116:119], v3, s[4:7], s73 offen sc1
    v_mfma_f32_16x16x32_bf16 v[176:179], a[228:231], a[144:147], v[176:179]
    v_mfma_f32_16x16x32_bf16 v[176:179], a[224:227], a[128:131], v[176:179]
    s_waitcnt lgkmcnt(8)
    v_mfma_f32_16x16x32_bf16 v[192:195], a[200:203], a[128:131], v[192:195]
    ds_read_b64_tr_b16 a[224:225], v43 offset:0
    v_mfma_f32_16x16x32_bf16 v[192:195], a[204:207], a[144:147], v[192:195]
    ds_read_b64_tr_b16 a[226:227], v43 offset:4096
    v_mfma_f32_16x16x32_bf16 v[196:199], a[204:207], a[148:151], v[196:199]
    ds_read_b64_tr_b16 a[228:229], v43 offset:8192
    v_mfma_f32_16x16x32_bf16 v[196:199], a[200:203], a[132:135], v[196:199]
    ds_read_b64_tr_b16 a[230:231], v43 offset:12288
    v_mfma_f32_16x16x32_bf16 v[200:203], a[200:203], a[136:139], v[200:203]
    buffer_load_dwordx4 a[120:123], v4, s[4:7], s73 offen sc1
    v_mfma_f32_16x16x32_bf16 v[200:203], a[204:207], a[152:155], v[200:203]
    buffer_load_dwordx4 a[124:127], v5, s[4:7], s73 offen sc1
    s_mov_b32 s73, s74
    v_mfma_f32_16x16x32_bf16 v[204:207], a[204:207], a[156:159], v[204:207]
    v_mfma_f32_16x16x32_bf16 v[204:207], a[200:203], a[140:143], v[204:207]
    s_waitcnt vmcnt(41) lgkmcnt(0)
    s_barrier
    v_mfma_f32_16x16x32_bf16 v[220:223], a[208:211], a[140:143], v[220:223]
    ds_read_b64_tr_b16 a[200:201], v36 offset:16384
    v_mfma_f32_16x16x32_bf16 v[220:223], a[212:215], a[156:159], v[220:223]
    ds_read_b64_tr_b16 a[202:203], v36 offset:20480
    v_mfma_f32_16x16x32_bf16 v[216:219], a[212:215], a[152:155], v[216:219]
    ds_read_b64_tr_b16 a[204:205], v36 offset:24576
    v_mfma_f32_16x16x32_bf16 v[216:219], a[208:211], a[136:139], v[216:219]
    ds_read_b64_tr_b16 a[206:207], v36 offset:28672
    v_mfma_f32_16x16x32_bf16 v[212:215], a[208:211], a[132:135], v[212:215]
    buffer_load_dwordx4 v9, s[24:27], s75 offen offset:3072 lds
    s_mov_b32 s75, s76
    v_mfma_f32_16x16x32_bf16 v[212:215], a[212:215], a[148:151], v[212:215]
    s_add_u32 m0, s66, 81920
    s_nop 0
    buffer_load_dwordx4 v6, s[28:31], s75 offen offset:0 lds
    v_mfma_f32_16x16x32_bf16 v[208:211], a[212:215], a[144:147], v[208:211]
    v_mfma_f32_16x16x32_bf16 v[208:211], a[208:211], a[128:131], v[208:211]
    v_mfma_f32_16x16x32_bf16 v[224:227], a[216:219], a[128:131], v[224:227]
    ds_read_b64_tr_b16 a[208:209], v37 offset:16384
    v_mfma_f32_16x16x32_bf16 v[224:227], a[220:223], a[144:147], v[224:227]
    ds_read_b64_tr_b16 a[210:211], v37 offset:20480
    v_mfma_f32_16x16x32_bf16 v[228:231], a[220:223], a[148:151], v[228:231]
    ds_read_b64_tr_b16 a[212:213], v37 offset:24576
    v_mfma_f32_16x16x32_bf16 v[228:231], a[216:219], a[132:135], v[228:231]
    ds_read_b64_tr_b16 a[214:215], v37 offset:28672
    v_mfma_f32_16x16x32_bf16 v[232:235], a[216:219], a[136:139], v[232:235]
    buffer_load_dwordx4 v7, s[28:31], s75 offen offset:1024 lds
    v_mfma_f32_16x16x32_bf16 v[232:235], a[220:223], a[152:155], v[232:235]
    buffer_load_dwordx4 v8, s[28:31], s75 offen offset:2048 lds
    v_mfma_f32_16x16x32_bf16 v[236:239], a[220:223], a[156:159], v[236:239]
    v_mfma_f32_16x16x32_bf16 v[236:239], a[216:219], a[140:143], v[236:239]
    v_mfma_f32_16x16x32_bf16 v[252:255], a[224:227], a[140:143], v[252:255]
    ds_read_b64_tr_b16 a[216:217], v38 offset:16384
    v_mfma_f32_16x16x32_bf16 v[252:255], a[228:231], a[156:159], v[252:255]
    ds_read_b64_tr_b16 a[218:219], v38 offset:20480
    v_mfma_f32_16x16x32_bf16 v[248:251], a[228:231], a[152:155], v[248:251]
    ds_read_b64_tr_b16 a[220:221], v38 offset:24576
    v_mfma_f32_16x16x32_bf16 v[248:251], a[224:227], a[136:139], v[248:251]
    v_mfma_f32_16x16x32_bf16 v[244:247], a[224:227], a[132:135], v[244:247]
    ds_read_b64_tr_b16 a[222:223], v38 offset:28672
    v_mfma_f32_16x16x32_bf16 v[244:247], a[228:231], a[148:151], v[244:247]
    buffer_load_dwordx4 v9, s[28:31], s75 offen offset:3072 lds
    s_add_u32 s75, s75, 131072
    v_mfma_f32_16x16x32_bf16 v[240:243], a[228:231], a[144:147], v[240:243]
    v_mfma_f32_16x16x32_bf16 v[240:243], a[224:227], a[128:131], v[240:243]
    s_waitcnt vmcnt(30)
    v_cmp_ne_u32 vcc, 1, v48
    s_cmp_eq_u64 vcc, 0
    s_cbranch_scc1 L_poo_ok_parallel_sum__sliding_block__glu_gated_swiglu__prompt_kernel
L_poo_parallel_sum__sliding_block__glu_gated_swiglu__prompt_kernel:
    s_add_u32 s1, s1, 1
    s_cmp_gt_u32 s1, 0x400000
    s_cbranch_scc1 L_end_parallel_sum__sliding_block__glu_gated_swiglu__prompt_kernel
    buffer_load_dword v48, v29, s[4:7], s61 offen offset:32 sc1
    s_waitcnt vmcnt(0)
    v_cmp_ne_u32 vcc, 1, v48
    s_cmp_eq_u64 vcc, 0
    s_cbranch_scc0 L_poo_parallel_sum__sliding_block__glu_gated_swiglu__prompt_kernel
L_poo_ok_parallel_sum__sliding_block__glu_gated_swiglu__prompt_kernel:
    s_waitcnt lgkmcnt(8)
    v_mfma_f32_16x16x32_bf16 v[128:131], a[200:203], a[0:3], v[128:131]
    ds_read_b64_tr_b16 a[224:225], v39 offset:16384
    v_mfma_f32_16x16x32_bf16 v[128:131], a[204:207], a[16:19], v[128:131]
    ds_read_b64_tr_b16 a[226:227], v39 offset:20480
    v_mfma_f32_16x16x32_bf16 v[132:135], a[204:207], a[20:23], v[132:135]
    ds_read_b64_tr_b16 a[228:229], v39 offset:24576
    v_mfma_f32_16x16x32_bf16 v[132:135], a[200:203], a[4:7], v[132:135]
    ds_read_b64_tr_b16 a[230:231], v39 offset:28672
    v_mfma_f32_16x16x32_bf16 v[136:139], a[200:203], a[8:11], v[136:139]
    buffer_load_dwordx4 a[128:131], v2, s[4:7], s73 offen sc1
    v_mfma_f32_16x16x32_bf16 v[136:139], a[204:207], a[24:27], v[136:139]
    buffer_load_dwordx4 a[132:135], v3, s[4:7], s73 offen sc1
    v_mfma_f32_16x16x32_bf16 v[140:143], a[204:207], a[28:31], v[140:143]
    v_mfma_f32_16x16x32_bf16 v[140:143], a[200:203], a[12:15], v[140:143]
    s_waitcnt lgkmcnt(8)
    v_mfma_f32_16x16x32_bf16 v[156:159], a[208:211], a[12:15], v[156:159]
    ds_read_b64_tr_b16 a[200:201], v40 offset:16384
    v_mfma_f32_16x16x32_bf16 v[156:159], a[212:215], a[28:31], v[156:159]
    ds_read_b64_tr_b16 a[202:203], v40 offset:20480
    v_mfma_f32_16x16x32_bf16 v[152:155], a[212:215], a[24:27], v[152:155]
    ds_read_b64_tr_b16 a[204:205], v40 offset:24576
    v_mfma_f32_16x16x32_bf16 v[152:155], a[208:211], a[8:11], v[152:155]
    v_mfma_f32_16x16x32_bf16 v[148:151], a[208:211], a[4:7], v[148:151]
    ds_read_b64_tr_b16 a[206:207], v40 offset:28672
    v_mfma_f32_16x16x32_bf16 v[148:151], a[212:215], a[20:23], v[148:151]
    buffer_load_dwordx4 a[136:139], v4, s[4:7], s73 offen sc1
    v_mfma_f32_16x16x32_bf16 v[144:147], a[212:215], a[16:19], v[144:147]
    v_mfma_f32_16x16x32_bf16 v[144:147], a[208:211], a[0:3], v[144:147]
    s_waitcnt lgkmcnt(8)
    v_mfma_f32_16x16x32_bf16 v[160:163], a[216:219], a[0:3], v[160:163]
    ds_read_b64_tr_b16 a[208:209], v41 offset:16384
    v_mfma_f32_16x16x32_bf16 v[160:163], a[220:223], a[16:19], v[160:163]
    ds_read_b64_tr_b16 a[210:211], v41 offset:20480
    v_mfma_f32_16x16x32_bf16 v[164:167], a[220:223], a[20:23], v[164:167]
    ds_read_b64_tr_b16 a[212:213], v41 offset:24576
    v_mfma_f32_16x16x32_bf16 v[164:167], a[216:219], a[4:7], v[164:167]
    ds_read_b64_tr_b16 a[214:215], v41 offset:28672
    v_mfma_f32_16x16x32_bf16 v[168:171], a[216:219], a[8:11], v[168:171]
    buffer_load_dwordx4 a[140:143], v5, s[4:7], s73 offen sc1
    s_add_u32 s73, s73, 131072
    v_mfma_f32_16x16x32_bf16 v[168:171], a[220:223], a[24:27], v[168:171]
    buffer_load_dwordx4 a[144:147], v2, s[4:7], s73 offen sc1
    v_mfma_f32_16x16x32_bf16 v[172:175], a[220:223], a[28:31], v[172:175]
    v_mfma_f32_16x16x32_bf16 v[172:175], a[216:219], a[12:15], v[172:175]
    s_waitcnt lgkmcnt(8)
    v_mfma_f32_16x16x32_bf16 v[188:191], a[224:227], a[12:15], v[188:191]
    ds_read_b64_tr_b16 a[216:217], v42 offset:16384
    v_mfma_f32_16x16x32_bf16 v[188:191], a[228:231], a[28:31], v[188:191]
    ds_read_b64_tr_b16 a[218:219], v42 offset:20480
    v_mfma_f32_16x16x32_bf16 v[184:187], a[228:231], a[24:27], v[184:187]
    ds_read_b64_tr_b16 a[220:221], v42 offset:24576
    v_mfma_f32_16x16x32_bf16 v[184:187], a[224:227], a[8:11], v[184:187]
    v_mfma_f32_16x16x32_bf16 v[180:183], a[224:227], a[4:7], v[180:183]
    ds_read_b64_tr_b16 a[222:223], v42 offset:28672
    v_mfma_f32_16x16x32_bf16 v[180:183], a[228:231], a[20:23], v[180:183]
    buffer_load_dwordx4 a[148:151], v3, s[4:7], s73 offen sc1
    v_mfma_f32_16x16x32_bf16 v[176:179], a[228:231], a[16:19], v[176:179]
    v_mfma_f32_16x16x32_bf16 v[176:179], a[224:227], a[0:3], v[176:179]
    s_waitcnt lgkmcnt(8)
    v_mfma_f32_16x16x32_bf16 v[192:195], a[200:203], a[0:3], v[192:195]
    ds_read_b64_tr_b16 a[224:225], v43 offset:16384
    v_mfma_f32_16x16x32_bf16 v[192:195], a[204:207], a[16:19], v[192:195]
    ds_read_b64_tr_b16 a[226:227], v43 offset:20480
    v_mfma_f32_16x16x32_bf16 v[196:199], a[204:207], a[20:23], v[196:199]
    ds_read_b64_tr_b16 a[228:229], v43 offset:24576
    v_mfma_f32_16x16x32_bf16 v[196:199], a[200:203], a[4:7], v[196:199]
    ds_read_b64_tr_b16 a[230:231], v43 offset:28672
    v_mfma_f32_16x16x32_bf16 v[200:203], a[200:203], a[8:11], v[200:203]
    buffer_load_dwordx4 a[152:155], v4, s[4:7], s73 offen sc1
    v_mfma_f32_16x16x32_bf16 v[200:203], a[204:207], a[24:27], v[200:203]
    buffer_load_dwordx4 a[156:159], v5, s[4:7], s73 offen sc1
    s_add_u32 s73, s73, 131072
    v_mfma_f32_16x16x32_bf16 v[204:207], a[204:207], a[28:31], v[204:207]
    v_mfma_f32_16x16x32_bf16 v[204:207], a[200:203], a[12:15], v[204:207]
    s_waitcnt lgkmcnt(0)
    s_barrier
    v_mfma_f32_16x16x32_bf16 v[220:223], a[208:211], a[12:15], v[220:223]
    ds_read_b64_tr_b16 a[200:201], v36 offset:32768
    v_mfma_f32_16x16x32_bf16 v[220:223], a[212:215], a[28:31], v[220:223]
    ds_read_b64_tr_b16 a[202:203], v36 offset:36864
    v_mfma_f32_16x16x32_bf16 v[216:219], a[212:215], a[24:27], v[216:219]
    ds_read_b64_tr_b16 a[204:205], v36 offset:40960
    v_mfma_f32_16x16x32_bf16 v[216:219], a[208:211], a[8:11], v[216:219]
    v_mfma_f32_16x16x32_bf16 v[212:215], a[208:211], a[4:7], v[212:215]
    ds_read_b64_tr_b16 a[206:207], v36 offset:45056
    v_mfma_f32_16x16x32_bf16 v[212:215], a[212:215], a[20:23], v[212:215]
    s_add_u32 m0, s66, 0
    s_nop 0
    buffer_load_dwordx4 v6, s[28:31], s75 offen offset:0 lds
    v_mfma_f32_16x16x32_bf16 v[208:211], a[212:215], a[16:19], v[208:211]
    v_mfma_f32_16x16x32_bf16 v[208:211], a[208:211], a[0:3], v[208:211]
    v_mfma_f32_16x16x32_bf16 v[224:227], a[216:219], a[0:3], v[224:227]
    ds_read_b64_tr_b16 a[208:209], v37 offset:32768
    v_mfma_f32_16x16x32_bf16 v[224:227], a[220:223], a[16:19], v[224:227]
    ds_read_b64_tr_b16 a[210:211], v37 offset:36864
    v_mfma_f32_16x16x32_bf16 v[228:231], a[220:223], a[20:23], v[228:231]
    ds_read_b64_tr_b16 a[212:213], v37 offset:40960
    v_mfma_f32_16x16x32_bf16 v[228:231], a[216:219], a[4:7], v[228:231]
    ds_read_b64_tr_b16 a[214:215], v37 offset:45056
    v_mfma_f32_16x16x32_bf16 v[232:235], a[216:219], a[8:11], v[232:235]
    buffer_load_dwordx4 v7, s[28:31], s75 offen offset:1024 lds
    v_mfma_f32_16x16x32_bf16 v[232:235], a[220:223], a[24:27], v[232:235]
    buffer_load_dwordx4 v8, s[28:31], s75 offen offset:2048 lds
    v_mfma_f32_16x16x32_bf16 v[236:239], a[220:223], a[28:31], v[236:239]
    v_mfma_f32_16x16x32_bf16 v[236:239], a[216:219], a[12:15], v[236:239]
    v_mfma_f32_16x16x32_bf16 v[252:255], a[224:227], a[12:15], v[252:255]
    ds_read_b64_tr_b16 a[216:217], v38 offset:32768
    v_mfma_f32_16x16x32_bf16 v[252:255], a[228:231], a[28:31], v[252:255]
    ds_read_b64_tr_b16 a[218:219], v38 offset:36864
    v_mfma_f32_16x16x32_bf16 v[248:251], a[228:231], a[24:27], v[248:251]
    ds_read_b64_tr_b16 a[220:221], v38 offset:40960
    v_mfma_f32_16x16x32_bf16 v[248:251], a[224:227], a[8:11], v[248:251]
    v_mfma_f32_16x16x32_bf16 v[244:247], a[224:227], a[4:7], v[244:247]
    ds_read_b64_tr_b16 a[222:223], v38 offset:45056
    v_mfma_f32_16x16x32_bf16 v[244:247], a[228:231], a[20:23], v[244:247]
    buffer_load_dwordx4 v9, s[28:31], s75 offen offset:3072 lds
    s_add_u32 s75, s75, 131072
    v_mfma_f32_16x16x32_bf16 v[240:243], a[228:231], a[16:19], v[240:243]
    v_mfma_f32_16x16x32_bf16 v[240:243], a[224:227], a[0:3], v[240:243]
    s_waitcnt vmcnt(38) lgkmcnt(8)
    v_mfma_f32_16x16x32_bf16 v[128:131], a[200:203], a[32:35], v[128:131]
    ds_read_b64_tr_b16 a[224:225], v39 offset:32768
    v_mfma_f32_16x16x32_bf16 v[128:131], a[204:207], a[48:51], v[128:131]
    ds_read_b64_tr_b16 a[226:227], v39 offset:36864
    v_mfma_f32_16x16x32_bf16 v[132:135], a[204:207], a[52:55], v[132:135]
    ds_read_b64_tr_b16 a[228:229], v39 offset:40960
    v_mfma_f32_16x16x32_bf16 v[132:135], a[200:203], a[36:39], v[132:135]
    ds_read_b64_tr_b16 a[230:231], v39 offset:45056
    v_mfma_f32_16x16x32_bf16 v[136:139], a[200:203], a[40:43], v[136:139]
    buffer_load_dwordx4 a[0:3], v2, s[4:7], s73 offen sc1
    v_mfma_f32_16x16x32_bf16 v[136:139], a[204:207], a[56:59], v[136:139]
    buffer_load_dwordx4 a[4:7], v3, s[4:7], s73 offen sc1
    v_mfma_f32_16x16x32_bf16 v[140:143], a[204:207], a[60:63], v[140:143]
    v_mfma_f32_16x16x32_bf16 v[140:143], a[200:203], a[44:47], v[140:143]
    s_waitcnt lgkmcnt(8)
    v_mfma_f32_16x16x32_bf16 v[156:159], a[208:211], a[44:47], v[156:159]
    ds_read_b64_tr_b16 a[200:201], v40 offset:32768
    v_mfma_f32_16x16x32_bf16 v[156:159], a[212:215], a[60:63], v[156:159]
    ds_read_b64_tr_b16 a[202:203], v40 offset:36864
    v_mfma_f32_16x16x32_bf16 v[152:155], a[212:215], a[56:59], v[152:155]
    ds_read_b64_tr_b16 a[204:205], v40 offset:40960
    v_mfma_f32_16x16x32_bf16 v[152:155], a[208:211], a[40:43], v[152:155]
    v_mfma_f32_16x16x32_bf16 v[148:151], a[208:211], a[36:39], v[148:151]
    ds_read_b64_tr_b16 a[206:207], v40 offset:45056
    v_mfma_f32_16x16x32_bf16 v[148:151], a[212:215], a[52:55], v[148:151]
    buffer_load_dwordx4 a[8:11], v4, s[4:7], s73 offen sc1
    v_mfma_f32_16x16x32_bf16 v[144:147], a[212:215], a[48:51], v[144:147]
    v_mfma_f32_16x16x32_bf16 v[144:147], a[208:211], a[32:35], v[144:147]
    s_waitcnt lgkmcnt(8)
    v_mfma_f32_16x16x32_bf16 v[160:163], a[216:219], a[32:35], v[160:163]
    ds_read_b64_tr_b16 a[208:209], v41 offset:32768
    v_mfma_f32_16x16x32_bf16 v[160:163], a[220:223], a[48:51], v[160:163]
    ds_read_b64_tr_b16 a[210:211], v41 offset:36864
    v_mfma_f32_16x16x32_bf16 v[164:167], a[220:223], a[52:55], v[164:167]
    ds_read_b64_tr_b16 a[212:213], v41 offset:40960
    v_mfma_f32_16x16x32_bf16 v[164:167], a[216:219], a[36:39], v[164:167]
    ds_read_b64_tr_b16 a[214:215], v41 offset:45056
    v_mfma_f32_16x16x32_bf16 v[168:171], a[216:219], a[40:43], v[168:171]
    buffer_load_dwordx4 a[12:15], v5, s[4:7], s73 offen sc1
    s_add_u32 s73, s73, 131072
    v_mfma_f32_16x16x32_bf16 v[168:171], a[220:223], a[56:59], v[168:171]
    buffer_load_dwordx4 a[16:19], v2, s[4:7], s73 offen sc1
    v_mfma_f32_16x16x32_bf16 v[172:175], a[220:223], a[60:63], v[172:175]
    v_mfma_f32_16x16x32_bf16 v[172:175], a[216:219], a[44:47], v[172:175]
    s_waitcnt lgkmcnt(8)
    v_mfma_f32_16x16x32_bf16 v[188:191], a[224:227], a[44:47], v[188:191]
    ds_read_b64_tr_b16 a[216:217], v42 offset:32768
    v_mfma_f32_16x16x32_bf16 v[188:191], a[228:231], a[60:63], v[188:191]
    ds_read_b64_tr_b16 a[218:219], v42 offset:36864
    v_mfma_f32_16x16x32_bf16 v[184:187], a[228:231], a[56:59], v[184:187]
    ds_read_b64_tr_b16 a[220:221], v42 offset:40960
    v_mfma_f32_16x16x32_bf16 v[184:187], a[224:227], a[40:43], v[184:187]
    v_mfma_f32_16x16x32_bf16 v[180:183], a[224:227], a[36:39], v[180:183]
    ds_read_b64_tr_b16 a[222:223], v42 offset:45056
    v_mfma_f32_16x16x32_bf16 v[180:183], a[228:231], a[52:55], v[180:183]
    buffer_load_dwordx4 a[20:23], v3, s[4:7], s73 offen sc1
    v_mfma_f32_16x16x32_bf16 v[176:179], a[228:231], a[48:51], v[176:179]
    v_mfma_f32_16x16x32_bf16 v[176:179], a[224:227], a[32:35], v[176:179]
    s_waitcnt lgkmcnt(8)
    v_mfma_f32_16x16x32_bf16 v[192:195], a[200:203], a[32:35], v[192:195]
    ds_read_b64_tr_b16 a[224:225], v43 offset:32768
    v_mfma_f32_16x16x32_bf16 v[192:195], a[204:207], a[48:51], v[192:195]
    ds_read_b64_tr_b16 a[226:227], v43 offset:36864
    v_mfma_f32_16x16x32_bf16 v[196:199], a[204:207], a[52:55], v[196:199]
    ds_read_b64_tr_b16 a[228:229], v43 offset:40960
    v_mfma_f32_16x16x32_bf16 v[196:199], a[200:203], a[36:39], v[196:199]
    ds_read_b64_tr_b16 a[230:231], v43 offset:45056
    v_mfma_f32_16x16x32_bf16 v[200:203], a[200:203], a[40:43], v[200:203]
    buffer_load_dwordx4 a[24:27], v4, s[4:7], s73 offen sc1
    v_mfma_f32_16x16x32_bf16 v[200:203], a[204:207], a[56:59], v[200:203]
    buffer_load_dwordx4 a[28:31], v5, s[4:7], s73 offen sc1
    s_add_u32 s73, s73, 131072
    v_mfma_f32_16x16x32_bf16 v[204:207], a[204:207], a[60:63], v[204:207]
    v_mfma_f32_16x16x32_bf16 v[204:207], a[200:203], a[44:47], v[204:207]
    s_waitcnt vmcnt(38) lgkmcnt(0)
    s_barrier
    v_mfma_f32_16x16x32_bf16 v[220:223], a[208:211], a[44:47], v[220:223]
    ds_read_b64_tr_b16 a[200:201], v36 offset:49152
    v_mfma_f32_16x16x32_bf16 v[220:223], a[212:215], a[60:63], v[220:223]
    ds_read_b64_tr_b16 a[202:203], v36 offset:53248
    v_mfma_f32_16x16x32_bf16 v[216:219], a[212:215], a[56:59], v[216:219]
    ds_read_b64_tr_b16 a[204:205], v36 offset:57344
    v_mfma_f32_16x16x32_bf16 v[216:219], a[208:211], a[40:43], v[216:219]
    v_mfma_f32_16x16x32_bf16 v[212:215], a[208:211], a[36:39], v[212:215]
    ds_read_b64_tr_b16 a[206:207], v36 offset:61440
    v_mfma_f32_16x16x32_bf16 v[212:215], a[212:215], a[52:55], v[212:215]
    s_add_u32 m0, s66, 16384
    s_nop 0
    buffer_load_dwordx4 v6, s[28:31], s75 offen offset:0 lds
    v_mfma_f32_16x16x32_bf16 v[208:211], a[212:215], a[48:51], v[208:211]
    v_mfma_f32_16x16x32_bf16 v[208:211], a[208:211], a[32:35], v[208:211]
    v_mfma_f32_16x16x32_bf16 v[224:227], a[216:219], a[32:35], v[224:227]
    ds_read_b64_tr_b16 a[208:209], v37 offset:49152
    v_mfma_f32_16x16x32_bf16 v[224:227], a[220:223], a[48:51], v[224:227]
    ds_read_b64_tr_b16 a[210:211], v37 offset:53248
    v_mfma_f32_16x16x32_bf16 v[228:231], a[220:223], a[52:55], v[228:231]
    ds_read_b64_tr_b16 a[212:213], v37 offset:57344
    v_mfma_f32_16x16x32_bf16 v[228:231], a[216:219], a[36:39], v[228:231]
    ds_read_b64_tr_b16 a[214:215], v37 offset:61440
    v_mfma_f32_16x16x32_bf16 v[232:235], a[216:219], a[40:43], v[232:235]
    buffer_load_dwordx4 v7, s[28:31], s75 offen offset:1024 lds
    v_mfma_f32_16x16x32_bf16 v[232:235], a[220:223], a[56:59], v[232:235]
    buffer_load_dwordx4 v8, s[28:31], s75 offen offset:2048 lds
    v_mfma_f32_16x16x32_bf16 v[236:239], a[220:223], a[60:63], v[236:239]
    v_mfma_f32_16x16x32_bf16 v[236:239], a[216:219], a[44:47], v[236:239]
    v_mfma_f32_16x16x32_bf16 v[252:255], a[224:227], a[44:47], v[252:255]
    ds_read_b64_tr_b16 a[216:217], v38 offset:49152
    v_mfma_f32_16x16x32_bf16 v[252:255], a[228:231], a[60:63], v[252:255]
    ds_read_b64_tr_b16 a[218:219], v38 offset:53248
    v_mfma_f32_16x16x32_bf16 v[248:251], a[228:231], a[56:59], v[248:251]
    ds_read_b64_tr_b16 a[220:221], v38 offset:57344
    v_mfma_f32_16x16x32_bf16 v[248:251], a[224:227], a[40:43], v[248:251]
    v_mfma_f32_16x16x32_bf16 v[244:247], a[224:227], a[36:39], v[244:247]
    ds_read_b64_tr_b16 a[222:223], v38 offset:61440
    v_mfma_f32_16x16x32_bf16 v[244:247], a[228:231], a[52:55], v[244:247]
    buffer_load_dwordx4 v9, s[28:31], s75 offen offset:3072 lds
    s_add_u32 s75, s75, 131072
    v_mfma_f32_16x16x32_bf16 v[240:243], a[228:231], a[48:51], v[240:243]
    v_mfma_f32_16x16x32_bf16 v[240:243], a[224:227], a[32:35], v[240:243]
    s_waitcnt vmcnt(37) lgkmcnt(8)
    v_mfma_f32_16x16x32_bf16 v[128:131], a[200:203], a[64:67], v[128:131]
    ds_read_b64_tr_b16 a[224:225], v39 offset:49152
    v_mfma_f32_16x16x32_bf16 v[128:131], a[204:207], a[80:83], v[128:131]
    ds_read_b64_tr_b16 a[226:227], v39 offset:53248
    v_mfma_f32_16x16x32_bf16 v[132:135], a[204:207], a[84:87], v[132:135]
    ds_read_b64_tr_b16 a[228:229], v39 offset:57344
    v_mfma_f32_16x16x32_bf16 v[132:135], a[200:203], a[68:71], v[132:135]
    ds_read_b64_tr_b16 a[230:231], v39 offset:61440
    v_mfma_f32_16x16x32_bf16 v[136:139], a[200:203], a[72:75], v[136:139]
    buffer_load_dwordx4 a[32:35], v2, s[4:7], s73 offen sc1
    v_mfma_f32_16x16x32_bf16 v[136:139], a[204:207], a[88:91], v[136:139]
    buffer_load_dwordx4 a[36:39], v3, s[4:7], s73 offen sc1
    v_mfma_f32_16x16x32_bf16 v[140:143], a[204:207], a[92:95], v[140:143]
    v_mfma_f32_16x16x32_bf16 v[140:143], a[200:203], a[76:79], v[140:143]
    s_waitcnt lgkmcnt(8)
    v_mfma_f32_16x16x32_bf16 v[156:159], a[208:211], a[76:79], v[156:159]
    ds_read_b64_tr_b16 a[200:201], v40 offset:49152
    v_mfma_f32_16x16x32_bf16 v[156:159], a[212:215], a[92:95], v[156:159]
    ds_read_b64_tr_b16 a[202:203], v40 offset:53248
    v_mfma_f32_16x16x32_bf16 v[152:155], a[212:215], a[88:91], v[152:155]
    ds_read_b64_tr_b16 a[204:205], v40 offset:57344
    v_mfma_f32_16x16x32_bf16 v[152:155], a[208:211], a[72:75], v[152:155]
    v_mfma_f32_16x16x32_bf16 v[148:151], a[208:211], a[68:71], v[148:151]
    ds_read_b64_tr_b16 a[206:207], v40 offset:61440
    v_mfma_f32_16x16x32_bf16 v[148:151], a[212:215], a[84:87], v[148:151]
    buffer_load_dwordx4 a[40:43], v4, s[4:7], s73 offen sc1
    v_mfma_f32_16x16x32_bf16 v[144:147], a[212:215], a[80:83], v[144:147]
    v_mfma_f32_16x16x32_bf16 v[144:147], a[208:211], a[64:67], v[144:147]
    s_waitcnt lgkmcnt(8)
    v_mfma_f32_16x16x32_bf16 v[160:163], a[216:219], a[64:67], v[160:163]
    ds_read_b64_tr_b16 a[208:209], v41 offset:49152
    v_mfma_f32_16x16x32_bf16 v[160:163], a[220:223], a[80:83], v[160:163]
    ds_read_b64_tr_b16 a[210:211], v41 offset:53248
    v_mfma_f32_16x16x32_bf16 v[164:167], a[220:223], a[84:87], v[164:167]
    ds_read_b64_tr_b16 a[212:213], v41 offset:57344
    v_mfma_f32_16x16x32_bf16 v[164:167], a[216:219], a[68:71], v[164:167]
    ds_read_b64_tr_b16 a[214:215], v41 offset:61440
    v_mfma_f32_16x16x32_bf16 v[168:171], a[216:219], a[72:75], v[168:171]
    buffer_load_dwordx4 a[44:47], v5, s[4:7], s73 offen sc1
    s_add_u32 s73, s73, 131072
    v_mfma_f32_16x16x32_bf16 v[168:171], a[220:223], a[88:91], v[168:171]
    buffer_load_dwordx4 a[48:51], v2, s[4:7], s73 offen sc1
    v_mfma_f32_16x16x32_bf16 v[172:175], a[220:223], a[92:95], v[172:175]
    v_mfma_f32_16x16x32_bf16 v[172:175], a[216:219], a[76:79], v[172:175]
    s_waitcnt lgkmcnt(8)
    v_mfma_f32_16x16x32_bf16 v[188:191], a[224:227], a[76:79], v[188:191]
    ds_read_b64_tr_b16 a[216:217], v42 offset:49152
    v_mfma_f32_16x16x32_bf16 v[188:191], a[228:231], a[92:95], v[188:191]
    ds_read_b64_tr_b16 a[218:219], v42 offset:53248
    v_mfma_f32_16x16x32_bf16 v[184:187], a[228:231], a[88:91], v[184:187]
    ds_read_b64_tr_b16 a[220:221], v42 offset:57344
    v_mfma_f32_16x16x32_bf16 v[184:187], a[224:227], a[72:75], v[184:187]
    v_mfma_f32_16x16x32_bf16 v[180:183], a[224:227], a[68:71], v[180:183]
    ds_read_b64_tr_b16 a[222:223], v42 offset:61440
    v_mfma_f32_16x16x32_bf16 v[180:183], a[228:231], a[84:87], v[180:183]
    buffer_load_dwordx4 a[52:55], v3, s[4:7], s73 offen sc1
    v_mfma_f32_16x16x32_bf16 v[176:179], a[228:231], a[80:83], v[176:179]
    v_mfma_f32_16x16x32_bf16 v[176:179], a[224:227], a[64:67], v[176:179]
    s_waitcnt lgkmcnt(8)
    v_mfma_f32_16x16x32_bf16 v[192:195], a[200:203], a[64:67], v[192:195]
    ds_read_b64_tr_b16 a[224:225], v43 offset:49152
    v_mfma_f32_16x16x32_bf16 v[192:195], a[204:207], a[80:83], v[192:195]
    ds_read_b64_tr_b16 a[226:227], v43 offset:53248
    v_mfma_f32_16x16x32_bf16 v[196:199], a[204:207], a[84:87], v[196:199]
    ds_read_b64_tr_b16 a[228:229], v43 offset:57344
    v_mfma_f32_16x16x32_bf16 v[196:199], a[200:203], a[68:71], v[196:199]
    ds_read_b64_tr_b16 a[230:231], v43 offset:61440
    v_mfma_f32_16x16x32_bf16 v[200:203], a[200:203], a[72:75], v[200:203]
    buffer_load_dwordx4 a[56:59], v4, s[4:7], s73 offen sc1
    v_mfma_f32_16x16x32_bf16 v[200:203], a[204:207], a[88:91], v[200:203]
    buffer_load_dwordx4 a[60:63], v5, s[4:7], s73 offen sc1
    s_add_u32 s73, s73, 131072
    v_mfma_f32_16x16x32_bf16 v[204:207], a[204:207], a[92:95], v[204:207]
    v_mfma_f32_16x16x32_bf16 v[204:207], a[200:203], a[76:79], v[204:207]
    s_waitcnt vmcnt(8) lgkmcnt(0)
    s_barrier
    v_mfma_f32_16x16x32_bf16 v[220:223], a[208:211], a[76:79], v[220:223]
    ds_read_b64_tr_b16 a[200:201], v52 offset:0
    v_mfma_f32_16x16x32_bf16 v[220:223], a[212:215], a[92:95], v[220:223]
    ds_read_b64_tr_b16 a[202:203], v52 offset:4096
    v_mfma_f32_16x16x32_bf16 v[216:219], a[212:215], a[88:91], v[216:219]
    ds_read_b64_tr_b16 a[204:205], v52 offset:8192
    v_mfma_f32_16x16x32_bf16 v[216:219], a[208:211], a[72:75], v[216:219]
    v_mfma_f32_16x16x32_bf16 v[212:215], a[208:211], a[68:71], v[212:215]
    ds_read_b64_tr_b16 a[206:207], v52 offset:12288
    v_mfma_f32_16x16x32_bf16 v[212:215], a[212:215], a[84:87], v[212:215]
    buffer_load_dwordx4 v[100:103], v44, s[16:19], 0 offen offset:0
    v_mfma_f32_16x16x32_bf16 v[208:211], a[212:215], a[80:83], v[208:211]
    v_mfma_f32_16x16x32_bf16 v[208:211], a[208:211], a[64:67], v[208:211]
    v_mfma_f32_16x16x32_bf16 v[224:227], a[216:219], a[64:67], v[224:227]
    ds_read_b64_tr_b16 a[208:209], v52 offset:16384
    v_mfma_f32_16x16x32_bf16 v[224:227], a[220:223], a[80:83], v[224:227]
    ds_read_b64_tr_b16 a[210:211], v52 offset:20480
    v_mfma_f32_16x16x32_bf16 v[228:231], a[220:223], a[84:87], v[228:231]
    ds_read_b64_tr_b16 a[212:213], v52 offset:24576
    v_mfma_f32_16x16x32_bf16 v[228:231], a[216:219], a[68:71], v[228:231]
    ds_read_b64_tr_b16 a[214:215], v52 offset:28672
    v_mfma_f32_16x16x32_bf16 v[232:235], a[216:219], a[72:75], v[232:235]
    buffer_load_dwordx4 v[104:107], v44, s[16:19], 0 offen offset:64
    v_mfma_f32_16x16x32_bf16 v[232:235], a[220:223], a[88:91], v[232:235]
    buffer_load_dwordx4 v[108:111], v44, s[16:19], 0 offen offset:128
    v_mfma_f32_16x16x32_bf16 v[236:239], a[220:223], a[92:95], v[236:239]
    v_mfma_f32_16x16x32_bf16 v[236:239], a[216:219], a[76:79], v[236:239]
    v_mfma_f32_16x16x32_bf16 v[252:255], a[224:227], a[76:79], v[252:255]
    ds_read_b64_tr_b16 a[216:217], v36 offset:0
    v_mfma_f32_16x16x32_bf16 v[252:255], a[228:231], a[92:95], v[252:255]
    ds_read_b64_tr_b16 a[218:219], v36 offset:4096
    v_mfma_f32_16x16x32_bf16 v[248:251], a[228:231], a[88:91], v[248:251]
    ds_read_b64_tr_b16 a[220:221], v36 offset:8192
    v_mfma_f32_16x16x32_bf16 v[248:251], a[224:227], a[72:75], v[248:251]
    v_mfma_f32_16x16x32_bf16 v[244:247], a[224:227], a[68:71], v[244:247]
    ds_read_b64_tr_b16 a[222:223], v36 offset:12288
    v_mfma_f32_16x16x32_bf16 v[244:247], a[228:231], a[84:87], v[244:247]
    buffer_load_dwordx4 v[112:115], v44, s[16:19], 0 offen offset:192
    v_mfma_f32_16x16x32_bf16 v[240:243], a[228:231], a[80:83], v[240:243]
    v_mfma_f32_16x16x32_bf16 v[240:243], a[224:227], a[64:67], v[240:243]
    s_waitcnt lgkmcnt(8)
    v_mfma_f32_16x16x32_bf16 v[128:131], a[200:203], a[96:99], v[128:131]
    ds_read_b64_tr_b16 a[224:225], v36 offset:16384
    v_mfma_f32_16x16x32_bf16 v[128:131], a[204:207], a[112:115], v[128:131]
    ds_read_b64_tr_b16 a[226:227], v36 offset:20480
    v_mfma_f32_16x16x32_bf16 v[132:135], a[204:207], a[116:119], v[132:135]
    v_mfma_f32_16x16x32_bf16 v[132:135], a[200:203], a[100:103], v[132:135]
    ds_read_b64_tr_b16 a[228:229], v36 offset:24576
    v_mfma_f32_16x16x32_bf16 v[136:139], a[200:203], a[104:107], v[136:139]
    v_mfma_f32_16x16x32_bf16 v[136:139], a[204:207], a[120:123], v[136:139]
    ds_read_b64_tr_b16 a[230:231], v36 offset:28672
    v_mfma_f32_16x16x32_bf16 v[140:143], a[204:207], a[124:127], v[140:143]
    v_mfma_f32_16x16x32_bf16 v[140:143], a[200:203], a[108:111], v[140:143]
    s_waitcnt lgkmcnt(8)
    v_mfma_f32_16x16x32_bf16 v[140:143], a[208:211], a[140:143], v[140:143]
    ds_read_b64_tr_b16 a[200:201], v53 offset:0
    v_mfma_f32_16x16x32_bf16 v[140:143], a[212:215], a[156:159], v[140:143]
    ds_read_b64_tr_b16 a[202:203], v53 offset:4096
    v_mfma_f32_16x16x32_bf16 v[136:139], a[212:215], a[152:155], v[136:139]
    v_mfma_f32_16x16x32_bf16 v[136:139], a[208:211], a[136:139], v[136:139]
    ds_read_b64_tr_b16 a[204:205], v53 offset:8192
    v_mfma_f32_16x16x32_bf16 v[132:135], a[208:211], a[132:135], v[132:135]
    v_mfma_f32_16x16x32_bf16 v[132:135], a[212:215], a[148:151], v[132:135]
    ds_read_b64_tr_b16 a[206:207], v53 offset:12288
    v_mfma_f32_16x16x32_bf16 v[128:131], a[212:215], a[144:147], v[128:131]
    v_mfma_f32_16x16x32_bf16 v[128:131], a[208:211], a[128:131], v[128:131]
    s_waitcnt lgkmcnt(8)
    v_mfma_f32_16x16x32_bf16 v[128:131], a[216:219], a[0:3], v[128:131]
    ds_read_b64_tr_b16 a[208:209], v53 offset:16384
    v_mfma_f32_16x16x32_bf16 v[128:131], a[220:223], a[16:19], v[128:131]
    ds_read_b64_tr_b16 a[210:211], v53 offset:20480
    v_mfma_f32_16x16x32_bf16 v[132:135], a[220:223], a[20:23], v[132:135]
    v_mfma_f32_16x16x32_bf16 v[132:135], a[216:219], a[4:7], v[132:135]
    ds_read_b64_tr_b16 a[212:213], v53 offset:24576
    v_mfma_f32_16x16x32_bf16 v[136:139], a[216:219], a[8:11], v[136:139]
    v_mfma_f32_16x16x32_bf16 v[136:139], a[220:223], a[24:27], v[136:139]
    ds_read_b64_tr_b16 a[214:215], v53 offset:28672
    v_mfma_f32_16x16x32_bf16 v[140:143], a[220:223], a[28:31], v[140:143]
    v_mfma_f32_16x16x32_bf16 v[140:143], a[216:219], a[12:15], v[140:143]
    s_waitcnt vmcnt(4) lgkmcnt(8)
    v_mfma_f32_16x16x32_bf16 v[140:143], a[224:227], a[44:47], v[140:143]
    ds_read_b64_tr_b16 a[216:217], v37 offset:0
    v_mfma_f32_16x16x32_bf16 v[140:143], a[228:231], a[60:63], v[140:143]
    ds_read_b64_tr_b16 a[218:219], v37 offset:4096
    v_mfma_f32_16x16x32_bf16 v[136:139], a[228:231], a[56:59], v[136:139]
    v_mfma_f32_16x16x32_bf16 v[136:139], a[224:227], a[40:43], v[136:139]
    ds_read_b64_tr_b16 a[220:221], v37 offset:8192
    v_mfma_f32_16x16x32_bf16 v[132:135], a[224:227], a[36:39], v[132:135]
    v_mfma_f32_16x16x32_bf16 v[132:135], a[228:231], a[52:55], v[132:135]
    ds_read_b64_tr_b16 a[222:223], v37 offset:12288
    v_mfma_f32_16x16x32_bf16 v[128:131], a[228:231], a[48:51], v[128:131]
    v_mfma_f32_16x16x32_bf16 v[128:131], a[224:227], a[32:35], v[128:131]
    s_waitcnt lgkmcnt(8)
    v_mfma_f32_16x16x32_bf16 v[144:147], a[200:203], a[96:99], v[144:147]
    ds_read_b64_tr_b16 a[224:225], v37 offset:16384
    v_mfma_f32_16x16x32_bf16 v[144:147], a[204:207], a[112:115], v[144:147]
    ds_read_b64_tr_b16 a[226:227], v37 offset:20480
    v_mfma_f32_16x16x32_bf16 v[148:151], a[204:207], a[116:119], v[148:151]
    v_mfma_f32_16x16x32_bf16 v[148:151], a[200:203], a[100:103], v[148:151]
    ds_read_b64_tr_b16 a[228:229], v37 offset:24576
    v_mfma_f32_16x16x32_bf16 v[152:155], a[200:203], a[104:107], v[152:155]
    v_mfma_f32_16x16x32_bf16 v[152:155], a[204:207], a[120:123], v[152:155]
    ds_read_b64_tr_b16 a[230:231], v37 offset:28672
    v_mfma_f32_16x16x32_bf16 v[156:159], a[204:207], a[124:127], v[156:159]
    v_mfma_f32_16x16x32_bf16 v[156:159], a[200:203], a[108:111], v[156:159]
    s_waitcnt lgkmcnt(8)
    v_mfma_f32_16x16x32_bf16 v[156:159], a[208:211], a[140:143], v[156:159]
    ds_read_b64_tr_b16 a[200:201], v54 offset:0
    v_mfma_f32_16x16x32_bf16 v[156:159], a[212:215], a[156:159], v[156:159]
    ds_read_b64_tr_b16 a[202:203], v54 offset:4096
    v_mfma_f32_16x16x32_bf16 v[152:155], a[212:215], a[152:155], v[152:155]
    v_mfma_f32_16x16x32_bf16 v[152:155], a[208:211], a[136:139], v[152:155]
    ds_read_b64_tr_b16 a[204:205], v54 offset:8192
    v_mfma_f32_16x16x32_bf16 v[148:151], a[208:211], a[132:135], v[148:151]
    v_mfma_f32_16x16x32_bf16 v[148:151], a[212:215], a[148:151], v[148:151]
    ds_read_b64_tr_b16 a[206:207], v54 offset:12288
    v_mfma_f32_16x16x32_bf16 v[144:147], a[212:215], a[144:147], v[144:147]
    v_mfma_f32_16x16x32_bf16 v[144:147], a[208:211], a[128:131], v[144:147]
    s_waitcnt lgkmcnt(8)
    v_mfma_f32_16x16x32_bf16 v[144:147], a[216:219], a[0:3], v[144:147]
    ds_read_b64_tr_b16 a[208:209], v54 offset:16384
    v_mfma_f32_16x16x32_bf16 v[144:147], a[220:223], a[16:19], v[144:147]
    ds_read_b64_tr_b16 a[210:211], v54 offset:20480
    v_mfma_f32_16x16x32_bf16 v[148:151], a[220:223], a[20:23], v[148:151]
    v_mfma_f32_16x16x32_bf16 v[148:151], a[216:219], a[4:7], v[148:151]
    ds_read_b64_tr_b16 a[212:213], v54 offset:24576
    v_mfma_f32_16x16x32_bf16 v[152:155], a[216:219], a[8:11], v[152:155]
    v_mfma_f32_16x16x32_bf16 v[152:155], a[220:223], a[24:27], v[152:155]
    ds_read_b64_tr_b16 a[214:215], v54 offset:28672
    v_mfma_f32_16x16x32_bf16 v[156:159], a[220:223], a[28:31], v[156:159]
    v_mfma_f32_16x16x32_bf16 v[156:159], a[216:219], a[12:15], v[156:159]
    s_waitcnt lgkmcnt(8)
    v_mfma_f32_16x16x32_bf16 v[156:159], a[224:227], a[44:47], v[156:159]
    ds_read_b64_tr_b16 a[216:217], v38 offset:0
    v_mfma_f32_16x16x32_bf16 v[156:159], a[228:231], a[60:63], v[156:159]
    ds_read_b64_tr_b16 a[218:219], v38 offset:4096
    v_mfma_f32_16x16x32_bf16 v[152:155], a[228:231], a[56:59], v[152:155]
    v_mfma_f32_16x16x32_bf16 v[152:155], a[224:227], a[40:43], v[152:155]
    ds_read_b64_tr_b16 a[220:221], v38 offset:8192
    v_mfma_f32_16x16x32_bf16 v[148:151], a[224:227], a[36:39], v[148:151]
    v_mfma_f32_16x16x32_bf16 v[148:151], a[228:231], a[52:55], v[148:151]
    ds_read_b64_tr_b16 a[222:223], v38 offset:12288
    v_mfma_f32_16x16x32_bf16 v[144:147], a[228:231], a[48:51], v[144:147]
    v_mfma_f32_16x16x32_bf16 v[144:147], a[224:227], a[32:35], v[144:147]
    s_waitcnt lgkmcnt(8)
    v_mfma_f32_16x16x32_bf16 v[160:163], a[200:203], a[96:99], v[160:163]
    ds_read_b64_tr_b16 a[224:225], v38 offset:16384
    v_mfma_f32_16x16x32_bf16 v[160:163], a[204:207], a[112:115], v[160:163]
    ds_read_b64_tr_b16 a[226:227], v38 offset:20480
    v_mfma_f32_16x16x32_bf16 v[164:167], a[204:207], a[116:119], v[164:167]
    v_cvt_pk_bf16_f32 v132, v132, v133
    v_mfma_f32_16x16x32_bf16 v[164:167], a[200:203], a[100:103], v[164:167]
    ds_read_b64_tr_b16 a[228:229], v38 offset:24576
    v_cvt_pk_bf16_f32 v133, v134, v135
    v_mfma_f32_16x16x32_bf16 v[168:171], a[200:203], a[104:107], v[168:171]
    v_cvt_pk_bf16_f32 v134, v148, v149
    v_mfma_f32_16x16x32_bf16 v[168:171], a[204:207], a[120:123], v[168:171]
    ds_read_b64_tr_b16 a[230:231], v38 offset:28672
    v_cvt_pk_bf16_f32 v135, v150, v151
    v_mfma_f32_16x16x32_bf16 v[172:175], a[204:207], a[124:127], v[172:175]
    buffer_store_dwordx4 v[132:135], v12, s[4:7], s86 offen offset:0 sc1
    v_mfma_f32_16x16x32_bf16 v[172:175], a[200:203], a[108:111], v[172:175]
    v_cvt_pk_bf16_f32 v136, v136, v137
    s_waitcnt lgkmcnt(8)
    v_mfma_f32_16x16x32_bf16 v[172:175], a[208:211], a[140:143], v[172:175]
    ds_read_b64_tr_b16 a[200:201], v55 offset:0
    v_mfma_f32_16x16x32_bf16 v[172:175], a[212:215], a[156:159], v[172:175]
    ds_read_b64_tr_b16 a[202:203], v55 offset:4096
    v_mfma_f32_16x16x32_bf16 v[168:171], a[212:215], a[152:155], v[168:171]
    v_cvt_pk_bf16_f32 v137, v138, v139
    v_mfma_f32_16x16x32_bf16 v[168:171], a[208:211], a[136:139], v[168:171]
    ds_read_b64_tr_b16 a[204:205], v55 offset:8192
    v_cvt_pk_bf16_f32 v138, v152, v153
    v_mfma_f32_16x16x32_bf16 v[164:167], a[208:211], a[132:135], v[164:167]
    v_cvt_pk_bf16_f32 v139, v154, v155
    v_mfma_f32_16x16x32_bf16 v[164:167], a[212:215], a[148:151], v[164:167]
    ds_read_b64_tr_b16 a[206:207], v55 offset:12288
    buffer_store_dwordx4 v[136:139], v12, s[4:7], s87 offen offset:0 sc1
    v_mfma_f32_16x16x32_bf16 v[160:163], a[212:215], a[144:147], v[160:163]
    v_cvt_pk_bf16_f32 v140, v140, v141
    v_mfma_f32_16x16x32_bf16 v[160:163], a[208:211], a[128:131], v[160:163]
    v_cvt_pk_bf16_f32 v141, v142, v143
    s_waitcnt lgkmcnt(8)
    v_mfma_f32_16x16x32_bf16 v[160:163], a[216:219], a[0:3], v[160:163]
    ds_read_b64_tr_b16 a[208:209], v55 offset:16384
    v_mfma_f32_16x16x32_bf16 v[160:163], a[220:223], a[16:19], v[160:163]
    ds_read_b64_tr_b16 a[210:211], v55 offset:20480
    v_mfma_f32_16x16x32_bf16 v[164:167], a[220:223], a[20:23], v[164:167]
    v_cvt_pk_bf16_f32 v142, v156, v157
    v_mfma_f32_16x16x32_bf16 v[164:167], a[216:219], a[4:7], v[164:167]
    ds_read_b64_tr_b16 a[212:213], v55 offset:24576
    v_cvt_pk_bf16_f32 v143, v158, v159
    v_mfma_f32_16x16x32_bf16 v[168:171], a[216:219], a[8:11], v[168:171]
    buffer_store_dwordx4 v[140:143], v12, s[4:7], s88 offen offset:0 sc1
    v_mfma_f32_16x16x32_bf16 v[168:171], a[220:223], a[24:27], v[168:171]
    ds_read_b64_tr_b16 a[214:215], v55 offset:28672
    v_mfma_f32_16x16x32_bf16 v[172:175], a[220:223], a[28:31], v[172:175]
    v_mfma_f32_16x16x32_bf16 v[172:175], a[216:219], a[12:15], v[172:175]
    s_waitcnt lgkmcnt(8)
    v_mfma_f32_16x16x32_bf16 v[172:175], a[224:227], a[44:47], v[172:175]
    ds_read_b64_tr_b16 a[216:217], v39 offset:0
    v_mfma_f32_16x16x32_bf16 v[172:175], a[228:231], a[60:63], v[172:175]
    ds_read_b64_tr_b16 a[218:219], v39 offset:4096
    v_mfma_f32_16x16x32_bf16 v[168:171], a[228:231], a[56:59], v[168:171]
    v_mfma_f32_16x16x32_bf16 v[168:171], a[224:227], a[40:43], v[168:171]
    ds_read_b64_tr_b16 a[220:221], v39 offset:8192
    v_mfma_f32_16x16x32_bf16 v[164:167], a[224:227], a[36:39], v[164:167]
    v_mfma_f32_16x16x32_bf16 v[164:167], a[228:231], a[52:55], v[164:167]
    ds_read_b64_tr_b16 a[222:223], v39 offset:12288
    v_mfma_f32_16x16x32_bf16 v[160:163], a[228:231], a[48:51], v[160:163]
    v_mfma_f32_16x16x32_bf16 v[160:163], a[224:227], a[32:35], v[160:163]
    s_waitcnt lgkmcnt(8)
    v_mfma_f32_16x16x32_bf16 v[176:179], a[200:203], a[96:99], v[176:179]
    ds_read_b64_tr_b16 a[224:225], v39 offset:16384
    v_mfma_f32_16x16x32_bf16 v[176:179], a[204:207], a[112:115], v[176:179]
    ds_read_b64_tr_b16 a[226:227], v39 offset:20480
    v_mfma_f32_16x16x32_bf16 v[180:183], a[204:207], a[116:119], v[180:183]
    v_mfma_f32_16x16x32_bf16 v[180:183], a[200:203], a[100:103], v[180:183]
    ds_read_b64_tr_b16 a[228:229], v39 offset:24576
    v_mfma_f32_16x16x32_bf16 v[184:187], a[200:203], a[104:107], v[184:187]
    v_mfma_f32_16x16x32_bf16 v[184:187], a[204:207], a[120:123], v[184:187]
    ds_read_b64_tr_b16 a[230:231], v39 offset:28672
    v_mfma_f32_16x16x32_bf16 v[188:191], a[204:207], a[124:127], v[188:191]
    v_mfma_f32_16x16x32_bf16 v[188:191], a[200:203], a[108:111], v[188:191]
    s_waitcnt lgkmcnt(8)
    v_mfma_f32_16x16x32_bf16 v[188:191], a[208:211], a[140:143], v[188:191]
    ds_read_b64_tr_b16 a[200:201], v56 offset:0
    v_mfma_f32_16x16x32_bf16 v[188:191], a[212:215], a[156:159], v[188:191]
    ds_read_b64_tr_b16 a[202:203], v56 offset:4096
    v_mfma_f32_16x16x32_bf16 v[184:187], a[212:215], a[152:155], v[184:187]
    v_mfma_f32_16x16x32_bf16 v[184:187], a[208:211], a[136:139], v[184:187]
    ds_read_b64_tr_b16 a[204:205], v56 offset:8192
    v_mfma_f32_16x16x32_bf16 v[180:183], a[208:211], a[132:135], v[180:183]
    v_mfma_f32_16x16x32_bf16 v[180:183], a[212:215], a[148:151], v[180:183]
    ds_read_b64_tr_b16 a[206:207], v56 offset:12288
    v_mfma_f32_16x16x32_bf16 v[176:179], a[212:215], a[144:147], v[176:179]
    v_mfma_f32_16x16x32_bf16 v[176:179], a[208:211], a[128:131], v[176:179]
    s_waitcnt lgkmcnt(8)
    v_mfma_f32_16x16x32_bf16 v[176:179], a[216:219], a[0:3], v[176:179]
    ds_read_b64_tr_b16 a[208:209], v56 offset:16384
    v_mfma_f32_16x16x32_bf16 v[176:179], a[220:223], a[16:19], v[176:179]
    ds_read_b64_tr_b16 a[210:211], v56 offset:20480
    v_mfma_f32_16x16x32_bf16 v[180:183], a[220:223], a[20:23], v[180:183]
    v_mfma_f32_16x16x32_bf16 v[180:183], a[216:219], a[4:7], v[180:183]
    ds_read_b64_tr_b16 a[212:213], v56 offset:24576
    v_mfma_f32_16x16x32_bf16 v[184:187], a[216:219], a[8:11], v[184:187]
    v_mfma_f32_16x16x32_bf16 v[184:187], a[220:223], a[24:27], v[184:187]
    ds_read_b64_tr_b16 a[214:215], v56 offset:28672
    v_mfma_f32_16x16x32_bf16 v[188:191], a[220:223], a[28:31], v[188:191]
    v_mfma_f32_16x16x32_bf16 v[188:191], a[216:219], a[12:15], v[188:191]
    s_waitcnt lgkmcnt(8)
    v_mfma_f32_16x16x32_bf16 v[188:191], a[224:227], a[44:47], v[188:191]
    ds_read_b64_tr_b16 a[216:217], v40 offset:0
    v_mfma_f32_16x16x32_bf16 v[188:191], a[228:231], a[60:63], v[188:191]
    ds_read_b64_tr_b16 a[218:219], v40 offset:4096
    v_mfma_f32_16x16x32_bf16 v[184:187], a[228:231], a[56:59], v[184:187]
    v_mfma_f32_16x16x32_bf16 v[184:187], a[224:227], a[40:43], v[184:187]
    ds_read_b64_tr_b16 a[220:221], v40 offset:8192
    v_mfma_f32_16x16x32_bf16 v[180:183], a[224:227], a[36:39], v[180:183]
    v_mfma_f32_16x16x32_bf16 v[180:183], a[228:231], a[52:55], v[180:183]
    ds_read_b64_tr_b16 a[222:223], v40 offset:12288
    v_mfma_f32_16x16x32_bf16 v[176:179], a[228:231], a[48:51], v[176:179]
    v_mfma_f32_16x16x32_bf16 v[176:179], a[224:227], a[32:35], v[176:179]
    s_waitcnt lgkmcnt(8)
    v_mfma_f32_16x16x32_bf16 v[192:195], a[200:203], a[96:99], v[192:195]
    ds_read_b64_tr_b16 a[224:225], v40 offset:16384
    v_mfma_f32_16x16x32_bf16 v[192:195], a[204:207], a[112:115], v[192:195]
    ds_read_b64_tr_b16 a[226:227], v40 offset:20480
    v_mfma_f32_16x16x32_bf16 v[196:199], a[204:207], a[116:119], v[196:199]
    v_cvt_pk_bf16_f32 v164, v164, v165
    v_mfma_f32_16x16x32_bf16 v[196:199], a[200:203], a[100:103], v[196:199]
    ds_read_b64_tr_b16 a[228:229], v40 offset:24576
    v_cvt_pk_bf16_f32 v165, v166, v167
    v_mfma_f32_16x16x32_bf16 v[200:203], a[200:203], a[104:107], v[200:203]
    v_cvt_pk_bf16_f32 v166, v180, v181
    v_mfma_f32_16x16x32_bf16 v[200:203], a[204:207], a[120:123], v[200:203]
    ds_read_b64_tr_b16 a[230:231], v40 offset:28672
    v_cvt_pk_bf16_f32 v167, v182, v183
    v_mfma_f32_16x16x32_bf16 v[204:207], a[204:207], a[124:127], v[204:207]
    buffer_store_dwordx4 v[164:167], v12, s[4:7], s86 offen offset:1024 sc1
    v_mfma_f32_16x16x32_bf16 v[204:207], a[200:203], a[108:111], v[204:207]
    v_cvt_pk_bf16_f32 v168, v168, v169
    s_waitcnt lgkmcnt(8)
    v_mfma_f32_16x16x32_bf16 v[204:207], a[208:211], a[140:143], v[204:207]
    ds_read_b64_tr_b16 a[200:201], v57 offset:0
    v_mfma_f32_16x16x32_bf16 v[204:207], a[212:215], a[156:159], v[204:207]
    ds_read_b64_tr_b16 a[202:203], v57 offset:4096
    v_mfma_f32_16x16x32_bf16 v[200:203], a[212:215], a[152:155], v[200:203]
    v_cvt_pk_bf16_f32 v169, v170, v171
    v_mfma_f32_16x16x32_bf16 v[200:203], a[208:211], a[136:139], v[200:203]
    ds_read_b64_tr_b16 a[204:205], v57 offset:8192
    v_cvt_pk_bf16_f32 v170, v184, v185
    v_mfma_f32_16x16x32_bf16 v[196:199], a[208:211], a[132:135], v[196:199]
    v_cvt_pk_bf16_f32 v171, v186, v187
    v_mfma_f32_16x16x32_bf16 v[196:199], a[212:215], a[148:151], v[196:199]
    ds_read_b64_tr_b16 a[206:207], v57 offset:12288
    buffer_store_dwordx4 v[168:171], v12, s[4:7], s87 offen offset:1024 sc1
    v_mfma_f32_16x16x32_bf16 v[192:195], a[212:215], a[144:147], v[192:195]
    v_cvt_pk_bf16_f32 v172, v172, v173
    v_mfma_f32_16x16x32_bf16 v[192:195], a[208:211], a[128:131], v[192:195]
    v_cvt_pk_bf16_f32 v173, v174, v175
    s_waitcnt lgkmcnt(8)
    v_mfma_f32_16x16x32_bf16 v[192:195], a[216:219], a[0:3], v[192:195]
    ds_read_b64_tr_b16 a[208:209], v57 offset:16384
    v_mfma_f32_16x16x32_bf16 v[192:195], a[220:223], a[16:19], v[192:195]
    ds_read_b64_tr_b16 a[210:211], v57 offset:20480
    v_mfma_f32_16x16x32_bf16 v[196:199], a[220:223], a[20:23], v[196:199]
    v_cvt_pk_bf16_f32 v174, v188, v189
    v_mfma_f32_16x16x32_bf16 v[196:199], a[216:219], a[4:7], v[196:199]
    ds_read_b64_tr_b16 a[212:213], v57 offset:24576
    v_cvt_pk_bf16_f32 v175, v190, v191
    v_mfma_f32_16x16x32_bf16 v[200:203], a[216:219], a[8:11], v[200:203]
    buffer_store_dwordx4 v[172:175], v12, s[4:7], s88 offen offset:1024 sc1
    v_mfma_f32_16x16x32_bf16 v[200:203], a[220:223], a[24:27], v[200:203]
    ds_read_b64_tr_b16 a[214:215], v57 offset:28672
    v_mfma_f32_16x16x32_bf16 v[204:207], a[220:223], a[28:31], v[204:207]
    v_mfma_f32_16x16x32_bf16 v[204:207], a[216:219], a[12:15], v[204:207]
    s_waitcnt lgkmcnt(8)
    v_mfma_f32_16x16x32_bf16 v[204:207], a[224:227], a[44:47], v[204:207]
    ds_read_b64_tr_b16 a[216:217], v41 offset:0
    v_mfma_f32_16x16x32_bf16 v[204:207], a[228:231], a[60:63], v[204:207]
    ds_read_b64_tr_b16 a[218:219], v41 offset:4096
    v_mfma_f32_16x16x32_bf16 v[200:203], a[228:231], a[56:59], v[200:203]
    v_mfma_f32_16x16x32_bf16 v[200:203], a[224:227], a[40:43], v[200:203]
    ds_read_b64_tr_b16 a[220:221], v41 offset:8192
    v_mfma_f32_16x16x32_bf16 v[196:199], a[224:227], a[36:39], v[196:199]
    v_mfma_f32_16x16x32_bf16 v[196:199], a[228:231], a[52:55], v[196:199]
    ds_read_b64_tr_b16 a[222:223], v41 offset:12288
    v_mfma_f32_16x16x32_bf16 v[192:195], a[228:231], a[48:51], v[192:195]
    v_mfma_f32_16x16x32_bf16 v[192:195], a[224:227], a[32:35], v[192:195]
    s_waitcnt lgkmcnt(8)
    v_mfma_f32_16x16x32_bf16 v[208:211], a[200:203], a[96:99], v[208:211]
    ds_read_b64_tr_b16 a[224:225], v41 offset:16384
    v_mfma_f32_16x16x32_bf16 v[208:211], a[204:207], a[112:115], v[208:211]
    ds_read_b64_tr_b16 a[226:227], v41 offset:20480
    v_mfma_f32_16x16x32_bf16 v[212:215], a[204:207], a[116:119], v[212:215]
    v_mfma_f32_16x16x32_bf16 v[212:215], a[200:203], a[100:103], v[212:215]
    ds_read_b64_tr_b16 a[228:229], v41 offset:24576
    v_mfma_f32_16x16x32_bf16 v[216:219], a[200:203], a[104:107], v[216:219]
    v_mfma_f32_16x16x32_bf16 v[216:219], a[204:207], a[120:123], v[216:219]
    ds_read_b64_tr_b16 a[230:231], v41 offset:28672
    v_mfma_f32_16x16x32_bf16 v[220:223], a[204:207], a[124:127], v[220:223]
    v_mfma_f32_16x16x32_bf16 v[220:223], a[200:203], a[108:111], v[220:223]
    s_waitcnt lgkmcnt(8)
    v_mfma_f32_16x16x32_bf16 v[220:223], a[208:211], a[140:143], v[220:223]
    ds_read_b64_tr_b16 a[200:201], v58 offset:0
    v_mfma_f32_16x16x32_bf16 v[220:223], a[212:215], a[156:159], v[220:223]
    ds_read_b64_tr_b16 a[202:203], v58 offset:4096
    v_mfma_f32_16x16x32_bf16 v[216:219], a[212:215], a[152:155], v[216:219]
    v_mfma_f32_16x16x32_bf16 v[216:219], a[208:211], a[136:139], v[216:219]
    ds_read_b64_tr_b16 a[204:205], v58 offset:8192
    v_mfma_f32_16x16x32_bf16 v[212:215], a[208:211], a[132:135], v[212:215]
    v_mfma_f32_16x16x32_bf16 v[212:215], a[212:215], a[148:151], v[212:215]
    ds_read_b64_tr_b16 a[206:207], v58 offset:12288
    v_mfma_f32_16x16x32_bf16 v[208:211], a[212:215], a[144:147], v[208:211]
    v_mfma_f32_16x16x32_bf16 v[208:211], a[208:211], a[128:131], v[208:211]
    s_waitcnt lgkmcnt(8)
    v_mfma_f32_16x16x32_bf16 v[208:211], a[216:219], a[0:3], v[208:211]
    ds_read_b64_tr_b16 a[208:209], v58 offset:16384
    v_mfma_f32_16x16x32_bf16 v[208:211], a[220:223], a[16:19], v[208:211]
    ds_read_b64_tr_b16 a[210:211], v58 offset:20480
    v_mfma_f32_16x16x32_bf16 v[212:215], a[220:223], a[20:23], v[212:215]
    v_mfma_f32_16x16x32_bf16 v[212:215], a[216:219], a[4:7], v[212:215]
    ds_read_b64_tr_b16 a[212:213], v58 offset:24576
    v_mfma_f32_16x16x32_bf16 v[216:219], a[216:219], a[8:11], v[216:219]
    v_mfma_f32_16x16x32_bf16 v[216:219], a[220:223], a[24:27], v[216:219]
    ds_read_b64_tr_b16 a[214:215], v58 offset:28672
    v_mfma_f32_16x16x32_bf16 v[220:223], a[220:223], a[28:31], v[220:223]
    v_mfma_f32_16x16x32_bf16 v[220:223], a[216:219], a[12:15], v[220:223]
    s_waitcnt lgkmcnt(8)
    v_mfma_f32_16x16x32_bf16 v[220:223], a[224:227], a[44:47], v[220:223]
    ds_read_b64_tr_b16 a[216:217], v42 offset:0
    v_mfma_f32_16x16x32_bf16 v[220:223], a[228:231], a[60:63], v[220:223]
    ds_read_b64_tr_b16 a[218:219], v42 offset:4096
    v_mfma_f32_16x16x32_bf16 v[216:219], a[228:231], a[56:59], v[216:219]
    v_mfma_f32_16x16x32_bf16 v[216:219], a[224:227], a[40:43], v[216:219]
    ds_read_b64_tr_b16 a[220:221], v42 offset:8192
    v_mfma_f32_16x16x32_bf16 v[212:215], a[224:227], a[36:39], v[212:215]
    v_mfma_f32_16x16x32_bf16 v[212:215], a[228:231], a[52:55], v[212:215]
    ds_read_b64_tr_b16 a[222:223], v42 offset:12288
    v_mfma_f32_16x16x32_bf16 v[208:211], a[228:231], a[48:51], v[208:211]
    v_mfma_f32_16x16x32_bf16 v[208:211], a[224:227], a[32:35], v[208:211]
    s_waitcnt lgkmcnt(8)
    v_mfma_f32_16x16x32_bf16 v[224:227], a[200:203], a[96:99], v[224:227]
    ds_read_b64_tr_b16 a[224:225], v42 offset:16384
    v_mfma_f32_16x16x32_bf16 v[224:227], a[204:207], a[112:115], v[224:227]
    ds_read_b64_tr_b16 a[226:227], v42 offset:20480
    v_mfma_f32_16x16x32_bf16 v[228:231], a[204:207], a[116:119], v[228:231]
    v_cvt_pk_bf16_f32 v196, v196, v197
    v_mfma_f32_16x16x32_bf16 v[228:231], a[200:203], a[100:103], v[228:231]
    ds_read_b64_tr_b16 a[228:229], v42 offset:24576
    v_cvt_pk_bf16_f32 v197, v198, v199
    v_mfma_f32_16x16x32_bf16 v[232:235], a[200:203], a[104:107], v[232:235]
    v_cvt_pk_bf16_f32 v198, v212, v213
    v_mfma_f32_16x16x32_bf16 v[232:235], a[204:207], a[120:123], v[232:235]
    ds_read_b64_tr_b16 a[230:231], v42 offset:28672
    v_cvt_pk_bf16_f32 v199, v214, v215
    v_mfma_f32_16x16x32_bf16 v[236:239], a[204:207], a[124:127], v[236:239]
    buffer_store_dwordx4 v[196:199], v12, s[4:7], s86 offen offset:2048 sc1
    v_mfma_f32_16x16x32_bf16 v[236:239], a[200:203], a[108:111], v[236:239]
    v_cvt_pk_bf16_f32 v200, v200, v201
    s_waitcnt lgkmcnt(8)
    v_mfma_f32_16x16x32_bf16 v[236:239], a[208:211], a[140:143], v[236:239]
    ds_read_b64_tr_b16 a[200:201], v59 offset:0
    v_mfma_f32_16x16x32_bf16 v[236:239], a[212:215], a[156:159], v[236:239]
    ds_read_b64_tr_b16 a[202:203], v59 offset:4096
    v_mfma_f32_16x16x32_bf16 v[232:235], a[212:215], a[152:155], v[232:235]
    v_cvt_pk_bf16_f32 v201, v202, v203
    v_mfma_f32_16x16x32_bf16 v[232:235], a[208:211], a[136:139], v[232:235]
    ds_read_b64_tr_b16 a[204:205], v59 offset:8192
    v_cvt_pk_bf16_f32 v202, v216, v217
    v_mfma_f32_16x16x32_bf16 v[228:231], a[208:211], a[132:135], v[228:231]
    v_cvt_pk_bf16_f32 v203, v218, v219
    v_mfma_f32_16x16x32_bf16 v[228:231], a[212:215], a[148:151], v[228:231]
    ds_read_b64_tr_b16 a[206:207], v59 offset:12288
    buffer_store_dwordx4 v[200:203], v12, s[4:7], s87 offen offset:2048 sc1
    v_mfma_f32_16x16x32_bf16 v[224:227], a[212:215], a[144:147], v[224:227]
    v_cvt_pk_bf16_f32 v204, v204, v205
    v_mfma_f32_16x16x32_bf16 v[224:227], a[208:211], a[128:131], v[224:227]
    v_cvt_pk_bf16_f32 v205, v206, v207
    s_waitcnt lgkmcnt(8)
    v_mfma_f32_16x16x32_bf16 v[224:227], a[216:219], a[0:3], v[224:227]
    ds_read_b64_tr_b16 a[208:209], v59 offset:16384
    v_mfma_f32_16x16x32_bf16 v[224:227], a[220:223], a[16:19], v[224:227]
    ds_read_b64_tr_b16 a[210:211], v59 offset:20480
    v_mfma_f32_16x16x32_bf16 v[228:231], a[220:223], a[20:23], v[228:231]
    v_cvt_pk_bf16_f32 v206, v220, v221
    v_mfma_f32_16x16x32_bf16 v[228:231], a[216:219], a[4:7], v[228:231]
    ds_read_b64_tr_b16 a[212:213], v59 offset:24576
    v_cvt_pk_bf16_f32 v207, v222, v223
    v_mfma_f32_16x16x32_bf16 v[232:235], a[216:219], a[8:11], v[232:235]
    buffer_store_dwordx4 v[204:207], v12, s[4:7], s88 offen offset:2048 sc1
    v_mfma_f32_16x16x32_bf16 v[232:235], a[220:223], a[24:27], v[232:235]
    ds_read_b64_tr_b16 a[214:215], v59 offset:28672
    v_mfma_f32_16x16x32_bf16 v[236:239], a[220:223], a[28:31], v[236:239]
    v_mfma_f32_16x16x32_bf16 v[236:239], a[216:219], a[12:15], v[236:239]
    s_waitcnt lgkmcnt(8)
    v_mfma_f32_16x16x32_bf16 v[236:239], a[224:227], a[44:47], v[236:239]
    ds_read_b64_tr_b16 a[216:217], v43 offset:0
    v_mfma_f32_16x16x32_bf16 v[236:239], a[228:231], a[60:63], v[236:239]
    ds_read_b64_tr_b16 a[218:219], v43 offset:4096
    v_mfma_f32_16x16x32_bf16 v[232:235], a[228:231], a[56:59], v[232:235]
    v_mfma_f32_16x16x32_bf16 v[232:235], a[224:227], a[40:43], v[232:235]
    ds_read_b64_tr_b16 a[220:221], v43 offset:8192
    v_mfma_f32_16x16x32_bf16 v[228:231], a[224:227], a[36:39], v[228:231]
    v_mfma_f32_16x16x32_bf16 v[228:231], a[228:231], a[52:55], v[228:231]
    ds_read_b64_tr_b16 a[222:223], v43 offset:12288
    v_mfma_f32_16x16x32_bf16 v[224:227], a[228:231], a[48:51], v[224:227]
    v_mfma_f32_16x16x32_bf16 v[224:227], a[224:227], a[32:35], v[224:227]
    s_waitcnt lgkmcnt(8)
    s_waitcnt vmcnt(3)
    s_mov_b64 exec, 1
    buffer_store_dword v17, v14, s[4:7], s89 offen offset:0 sc1
    buffer_store_dword v17, v14, s[4:7], s90 offen offset:0 sc1
    buffer_store_dword v17, v14, s[4:7], s91 offen offset:0 sc1
    s_mov_b64 exec, -1
    v_mfma_f32_16x16x32_bf16 v[240:243], a[200:203], a[96:99], v[240:243]
    ds_read_b64_tr_b16 a[224:225], v43 offset:16384
    v_mfma_f32_16x16x32_bf16 v[240:243], a[204:207], a[112:115], v[240:243]
    ds_read_b64_tr_b16 a[226:227], v43 offset:20480
    v_mfma_f32_16x16x32_bf16 v[244:247], a[204:207], a[116:119], v[244:247]
    v_mfma_f32_16x16x32_bf16 v[244:247], a[200:203], a[100:103], v[244:247]
    ds_read_b64_tr_b16 a[228:229], v43 offset:24576
    v_mfma_f32_16x16x32_bf16 v[248:251], a[200:203], a[104:107], v[248:251]
    v_mfma_f32_16x16x32_bf16 v[248:251], a[204:207], a[120:123], v[248:251]
    ds_read_b64_tr_b16 a[230:231], v43 offset:28672
    v_mfma_f32_16x16x32_bf16 v[252:255], a[204:207], a[124:127], v[252:255]
    v_mfma_f32_16x16x32_bf16 v[252:255], a[200:203], a[108:111], v[252:255]
    s_waitcnt lgkmcnt(8)
    v_mfma_f32_16x16x32_bf16 v[252:255], a[208:211], a[140:143], v[252:255]
    v_mfma_f32_16x16x32_bf16 v[252:255], a[212:215], a[156:159], v[252:255]
    v_mfma_f32_16x16x32_bf16 v[248:251], a[212:215], a[152:155], v[248:251]
    v_mfma_f32_16x16x32_bf16 v[248:251], a[208:211], a[136:139], v[248:251]
    v_mfma_f32_16x16x32_bf16 v[244:247], a[208:211], a[132:135], v[244:247]
    v_mfma_f32_16x16x32_bf16 v[244:247], a[212:215], a[148:151], v[244:247]
    v_mfma_f32_16x16x32_bf16 v[240:243], a[212:215], a[144:147], v[240:243]
    v_mfma_f32_16x16x32_bf16 v[240:243], a[208:211], a[128:131], v[240:243]
    s_waitcnt lgkmcnt(4)
    v_mfma_f32_16x16x32_bf16 v[240:243], a[216:219], a[0:3], v[240:243]
    v_mfma_f32_16x16x32_bf16 v[240:243], a[220:223], a[16:19], v[240:243]
    v_mfma_f32_16x16x32_bf16 v[244:247], a[220:223], a[20:23], v[244:247]
    v_mfma_f32_16x16x32_bf16 v[244:247], a[216:219], a[4:7], v[244:247]
    v_mfma_f32_16x16x32_bf16 v[248:251], a[216:219], a[8:11], v[248:251]
    v_mfma_f32_16x16x32_bf16 v[248:251], a[220:223], a[24:27], v[248:251]
    v_mfma_f32_16x16x32_bf16 v[252:255], a[220:223], a[28:31], v[252:255]
    v_mfma_f32_16x16x32_bf16 v[252:255], a[216:219], a[12:15], v[252:255]
    s_waitcnt lgkmcnt(0)
    v_mfma_f32_16x16x32_bf16 v[252:255], a[224:227], a[44:47], v[252:255]
    v_mfma_f32_16x16x32_bf16 v[252:255], a[228:231], a[60:63], v[252:255]
    v_mfma_f32_16x16x32_bf16 v[248:251], a[228:231], a[56:59], v[248:251]
    v_mfma_f32_16x16x32_bf16 v[248:251], a[224:227], a[40:43], v[248:251]
    v_mfma_f32_16x16x32_bf16 v[244:247], a[224:227], a[36:39], v[244:247]
    v_mfma_f32_16x16x32_bf16 v[244:247], a[228:231], a[52:55], v[244:247]
    v_mfma_f32_16x16x32_bf16 v[240:243], a[228:231], a[48:51], v[240:243]
    v_mfma_f32_16x16x32_bf16 v[240:243], a[224:227], a[32:35], v[240:243]
    v_cvt_pk_bf16_f32 v228, v228, v229
    v_cvt_pk_bf16_f32 v229, v230, v231
    s_nop 3
    v_cvt_pk_bf16_f32 v230, v244, v245
    v_cvt_pk_bf16_f32 v231, v246, v247
    buffer_store_dwordx4 v[228:231], v12, s[4:7], s86 offen offset:3072 sc1
    v_cvt_pk_bf16_f32 v232, v232, v233
    v_cvt_pk_bf16_f32 v233, v234, v235
    v_cvt_pk_bf16_f32 v234, v248, v249
    v_cvt_pk_bf16_f32 v235, v250, v251
    buffer_store_dwordx4 v[232:235], v12, s[4:7], s87 offen offset:3072 sc1
    v_cvt_pk_bf16_f32 v236, v236, v237
    v_cvt_pk_bf16_f32 v237, v238, v239
    v_cvt_pk_bf16_f32 v238, v252, v253
    v_cvt_pk_bf16_f32 v239, v254, v255
    buffer_store_dwordx4 v[236:239], v12, s[4:7], s88 offen offset:3072 sc1
L_p2end_parallel_sum__sliding_block__glu_gated_swiglu__prompt_kernel:
    buffer_load_dwordx3 v[24:26], v14, s[4:7], s97 offen offset:0 sc1
    v_permlane16_swap_b32 v100, v102
    v_permlane16_swap_b32 v101, v103
    v_permlane16_swap_b32 v104, v106
    v_permlane16_swap_b32 v105, v107
    v_permlane16_swap_b32 v108, v110
    v_permlane16_swap_b32 v109, v111
    v_permlane16_swap_b32 v112, v114
    v_permlane16_swap_b32 v113, v115
    v_lshlrev_b32 v20, 16, v100
    v_and_b32 v21, 0xffff0000, v100
    v_lshlrev_b32 v22, 16, v101
    v_and_b32 v23, 0xffff0000, v101
    v_pk_add_f32 v[128:129], v[128:129], v[20:21]
    v_pk_add_f32 v[130:131], v[130:131], v[22:23]
    v_lshlrev_b32 v20, 16, v102
    v_and_b32 v21, 0xffff0000, v102
    v_lshlrev_b32 v22, 16, v103
    v_and_b32 v23, 0xffff0000, v103
    v_pk_add_f32 v[144:145], v[144:145], v[20:21]
    v_pk_add_f32 v[146:147], v[146:147], v[22:23]
    v_lshlrev_b32_e64 v20, 16, v104
    v_and_b32 v21, 0xffff0000, v104
    v_lshlrev_b32_e64 v22, 16, v105
    v_and_b32 v23, 0xffff0000, v105
    v_pk_add_f32 v[160:161], v[160:161], v[20:21]
    v_pk_add_f32 v[162:163], v[162:163], v[22:23]
    v_lshlrev_b32 v20, 16, v106
    v_and_b32 v21, 0xffff0000, v106
    v_lshlrev_b32 v22, 16, v107
    v_and_b32 v23, 0xffff0000, v107
    v_pk_add_f32 v[176:177], v[176:177], v[20:21]
    v_pk_add_f32 v[178:179], v[178:179], v[22:23]
    v_lshlrev_b32 v20, 16, v108
    v_and_b32 v21, 0xffff0000, v108
    v_lshlrev_b32 v22, 16, v109
    v_and_b32 v23, 0xffff0000, v109
    v_pk_add_f32 v[192:193], v[192:193], v[20:21]
    v_pk_add_f32 v[194:195], v[194:195], v[22:23]
    v_lshlrev_b32_e64 v20, 16, v110
    v_and_b32 v21, 0xffff0000, v110
    v_lshlrev_b32_e64 v22, 16, v111
    v_and_b32 v23, 0xffff0000, v111
    v_pk_add_f32 v[208:209], v[208:209], v[20:21]
    v_pk_add_f32 v[210:211], v[210:211], v[22:23]
    v_lshlrev_b32 v20, 16, v112
    v_and_b32 v21, 0xffff0000, v112
    v_lshlrev_b32 v22, 16, v113
    v_and_b32 v23, 0xffff0000, v113
    v_pk_add_f32 v[224:225], v[224:225], v[20:21]
    v_pk_add_f32 v[226:227], v[226:227], v[22:23]
    v_lshlrev_b32 v20, 16, v114
    v_and_b32 v21, 0xffff0000, v114
    v_lshlrev_b32 v22, 16, v115
    v_and_b32 v23, 0xffff0000, v115
    v_pk_add_f32 v[240:241], v[240:241], v[20:21]
    v_pk_add_f32 v[242:243], v[242:243], v[22:23]
    s_waitcnt vmcnt(1)
    s_mov_b64 exec, 1
    buffer_store_dword v17, v14, s[4:7], s89 offen offset:64 sc1
    buffer_store_dword v17, v14, s[4:7], s90 offen offset:64 sc1
    buffer_store_dword v17, v14, s[4:7], s91 offen offset:64 sc1
    s_mov_b64 exec, -1
    s_waitcnt vmcnt(3)
    v_and_b32 v24, v24, v25
    v_and_b32 v24, v24, v26
    s_nop 0
    v_readfirstlane_b32 s59, v24
    s_cmp_eq_u32 s59, 1
    s_cbranch_scc1 L_pa_ok_parallel_sum__sliding_block__glu_gated_swiglu__prompt_kernel
L_pa_parallel_sum__sliding_block__glu_gated_swiglu__prompt_kernel:
    s_add_u32 s1, s1, 1
    s_cmp_gt_u32 s1, 0x400000
    s_cbranch_scc1 L_end_parallel_sum__sliding_block__glu_gated_swiglu__prompt_kernel
    buffer_load_dwordx3 v[24:26], v14, s[4:7], s97 offen offset:0 sc1
    s_waitcnt vmcnt(0)
    v_and_b32 v24, v24, v25
    v_and_b32 v24, v24, v26
    s_nop 0
    v_readfirstlane_b32 s59, v24
    s_cmp_eq_u32 s59, 1
    s_cbranch_scc0 L_pa_parallel_sum__sliding_block__glu_gated_swiglu__prompt_kernel
L_pa_ok_parallel_sum__sliding_block__glu_gated_swiglu__prompt_kernel:
    s_nop 0
    buffer_load_dwordx4 v[52:55], v12, s[4:7], s98 offen offset:0 sc1
    buffer_load_dwordx4 v[68:71], v12, s[4:7], s99 offen offset:0 sc1
    buffer_load_dwordx4 v[84:87], v12, s[4:7], s100 offen offset:0 sc1
    buffer_load_dwordx4 v[56:59], v12, s[4:7], s98 offen offset:1024 sc1
    buffer_load_dwordx4 v[72:75], v12, s[4:7], s99 offen offset:1024 sc1
    buffer_load_dwordx4 v[88:91], v12, s[4:7], s100 offen offset:1024 sc1
    buffer_load_dwordx3 v[24:26], v14, s[4:7], s97 offen offset:64 sc1
    s_waitcnt vmcnt(6)
    v_lshlrev_b32 v20, 16, v52
    v_and_b32 v21, 0xffff0000, v52
    v_lshlrev_b32_e64 v22, 16, v53
    v_and_b32 v23, 0xffff0000, v53
    v_pk_add_f32 v[128:129], v[128:129], v[20:21]
    v_pk_add_f32 v[130:131], v[130:131], v[22:23]
    v_lshlrev_b32_e64 v20, 16, v54
    v_and_b32 v21, 0xffff0000, v54
    v_lshlrev_b32_e64 v22, 16, v55
    v_and_b32 v23, 0xffff0000, v55
    v_pk_add_f32 v[144:145], v[144:145], v[20:21]
    v_pk_add_f32 v[146:147], v[146:147], v[22:23]
    s_waitcnt vmcnt(5)
    v_lshlrev_b32 v20, 16, v68
    v_and_b32 v21, 0xffff0000, v68
    v_lshlrev_b32_e64 v22, 16, v69
    v_and_b32 v23, 0xffff0000, v69
    v_pk_add_f32 v[128:129], v[128:129], v[20:21]
    v_pk_add_f32 v[130:131], v[130:131], v[22:23]
    v_lshlrev_b32_e64 v20, 16, v70
    v_and_b32 v21, 0xffff0000, v70
    v_lshlrev_b32_e64 v22, 16, v71
    v_and_b32 v23, 0xffff0000, v71
    v_pk_add_f32 v[144:145], v[144:145], v[20:21]
    v_pk_add_f32 v[146:147], v[146:147], v[22:23]
    s_waitcnt vmcnt(4)
    v_lshlrev_b32 v20, 16, v84
    v_and_b32 v21, 0xffff0000, v84
    v_lshlrev_b32_e64 v22, 16, v85
    v_and_b32 v23, 0xffff0000, v85
    v_pk_add_f32 v[128:129], v[128:129], v[20:21]
    v_pk_add_f32 v[130:131], v[130:131], v[22:23]
    v_lshlrev_b32_e64 v20, 16, v86
    v_and_b32 v21, 0xffff0000, v86
    v_lshlrev_b32_e64 v22, 16, v87
    v_and_b32 v23, 0xffff0000, v87
    v_pk_add_f32 v[144:145], v[144:145], v[20:21]
    v_pk_add_f32 v[146:147], v[146:147], v[22:23]
    v_cvt_pk_bf16_f32 v100, v128, v129
    v_cvt_pk_bf16_f32 v101, v130, v131
    v_cvt_pk_bf16_f32 v102, v144, v145
    v_cvt_pk_bf16_f32 v103, v146, v147
    s_nop 0
    v_permlane16_swap_b32 v100, v102
    v_permlane16_swap_b32 v101, v103
    buffer_store_dwordx4 v[100:103], v44, s[32:35], 0 offen offset:0
    s_waitcnt vmcnt(1)
    v_and_b32 v24, v24, v25
    v_and_b32 v24, v24, v26
    s_nop 0
    v_readfirstlane_b32 s59, v24
    s_cmp_eq_u32 s59, 1
    s_cbranch_scc1 L_pb_ok_parallel_sum__sliding_block__glu_gated_swiglu__prompt_kernel
L_pb_parallel_sum__sliding_block__glu_gated_swiglu__prompt_kernel:
    s_add_u32 s1, s1, 1
    s_cmp_gt_u32 s1, 0x400000
    s_cbranch_scc1 L_end_parallel_sum__sliding_block__glu_gated_swiglu__prompt_kernel
    buffer_load_dwordx3 v[24:26], v14, s[4:7], s97 offen offset:64 sc1
    s_waitcnt vmcnt(0)
    v_and_b32 v24, v24, v25
    v_and_b32 v24, v24, v26
    s_nop 0
    v_readfirstlane_b32 s59, v24
    s_cmp_eq_u32 s59, 1
    s_cbranch_scc0 L_pb_parallel_sum__sliding_block__glu_gated_swiglu__prompt_kernel
L_pb_ok_parallel_sum__sliding_block__glu_gated_swiglu__prompt_kernel:
    buffer_load_dwordx4 v[60:63], v12, s[4:7], s98 offen offset:2048 sc1
    buffer_load_dwordx4 v[76:79], v12, s[4:7], s99 offen offset:2048 sc1
    buffer_load_dwordx4 v[92:95], v12, s[4:7], s100 offen offset:2048 sc1
    buffer_load_dwordx4 v[64:67], v12, s[4:7], s98 offen offset:3072 sc1
    buffer_load_dwordx4 v[80:83], v12, s[4:7], s99 offen offset:3072 sc1
    buffer_load_dwordx4 v[96:99], v12, s[4:7], s100 offen offset:3072 sc1
    v_lshlrev_b32 v20, 16, v56
    v_and_b32 v21, 0xffff0000, v56
    v_lshlrev_b32_e64 v22, 16, v57
    v_and_b32 v23, 0xffff0000, v57
    v_pk_add_f32 v[160:161], v[160:161], v[20:21]
    v_pk_add_f32 v[162:163], v[162:163], v[22:23]
    v_lshlrev_b32 v20, 16, v58
    v_and_b32 v21, 0xffff0000, v58
    v_lshlrev_b32 v22, 16, v59
    v_and_b32 v23, 0xffff0000, v59
    v_pk_add_f32 v[176:177], v[176:177], v[20:21]
    v_pk_add_f32 v[178:179], v[178:179], v[22:23]
    v_lshlrev_b32 v20, 16, v72
    v_and_b32 v21, 0xffff0000, v72
    v_lshlrev_b32 v22, 16, v73
    v_and_b32 v23, 0xffff0000, v73
    v_pk_add_f32 v[160:161], v[160:161], v[20:21]
    v_pk_add_f32 v[162:163], v[162:163], v[22:23]
    v_lshlrev_b32_e64 v20, 16, v74
    v_and_b32 v21, 0xffff0000, v74
    v_lshlrev_b32_e64 v22, 16, v75
    v_and_b32 v23, 0xffff0000, v75
    v_pk_add_f32 v[176:177], v[176:177], v[20:21]
    v_pk_add_f32 v[178:179], v[178:179], v[22:23]
    v_lshlrev_b32 v20, 16, v88
    v_and_b32 v21, 0xffff0000, v88
    v_lshlrev_b32 v22, 16, v89
    v_and_b32 v23, 0xffff0000, v89
    v_pk_add_f32 v[160:161], v[160:161], v[20:21]
    v_pk_add_f32 v[162:163], v[162:163], v[22:23]
    v_lshlrev_b32 v20, 16, v90
    v_and_b32 v21, 0xffff0000, v90
    v_lshlrev_b32 v22, 16, v91
    v_and_b32 v23, 0xffff0000, v91
    v_pk_add_f32 v[176:177], v[176:177], v[20:21]
    v_pk_add_f32 v[178:179], v[178:179], v[22:23]
    v_cvt_pk_bf16_f32 v104, v160, v161
    v_cvt_pk_bf16_f32 v105, v162, v163
    v_cvt_pk_bf16_f32 v106, v176, v177
    v_cvt_pk_bf16_f32 v107, v178, v179
    s_nop 0
    v_permlane16_swap_b32 v104, v106
    v_permlane16_swap_b32 v105, v107
    buffer_store_dwordx4 v[104:107], v44, s[32:35], 0 offen offset:64
    s_waitcnt vmcnt(6)
    v_lshlrev_b32 v20, 16, v60
    v_and_b32 v21, 0xffff0000, v60
    v_lshlrev_b32 v22, 16, v61
    v_and_b32 v23, 0xffff0000, v61
    v_pk_add_f32 v[192:193], v[192:193], v[20:21]
    v_pk_add_f32 v[194:195], v[194:195], v[22:23]
    v_lshlrev_b32_e64 v20, 16, v62
    v_and_b32 v21, 0xffff0000, v62
    v_lshlrev_b32_e64 v22, 16, v63
    v_and_b32 v23, 0xffff0000, v63
    v_pk_add_f32 v[208:209], v[208:209], v[20:21]
    v_pk_add_f32 v[210:211], v[210:211], v[22:23]
    s_waitcnt vmcnt(5)
    v_lshlrev_b32 v20, 16, v76
    v_and_b32 v21, 0xffff0000, v76
    v_lshlrev_b32_e64 v22, 16, v77
    v_and_b32 v23, 0xffff0000, v77
    v_pk_add_f32 v[192:193], v[192:193], v[20:21]
    v_pk_add_f32 v[194:195], v[194:195], v[22:23]
    v_lshlrev_b32_e64 v20, 16, v78
    v_and_b32 v21, 0xffff0000, v78
    v_lshlrev_b32_e64 v22, 16, v79
    v_and_b32 v23, 0xffff0000, v79
    v_pk_add_f32 v[208:209], v[208:209], v[20:21]
    v_pk_add_f32 v[210:211], v[210:211], v[22:23]
    s_waitcnt vmcnt(4)
    v_lshlrev_b32 v20, 16, v92
    v_and_b32 v21, 0xffff0000, v92
    v_lshlrev_b32_e64 v22, 16, v93
    v_and_b32 v23, 0xffff0000, v93
    v_pk_add_f32 v[192:193], v[192:193], v[20:21]
    v_pk_add_f32 v[194:195], v[194:195], v[22:23]
    v_lshlrev_b32_e64 v20, 16, v94
    v_and_b32 v21, 0xffff0000, v94
    v_lshlrev_b32_e64 v22, 16, v95
    v_and_b32 v23, 0xffff0000, v95
    v_pk_add_f32 v[208:209], v[208:209], v[20:21]
    v_pk_add_f32 v[210:211], v[210:211], v[22:23]
    v_cvt_pk_bf16_f32 v108, v192, v193
    v_cvt_pk_bf16_f32 v109, v194, v195
    v_cvt_pk_bf16_f32 v110, v208, v209
    v_cvt_pk_bf16_f32 v111, v210, v211
    s_nop 0
    v_permlane16_swap_b32 v108, v110
    v_permlane16_swap_b32 v109, v111
    buffer_store_dwordx4 v[108:111], v44, s[32:35], 0 offen offset:128
    s_waitcnt vmcnt(4)
    v_lshlrev_b32 v20, 16, v64
    v_and_b32 v21, 0xffff0000, v64
    v_lshlrev_b32 v22, 16, v65
    v_and_b32 v23, 0xffff0000, v65
    v_pk_add_f32 v[224:225], v[224:225], v[20:21]
    v_pk_add_f32 v[226:227], v[226:227], v[22:23]
    v_lshlrev_b32 v20, 16, v66
    v_and_b32 v21, 0xffff0000, v66
    v_lshlrev_b32 v22, 16, v67
    v_and_b32 v23, 0xffff0000, v67
    v_pk_add_f32 v[240:241], v[240:241], v[20:21]
    v_pk_add_f32 v[242:243], v[242:243], v[22:23]
    s_waitcnt vmcnt(3)
    v_lshlrev_b32 v20, 16, v80
    v_and_b32 v21, 0xffff0000, v80
    v_lshlrev_b32 v22, 16, v81
    v_and_b32 v23, 0xffff0000, v81
    v_pk_add_f32 v[224:225], v[224:225], v[20:21]
    v_pk_add_f32 v[226:227], v[226:227], v[22:23]
    v_lshlrev_b32 v20, 16, v82
    v_and_b32 v21, 0xffff0000, v82
    v_lshlrev_b32_e64 v22, 16, v83
    v_and_b32 v23, 0xffff0000, v83
    v_pk_add_f32 v[240:241], v[240:241], v[20:21]
    v_pk_add_f32 v[242:243], v[242:243], v[22:23]
    s_waitcnt vmcnt(2)
    v_lshlrev_b32 v20, 16, v96
    v_and_b32 v21, 0xffff0000, v96
    v_lshlrev_b32_e64 v22, 16, v97
    v_and_b32 v23, 0xffff0000, v97
    v_pk_add_f32 v[224:225], v[224:225], v[20:21]
    v_pk_add_f32 v[226:227], v[226:227], v[22:23]
    v_lshlrev_b32_e64 v20, 16, v98
    v_and_b32 v21, 0xffff0000, v98
    v_lshlrev_b32_e64 v22, 16, v99
    v_and_b32 v23, 0xffff0000, v99
    v_pk_add_f32 v[240:241], v[240:241], v[20:21]
    v_pk_add_f32 v[242:243], v[242:243], v[22:23]
    v_cvt_pk_bf16_f32 v112, v224, v225
    v_cvt_pk_bf16_f32 v113, v226, v227
    v_cvt_pk_bf16_f32 v114, v240, v241
    v_cvt_pk_bf16_f32 v115, v242, v243
    s_nop 0
    v_permlane16_swap_b32 v112, v114
    v_permlane16_swap_b32 v113, v115
    buffer_store_dwordx4 v[112:115], v44, s[32:35], 0 offen offset:192
L_fin_parallel_sum__sliding_block__glu_gated_swiglu__prompt_kernel:
L_end_parallel_sum__sliding_block__glu_gated_swiglu__prompt_kernel:
    s_endpgm
.section .rodata,"a"
.p2align 6
.amdhsa_kernel parallel_sum__sliding_block__glu_gated_swiglu__prompt_kernel
  .amdhsa_next_free_vgpr 512
  .amdhsa_next_free_sgpr 102
  .amdhsa_accum_offset 256
  .amdhsa_group_segment_fixed_size 0
  .amdhsa_kernarg_size 80
  .amdhsa_user_sgpr_count 2
  .amdhsa_user_sgpr_kernarg_segment_ptr 1
  .amdhsa_system_sgpr_workgroup_id_x 1
  .amdhsa_float_denorm_mode_32 3
.end_amdhsa_kernel
```
